```python
import torch

def _softmax(x, axis=-1):
    return torch.softmax(x, dim=axis)
def _gelu(x):
    return torch.nn.functional.gelu(x, approximate="tanh")
def _silu(x):
    return torch.nn.functional.silu(x)
def _sigmoid(x):
    return torch.sigmoid(x)
def _layernorm(x, axis=-1, eps=1e-5):
    m = x.mean(dim=axis, keepdim=True)
    v = x.var(dim=axis, keepdim=True, unbiased=False)
    return (x - m) / torch.sqrt(v + eps)
def _scatter_add(tgt, idx, src, axis=0):
    return tgt.clone().index_add_(axis, idx, src)
def _segment_sum(src, seg, n):
    out = torch.zeros((n,) + src.shape[1:], dtype=src.dtype)
    return out.index_add_(0, seg, src)
def _pad(x, pw):
    flat = tuple(v for pair in reversed(pw) for v in pair)
    return torch.nn.functional.pad(x, flat)

kernel_name = 'concat_heads__mha_block_cached__mha_block_cached__near_ridge'

def setup_inputs():

    _w = (lambda a: (lambda t: t.to(torch.bfloat16) if t.is_floating_point() else t)(torch.as_tensor(a)))
    def _A_setup():
        B, Sq, D = 8, 144, 448
        H, Sk, Dh = 16, 1024, 256
        return {
            "x": _w((lambda *s: torch.randn(*s, dtype=torch.bfloat16) * 0.8)(B, Sq, D)),
            "k_cache": _w((lambda *s: torch.randn(*s, dtype=torch.bfloat16) * 0.8)(B, H, Sk, Dh)),
            "v_cache": _w((lambda *s: torch.randn(*s, dtype=torch.bfloat16) * 0.05)(B, H, Sk, Dh)),
            "wq": _w((lambda *s: torch.randn(*s, dtype=torch.bfloat16) * 0.8)(D, H * Dh) * (D ** -0.5)),
            "wo": _w((lambda *s: torch.randn(*s, dtype=torch.bfloat16) * 0.05)(H * Dh, D) * ((H * Dh) ** -0.5)),
        }
    _A_in = _A_setup()

    def _B_setup():
        B, Sq, D = 8, 144, 448
        H, Sk, Dh = 16, 1024, 256
        return {
            "x": _w((lambda *s: torch.randn(*s, dtype=torch.bfloat16) * 0.8)(B, Sq, D)),
            "k_cache": _w((lambda *s: torch.randn(*s, dtype=torch.bfloat16) * 0.8)(B, H, Sk, Dh)),
            "v_cache": _w((lambda *s: torch.randn(*s, dtype=torch.bfloat16) * 0.05)(B, H, Sk, Dh)),
            "wq": _w((lambda *s: torch.randn(*s, dtype=torch.bfloat16) * 0.8)(D, H * Dh) * (D ** -0.5)),
            "wo": _w((lambda *s: torch.randn(*s, dtype=torch.bfloat16) * 0.05)(H * Dh, D) * ((H * Dh) ** -0.5)),
        }
    _B_in = _B_setup()

    return {
        "A_x": _A_in["x"],
        "A_k_cache": _A_in["k_cache"],
        "A_v_cache": _A_in["v_cache"],
        "A_wq": _A_in["wq"],
        "A_wo": _A_in["wo"],
        "B_x": _B_in["x"],
        "B_k_cache": _B_in["k_cache"],
        "B_v_cache": _B_in["v_cache"],
        "B_wq": _B_in["wq"],
        "B_wo": _B_in["wo"],
    }

def reference(A_x, A_k_cache, A_v_cache, A_wq, A_wo, B_x, B_k_cache, B_v_cache, B_wq, B_wo):
    def _A_ref(x, k_cache, v_cache, wq, wo):
        B, Sq, D = x.shape
        H, Dh = 16, 256
        q = (lambda x, *d: x.permute(*d))((x @ wq).reshape(B, Sq, H, Dh), 0, 2, 1, 3)
        scores = torch.einsum("bhqd,bhkd->bhqk", q, k_cache) * (Dh ** -0.5)
        p = _softmax(scores, axis=-1)
        o = torch.einsum("bhqk,bhkd->bhqd", p, v_cache)
        return (lambda x, *d: x.permute(*d))(o, 0, 2, 1, 3).reshape(B, Sq, H * Dh) @ wo

    def _B_ref(x, k_cache, v_cache, wq, wo):
        B, Sq, D = x.shape
        H, Dh = 16, 256
        q = (lambda x, *d: x.permute(*d))((x @ wq).reshape(B, Sq, H, Dh), 0, 2, 1, 3)
        scores = torch.einsum("bhqd,bhkd->bhqk", q, k_cache) * (Dh ** -0.5)
        p = _softmax(scores, axis=-1)
        o = torch.einsum("bhqk,bhkd->bhqd", p, v_cache)
        return (lambda x, *d: x.permute(*d))(o, 0, 2, 1, 3).reshape(B, Sq, H * Dh) @ wo

    a = _A_ref(A_x, A_k_cache, A_v_cache, A_wq, A_wo)
    b = _B_ref(B_x, B_k_cache, B_v_cache, B_wq, B_wo)
    return torch.concatenate([a, b], axis=-1)
```

```asm
; @launch grid=(256,1,1) block=(256,1,1) lds=163840
.amdgcn_target "amdgcn-amd-amdhsa--gfx950"
.text
.globl concat_heads__mha_block_cached__mha_block_cached__near_ridge_kernel
.p2align 8
.type concat_heads__mha_block_cached__mha_block_cached__near_ridge_kernel,@function
concat_heads__mha_block_cached__mha_block_cached__near_ridge_kernel:
s_cmp_ge_u32 s2, 256
s_cbranch_scc1 L_done
s_load_dwordx8 s[68:75], s[0:1], 0
s_load_dwordx8 s[76:83], s[0:1], 40
s_load_dwordx2 s[4:5], s[0:1], 32
s_load_dwordx2 s[6:7], s[0:1], 72
s_load_dwordx4 s[84:87], s[0:1], 80
s_load_dwordx2 s[88:89], s[0:1], 96
v_lshrrev_b32 v7, 6, v0
v_and_b32 v0, 63, v0
v_readfirstlane_b32 s3, v7
s_and_b32 s98, s2, 7
s_lshr_b32 s99, s2, 3
s_lshr_b32 s42, s98, 2
s_and_b32 s98, s98, 3
s_and_b32 s51, s99, 3
s_lshl_b32 s44, s98, 2
s_add_u32 s44, s44, s51
s_lshr_b32 s43, s99, 2
s_lshl_b32 s45, s98, 5
s_add_u32 s45, s45, s99
s_lshl_b32 s51, s51, 1
s_add_u32 s90, s43, s51
s_cmp_ge_u32 s90, 7
s_cselect_b32 s51, 7, 0
s_sub_u32 s90, s90, s51
v_lshlrev_b32 v1, 4, v0
s_mul_i32 s49, s3, 8448
s_lshl_b32 s64, s3, 13
s_lshl_b32 s54, s3, 17
s_mul_i32 s65, s3, 35840
s_mul_i32 s66, s3, 5120
s_add_u32 s66, s66, 101376
v_lshrrev_b32 v10, 5, v0
v_and_b32 v11, 31, v0
v_lshlrev_b32 v7, 2, v10
v_xor_b32 v7, v11, v7
v_lshlrev_b32 v8, 13, v10
v_xor_b32 v28, 0, v7
v_lshl_add_u32 v28, v28, 4, v8
v_xor_b32 v30, 2, v7
v_lshl_add_u32 v30, v30, 4, v8
v_xor_b32 v29, 8, v7
v_lshl_add_u32 v29, v29, 4, v8
v_xor_b32 v31, 10, v7
v_lshl_add_u32 v31, v31, 4, v8
v_lshrrev_b32 v7, 3, v0
v_mul_u32_u24 v8, 896, v7
v_lshrrev_b32 v7, 1, v7
v_and_b32 v12, 7, v0
v_xor_b32 v7, v7, v12
s_and_b32 s51, s3, 1
s_lshl_b32 s51, s51, 2
v_xor_b32 v12, s51, v7
v_lshl_add_u32 v32, v12, 4, v8
v_xor_b32 v12, 4, v12
v_lshl_add_u32 v33, v12, 4, v8
s_waitcnt lgkmcnt(0)
s_cmp_eq_u32 s42, 0
s_cselect_b32 s16, s74, s82
s_cselect_b32 s17, s75, s83
s_cselect_b32 s20, s68, s76
s_cselect_b32 s21, s69, s77
s_cselect_b32 s8, s70, s78
s_cselect_b32 s9, s71, s79
s_cselect_b32 s12, s72, s80
s_cselect_b32 s13, s73, s81
s_cselect_b32 s24, s4, s6
s_cselect_b32 s25, s5, s7
s_lshl_b32 s4, s44, 9
s_add_u32 s16, s16, s4
s_addc_u32 s17, s17, 0
s_sub_u32 s18, 3670016, s4
s_mov_b32 s19, 0x20000
s_mul_i32 s4, s43, 129024
s_add_u32 s20, s20, s4
s_addc_u32 s21, s21, 0
s_mov_b32 s22, 129024
s_mov_b32 s23, 0x20000
s_lshl_b32 s91, s90, 19
s_add_u32 s91, s91, s54
s_lshl_b32 s92, s90, 7
s_add_u32 s92, s92, s65
s_add_u32 m0, s66, 0
s_add_u32 s48, s92, 0
buffer_load_dwordx4 v32, s[20:23], s48 offen lds
s_add_u32 m0, s64, 0
s_add_u32 s48, s91, 0
buffer_load_dwordx4 v28, s[16:19], s48 offen lds
s_add_u32 m0, s66, 1024
s_add_u32 s48, s92, 7168
buffer_load_dwordx4 v33, s[20:23], s48 offen lds
s_add_u32 m0, s64, 1024
s_add_u32 s48, s91, 16384
buffer_load_dwordx4 v29, s[16:19], s48 offen lds
s_add_u32 m0, s66, 2048
s_add_u32 s48, s92, 14336
buffer_load_dwordx4 v32, s[20:23], s48 offen lds
s_add_u32 m0, s64, 2048
s_add_u32 s48, s91, 32768
buffer_load_dwordx4 v28, s[16:19], s48 offen lds
s_add_u32 m0, s66, 3072
s_add_u32 s48, s92, 21504
buffer_load_dwordx4 v33, s[20:23], s48 offen lds
s_add_u32 m0, s64, 3072
s_add_u32 s48, s91, 49152
buffer_load_dwordx4 v29, s[16:19], s48 offen lds
s_add_u32 m0, s66, 4096
s_add_u32 s48, s92, 28672
buffer_load_dwordx4 v32, s[20:23], s48 offen lds
s_add_u32 m0, s64, 4096
s_add_u32 s48, s91, 65536
buffer_load_dwordx4 v30, s[16:19], s48 offen lds
s_add_u32 m0, s64, 5120
s_add_u32 s48, s91, 81920
buffer_load_dwordx4 v31, s[16:19], s48 offen lds
s_add_u32 m0, s64, 6144
s_add_u32 s48, s91, 98304
buffer_load_dwordx4 v30, s[16:19], s48 offen lds
s_add_u32 m0, s64, 7168
s_add_u32 s48, s91, 114688
buffer_load_dwordx4 v31, s[16:19], s48 offen lds
s_lshl_b32 s55, s3, 13
s_lshl_b32 s56, s3, 15
s_mov_b32 s50, 0x41000000
s_mov_b32 s52, 0x3db8aa3b
s_mov_b32 s53, 0x3db8aa3b
s_lshl_b32 s4, s43, 4
s_add_u32 s4, s4, s44
s_lshl_b32 s4, s4, 19
s_add_u32 s8, s8, s4
s_addc_u32 s9, s9, 0
s_mov_b32 s10, 524288
s_mov_b32 s11, 0x20000
s_add_u32 s12, s12, s4
s_addc_u32 s13, s13, 0
s_mov_b32 s14, 524288
s_mov_b32 s15, 0x20000
s_mov_b32 s26, 3670016
s_mov_b32 s27, 0x20000
s_mov_b32 s28, s88
s_mov_b32 s29, s89
s_mov_b32 s30, 27272192
s_mov_b32 s31, 0x20000
s_mov_b32 s32, s84
s_mov_b32 s33, s85
s_mov_b32 s34, 2064384
s_mov_b32 s35, 0x20000
s_mov_b32 s36, s86
s_mov_b32 s37, s87
s_mov_b32 s38, 256
s_mov_b32 s39, 0x20000
s_cmp_lg_u32 s2, 0
s_cbranch_scc1 L_nonce_done
s_cmp_lg_u32 s3, 0
s_cbranch_scc1 L_nonce_done
s_memrealtime s[98:99]
s_waitcnt lgkmcnt(0)
s_or_b32 s98, s98, 1
v_mov_b32 v10, s98
s_mov_b64 exec, 1
buffer_store_dword v10, off, s[36:39], 0 sc1
s_mov_b64 exec, -1
L_nonce_done:
s_mul_i32 s46, s45, 147
s_lshr_b32 s46, s46, 10
s_mul_i32 s47, s46, 7
s_sub_u32 s47, s45, s47
s_lshl_b32 s4, s42, 6
s_add_u32 s4, s4, s44
s_mul_i32 s4, s4, 144
s_mul_i32 s5, s43, 9
s_add_u32 s4, s4, s5
s_lshl_b32 s57, s4, 10
s_lshl_b32 s4, s42, 3
s_add_u32 s4, s4, s43
s_lshl_b32 s4, s4, 9
s_lshl_b32 s5, s44, 2
s_add_u32 s4, s4, s5
s_add_u32 s59, s4, 26214400
v_bfe_u32 v40, v0, 2, 2
v_and_b32 v41, 3, v0
v_lshrrev_b32 v42, 4, v0
v_lshrrev_b32 v43, 5, v0
v_lshlrev_b32 v7, 3, v42
v_add_u32 v7, v7, v40
v_lshlrev_b32 v7, 9, v7
v_lshl_add_u32 v7, v41, 3, v7
v_and_b32 v8, 1, v42
v_lshl_add_u32 v44, v40, 1, v8
v_xor_b32 v8, 0, v44
v_lshl_add_u32 v12, v8, 5, v7
v_xor_b32 v8, 1, v44
v_lshl_add_u32 v13, v8, 5, v7
v_xor_b32 v8, 2, v44
v_lshl_add_u32 v14, v8, 5, v7
v_xor_b32 v8, 3, v44
v_lshl_add_u32 v15, v8, 5, v7
v_xor_b32 v8, 4, v44
v_lshl_add_u32 v16, v8, 5, v7
v_xor_b32 v8, 5, v44
v_lshl_add_u32 v17, v8, 5, v7
v_xor_b32 v8, 6, v44
v_lshl_add_u32 v18, v8, 5, v7
v_xor_b32 v8, 7, v44
v_lshl_add_u32 v19, v8, 5, v7
s_lshr_b32 s4, s3, 1
s_lshl_b32 s4, s4, 8
v_add_u32 v7, s4, v7
s_and_b32 s4, s3, 1
s_lshl_b32 s4, s4, 2
v_xor_b32 v44, s4, v44
v_xor_b32 v8, 0, v44
v_lshl_add_u32 v20, v8, 5, v7
v_xor_b32 v8, 1, v44
v_lshl_add_u32 v21, v8, 5, v7
v_xor_b32 v8, 2, v44
v_lshl_add_u32 v22, v8, 5, v7
v_xor_b32 v8, 3, v44
v_lshl_add_u32 v23, v8, 5, v7
v_and_b32 v45, 15, v0
v_lshlrev_b32 v7, 7, v45
v_lshrrev_b32 v8, 1, v45
v_xor_b32 v8, v8, v42
s_lshl_b32 s4, s3, 12
s_add_u32 s4, s4, 101376
v_xor_b32 v46, 0, v8
v_lshl_add_u32 v46, v46, 4, v7
v_add_u32 v24, s4, v46
v_add_u32 v26, 117760, v46
v_xor_b32 v46, 4, v8
v_lshl_add_u32 v46, v46, 4, v7
v_add_u32 v25, s4, v46
v_add_u32 v27, 117760, v46
v_and_b32 v7, 31, v0
v_xor_b32 v7, v7, v43
v_lshlrev_b32 v8, 9, v43
v_lshl_add_u32 v3, v7, 4, v8
v_lshrrev_b32 v7, 3, v0
v_and_b32 v8, 6, v7
v_and_b32 v46, 7, v0
v_xor_b32 v8, v8, v46
v_lshlrev_b32 v7, 9, v7
v_lshl_add_u32 v2, v8, 4, v7
v_and_b32 v45, 15, v0
v_lshrrev_b32 v7, 1, v45
v_mul_u32_u24 v7, 1056, v7
v_and_b32 v8, 1, v45
v_xor_b32 v46, v8, v42
v_lshl_add_u32 v7, v8, 9, v7
v_lshl_add_u32 v4, v46, 4, v7
v_add_u32 v5, s49, v4
s_getpc_b64 s[60:61]
L_pc0:
s_sub_u32 s60, s60, L_pc0-concat_heads__mha_block_cached__mha_block_cached__near_ridge_kernel
s_subb_u32 s61, s61, 0
s_mov_b32 s62, L_code_end-concat_heads__mha_block_cached__mha_block_cached__near_ridge_kernel
s_mov_b32 s63, 0x20000
s_lshr_b32 s4, s2, 3
s_and_b32 s4, s4, 31
s_lshl_b32 s4, s4, 2
s_add_u32 s4, s4, s3
s_lshl_b32 s4, s4, 10
buffer_load_dwordx4 a[252:255], v1, s[60:63], s4 offen
L_stage0:
s_waitcnt vmcnt(1)
s_barrier
ds_read_b128 a[96:99], v24
ds_read_b128 a[104:107], v24 offset:2048
ds_read_b128 a[112:115], v26
ds_read_b128 a[100:103], v25
ds_read_b128 a[108:111], v25 offset:2048
ds_read_b128 a[116:119], v27
ds_read_b64_tr_b16 v[188:189], v12
ds_read_b64_tr_b16 v[190:191], v12 offset:2048
ds_read_b64_tr_b16 v[192:193], v13
ds_read_b64_tr_b16 v[194:195], v13 offset:2048
ds_read_b64_tr_b16 v[196:197], v14
ds_read_b64_tr_b16 v[198:199], v14 offset:2048
s_waitcnt lgkmcnt(4)
v_mfma_f32_16x16x32_bf16 v[44:47], v[188:191], a[96:99], 0
ds_read_b64_tr_b16 v[200:201], v15
ds_read_b64_tr_b16 v[202:203], v15 offset:2048
v_mfma_f32_16x16x32_bf16 v[108:111], v[188:191], a[104:107], 0
ds_read_b64_tr_b16 v[204:205], v20
ds_read_b64_tr_b16 v[206:207], v20 offset:2048
s_waitcnt lgkmcnt(6)
v_mfma_f32_16x16x32_bf16 v[48:51], v[192:195], a[96:99], 0
ds_read_b64_tr_b16 v[208:209], v16
ds_read_b64_tr_b16 v[210:211], v16 offset:2048
v_mfma_f32_16x16x32_bf16 v[112:115], v[192:195], a[104:107], 0
ds_read_b64_tr_b16 v[212:213], v17
ds_read_b64_tr_b16 v[214:215], v17 offset:2048
s_waitcnt lgkmcnt(6)
v_mfma_f32_16x16x32_bf16 v[52:55], v[196:199], a[96:99], 0
ds_read_b64_tr_b16 v[216:217], v18
ds_read_b64_tr_b16 v[218:219], v18 offset:2048
v_mfma_f32_16x16x32_bf16 v[116:119], v[196:199], a[104:107], 0
ds_read_b64_tr_b16 v[220:221], v19
v_mfma_f32_16x16x32_bf16 v[56:59], v[200:203], a[96:99], 0
ds_read_b64_tr_b16 v[222:223], v19 offset:2048
ds_read_b64_tr_b16 v[224:225], v21
v_mfma_f32_16x16x32_bf16 v[120:123], v[200:203], a[104:107], 0
ds_read_b64_tr_b16 v[226:227], v21 offset:2048
s_add_u32 s90, s90, 1
s_cmp_eq_u32 s90, 7
s_cselect_b32 s90, 0, s90
s_lshl_b32 s91, s90, 19
s_add_u32 s91, s91, s54
s_lshl_b32 s92, s90, 7
s_add_u32 s92, s92, s65
s_waitcnt lgkmcnt(1)
v_mfma_f32_16x16x32_bf16 v[172:175], v[204:207], a[112:115], 0
s_add_u32 m0, s66, 20480
s_add_u32 s48, s92, 0
buffer_load_dwordx4 v32, s[20:23], s48 offen lds
v_mfma_f32_16x16x32_bf16 v[60:63], v[208:211], a[96:99], 0
ds_read_b64_tr_b16 v[228:229], v12 offset:256
ds_read_b64_tr_b16 v[230:231], v12 offset:2304
v_mfma_f32_16x16x32_bf16 v[124:127], v[208:211], a[104:107], 0
ds_read_b64_tr_b16 v[232:233], v13 offset:256
ds_read_b64_tr_b16 v[234:235], v13 offset:2304
s_add_u32 m0, s64, 33792
v_mfma_f32_16x16x32_bf16 v[64:67], v[212:215], a[96:99], 0
s_add_u32 s48, s91, 0
buffer_load_dwordx4 v28, s[16:19], s48 offen lds
v_mfma_f32_16x16x32_bf16 v[128:131], v[212:215], a[104:107], 0
ds_read_b64_tr_b16 v[236:237], v14 offset:256
ds_read_b64_tr_b16 v[238:239], v14 offset:2304
s_add_u32 m0, s66, 21504
s_add_u32 s48, s92, 7168
v_mfma_f32_16x16x32_bf16 v[68:71], v[216:219], a[96:99], 0
buffer_load_dwordx4 v33, s[20:23], s48 offen lds
ds_read_b64_tr_b16 v[240:241], v15 offset:256
v_mfma_f32_16x16x32_bf16 v[132:135], v[216:219], a[104:107], 0
ds_read_b64_tr_b16 v[242:243], v15 offset:2304
ds_read_b64_tr_b16 v[244:245], v22
v_mfma_f32_16x16x32_bf16 v[72:75], v[220:223], a[96:99], 0
ds_read_b64_tr_b16 v[246:247], v22 offset:2048
s_add_u32 m0, s64, 34816
s_add_u32 s48, s91, 16384
v_mfma_f32_16x16x32_bf16 v[136:139], v[220:223], a[104:107], 0
buffer_load_dwordx4 v29, s[16:19], s48 offen lds
ds_read_b64_tr_b16 v[188:189], v16 offset:256
s_waitcnt lgkmcnt(4)
v_mfma_f32_16x16x32_bf16 v[176:179], v[224:227], a[112:115], 0
ds_read_b64_tr_b16 v[190:191], v16 offset:2304
ds_read_b64_tr_b16 v[192:193], v17 offset:256
v_mfma_f32_16x16x32_bf16 v[76:79], v[228:231], a[96:99], 0
ds_read_b64_tr_b16 v[194:195], v17 offset:2304
s_add_u32 m0, s66, 22528
s_add_u32 s48, s92, 14336
v_mfma_f32_16x16x32_bf16 v[140:143], v[228:231], a[104:107], 0
buffer_load_dwordx4 v32, s[20:23], s48 offen lds
ds_read_b64_tr_b16 v[196:197], v18 offset:256
v_mfma_f32_16x16x32_bf16 v[80:83], v[232:235], a[96:99], 0
ds_read_b64_tr_b16 v[198:199], v18 offset:2304
s_add_u32 m0, s64, 35840
s_add_u32 s48, s91, 32768
buffer_load_dwordx4 v28, s[16:19], s48 offen lds
v_mfma_f32_16x16x32_bf16 v[144:147], v[232:235], a[104:107], 0
ds_read_b64_tr_b16 v[200:201], v19 offset:256
v_mfma_f32_16x16x32_bf16 v[84:87], v[236:239], a[96:99], 0
ds_read_b64_tr_b16 v[202:203], v19 offset:2304
ds_read_b64_tr_b16 v[204:205], v23
v_mfma_f32_16x16x32_bf16 v[148:151], v[236:239], a[104:107], 0
ds_read_b64_tr_b16 v[206:207], v23 offset:2048
s_add_u32 m0, s66, 23552
s_add_u32 s48, s92, 21504
buffer_load_dwordx4 v33, s[20:23], s48 offen lds
s_waitcnt lgkmcnt(4)
v_mfma_f32_16x16x32_bf16 v[88:91], v[240:243], a[96:99], 0
ds_read_b64_tr_b16 v[208:209], v12 offset:16384
ds_read_b64_tr_b16 v[210:211], v12 offset:18432
v_mfma_f32_16x16x32_bf16 v[152:155], v[240:243], a[104:107], 0
ds_read_b64_tr_b16 v[212:213], v13 offset:16384
ds_read_b64_tr_b16 v[214:215], v13 offset:18432
v_mfma_f32_16x16x32_bf16 v[180:183], v[244:247], a[112:115], 0
s_add_u32 m0, s64, 36864
s_add_u32 s48, s91, 49152
buffer_load_dwordx4 v29, s[16:19], s48 offen lds
v_mfma_f32_16x16x32_bf16 v[92:95], v[188:191], a[96:99], 0
ds_read_b64_tr_b16 v[216:217], v14 offset:16384
ds_read_b64_tr_b16 v[218:219], v14 offset:18432
s_add_u32 m0, s66, 24576
s_add_u32 s48, s92, 28672
v_mfma_f32_16x16x32_bf16 v[156:159], v[188:191], a[104:107], 0
buffer_load_dwordx4 v32, s[20:23], s48 offen lds
v_mfma_f32_16x16x32_bf16 v[96:99], v[192:195], a[96:99], 0
ds_read_b64_tr_b16 v[220:221], v15 offset:16384
ds_read_b64_tr_b16 v[222:223], v15 offset:18432
v_mfma_f32_16x16x32_bf16 v[160:163], v[192:195], a[104:107], 0
ds_read_b64_tr_b16 v[224:225], v20 offset:16384
ds_read_b64_tr_b16 v[226:227], v20 offset:18432
s_add_u32 m0, s64, 37888
s_add_u32 s48, s91, 65536
v_mfma_f32_16x16x32_bf16 v[100:103], v[196:199], a[96:99], 0
buffer_load_dwordx4 v30, s[16:19], s48 offen lds
ds_read_b64_tr_b16 v[228:229], v16 offset:16384
v_mfma_f32_16x16x32_bf16 v[164:167], v[196:199], a[104:107], 0
ds_read_b64_tr_b16 v[230:231], v16 offset:18432
s_add_u32 m0, s64, 38912
s_add_u32 s48, s91, 81920
s_waitcnt lgkmcnt(2)
v_mfma_f32_16x16x32_bf16 v[104:107], v[200:203], a[96:99], 0
buffer_load_dwordx4 v31, s[16:19], s48 offen lds
ds_read_b64_tr_b16 v[232:233], v17 offset:16384
v_mfma_f32_16x16x32_bf16 v[168:171], v[200:203], a[104:107], 0
ds_read_b64_tr_b16 v[234:235], v17 offset:18432
ds_read_b64_tr_b16 v[236:237], v18 offset:16384
v_mfma_f32_16x16x32_bf16 v[184:187], v[204:207], a[112:115], 0
ds_read_b64_tr_b16 v[238:239], v18 offset:18432
s_add_u32 m0, s64, 39936
s_add_u32 s48, s91, 98304
v_mfma_f32_16x16x32_bf16 v[44:47], v[208:211], a[100:103], v[44:47]
buffer_load_dwordx4 v30, s[16:19], s48 offen lds
ds_read_b64_tr_b16 v[240:241], v19 offset:16384
v_mfma_f32_16x16x32_bf16 v[108:111], v[208:211], a[108:111], v[108:111]
ds_read_b64_tr_b16 v[242:243], v19 offset:18432
ds_read_b64_tr_b16 v[244:245], v21 offset:16384
v_mfma_f32_16x16x32_bf16 v[48:51], v[212:215], a[100:103], v[48:51]
ds_read_b64_tr_b16 v[246:247], v21 offset:18432
s_add_u32 m0, s64, 40960
s_add_u32 s48, s91, 114688
buffer_load_dwordx4 v31, s[16:19], s48 offen lds
v_mfma_f32_16x16x32_bf16 v[112:115], v[212:215], a[108:111], v[112:115]
ds_read_b64_tr_b16 v[188:189], v12 offset:16640
ds_read_b64_tr_b16 v[190:191], v12 offset:18688
v_mfma_f32_16x16x32_bf16 v[52:55], v[216:219], a[100:103], v[52:55]
s_lshl_b32 s51, s44, 8
s_lshl_b32 s48, s43, 5
s_add_u32 s51, s51, s48
s_mul_i32 s51, s51, 896
s_mul_i32 s48, s3, 7168
s_add_u32 s51, s51, s48
s_add_u32 s48, s51, 0
v_mfma_f32_16x16x32_bf16 v[116:119], v[216:219], a[108:111], v[116:119]
buffer_load_dwordx4 a[148:151], v1, s[24:27], s48 offen
ds_read_b64_tr_b16 v[192:193], v13 offset:16640
v_mfma_f32_16x16x32_bf16 v[56:59], v[220:223], a[100:103], v[56:59]
ds_read_b64_tr_b16 v[194:195], v13 offset:18688
ds_read_b64_tr_b16 v[196:197], v14 offset:16640
v_mfma_f32_16x16x32_bf16 v[120:123], v[220:223], a[108:111], v[120:123]
ds_read_b64_tr_b16 v[198:199], v14 offset:18688
s_add_u32 s90, s90, 1
s_cmp_eq_u32 s90, 7
s_cselect_b32 s90, 0, s90
s_lshl_b32 s91, s90, 19
v_mfma_f32_16x16x32_bf16 v[172:175], v[224:227], a[116:119], v[172:175]
s_add_u32 s91, s91, s54
s_lshl_b32 s92, s90, 7
s_add_u32 s92, s92, s65
s_add_u32 m0, s66, 40960
s_add_u32 s48, s92, 0
s_waitcnt lgkmcnt(0)
v_mfma_f32_16x16x32_bf16 v[60:63], v[228:231], a[100:103], v[60:63]
buffer_load_dwordx4 v32, s[20:23], s48 offen lds
ds_read_b64_tr_b16 v[200:201], v15 offset:16640
v_mfma_f32_16x16x32_bf16 v[124:127], v[228:231], a[108:111], v[124:127]
ds_read_b64_tr_b16 v[202:203], v15 offset:18688
ds_read_b64_tr_b16 v[204:205], v22 offset:16384
v_mfma_f32_16x16x32_bf16 v[64:67], v[232:235], a[100:103], v[64:67]
ds_read_b64_tr_b16 v[206:207], v22 offset:18432
s_add_u32 m0, s64, 67584
s_add_u32 s48, s91, 0
buffer_load_dwordx4 v28, s[16:19], s48 offen lds
v_mfma_f32_16x16x32_bf16 v[128:131], v[232:235], a[108:111], v[128:131]
ds_read_b64_tr_b16 v[208:209], v16 offset:16640
v_mfma_f32_16x16x32_bf16 v[68:71], v[236:239], a[100:103], v[68:71]
ds_read_b64_tr_b16 v[210:211], v16 offset:18688
s_add_u32 m0, s66, 41984
s_add_u32 s48, s92, 7168
buffer_load_dwordx4 v33, s[20:23], s48 offen lds
v_mfma_f32_16x16x32_bf16 v[132:135], v[236:239], a[108:111], v[132:135]
ds_read_b64_tr_b16 v[212:213], v17 offset:16640
ds_read_b64_tr_b16 v[214:215], v17 offset:18688
v_mfma_f32_16x16x32_bf16 v[72:75], v[240:243], a[100:103], v[72:75]
ds_read_b64_tr_b16 v[216:217], v18 offset:16640
ds_read_b64_tr_b16 v[218:219], v18 offset:18688
s_add_u32 m0, s64, 68608
v_mfma_f32_16x16x32_bf16 v[136:139], v[240:243], a[108:111], v[136:139]
s_add_u32 s48, s91, 16384
buffer_load_dwordx4 v29, s[16:19], s48 offen lds
v_mfma_f32_16x16x32_bf16 v[176:179], v[244:247], a[116:119], v[176:179]
ds_read_b64_tr_b16 v[220:221], v19 offset:16640
ds_read_b64_tr_b16 v[222:223], v19 offset:18688
v_mfma_f32_16x16x32_bf16 v[76:79], v[188:191], a[100:103], v[76:79]
ds_read_b64_tr_b16 v[224:225], v23 offset:16384
ds_read_b64_tr_b16 v[226:227], v23 offset:18432
s_add_u32 m0, s66, 43008
s_add_u32 s48, s92, 14336
v_mfma_f32_16x16x32_bf16 v[140:143], v[188:191], a[108:111], v[140:143]
buffer_load_dwordx4 v32, s[20:23], s48 offen lds
s_add_u32 m0, s64, 69632
s_add_u32 s48, s91, 32768
v_mfma_f32_16x16x32_bf16 v[80:83], v[192:195], a[100:103], v[80:83]
buffer_load_dwordx4 v28, s[16:19], s48 offen lds
s_add_u32 m0, s66, 44032
s_add_u32 s48, s92, 21504
v_mfma_f32_16x16x32_bf16 v[144:147], v[192:195], a[108:111], v[144:147]
buffer_load_dwordx4 v33, s[20:23], s48 offen lds
s_add_u32 m0, s64, 70656
s_add_u32 s48, s91, 49152
buffer_load_dwordx4 v29, s[16:19], s48 offen lds
s_add_u32 m0, s66, 45056
v_mfma_f32_16x16x32_bf16 v[84:87], v[196:199], a[100:103], v[84:87]
s_add_u32 s48, s92, 28672
buffer_load_dwordx4 v32, s[20:23], s48 offen lds
v_mfma_f32_16x16x32_bf16 v[148:151], v[196:199], a[108:111], v[148:151]
v_add_u32 v12, 33792, v12
v_add_u32 v13, 33792, v13
s_waitcnt lgkmcnt(0)
v_mfma_f32_16x16x32_bf16 v[88:91], v[200:203], a[100:103], v[88:91]
v_add_u32 v14, 33792, v14
v_add_u32 v15, 33792, v15
v_mfma_f32_16x16x32_bf16 v[152:155], v[200:203], a[108:111], v[152:155]
v_add_u32 v16, 33792, v16
v_add_u32 v17, 33792, v17
v_mfma_f32_16x16x32_bf16 v[180:183], v[204:207], a[116:119], v[180:183]
v_add_u32 v18, 33792, v18
v_add_u32 v19, 33792, v19
v_mfma_f32_16x16x32_bf16 v[92:95], v[208:211], a[100:103], v[92:95]
v_add_u32 v20, 33792, v20
v_add_u32 v21, 33792, v21
v_mfma_f32_16x16x32_bf16 v[156:159], v[208:211], a[108:111], v[156:159]
v_add_u32 v22, 33792, v22
v_add_u32 v23, 33792, v23
L_stage1:
s_waitcnt vmcnt(10)
s_barrier
ds_read_b128 a[120:123], v24 offset:20480
ds_read_b128 a[128:131], v24 offset:22528
v_mfma_f32_16x16x32_bf16 v[96:99], v[212:215], a[100:103], v[96:99]
ds_read_b128 a[136:139], v26 offset:20480
ds_read_b128 a[124:127], v25 offset:20480
ds_read_b128 a[132:135], v25 offset:22528
v_mfma_f32_16x16x32_bf16 v[160:163], v[212:215], a[108:111], v[160:163]
ds_read_b128 a[140:143], v27 offset:20480
ds_read_b64_tr_b16 v[228:229], v12
ds_read_b64_tr_b16 v[230:231], v12 offset:2048
v_mfma_f32_16x16x32_bf16 v[100:103], v[216:219], a[100:103], v[100:103]
ds_read_b64_tr_b16 v[232:233], v13
v_mfma_f32_16x16x32_bf16 v[164:167], v[216:219], a[108:111], v[164:167]
ds_read_b64_tr_b16 v[234:235], v13 offset:2048
ds_read_b64_tr_b16 v[236:237], v14
v_mfma_f32_16x16x32_bf16 v[104:107], v[220:223], a[100:103], v[104:107]
ds_read_b64_tr_b16 v[238:239], v14 offset:2048
ds_read_b64_tr_b16 v[240:241], v15
v_mfma_f32_16x16x32_bf16 v[168:171], v[220:223], a[108:111], v[168:171]
ds_read_b64_tr_b16 v[242:243], v15 offset:2048
v_mfma_f32_16x16x32_bf16 v[184:187], v[224:227], a[116:119], v[184:187]
ds_read_b64_tr_b16 v[244:245], v20
ds_read_b64_tr_b16 v[246:247], v20 offset:2048
s_waitcnt lgkmcnt(6)
v_mfma_f32_16x16x32_bf16 v[44:47], v[228:231], a[120:123], v[44:47]
ds_read_b64_tr_b16 v[188:189], v16
ds_read_b64_tr_b16 v[190:191], v16 offset:2048
v_mfma_f32_16x16x32_bf16 v[108:111], v[228:231], a[128:131], v[108:111]
s_add_u32 m0, s64, 71680
s_add_u32 s48, s91, 65536
buffer_load_dwordx4 v30, s[16:19], s48 offen lds
v_mfma_f32_16x16x32_bf16 v[48:51], v[232:235], a[120:123], v[48:51]
ds_read_b64_tr_b16 v[192:193], v17
v_mfma_f32_16x16x32_bf16 v[112:115], v[232:235], a[128:131], v[112:115]
ds_read_b64_tr_b16 v[194:195], v17 offset:2048
ds_read_b64_tr_b16 v[196:197], v18
s_waitcnt lgkmcnt(3)
v_mfma_f32_16x16x32_bf16 v[52:55], v[236:239], a[120:123], v[52:55]
ds_read_b64_tr_b16 v[198:199], v18 offset:2048
ds_read_b64_tr_b16 v[200:201], v19
v_mfma_f32_16x16x32_bf16 v[116:119], v[236:239], a[128:131], v[116:119]
ds_read_b64_tr_b16 v[202:203], v19 offset:2048
s_add_u32 m0, s64, 72704
s_add_u32 s48, s91, 81920
v_mfma_f32_16x16x32_bf16 v[56:59], v[240:243], a[120:123], v[56:59]
buffer_load_dwordx4 v31, s[16:19], s48 offen lds
v_mfma_f32_16x16x32_bf16 v[120:123], v[240:243], a[128:131], v[120:123]
ds_read_b64_tr_b16 v[204:205], v21
ds_read_b64_tr_b16 v[206:207], v21 offset:2048
v_mfma_f32_16x16x32_bf16 v[172:175], v[244:247], a[136:139], v[172:175]
ds_read_b64_tr_b16 v[208:209], v12 offset:256
ds_read_b64_tr_b16 v[210:211], v12 offset:2304
v_mfma_f32_16x16x32_bf16 v[60:63], v[188:191], a[120:123], v[60:63]
ds_read_b64_tr_b16 v[212:213], v13 offset:256
v_mfma_f32_16x16x32_bf16 v[124:127], v[188:191], a[128:131], v[124:127]
ds_read_b64_tr_b16 v[214:215], v13 offset:2304
s_add_u32 m0, s64, 73728
s_add_u32 s48, s91, 98304
s_waitcnt lgkmcnt(4)
v_mfma_f32_16x16x32_bf16 v[64:67], v[192:195], a[120:123], v[64:67]
buffer_load_dwordx4 v30, s[16:19], s48 offen lds
ds_read_b64_tr_b16 v[216:217], v14 offset:256
v_mfma_f32_16x16x32_bf16 v[128:131], v[192:195], a[128:131], v[128:131]
ds_read_b64_tr_b16 v[218:219], v14 offset:2304
ds_read_b64_tr_b16 v[220:221], v15 offset:256
v_mfma_f32_16x16x32_bf16 v[68:71], v[196:199], a[120:123], v[68:71]
ds_read_b64_tr_b16 v[222:223], v15 offset:2304
v_mfma_f32_16x16x32_bf16 v[132:135], v[196:199], a[128:131], v[132:135]
ds_read_b64_tr_b16 v[224:225], v22
ds_read_b64_tr_b16 v[226:227], v22 offset:2048
s_add_u32 m0, s64, 74752
v_mfma_f32_16x16x32_bf16 v[72:75], v[200:203], a[120:123], v[72:75]
s_add_u32 s48, s91, 114688
buffer_load_dwordx4 v31, s[16:19], s48 offen lds
v_mfma_f32_16x16x32_bf16 v[136:139], v[200:203], a[128:131], v[136:139]
ds_read_b64_tr_b16 v[228:229], v16 offset:256
ds_read_b64_tr_b16 v[230:231], v16 offset:2304
v_mfma_f32_16x16x32_bf16 v[176:179], v[204:207], a[136:139], v[176:179]
ds_read_b64_tr_b16 v[232:233], v17 offset:256
s_waitcnt lgkmcnt(3)
v_mfma_f32_16x16x32_bf16 v[76:79], v[208:211], a[120:123], v[76:79]
ds_read_b64_tr_b16 v[234:235], v17 offset:2304
s_lshl_b32 s51, s44, 8
s_lshl_b32 s48, s43, 5
s_add_u32 s51, s51, s48
s_mul_i32 s51, s51, 896
s_mul_i32 s48, s3, 7168
v_mfma_f32_16x16x32_bf16 v[140:143], v[208:211], a[128:131], v[140:143]
s_add_u32 s51, s51, s48
s_add_u32 s48, s51, 1024
buffer_load_dwordx4 a[152:155], v1, s[24:27], s48 offen
v_mfma_f32_16x16x32_bf16 v[80:83], v[212:215], a[120:123], v[80:83]
ds_read_b64_tr_b16 v[236:237], v18 offset:256
v_mfma_f32_16x16x32_bf16 v[144:147], v[212:215], a[128:131], v[144:147]
ds_read_b64_tr_b16 v[238:239], v18 offset:2304
ds_read_b64_tr_b16 v[240:241], v19 offset:256
v_mfma_f32_16x16x32_bf16 v[84:87], v[216:219], a[120:123], v[84:87]
ds_read_b64_tr_b16 v[242:243], v19 offset:2304
ds_read_b64_tr_b16 v[244:245], v23
v_mfma_f32_16x16x32_bf16 v[148:151], v[216:219], a[128:131], v[148:151]
ds_read_b64_tr_b16 v[246:247], v23 offset:2048
s_add_u32 s90, s90, 1
s_cmp_eq_u32 s90, 7
s_cselect_b32 s90, 0, s90
v_mfma_f32_16x16x32_bf16 v[88:91], v[220:223], a[120:123], v[88:91]
s_lshl_b32 s91, s90, 19
s_add_u32 s91, s91, s54
s_lshl_b32 s92, s90, 7
s_add_u32 s92, s92, s65
s_add_u32 m0, s66, 0
s_add_u32 s48, s92, 0
v_mfma_f32_16x16x32_bf16 v[152:155], v[220:223], a[128:131], v[152:155]
buffer_load_dwordx4 v32, s[20:23], s48 offen lds
v_mfma_f32_16x16x32_bf16 v[180:183], v[224:227], a[136:139], v[180:183]
ds_read_b64_tr_b16 v[188:189], v12 offset:16384
ds_read_b64_tr_b16 v[190:191], v12 offset:18432
s_waitcnt lgkmcnt(2)
v_mfma_f32_16x16x32_bf16 v[92:95], v[228:231], a[120:123], v[92:95]
ds_read_b64_tr_b16 v[192:193], v13 offset:16384
ds_read_b64_tr_b16 v[194:195], v13 offset:18432
v_mfma_f32_16x16x32_bf16 v[156:159], v[228:231], a[128:131], v[156:159]
s_add_u32 m0, s64, 0
s_add_u32 s48, s91, 0
buffer_load_dwordx4 v28, s[16:19], s48 offen lds
v_mfma_f32_16x16x32_bf16 v[96:99], v[232:235], a[120:123], v[96:99]
ds_read_b64_tr_b16 v[196:197], v14 offset:16384
v_mfma_f32_16x16x32_bf16 v[160:163], v[232:235], a[128:131], v[160:163]
ds_read_b64_tr_b16 v[198:199], v14 offset:18432
ds_read_b64_tr_b16 v[200:201], v15 offset:16384
v_mfma_f32_16x16x32_bf16 v[100:103], v[236:239], a[120:123], v[100:103]
ds_read_b64_tr_b16 v[202:203], v15 offset:18432
ds_read_b64_tr_b16 v[204:205], v20 offset:16384
v_mfma_f32_16x16x32_bf16 v[164:167], v[236:239], a[128:131], v[164:167]
ds_read_b64_tr_b16 v[206:207], v20 offset:18432
s_add_u32 m0, s66, 1024
s_add_u32 s48, s92, 7168
v_mfma_f32_16x16x32_bf16 v[104:107], v[240:243], a[120:123], v[104:107]
buffer_load_dwordx4 v33, s[20:23], s48 offen lds
v_mfma_f32_16x16x32_bf16 v[168:171], v[240:243], a[128:131], v[168:171]
ds_read_b64_tr_b16 v[208:209], v16 offset:16384
ds_read_b64_tr_b16 v[210:211], v16 offset:18432
v_mfma_f32_16x16x32_bf16 v[184:187], v[244:247], a[136:139], v[184:187]
ds_read_b64_tr_b16 v[212:213], v17 offset:16384
ds_read_b64_tr_b16 v[214:215], v17 offset:18432
s_waitcnt lgkmcnt(4)
v_mfma_f32_16x16x32_bf16 v[44:47], v[188:191], a[124:127], v[44:47]
ds_read_b64_tr_b16 v[216:217], v18 offset:16384
v_mfma_f32_16x16x32_bf16 v[108:111], v[188:191], a[132:135], v[108:111]
ds_read_b64_tr_b16 v[218:219], v18 offset:18432
s_add_u32 m0, s64, 1024
s_add_u32 s48, s91, 16384
v_mfma_f32_16x16x32_bf16 v[48:51], v[192:195], a[124:127], v[48:51]
buffer_load_dwordx4 v29, s[16:19], s48 offen lds
ds_read_b64_tr_b16 v[220:221], v19 offset:16384
v_mfma_f32_16x16x32_bf16 v[112:115], v[192:195], a[132:135], v[112:115]
ds_read_b64_tr_b16 v[222:223], v19 offset:18432
ds_read_b64_tr_b16 v[224:225], v21 offset:16384
v_mfma_f32_16x16x32_bf16 v[52:55], v[196:199], a[124:127], v[52:55]
ds_read_b64_tr_b16 v[226:227], v21 offset:18432
s_add_u32 m0, s66, 2048
s_add_u32 s48, s92, 14336
v_mfma_f32_16x16x32_bf16 v[116:119], v[196:199], a[132:135], v[116:119]
buffer_load_dwordx4 v32, s[20:23], s48 offen lds
v_mfma_f32_16x16x32_bf16 v[56:59], v[200:203], a[124:127], v[56:59]
ds_read_b64_tr_b16 v[228:229], v12 offset:16640
ds_read_b64_tr_b16 v[230:231], v12 offset:18688
v_mfma_f32_16x16x32_bf16 v[120:123], v[200:203], a[132:135], v[120:123]
ds_read_b64_tr_b16 v[232:233], v13 offset:16640
ds_read_b64_tr_b16 v[234:235], v13 offset:18688
v_mfma_f32_16x16x32_bf16 v[172:175], v[204:207], a[140:143], v[172:175]
ds_read_b64_tr_b16 v[236:237], v14 offset:16640
s_waitcnt lgkmcnt(5)
v_mfma_f32_16x16x32_bf16 v[60:63], v[208:211], a[124:127], v[60:63]
ds_read_b64_tr_b16 v[238:239], v14 offset:18688
s_add_u32 m0, s64, 2048
s_add_u32 s48, s91, 32768
v_mfma_f32_16x16x32_bf16 v[124:127], v[208:211], a[132:135], v[124:127]
buffer_load_dwordx4 v28, s[16:19], s48 offen lds
ds_read_b64_tr_b16 v[240:241], v15 offset:16640
v_mfma_f32_16x16x32_bf16 v[64:67], v[212:215], a[124:127], v[64:67]
ds_read_b64_tr_b16 v[242:243], v15 offset:18688
ds_read_b64_tr_b16 v[244:245], v22 offset:16384
v_mfma_f32_16x16x32_bf16 v[128:131], v[212:215], a[132:135], v[128:131]
ds_read_b64_tr_b16 v[246:247], v22 offset:18432
v_mfma_f32_16x16x32_bf16 v[68:71], v[216:219], a[124:127], v[68:71]
ds_read_b64_tr_b16 v[188:189], v16 offset:16640
ds_read_b64_tr_b16 v[190:191], v16 offset:18688
s_add_u32 m0, s66, 3072
v_mfma_f32_16x16x32_bf16 v[132:135], v[216:219], a[132:135], v[132:135]
s_add_u32 s48, s92, 21504
buffer_load_dwordx4 v33, s[20:23], s48 offen lds
v_mfma_f32_16x16x32_bf16 v[72:75], v[220:223], a[124:127], v[72:75]
ds_read_b64_tr_b16 v[192:193], v17 offset:16640
ds_read_b64_tr_b16 v[194:195], v17 offset:18688
v_mfma_f32_16x16x32_bf16 v[136:139], v[220:223], a[132:135], v[136:139]
ds_read_b64_tr_b16 v[196:197], v18 offset:16640
v_mfma_f32_16x16x32_bf16 v[176:179], v[224:227], a[140:143], v[176:179]
ds_read_b64_tr_b16 v[198:199], v18 offset:18688
s_add_u32 m0, s64, 3072
s_add_u32 s48, s91, 49152
s_waitcnt lgkmcnt(4)
v_mfma_f32_16x16x32_bf16 v[76:79], v[228:231], a[124:127], v[76:79]
buffer_load_dwordx4 v29, s[16:19], s48 offen lds
ds_read_b64_tr_b16 v[200:201], v19 offset:16640
v_mfma_f32_16x16x32_bf16 v[140:143], v[228:231], a[132:135], v[140:143]
ds_read_b64_tr_b16 v[202:203], v19 offset:18688
ds_read_b64_tr_b16 v[204:205], v23 offset:16384
v_mfma_f32_16x16x32_bf16 v[80:83], v[232:235], a[124:127], v[80:83]
ds_read_b64_tr_b16 v[206:207], v23 offset:18432
s_add_u32 m0, s66, 4096
s_add_u32 s48, s92, 28672
v_mfma_f32_16x16x32_bf16 v[144:147], v[232:235], a[132:135], v[144:147]
buffer_load_dwordx4 v32, s[20:23], s48 offen lds
v_mfma_f32_16x16x32_bf16 v[84:87], v[236:239], a[124:127], v[84:87]
v_add_u32 v12, 33792, v12
v_add_u32 v13, 33792, v13
v_mfma_f32_16x16x32_bf16 v[148:151], v[236:239], a[132:135], v[148:151]
v_add_u32 v14, 33792, v14
v_add_u32 v15, 33792, v15
v_mfma_f32_16x16x32_bf16 v[88:91], v[240:243], a[124:127], v[88:91]
v_add_u32 v16, 33792, v16
v_mfma_f32_16x16x32_bf16 v[152:155], v[240:243], a[132:135], v[152:155]
v_add_u32 v17, 33792, v17
v_add_u32 v18, 33792, v18
v_mfma_f32_16x16x32_bf16 v[180:183], v[244:247], a[140:143], v[180:183]
v_add_u32 v19, 33792, v19
v_add_u32 v20, 33792, v20
v_mfma_f32_16x16x32_bf16 v[92:95], v[188:191], a[124:127], v[92:95]
v_add_u32 v21, 33792, v21
v_mfma_f32_16x16x32_bf16 v[156:159], v[188:191], a[132:135], v[156:159]
v_add_u32 v22, 33792, v22
v_add_u32 v23, 33792, v23
L_stage2:
s_waitcnt vmcnt(10)
s_waitcnt lgkmcnt(0)
s_barrier
ds_read_b128 a[96:99], v24 offset:40960
ds_read_b128 a[104:107], v24 offset:43008
v_mfma_f32_16x16x32_bf16 v[96:99], v[192:195], a[124:127], v[96:99]
ds_read_b128 a[112:115], v26 offset:40960
ds_read_b128 a[100:103], v25 offset:40960
ds_read_b128 a[108:111], v25 offset:43008
v_mfma_f32_16x16x32_bf16 v[160:163], v[192:195], a[132:135], v[160:163]
ds_read_b128 a[116:119], v27 offset:40960
ds_read_b64_tr_b16 v[208:209], v12
ds_read_b64_tr_b16 v[210:211], v12 offset:2048
v_mfma_f32_16x16x32_bf16 v[100:103], v[196:199], a[124:127], v[100:103]
ds_read_b64_tr_b16 v[212:213], v13
v_mfma_f32_16x16x32_bf16 v[164:167], v[196:199], a[132:135], v[164:167]
ds_read_b64_tr_b16 v[214:215], v13 offset:2048
ds_read_b64_tr_b16 v[216:217], v14
v_mfma_f32_16x16x32_bf16 v[104:107], v[200:203], a[124:127], v[104:107]
ds_read_b64_tr_b16 v[218:219], v14 offset:2048
ds_read_b64_tr_b16 v[220:221], v15
v_mfma_f32_16x16x32_bf16 v[168:171], v[200:203], a[132:135], v[168:171]
ds_read_b64_tr_b16 v[222:223], v15 offset:2048
v_mfma_f32_16x16x32_bf16 v[184:187], v[204:207], a[140:143], v[184:187]
ds_read_b64_tr_b16 v[224:225], v20
ds_read_b64_tr_b16 v[226:227], v20 offset:2048
s_waitcnt lgkmcnt(6)
v_mfma_f32_16x16x32_bf16 v[44:47], v[208:211], a[96:99], v[44:47]
ds_read_b64_tr_b16 v[228:229], v16
ds_read_b64_tr_b16 v[230:231], v16 offset:2048
v_mfma_f32_16x16x32_bf16 v[108:111], v[208:211], a[104:107], v[108:111]
s_add_u32 m0, s64, 4096
s_add_u32 s48, s91, 65536
buffer_load_dwordx4 v30, s[16:19], s48 offen lds
v_mfma_f32_16x16x32_bf16 v[48:51], v[212:215], a[96:99], v[48:51]
ds_read_b64_tr_b16 v[232:233], v17
v_mfma_f32_16x16x32_bf16 v[112:115], v[212:215], a[104:107], v[112:115]
ds_read_b64_tr_b16 v[234:235], v17 offset:2048
ds_read_b64_tr_b16 v[236:237], v18
s_waitcnt lgkmcnt(3)
v_mfma_f32_16x16x32_bf16 v[52:55], v[216:219], a[96:99], v[52:55]
ds_read_b64_tr_b16 v[238:239], v18 offset:2048
ds_read_b64_tr_b16 v[240:241], v19
v_mfma_f32_16x16x32_bf16 v[116:119], v[216:219], a[104:107], v[116:119]
ds_read_b64_tr_b16 v[242:243], v19 offset:2048
s_add_u32 m0, s64, 5120
s_add_u32 s48, s91, 81920
v_mfma_f32_16x16x32_bf16 v[56:59], v[220:223], a[96:99], v[56:59]
buffer_load_dwordx4 v31, s[16:19], s48 offen lds
v_mfma_f32_16x16x32_bf16 v[120:123], v[220:223], a[104:107], v[120:123]
ds_read_b64_tr_b16 v[244:245], v21
ds_read_b64_tr_b16 v[246:247], v21 offset:2048
v_mfma_f32_16x16x32_bf16 v[172:175], v[224:227], a[112:115], v[172:175]
ds_read_b64_tr_b16 v[188:189], v12 offset:256
ds_read_b64_tr_b16 v[190:191], v12 offset:2304
v_mfma_f32_16x16x32_bf16 v[60:63], v[228:231], a[96:99], v[60:63]
ds_read_b64_tr_b16 v[192:193], v13 offset:256
v_mfma_f32_16x16x32_bf16 v[124:127], v[228:231], a[104:107], v[124:127]
ds_read_b64_tr_b16 v[194:195], v13 offset:2304
s_add_u32 m0, s64, 6144
s_add_u32 s48, s91, 98304
s_waitcnt lgkmcnt(4)
v_mfma_f32_16x16x32_bf16 v[64:67], v[232:235], a[96:99], v[64:67]
buffer_load_dwordx4 v30, s[16:19], s48 offen lds
ds_read_b64_tr_b16 v[196:197], v14 offset:256
v_mfma_f32_16x16x32_bf16 v[128:131], v[232:235], a[104:107], v[128:131]
ds_read_b64_tr_b16 v[198:199], v14 offset:2304
ds_read_b64_tr_b16 v[200:201], v15 offset:256
v_mfma_f32_16x16x32_bf16 v[68:71], v[236:239], a[96:99], v[68:71]
ds_read_b64_tr_b16 v[202:203], v15 offset:2304
v_mfma_f32_16x16x32_bf16 v[132:135], v[236:239], a[104:107], v[132:135]
ds_read_b64_tr_b16 v[204:205], v22
ds_read_b64_tr_b16 v[206:207], v22 offset:2048
s_add_u32 m0, s64, 7168
v_mfma_f32_16x16x32_bf16 v[72:75], v[240:243], a[96:99], v[72:75]
s_add_u32 s48, s91, 114688
buffer_load_dwordx4 v31, s[16:19], s48 offen lds
v_mfma_f32_16x16x32_bf16 v[136:139], v[240:243], a[104:107], v[136:139]
ds_read_b64_tr_b16 v[208:209], v16 offset:256
ds_read_b64_tr_b16 v[210:211], v16 offset:2304
v_mfma_f32_16x16x32_bf16 v[176:179], v[244:247], a[112:115], v[176:179]
ds_read_b64_tr_b16 v[212:213], v17 offset:256
s_waitcnt lgkmcnt(3)
v_mfma_f32_16x16x32_bf16 v[76:79], v[188:191], a[96:99], v[76:79]
ds_read_b64_tr_b16 v[214:215], v17 offset:2304
s_lshl_b32 s51, s44, 8
s_lshl_b32 s48, s43, 5
s_add_u32 s51, s51, s48
s_mul_i32 s51, s51, 896
s_mul_i32 s48, s3, 7168
v_mfma_f32_16x16x32_bf16 v[140:143], v[188:191], a[104:107], v[140:143]
s_add_u32 s51, s51, s48
s_add_u32 s48, s51, 2048
buffer_load_dwordx4 a[148:151], v1, s[24:27], s48 offen
v_mfma_f32_16x16x32_bf16 v[80:83], v[192:195], a[96:99], v[80:83]
ds_read_b64_tr_b16 v[216:217], v18 offset:256
v_mfma_f32_16x16x32_bf16 v[144:147], v[192:195], a[104:107], v[144:147]
ds_read_b64_tr_b16 v[218:219], v18 offset:2304
ds_read_b64_tr_b16 v[220:221], v19 offset:256
v_mfma_f32_16x16x32_bf16 v[84:87], v[196:199], a[96:99], v[84:87]
ds_read_b64_tr_b16 v[222:223], v19 offset:2304
ds_read_b64_tr_b16 v[224:225], v23
v_mfma_f32_16x16x32_bf16 v[148:151], v[196:199], a[104:107], v[148:151]
ds_read_b64_tr_b16 v[226:227], v23 offset:2048
s_add_u32 s90, s90, 1
s_cmp_eq_u32 s90, 7
s_cselect_b32 s90, 0, s90
v_mfma_f32_16x16x32_bf16 v[88:91], v[200:203], a[96:99], v[88:91]
s_lshl_b32 s91, s90, 19
s_add_u32 s91, s91, s54
s_lshl_b32 s92, s90, 7
s_add_u32 s92, s92, s65
s_add_u32 m0, s66, 20480
s_add_u32 s48, s92, 0
v_mfma_f32_16x16x32_bf16 v[152:155], v[200:203], a[104:107], v[152:155]
buffer_load_dwordx4 v32, s[20:23], s48 offen lds
v_mfma_f32_16x16x32_bf16 v[180:183], v[204:207], a[112:115], v[180:183]
ds_read_b64_tr_b16 v[228:229], v12 offset:16384
ds_read_b64_tr_b16 v[230:231], v12 offset:18432
s_waitcnt lgkmcnt(2)
v_mfma_f32_16x16x32_bf16 v[92:95], v[208:211], a[96:99], v[92:95]
ds_read_b64_tr_b16 v[232:233], v13 offset:16384
ds_read_b64_tr_b16 v[234:235], v13 offset:18432
v_mfma_f32_16x16x32_bf16 v[156:159], v[208:211], a[104:107], v[156:159]
s_add_u32 m0, s64, 33792
s_add_u32 s48, s91, 0
buffer_load_dwordx4 v28, s[16:19], s48 offen lds
v_mfma_f32_16x16x32_bf16 v[96:99], v[212:215], a[96:99], v[96:99]
ds_read_b64_tr_b16 v[236:237], v14 offset:16384
v_mfma_f32_16x16x32_bf16 v[160:163], v[212:215], a[104:107], v[160:163]
ds_read_b64_tr_b16 v[238:239], v14 offset:18432
ds_read_b64_tr_b16 v[240:241], v15 offset:16384
v_mfma_f32_16x16x32_bf16 v[100:103], v[216:219], a[96:99], v[100:103]
ds_read_b64_tr_b16 v[242:243], v15 offset:18432
ds_read_b64_tr_b16 v[244:245], v20 offset:16384
v_mfma_f32_16x16x32_bf16 v[164:167], v[216:219], a[104:107], v[164:167]
ds_read_b64_tr_b16 v[246:247], v20 offset:18432
s_add_u32 m0, s66, 21504
s_add_u32 s48, s92, 7168
v_mfma_f32_16x16x32_bf16 v[104:107], v[220:223], a[96:99], v[104:107]
buffer_load_dwordx4 v33, s[20:23], s48 offen lds
v_mfma_f32_16x16x32_bf16 v[168:171], v[220:223], a[104:107], v[168:171]
ds_read_b64_tr_b16 v[188:189], v16 offset:16384
ds_read_b64_tr_b16 v[190:191], v16 offset:18432
v_mfma_f32_16x16x32_bf16 v[184:187], v[224:227], a[112:115], v[184:187]
ds_read_b64_tr_b16 v[192:193], v17 offset:16384
ds_read_b64_tr_b16 v[194:195], v17 offset:18432
s_waitcnt lgkmcnt(4)
v_mfma_f32_16x16x32_bf16 v[44:47], v[228:231], a[100:103], v[44:47]
ds_read_b64_tr_b16 v[196:197], v18 offset:16384
v_mfma_f32_16x16x32_bf16 v[108:111], v[228:231], a[108:111], v[108:111]
ds_read_b64_tr_b16 v[198:199], v18 offset:18432
s_add_u32 m0, s64, 34816
s_add_u32 s48, s91, 16384
v_mfma_f32_16x16x32_bf16 v[48:51], v[232:235], a[100:103], v[48:51]
buffer_load_dwordx4 v29, s[16:19], s48 offen lds
ds_read_b64_tr_b16 v[200:201], v19 offset:16384
v_mfma_f32_16x16x32_bf16 v[112:115], v[232:235], a[108:111], v[112:115]
ds_read_b64_tr_b16 v[202:203], v19 offset:18432
ds_read_b64_tr_b16 v[204:205], v21 offset:16384
v_mfma_f32_16x16x32_bf16 v[52:55], v[236:239], a[100:103], v[52:55]
ds_read_b64_tr_b16 v[206:207], v21 offset:18432
s_add_u32 m0, s66, 22528
s_add_u32 s48, s92, 14336
v_mfma_f32_16x16x32_bf16 v[116:119], v[236:239], a[108:111], v[116:119]
buffer_load_dwordx4 v32, s[20:23], s48 offen lds
v_mfma_f32_16x16x32_bf16 v[56:59], v[240:243], a[100:103], v[56:59]
ds_read_b64_tr_b16 v[208:209], v12 offset:16640
ds_read_b64_tr_b16 v[210:211], v12 offset:18688
v_mfma_f32_16x16x32_bf16 v[120:123], v[240:243], a[108:111], v[120:123]
ds_read_b64_tr_b16 v[212:213], v13 offset:16640
ds_read_b64_tr_b16 v[214:215], v13 offset:18688
v_mfma_f32_16x16x32_bf16 v[172:175], v[244:247], a[116:119], v[172:175]
ds_read_b64_tr_b16 v[216:217], v14 offset:16640
s_waitcnt lgkmcnt(5)
v_mfma_f32_16x16x32_bf16 v[60:63], v[188:191], a[100:103], v[60:63]
ds_read_b64_tr_b16 v[218:219], v14 offset:18688
s_add_u32 m0, s64, 35840
s_add_u32 s48, s91, 32768
v_mfma_f32_16x16x32_bf16 v[124:127], v[188:191], a[108:111], v[124:127]
buffer_load_dwordx4 v28, s[16:19], s48 offen lds
ds_read_b64_tr_b16 v[220:221], v15 offset:16640
v_mfma_f32_16x16x32_bf16 v[64:67], v[192:195], a[100:103], v[64:67]
ds_read_b64_tr_b16 v[222:223], v15 offset:18688
ds_read_b64_tr_b16 v[224:225], v22 offset:16384
v_mfma_f32_16x16x32_bf16 v[128:131], v[192:195], a[108:111], v[128:131]
ds_read_b64_tr_b16 v[226:227], v22 offset:18432
v_mfma_f32_16x16x32_bf16 v[68:71], v[196:199], a[100:103], v[68:71]
ds_read_b64_tr_b16 v[228:229], v16 offset:16640
ds_read_b64_tr_b16 v[230:231], v16 offset:18688
s_add_u32 m0, s66, 23552
v_mfma_f32_16x16x32_bf16 v[132:135], v[196:199], a[108:111], v[132:135]
s_add_u32 s48, s92, 21504
buffer_load_dwordx4 v33, s[20:23], s48 offen lds
v_mfma_f32_16x16x32_bf16 v[72:75], v[200:203], a[100:103], v[72:75]
ds_read_b64_tr_b16 v[232:233], v17 offset:16640
ds_read_b64_tr_b16 v[234:235], v17 offset:18688
v_mfma_f32_16x16x32_bf16 v[136:139], v[200:203], a[108:111], v[136:139]
ds_read_b64_tr_b16 v[236:237], v18 offset:16640
v_mfma_f32_16x16x32_bf16 v[176:179], v[204:207], a[116:119], v[176:179]
ds_read_b64_tr_b16 v[238:239], v18 offset:18688
s_add_u32 m0, s64, 36864
s_add_u32 s48, s91, 49152
s_waitcnt lgkmcnt(4)
v_mfma_f32_16x16x32_bf16 v[76:79], v[208:211], a[100:103], v[76:79]
buffer_load_dwordx4 v29, s[16:19], s48 offen lds
ds_read_b64_tr_b16 v[240:241], v19 offset:16640
v_mfma_f32_16x16x32_bf16 v[140:143], v[208:211], a[108:111], v[140:143]
ds_read_b64_tr_b16 v[242:243], v19 offset:18688
ds_read_b64_tr_b16 v[244:245], v23 offset:16384
v_mfma_f32_16x16x32_bf16 v[80:83], v[212:215], a[100:103], v[80:83]
ds_read_b64_tr_b16 v[246:247], v23 offset:18432
s_add_u32 m0, s66, 24576
s_add_u32 s48, s92, 28672
v_mfma_f32_16x16x32_bf16 v[144:147], v[212:215], a[108:111], v[144:147]
buffer_load_dwordx4 v32, s[20:23], s48 offen lds
v_mfma_f32_16x16x32_bf16 v[84:87], v[216:219], a[100:103], v[84:87]
v_subrev_u32 v12, 67584, v12
v_subrev_u32 v13, 67584, v13
v_mfma_f32_16x16x32_bf16 v[148:151], v[216:219], a[108:111], v[148:151]
v_subrev_u32 v14, 67584, v14
v_subrev_u32 v15, 67584, v15
v_mfma_f32_16x16x32_bf16 v[88:91], v[220:223], a[100:103], v[88:91]
v_subrev_u32 v16, 67584, v16
v_mfma_f32_16x16x32_bf16 v[152:155], v[220:223], a[108:111], v[152:155]
v_subrev_u32 v17, 67584, v17
v_subrev_u32 v18, 67584, v18
v_mfma_f32_16x16x32_bf16 v[180:183], v[224:227], a[116:119], v[180:183]
v_subrev_u32 v19, 67584, v19
v_subrev_u32 v20, 67584, v20
v_mfma_f32_16x16x32_bf16 v[92:95], v[228:231], a[100:103], v[92:95]
v_subrev_u32 v21, 67584, v21
v_mfma_f32_16x16x32_bf16 v[156:159], v[228:231], a[108:111], v[156:159]
v_subrev_u32 v22, 67584, v22
v_subrev_u32 v23, 67584, v23
L_stage3:
s_waitcnt vmcnt(10)
s_waitcnt lgkmcnt(0)
s_barrier
ds_read_b128 a[120:123], v24
ds_read_b128 a[128:131], v24 offset:2048
v_mfma_f32_16x16x32_bf16 v[96:99], v[232:235], a[100:103], v[96:99]
ds_read_b128 a[136:139], v26
ds_read_b128 a[124:127], v25
ds_read_b128 a[132:135], v25 offset:2048
v_mfma_f32_16x16x32_bf16 v[160:163], v[232:235], a[108:111], v[160:163]
ds_read_b128 a[140:143], v27
ds_read_b64_tr_b16 v[188:189], v12
ds_read_b64_tr_b16 v[190:191], v12 offset:2048
v_mfma_f32_16x16x32_bf16 v[100:103], v[236:239], a[100:103], v[100:103]
ds_read_b64_tr_b16 v[192:193], v13
v_mfma_f32_16x16x32_bf16 v[164:167], v[236:239], a[108:111], v[164:167]
ds_read_b64_tr_b16 v[194:195], v13 offset:2048
ds_read_b64_tr_b16 v[196:197], v14
v_mfma_f32_16x16x32_bf16 v[104:107], v[240:243], a[100:103], v[104:107]
ds_read_b64_tr_b16 v[198:199], v14 offset:2048
ds_read_b64_tr_b16 v[200:201], v15
v_mfma_f32_16x16x32_bf16 v[168:171], v[240:243], a[108:111], v[168:171]
ds_read_b64_tr_b16 v[202:203], v15 offset:2048
v_mfma_f32_16x16x32_bf16 v[184:187], v[244:247], a[116:119], v[184:187]
ds_read_b64_tr_b16 v[204:205], v20
ds_read_b64_tr_b16 v[206:207], v20 offset:2048
s_waitcnt lgkmcnt(6)
v_mfma_f32_16x16x32_bf16 v[44:47], v[188:191], a[120:123], v[44:47]
ds_read_b64_tr_b16 v[208:209], v16
ds_read_b64_tr_b16 v[210:211], v16 offset:2048
v_mfma_f32_16x16x32_bf16 v[108:111], v[188:191], a[128:131], v[108:111]
s_add_u32 m0, s64, 37888
s_add_u32 s48, s91, 65536
buffer_load_dwordx4 v30, s[16:19], s48 offen lds
v_mfma_f32_16x16x32_bf16 v[48:51], v[192:195], a[120:123], v[48:51]
ds_read_b64_tr_b16 v[212:213], v17
v_mfma_f32_16x16x32_bf16 v[112:115], v[192:195], a[128:131], v[112:115]
ds_read_b64_tr_b16 v[214:215], v17 offset:2048
ds_read_b64_tr_b16 v[216:217], v18
s_waitcnt lgkmcnt(3)
v_mfma_f32_16x16x32_bf16 v[52:55], v[196:199], a[120:123], v[52:55]
ds_read_b64_tr_b16 v[218:219], v18 offset:2048
ds_read_b64_tr_b16 v[220:221], v19
v_mfma_f32_16x16x32_bf16 v[116:119], v[196:199], a[128:131], v[116:119]
ds_read_b64_tr_b16 v[222:223], v19 offset:2048
s_add_u32 m0, s64, 38912
s_add_u32 s48, s91, 81920
v_mfma_f32_16x16x32_bf16 v[56:59], v[200:203], a[120:123], v[56:59]
buffer_load_dwordx4 v31, s[16:19], s48 offen lds
v_mfma_f32_16x16x32_bf16 v[120:123], v[200:203], a[128:131], v[120:123]
ds_read_b64_tr_b16 v[224:225], v21
ds_read_b64_tr_b16 v[226:227], v21 offset:2048
v_mfma_f32_16x16x32_bf16 v[172:175], v[204:207], a[136:139], v[172:175]
ds_read_b64_tr_b16 v[228:229], v12 offset:256
ds_read_b64_tr_b16 v[230:231], v12 offset:2304
v_mfma_f32_16x16x32_bf16 v[60:63], v[208:211], a[120:123], v[60:63]
ds_read_b64_tr_b16 v[232:233], v13 offset:256
v_mfma_f32_16x16x32_bf16 v[124:127], v[208:211], a[128:131], v[124:127]
ds_read_b64_tr_b16 v[234:235], v13 offset:2304
s_add_u32 m0, s64, 39936
s_add_u32 s48, s91, 98304
s_waitcnt lgkmcnt(4)
v_mfma_f32_16x16x32_bf16 v[64:67], v[212:215], a[120:123], v[64:67]
buffer_load_dwordx4 v30, s[16:19], s48 offen lds
ds_read_b64_tr_b16 v[236:237], v14 offset:256
v_mfma_f32_16x16x32_bf16 v[128:131], v[212:215], a[128:131], v[128:131]
ds_read_b64_tr_b16 v[238:239], v14 offset:2304
ds_read_b64_tr_b16 v[240:241], v15 offset:256
v_mfma_f32_16x16x32_bf16 v[68:71], v[216:219], a[120:123], v[68:71]
ds_read_b64_tr_b16 v[242:243], v15 offset:2304
v_mfma_f32_16x16x32_bf16 v[132:135], v[216:219], a[128:131], v[132:135]
ds_read_b64_tr_b16 v[244:245], v22
ds_read_b64_tr_b16 v[246:247], v22 offset:2048
s_add_u32 m0, s64, 40960
v_mfma_f32_16x16x32_bf16 v[72:75], v[220:223], a[120:123], v[72:75]
s_add_u32 s48, s91, 114688
buffer_load_dwordx4 v31, s[16:19], s48 offen lds
v_mfma_f32_16x16x32_bf16 v[136:139], v[220:223], a[128:131], v[136:139]
ds_read_b64_tr_b16 v[188:189], v16 offset:256
ds_read_b64_tr_b16 v[190:191], v16 offset:2304
v_mfma_f32_16x16x32_bf16 v[176:179], v[224:227], a[136:139], v[176:179]
ds_read_b64_tr_b16 v[192:193], v17 offset:256
s_waitcnt lgkmcnt(3)
v_mfma_f32_16x16x32_bf16 v[76:79], v[228:231], a[120:123], v[76:79]
ds_read_b64_tr_b16 v[194:195], v17 offset:2304
s_lshl_b32 s51, s44, 8
s_lshl_b32 s48, s43, 5
s_add_u32 s51, s51, s48
s_mul_i32 s51, s51, 896
s_mul_i32 s48, s3, 7168
v_mfma_f32_16x16x32_bf16 v[140:143], v[228:231], a[128:131], v[140:143]
s_add_u32 s51, s51, s48
s_add_u32 s48, s51, 3072
buffer_load_dwordx4 a[152:155], v1, s[24:27], s48 offen
v_mfma_f32_16x16x32_bf16 v[80:83], v[232:235], a[120:123], v[80:83]
ds_read_b64_tr_b16 v[196:197], v18 offset:256
v_mfma_f32_16x16x32_bf16 v[144:147], v[232:235], a[128:131], v[144:147]
ds_read_b64_tr_b16 v[198:199], v18 offset:2304
ds_read_b64_tr_b16 v[200:201], v19 offset:256
v_mfma_f32_16x16x32_bf16 v[84:87], v[236:239], a[120:123], v[84:87]
ds_read_b64_tr_b16 v[202:203], v19 offset:2304
ds_read_b64_tr_b16 v[204:205], v23
v_mfma_f32_16x16x32_bf16 v[148:151], v[236:239], a[128:131], v[148:151]
ds_read_b64_tr_b16 v[206:207], v23 offset:2048
s_add_u32 s90, s90, 1
s_cmp_eq_u32 s90, 7
s_cselect_b32 s90, 0, s90
v_mfma_f32_16x16x32_bf16 v[88:91], v[240:243], a[120:123], v[88:91]
s_lshl_b32 s91, s90, 19
s_add_u32 s91, s91, s54
s_lshl_b32 s92, s90, 7
s_add_u32 s92, s92, s65
s_add_u32 m0, s66, 40960
s_add_u32 s48, s92, 0
v_mfma_f32_16x16x32_bf16 v[152:155], v[240:243], a[128:131], v[152:155]
buffer_load_dwordx4 v32, s[20:23], s48 offen lds
v_mfma_f32_16x16x32_bf16 v[180:183], v[244:247], a[136:139], v[180:183]
ds_read_b64_tr_b16 v[208:209], v12 offset:16384
ds_read_b64_tr_b16 v[210:211], v12 offset:18432
s_waitcnt lgkmcnt(2)
v_mfma_f32_16x16x32_bf16 v[92:95], v[188:191], a[120:123], v[92:95]
ds_read_b64_tr_b16 v[212:213], v13 offset:16384
ds_read_b64_tr_b16 v[214:215], v13 offset:18432
v_mfma_f32_16x16x32_bf16 v[156:159], v[188:191], a[128:131], v[156:159]
s_add_u32 m0, s64, 67584
s_add_u32 s48, s91, 0
buffer_load_dwordx4 v28, s[16:19], s48 offen lds
v_mfma_f32_16x16x32_bf16 v[96:99], v[192:195], a[120:123], v[96:99]
ds_read_b64_tr_b16 v[216:217], v14 offset:16384
v_mfma_f32_16x16x32_bf16 v[160:163], v[192:195], a[128:131], v[160:163]
ds_read_b64_tr_b16 v[218:219], v14 offset:18432
ds_read_b64_tr_b16 v[220:221], v15 offset:16384
v_mfma_f32_16x16x32_bf16 v[100:103], v[196:199], a[120:123], v[100:103]
ds_read_b64_tr_b16 v[222:223], v15 offset:18432
ds_read_b64_tr_b16 v[224:225], v20 offset:16384
v_mfma_f32_16x16x32_bf16 v[164:167], v[196:199], a[128:131], v[164:167]
ds_read_b64_tr_b16 v[226:227], v20 offset:18432
s_add_u32 m0, s66, 41984
s_add_u32 s48, s92, 7168
v_mfma_f32_16x16x32_bf16 v[104:107], v[200:203], a[120:123], v[104:107]
buffer_load_dwordx4 v33, s[20:23], s48 offen lds
v_mfma_f32_16x16x32_bf16 v[168:171], v[200:203], a[128:131], v[168:171]
ds_read_b64_tr_b16 v[228:229], v16 offset:16384
ds_read_b64_tr_b16 v[230:231], v16 offset:18432
v_mfma_f32_16x16x32_bf16 v[184:187], v[204:207], a[136:139], v[184:187]
ds_read_b64_tr_b16 v[232:233], v17 offset:16384
ds_read_b64_tr_b16 v[234:235], v17 offset:18432
s_waitcnt lgkmcnt(4)
v_mfma_f32_16x16x32_bf16 v[44:47], v[208:211], a[124:127], v[44:47]
ds_read_b64_tr_b16 v[236:237], v18 offset:16384
v_mfma_f32_16x16x32_bf16 v[108:111], v[208:211], a[132:135], v[108:111]
ds_read_b64_tr_b16 v[238:239], v18 offset:18432
s_add_u32 m0, s64, 68608
s_add_u32 s48, s91, 16384
v_mfma_f32_16x16x32_bf16 v[48:51], v[212:215], a[124:127], v[48:51]
buffer_load_dwordx4 v29, s[16:19], s48 offen lds
ds_read_b64_tr_b16 v[240:241], v19 offset:16384
v_mfma_f32_16x16x32_bf16 v[112:115], v[212:215], a[132:135], v[112:115]
ds_read_b64_tr_b16 v[242:243], v19 offset:18432
ds_read_b64_tr_b16 v[244:245], v21 offset:16384
v_mfma_f32_16x16x32_bf16 v[52:55], v[216:219], a[124:127], v[52:55]
ds_read_b64_tr_b16 v[246:247], v21 offset:18432
s_add_u32 m0, s66, 43008
s_add_u32 s48, s92, 14336
v_mfma_f32_16x16x32_bf16 v[116:119], v[216:219], a[132:135], v[116:119]
buffer_load_dwordx4 v32, s[20:23], s48 offen lds
v_mfma_f32_16x16x32_bf16 v[56:59], v[220:223], a[124:127], v[56:59]
ds_read_b64_tr_b16 v[188:189], v12 offset:16640
ds_read_b64_tr_b16 v[190:191], v12 offset:18688
v_mfma_f32_16x16x32_bf16 v[120:123], v[220:223], a[132:135], v[120:123]
ds_read_b64_tr_b16 v[192:193], v13 offset:16640
ds_read_b64_tr_b16 v[194:195], v13 offset:18688
v_mfma_f32_16x16x32_bf16 v[172:175], v[224:227], a[140:143], v[172:175]
ds_read_b64_tr_b16 v[196:197], v14 offset:16640
s_waitcnt lgkmcnt(5)
v_mfma_f32_16x16x32_bf16 v[60:63], v[228:231], a[124:127], v[60:63]
ds_read_b64_tr_b16 v[198:199], v14 offset:18688
s_add_u32 m0, s64, 69632
s_add_u32 s48, s91, 32768
v_mfma_f32_16x16x32_bf16 v[124:127], v[228:231], a[132:135], v[124:127]
buffer_load_dwordx4 v28, s[16:19], s48 offen lds
ds_read_b64_tr_b16 v[200:201], v15 offset:16640
v_mfma_f32_16x16x32_bf16 v[64:67], v[232:235], a[124:127], v[64:67]
ds_read_b64_tr_b16 v[202:203], v15 offset:18688
ds_read_b64_tr_b16 v[204:205], v22 offset:16384
v_mfma_f32_16x16x32_bf16 v[128:131], v[232:235], a[132:135], v[128:131]
ds_read_b64_tr_b16 v[206:207], v22 offset:18432
v_mfma_f32_16x16x32_bf16 v[68:71], v[236:239], a[124:127], v[68:71]
ds_read_b64_tr_b16 v[208:209], v16 offset:16640
ds_read_b64_tr_b16 v[210:211], v16 offset:18688
s_add_u32 m0, s66, 44032
v_mfma_f32_16x16x32_bf16 v[132:135], v[236:239], a[132:135], v[132:135]
s_add_u32 s48, s92, 21504
buffer_load_dwordx4 v33, s[20:23], s48 offen lds
v_mfma_f32_16x16x32_bf16 v[72:75], v[240:243], a[124:127], v[72:75]
ds_read_b64_tr_b16 v[212:213], v17 offset:16640
ds_read_b64_tr_b16 v[214:215], v17 offset:18688
v_mfma_f32_16x16x32_bf16 v[136:139], v[240:243], a[132:135], v[136:139]
ds_read_b64_tr_b16 v[216:217], v18 offset:16640
v_mfma_f32_16x16x32_bf16 v[176:179], v[244:247], a[140:143], v[176:179]
ds_read_b64_tr_b16 v[218:219], v18 offset:18688
s_add_u32 m0, s64, 70656
s_add_u32 s48, s91, 49152
s_waitcnt lgkmcnt(4)
v_mfma_f32_16x16x32_bf16 v[76:79], v[188:191], a[124:127], v[76:79]
buffer_load_dwordx4 v29, s[16:19], s48 offen lds
ds_read_b64_tr_b16 v[220:221], v19 offset:16640
v_mfma_f32_16x16x32_bf16 v[140:143], v[188:191], a[132:135], v[140:143]
ds_read_b64_tr_b16 v[222:223], v19 offset:18688
ds_read_b64_tr_b16 v[224:225], v23 offset:16384
v_mfma_f32_16x16x32_bf16 v[80:83], v[192:195], a[124:127], v[80:83]
ds_read_b64_tr_b16 v[226:227], v23 offset:18432
s_add_u32 m0, s66, 45056
s_add_u32 s48, s92, 28672
v_mfma_f32_16x16x32_bf16 v[144:147], v[192:195], a[132:135], v[144:147]
buffer_load_dwordx4 v32, s[20:23], s48 offen lds
v_mfma_f32_16x16x32_bf16 v[84:87], v[196:199], a[124:127], v[84:87]
v_add_u32 v12, 33792, v12
v_add_u32 v13, 33792, v13
v_mfma_f32_16x16x32_bf16 v[148:151], v[196:199], a[132:135], v[148:151]
v_add_u32 v14, 33792, v14
v_add_u32 v15, 33792, v15
v_mfma_f32_16x16x32_bf16 v[88:91], v[200:203], a[124:127], v[88:91]
v_add_u32 v16, 33792, v16
v_mfma_f32_16x16x32_bf16 v[152:155], v[200:203], a[132:135], v[152:155]
v_add_u32 v17, 33792, v17
v_add_u32 v18, 33792, v18
v_mfma_f32_16x16x32_bf16 v[180:183], v[204:207], a[140:143], v[180:183]
v_add_u32 v19, 33792, v19
v_add_u32 v20, 33792, v20
v_mfma_f32_16x16x32_bf16 v[92:95], v[208:211], a[124:127], v[92:95]
v_add_u32 v21, 33792, v21
v_mfma_f32_16x16x32_bf16 v[156:159], v[208:211], a[132:135], v[156:159]
v_add_u32 v22, 33792, v22
v_add_u32 v23, 33792, v23
L_stage4:
s_waitcnt vmcnt(10)
s_waitcnt lgkmcnt(0)
s_barrier
ds_read_b128 a[96:99], v24 offset:20480
ds_read_b128 a[104:107], v24 offset:22528
v_mfma_f32_16x16x32_bf16 v[96:99], v[212:215], a[124:127], v[96:99]
ds_read_b128 a[112:115], v26 offset:20480
ds_read_b128 a[100:103], v25 offset:20480
ds_read_b128 a[108:111], v25 offset:22528
v_mfma_f32_16x16x32_bf16 v[160:163], v[212:215], a[132:135], v[160:163]
ds_read_b128 a[116:119], v27 offset:20480
ds_read_b64_tr_b16 v[228:229], v12
ds_read_b64_tr_b16 v[230:231], v12 offset:2048
v_mfma_f32_16x16x32_bf16 v[100:103], v[216:219], a[124:127], v[100:103]
ds_read_b64_tr_b16 v[232:233], v13
v_mfma_f32_16x16x32_bf16 v[164:167], v[216:219], a[132:135], v[164:167]
ds_read_b64_tr_b16 v[234:235], v13 offset:2048
ds_read_b64_tr_b16 v[236:237], v14
v_mfma_f32_16x16x32_bf16 v[104:107], v[220:223], a[124:127], v[104:107]
ds_read_b64_tr_b16 v[238:239], v14 offset:2048
ds_read_b64_tr_b16 v[240:241], v15
v_mfma_f32_16x16x32_bf16 v[168:171], v[220:223], a[132:135], v[168:171]
ds_read_b64_tr_b16 v[242:243], v15 offset:2048
v_mfma_f32_16x16x32_bf16 v[184:187], v[224:227], a[140:143], v[184:187]
ds_read_b64_tr_b16 v[244:245], v20
ds_read_b64_tr_b16 v[246:247], v20 offset:2048
s_waitcnt lgkmcnt(6)
v_mfma_f32_16x16x32_bf16 v[44:47], v[228:231], a[96:99], v[44:47]
ds_read_b64_tr_b16 v[188:189], v16
ds_read_b64_tr_b16 v[190:191], v16 offset:2048
v_mfma_f32_16x16x32_bf16 v[108:111], v[228:231], a[104:107], v[108:111]
s_add_u32 m0, s64, 71680
s_add_u32 s48, s91, 65536
buffer_load_dwordx4 v30, s[16:19], s48 offen lds
v_mfma_f32_16x16x32_bf16 v[48:51], v[232:235], a[96:99], v[48:51]
ds_read_b64_tr_b16 v[192:193], v17
v_mfma_f32_16x16x32_bf16 v[112:115], v[232:235], a[104:107], v[112:115]
ds_read_b64_tr_b16 v[194:195], v17 offset:2048
ds_read_b64_tr_b16 v[196:197], v18
s_waitcnt lgkmcnt(3)
v_mfma_f32_16x16x32_bf16 v[52:55], v[236:239], a[96:99], v[52:55]
ds_read_b64_tr_b16 v[198:199], v18 offset:2048
ds_read_b64_tr_b16 v[200:201], v19
v_mfma_f32_16x16x32_bf16 v[116:119], v[236:239], a[104:107], v[116:119]
ds_read_b64_tr_b16 v[202:203], v19 offset:2048
s_add_u32 m0, s64, 72704
s_add_u32 s48, s91, 81920
v_mfma_f32_16x16x32_bf16 v[56:59], v[240:243], a[96:99], v[56:59]
buffer_load_dwordx4 v31, s[16:19], s48 offen lds
v_mfma_f32_16x16x32_bf16 v[120:123], v[240:243], a[104:107], v[120:123]
ds_read_b64_tr_b16 v[204:205], v21
ds_read_b64_tr_b16 v[206:207], v21 offset:2048
v_mfma_f32_16x16x32_bf16 v[172:175], v[244:247], a[112:115], v[172:175]
ds_read_b64_tr_b16 v[208:209], v12 offset:256
ds_read_b64_tr_b16 v[210:211], v12 offset:2304
v_mfma_f32_16x16x32_bf16 v[60:63], v[188:191], a[96:99], v[60:63]
ds_read_b64_tr_b16 v[212:213], v13 offset:256
v_mfma_f32_16x16x32_bf16 v[124:127], v[188:191], a[104:107], v[124:127]
ds_read_b64_tr_b16 v[214:215], v13 offset:2304
s_add_u32 m0, s64, 73728
s_add_u32 s48, s91, 98304
s_waitcnt lgkmcnt(4)
v_mfma_f32_16x16x32_bf16 v[64:67], v[192:195], a[96:99], v[64:67]
buffer_load_dwordx4 v30, s[16:19], s48 offen lds
ds_read_b64_tr_b16 v[216:217], v14 offset:256
v_mfma_f32_16x16x32_bf16 v[128:131], v[192:195], a[104:107], v[128:131]
ds_read_b64_tr_b16 v[218:219], v14 offset:2304
ds_read_b64_tr_b16 v[220:221], v15 offset:256
v_mfma_f32_16x16x32_bf16 v[68:71], v[196:199], a[96:99], v[68:71]
ds_read_b64_tr_b16 v[222:223], v15 offset:2304
v_mfma_f32_16x16x32_bf16 v[132:135], v[196:199], a[104:107], v[132:135]
ds_read_b64_tr_b16 v[224:225], v22
ds_read_b64_tr_b16 v[226:227], v22 offset:2048
s_add_u32 m0, s64, 74752
v_mfma_f32_16x16x32_bf16 v[72:75], v[200:203], a[96:99], v[72:75]
s_add_u32 s48, s91, 114688
buffer_load_dwordx4 v31, s[16:19], s48 offen lds
v_mfma_f32_16x16x32_bf16 v[136:139], v[200:203], a[104:107], v[136:139]
ds_read_b64_tr_b16 v[228:229], v16 offset:256
ds_read_b64_tr_b16 v[230:231], v16 offset:2304
v_mfma_f32_16x16x32_bf16 v[176:179], v[204:207], a[112:115], v[176:179]
ds_read_b64_tr_b16 v[232:233], v17 offset:256
s_waitcnt lgkmcnt(3)
v_mfma_f32_16x16x32_bf16 v[76:79], v[208:211], a[96:99], v[76:79]
ds_read_b64_tr_b16 v[234:235], v17 offset:2304
s_lshl_b32 s51, s44, 8
s_lshl_b32 s48, s43, 5
s_add_u32 s51, s51, s48
s_mul_i32 s51, s51, 896
s_mul_i32 s48, s3, 7168
v_mfma_f32_16x16x32_bf16 v[140:143], v[208:211], a[104:107], v[140:143]
s_add_u32 s51, s51, s48
s_add_u32 s48, s51, 4096
buffer_load_dwordx4 a[148:151], v1, s[24:27], s48 offen
v_mfma_f32_16x16x32_bf16 v[80:83], v[212:215], a[96:99], v[80:83]
ds_read_b64_tr_b16 v[236:237], v18 offset:256
v_mfma_f32_16x16x32_bf16 v[144:147], v[212:215], a[104:107], v[144:147]
ds_read_b64_tr_b16 v[238:239], v18 offset:2304
ds_read_b64_tr_b16 v[240:241], v19 offset:256
v_mfma_f32_16x16x32_bf16 v[84:87], v[216:219], a[96:99], v[84:87]
ds_read_b64_tr_b16 v[242:243], v19 offset:2304
ds_read_b64_tr_b16 v[244:245], v23
v_mfma_f32_16x16x32_bf16 v[148:151], v[216:219], a[104:107], v[148:151]
ds_read_b64_tr_b16 v[246:247], v23 offset:2048
s_add_u32 s90, s90, 1
s_cmp_eq_u32 s90, 7
s_cselect_b32 s90, 0, s90
v_mfma_f32_16x16x32_bf16 v[88:91], v[220:223], a[96:99], v[88:91]
s_lshl_b32 s91, s90, 19
s_add_u32 s91, s91, s54
s_lshl_b32 s92, s90, 7
s_add_u32 s92, s92, s65
s_add_u32 m0, s66, 0
s_add_u32 s48, s92, 0
v_mfma_f32_16x16x32_bf16 v[152:155], v[220:223], a[104:107], v[152:155]
buffer_load_dwordx4 v32, s[20:23], s48 offen lds
v_mfma_f32_16x16x32_bf16 v[180:183], v[224:227], a[112:115], v[180:183]
ds_read_b64_tr_b16 v[188:189], v12 offset:16384
ds_read_b64_tr_b16 v[190:191], v12 offset:18432
s_waitcnt lgkmcnt(2)
v_mfma_f32_16x16x32_bf16 v[92:95], v[228:231], a[96:99], v[92:95]
ds_read_b64_tr_b16 v[192:193], v13 offset:16384
ds_read_b64_tr_b16 v[194:195], v13 offset:18432
v_mfma_f32_16x16x32_bf16 v[156:159], v[228:231], a[104:107], v[156:159]
s_add_u32 m0, s64, 0
s_add_u32 s48, s91, 0
buffer_load_dwordx4 v28, s[16:19], s48 offen lds
v_mfma_f32_16x16x32_bf16 v[96:99], v[232:235], a[96:99], v[96:99]
ds_read_b64_tr_b16 v[196:197], v14 offset:16384
v_mfma_f32_16x16x32_bf16 v[160:163], v[232:235], a[104:107], v[160:163]
ds_read_b64_tr_b16 v[198:199], v14 offset:18432
ds_read_b64_tr_b16 v[200:201], v15 offset:16384
v_mfma_f32_16x16x32_bf16 v[100:103], v[236:239], a[96:99], v[100:103]
ds_read_b64_tr_b16 v[202:203], v15 offset:18432
ds_read_b64_tr_b16 v[204:205], v20 offset:16384
v_mfma_f32_16x16x32_bf16 v[164:167], v[236:239], a[104:107], v[164:167]
ds_read_b64_tr_b16 v[206:207], v20 offset:18432
s_add_u32 m0, s66, 1024
s_add_u32 s48, s92, 7168
v_mfma_f32_16x16x32_bf16 v[104:107], v[240:243], a[96:99], v[104:107]
buffer_load_dwordx4 v33, s[20:23], s48 offen lds
v_mfma_f32_16x16x32_bf16 v[168:171], v[240:243], a[104:107], v[168:171]
ds_read_b64_tr_b16 v[208:209], v16 offset:16384
ds_read_b64_tr_b16 v[210:211], v16 offset:18432
v_mfma_f32_16x16x32_bf16 v[184:187], v[244:247], a[112:115], v[184:187]
ds_read_b64_tr_b16 v[212:213], v17 offset:16384
ds_read_b64_tr_b16 v[214:215], v17 offset:18432
s_waitcnt lgkmcnt(4)
v_mfma_f32_16x16x32_bf16 v[44:47], v[188:191], a[100:103], v[44:47]
ds_read_b64_tr_b16 v[216:217], v18 offset:16384
v_mfma_f32_16x16x32_bf16 v[108:111], v[188:191], a[108:111], v[108:111]
ds_read_b64_tr_b16 v[218:219], v18 offset:18432
s_add_u32 m0, s64, 1024
s_add_u32 s48, s91, 16384
v_mfma_f32_16x16x32_bf16 v[48:51], v[192:195], a[100:103], v[48:51]
buffer_load_dwordx4 v29, s[16:19], s48 offen lds
ds_read_b64_tr_b16 v[220:221], v19 offset:16384
v_mfma_f32_16x16x32_bf16 v[112:115], v[192:195], a[108:111], v[112:115]
ds_read_b64_tr_b16 v[222:223], v19 offset:18432
ds_read_b64_tr_b16 v[224:225], v21 offset:16384
v_mfma_f32_16x16x32_bf16 v[52:55], v[196:199], a[100:103], v[52:55]
ds_read_b64_tr_b16 v[226:227], v21 offset:18432
s_add_u32 m0, s66, 2048
s_add_u32 s48, s92, 14336
v_mfma_f32_16x16x32_bf16 v[116:119], v[196:199], a[108:111], v[116:119]
buffer_load_dwordx4 v32, s[20:23], s48 offen lds
v_mfma_f32_16x16x32_bf16 v[56:59], v[200:203], a[100:103], v[56:59]
ds_read_b64_tr_b16 v[228:229], v12 offset:16640
ds_read_b64_tr_b16 v[230:231], v12 offset:18688
v_mfma_f32_16x16x32_bf16 v[120:123], v[200:203], a[108:111], v[120:123]
ds_read_b64_tr_b16 v[232:233], v13 offset:16640
ds_read_b64_tr_b16 v[234:235], v13 offset:18688
v_mfma_f32_16x16x32_bf16 v[172:175], v[204:207], a[116:119], v[172:175]
ds_read_b64_tr_b16 v[236:237], v14 offset:16640
s_waitcnt lgkmcnt(5)
v_mfma_f32_16x16x32_bf16 v[60:63], v[208:211], a[100:103], v[60:63]
ds_read_b64_tr_b16 v[238:239], v14 offset:18688
s_add_u32 m0, s64, 2048
s_add_u32 s48, s91, 32768
v_mfma_f32_16x16x32_bf16 v[124:127], v[208:211], a[108:111], v[124:127]
buffer_load_dwordx4 v28, s[16:19], s48 offen lds
ds_read_b64_tr_b16 v[240:241], v15 offset:16640
v_mfma_f32_16x16x32_bf16 v[64:67], v[212:215], a[100:103], v[64:67]
ds_read_b64_tr_b16 v[242:243], v15 offset:18688
ds_read_b64_tr_b16 v[244:245], v22 offset:16384
v_mfma_f32_16x16x32_bf16 v[128:131], v[212:215], a[108:111], v[128:131]
ds_read_b64_tr_b16 v[246:247], v22 offset:18432
v_mfma_f32_16x16x32_bf16 v[68:71], v[216:219], a[100:103], v[68:71]
ds_read_b64_tr_b16 v[188:189], v16 offset:16640
ds_read_b64_tr_b16 v[190:191], v16 offset:18688
s_add_u32 m0, s66, 3072
v_mfma_f32_16x16x32_bf16 v[132:135], v[216:219], a[108:111], v[132:135]
s_add_u32 s48, s92, 21504
buffer_load_dwordx4 v33, s[20:23], s48 offen lds
v_mfma_f32_16x16x32_bf16 v[72:75], v[220:223], a[100:103], v[72:75]
ds_read_b64_tr_b16 v[192:193], v17 offset:16640
ds_read_b64_tr_b16 v[194:195], v17 offset:18688
v_mfma_f32_16x16x32_bf16 v[136:139], v[220:223], a[108:111], v[136:139]
ds_read_b64_tr_b16 v[196:197], v18 offset:16640
v_mfma_f32_16x16x32_bf16 v[176:179], v[224:227], a[116:119], v[176:179]
ds_read_b64_tr_b16 v[198:199], v18 offset:18688
s_add_u32 m0, s64, 3072
s_add_u32 s48, s91, 49152
s_waitcnt lgkmcnt(4)
v_mfma_f32_16x16x32_bf16 v[76:79], v[228:231], a[100:103], v[76:79]
buffer_load_dwordx4 v29, s[16:19], s48 offen lds
ds_read_b64_tr_b16 v[200:201], v19 offset:16640
v_mfma_f32_16x16x32_bf16 v[140:143], v[228:231], a[108:111], v[140:143]
ds_read_b64_tr_b16 v[202:203], v19 offset:18688
ds_read_b64_tr_b16 v[204:205], v23 offset:16384
v_mfma_f32_16x16x32_bf16 v[80:83], v[232:235], a[100:103], v[80:83]
ds_read_b64_tr_b16 v[206:207], v23 offset:18432
s_add_u32 m0, s66, 4096
s_add_u32 s48, s92, 28672
v_mfma_f32_16x16x32_bf16 v[144:147], v[232:235], a[108:111], v[144:147]
buffer_load_dwordx4 v32, s[20:23], s48 offen lds
v_mfma_f32_16x16x32_bf16 v[84:87], v[236:239], a[100:103], v[84:87]
v_add_u32 v12, 33792, v12
v_add_u32 v13, 33792, v13
v_mfma_f32_16x16x32_bf16 v[148:151], v[236:239], a[108:111], v[148:151]
v_add_u32 v14, 33792, v14
v_add_u32 v15, 33792, v15
v_mfma_f32_16x16x32_bf16 v[88:91], v[240:243], a[100:103], v[88:91]
v_add_u32 v16, 33792, v16
v_mfma_f32_16x16x32_bf16 v[152:155], v[240:243], a[108:111], v[152:155]
v_add_u32 v17, 33792, v17
v_add_u32 v18, 33792, v18
v_mfma_f32_16x16x32_bf16 v[180:183], v[244:247], a[116:119], v[180:183]
v_add_u32 v19, 33792, v19
v_add_u32 v20, 33792, v20
v_mfma_f32_16x16x32_bf16 v[92:95], v[188:191], a[100:103], v[92:95]
v_add_u32 v21, 33792, v21
v_mfma_f32_16x16x32_bf16 v[156:159], v[188:191], a[108:111], v[156:159]
v_add_u32 v22, 33792, v22
v_add_u32 v23, 33792, v23
L_stage5:
s_waitcnt vmcnt(10)
s_waitcnt lgkmcnt(0)
s_barrier
ds_read_b128 a[120:123], v24 offset:40960
ds_read_b128 a[128:131], v24 offset:43008
v_mfma_f32_16x16x32_bf16 v[96:99], v[192:195], a[100:103], v[96:99]
ds_read_b128 a[136:139], v26 offset:40960
ds_read_b128 a[124:127], v25 offset:40960
ds_read_b128 a[132:135], v25 offset:43008
v_mfma_f32_16x16x32_bf16 v[160:163], v[192:195], a[108:111], v[160:163]
ds_read_b128 a[140:143], v27 offset:40960
ds_read_b64_tr_b16 v[208:209], v12
ds_read_b64_tr_b16 v[210:211], v12 offset:2048
v_mfma_f32_16x16x32_bf16 v[100:103], v[196:199], a[100:103], v[100:103]
ds_read_b64_tr_b16 v[212:213], v13
v_mfma_f32_16x16x32_bf16 v[164:167], v[196:199], a[108:111], v[164:167]
ds_read_b64_tr_b16 v[214:215], v13 offset:2048
ds_read_b64_tr_b16 v[216:217], v14
v_mfma_f32_16x16x32_bf16 v[104:107], v[200:203], a[100:103], v[104:107]
ds_read_b64_tr_b16 v[218:219], v14 offset:2048
v_mfma_f32_16x16x32_bf16 v[168:171], v[200:203], a[108:111], v[168:171]
ds_read_b64_tr_b16 v[220:221], v15
ds_read_b64_tr_b16 v[222:223], v15 offset:2048
v_mfma_f32_16x16x32_bf16 v[184:187], v[204:207], a[116:119], v[184:187]
ds_read_b64_tr_b16 v[224:225], v20
s_waitcnt lgkmcnt(6)
v_mfma_f32_16x16x32_bf16 v[44:47], v[208:211], a[120:123], v[44:47]
ds_read_b64_tr_b16 v[226:227], v20 offset:2048
ds_read_b64_tr_b16 v[228:229], v16
v_mfma_f32_16x16x32_bf16 v[108:111], v[208:211], a[128:131], v[108:111]
ds_read_b64_tr_b16 v[230:231], v16 offset:2048
s_add_u32 m0, s64, 4096
s_add_u32 s48, s91, 65536
s_waitcnt lgkmcnt(4)
v_mfma_f32_16x16x32_bf16 v[48:51], v[212:215], a[120:123], v[48:51]
buffer_load_dwordx4 v30, s[16:19], s48 offen lds
ds_read_b64_tr_b16 v[232:233], v17
v_mfma_f32_16x16x32_bf16 v[112:115], v[212:215], a[128:131], v[112:115]
ds_read_b64_tr_b16 v[234:235], v17 offset:2048
v_mfma_f32_16x16x32_bf16 v[52:55], v[216:219], a[120:123], v[52:55]
ds_read_b64_tr_b16 v[236:237], v18
ds_read_b64_tr_b16 v[238:239], v18 offset:2048
v_mfma_f32_16x16x32_bf16 v[116:119], v[216:219], a[128:131], v[116:119]
ds_read_b64_tr_b16 v[240:241], v19
v_mfma_f32_16x16x32_bf16 v[56:59], v[220:223], a[120:123], v[56:59]
ds_read_b64_tr_b16 v[242:243], v19 offset:2048
ds_read_b64_tr_b16 v[244:245], v21
v_mfma_f32_16x16x32_bf16 v[120:123], v[220:223], a[128:131], v[120:123]
ds_read_b64_tr_b16 v[246:247], v21 offset:2048
s_add_u32 m0, s64, 5120
s_add_u32 s48, s91, 81920
s_waitcnt lgkmcnt(4)
v_mfma_f32_16x16x32_bf16 v[172:175], v[224:227], a[136:139], v[172:175]
buffer_load_dwordx4 v31, s[16:19], s48 offen lds
v_mfma_f32_16x16x32_bf16 v[60:63], v[228:231], a[120:123], v[60:63]
ds_read_b64_tr_b16 v[188:189], v12 offset:256
ds_read_b64_tr_b16 v[190:191], v12 offset:2304
v_mfma_f32_16x16x32_bf16 v[124:127], v[228:231], a[128:131], v[124:127]
ds_read_b64_tr_b16 v[192:193], v13 offset:256
v_mfma_f32_16x16x32_bf16 v[64:67], v[232:235], a[120:123], v[64:67]
ds_read_b64_tr_b16 v[194:195], v13 offset:2304
ds_read_b64_tr_b16 v[196:197], v14 offset:256
v_mfma_f32_16x16x32_bf16 v[128:131], v[232:235], a[128:131], v[128:131]
ds_read_b64_tr_b16 v[198:199], v14 offset:2304
s_add_u32 m0, s64, 6144
s_add_u32 s48, s91, 98304
v_mfma_f32_16x16x32_bf16 v[68:71], v[236:239], a[120:123], v[68:71]
buffer_load_dwordx4 v30, s[16:19], s48 offen lds
ds_read_b64_tr_b16 v[200:201], v15 offset:256
v_mfma_f32_16x16x32_bf16 v[132:135], v[236:239], a[128:131], v[132:135]
ds_read_b64_tr_b16 v[202:203], v15 offset:2304
s_waitcnt lgkmcnt(3)
v_mfma_f32_16x16x32_bf16 v[72:75], v[240:243], a[120:123], v[72:75]
ds_read_b64_tr_b16 v[204:205], v22
ds_read_b64_tr_b16 v[206:207], v22 offset:2048
v_mfma_f32_16x16x32_bf16 v[136:139], v[240:243], a[128:131], v[136:139]
ds_read_b64_tr_b16 v[208:209], v16 offset:256
v_mfma_f32_16x16x32_bf16 v[176:179], v[244:247], a[136:139], v[176:179]
ds_read_b64_tr_b16 v[210:211], v16 offset:2304
ds_read_b64_tr_b16 v[212:213], v17 offset:256
v_mfma_f32_16x16x32_bf16 v[76:79], v[188:191], a[120:123], v[76:79]
ds_read_b64_tr_b16 v[214:215], v17 offset:2304
s_add_u32 m0, s64, 7168
s_add_u32 s48, s91, 114688
v_mfma_f32_16x16x32_bf16 v[140:143], v[188:191], a[128:131], v[140:143]
buffer_load_dwordx4 v31, s[16:19], s48 offen lds
v_mfma_f32_16x16x32_bf16 v[80:83], v[192:195], a[120:123], v[80:83]
ds_read_b64_tr_b16 v[216:217], v18 offset:256
ds_read_b64_tr_b16 v[218:219], v18 offset:2304
v_mfma_f32_16x16x32_bf16 v[144:147], v[192:195], a[128:131], v[144:147]
ds_read_b64_tr_b16 v[220:221], v19 offset:256
s_waitcnt lgkmcnt(3)
v_mfma_f32_16x16x32_bf16 v[84:87], v[196:199], a[120:123], v[84:87]
ds_read_b64_tr_b16 v[222:223], v19 offset:2304
ds_read_b64_tr_b16 v[224:225], v23
v_mfma_f32_16x16x32_bf16 v[148:151], v[196:199], a[128:131], v[148:151]
ds_read_b64_tr_b16 v[226:227], v23 offset:2048
s_lshl_b32 s51, s44, 8
s_lshl_b32 s48, s43, 5
s_add_u32 s51, s51, s48
v_mfma_f32_16x16x32_bf16 v[88:91], v[200:203], a[120:123], v[88:91]
s_mul_i32 s51, s51, 896
s_mul_i32 s48, s3, 7168
s_add_u32 s51, s51, s48
s_add_u32 s48, s51, 5120
v_mfma_f32_16x16x32_bf16 v[152:155], v[200:203], a[128:131], v[152:155]
buffer_load_dwordx4 a[152:155], v1, s[24:27], s48 offen
ds_read_b64_tr_b16 v[228:229], v12 offset:16384
v_mfma_f32_16x16x32_bf16 v[180:183], v[204:207], a[136:139], v[180:183]
ds_read_b64_tr_b16 v[230:231], v12 offset:18432
v_mfma_f32_16x16x32_bf16 v[92:95], v[208:211], a[120:123], v[92:95]
ds_read_b64_tr_b16 v[232:233], v13 offset:16384
ds_read_b64_tr_b16 v[234:235], v13 offset:18432
v_mfma_f32_16x16x32_bf16 v[156:159], v[208:211], a[128:131], v[156:159]
ds_read_b64_tr_b16 v[236:237], v14 offset:16384
v_mfma_f32_16x16x32_bf16 v[96:99], v[212:215], a[120:123], v[96:99]
ds_read_b64_tr_b16 v[238:239], v14 offset:18432
s_add_u32 m0, s49, 33792
s_add_u32 s48, s55, 0
v_mfma_f32_16x16x32_bf16 v[160:163], v[212:215], a[128:131], v[160:163]
buffer_load_dwordx4 v3, s[8:11], s48 offen nt lds
ds_read_b64_tr_b16 v[240:241], v15 offset:16384
s_waitcnt lgkmcnt(3)
v_mfma_f32_16x16x32_bf16 v[100:103], v[216:219], a[120:123], v[100:103]
ds_read_b64_tr_b16 v[242:243], v15 offset:18432
ds_read_b64_tr_b16 v[244:245], v20 offset:16384
v_mfma_f32_16x16x32_bf16 v[164:167], v[216:219], a[128:131], v[164:167]
ds_read_b64_tr_b16 v[246:247], v20 offset:18432
v_mfma_f32_16x16x32_bf16 v[104:107], v[220:223], a[120:123], v[104:107]
ds_read_b64_tr_b16 v[188:189], v16 offset:16384
ds_read_b64_tr_b16 v[190:191], v16 offset:18432
v_mfma_f32_16x16x32_bf16 v[168:171], v[220:223], a[128:131], v[168:171]
ds_read_b64_tr_b16 v[192:193], v17 offset:16384
v_mfma_f32_16x16x32_bf16 v[184:187], v[224:227], a[136:139], v[184:187]
ds_read_b64_tr_b16 v[194:195], v17 offset:18432
s_add_u32 m0, s49, 34848
s_add_u32 s48, s55, 1024
v_mfma_f32_16x16x32_bf16 v[44:47], v[228:231], a[124:127], v[44:47]
buffer_load_dwordx4 v3, s[8:11], s48 offen nt lds
ds_read_b64_tr_b16 v[196:197], v18 offset:16384
v_mfma_f32_16x16x32_bf16 v[108:111], v[228:231], a[132:135], v[108:111]
ds_read_b64_tr_b16 v[198:199], v18 offset:18432
v_mfma_f32_16x16x32_bf16 v[48:51], v[232:235], a[124:127], v[48:51]
ds_read_b64_tr_b16 v[200:201], v19 offset:16384
ds_read_b64_tr_b16 v[202:203], v19 offset:18432
v_mfma_f32_16x16x32_bf16 v[112:115], v[232:235], a[132:135], v[112:115]
ds_read_b64_tr_b16 v[204:205], v21 offset:16384
s_waitcnt lgkmcnt(5)
v_mfma_f32_16x16x32_bf16 v[52:55], v[236:239], a[124:127], v[52:55]
ds_read_b64_tr_b16 v[206:207], v21 offset:18432
s_add_u32 m0, s49, 35904
s_add_u32 s48, s55, 2048
v_mfma_f32_16x16x32_bf16 v[116:119], v[236:239], a[132:135], v[116:119]
buffer_load_dwordx4 v3, s[8:11], s48 offen nt lds
ds_read_b64_tr_b16 v[208:209], v12 offset:16640
v_mfma_f32_16x16x32_bf16 v[56:59], v[240:243], a[124:127], v[56:59]
ds_read_b64_tr_b16 v[210:211], v12 offset:18688
v_mfma_f32_16x16x32_bf16 v[120:123], v[240:243], a[132:135], v[120:123]
ds_read_b64_tr_b16 v[212:213], v13 offset:16640
ds_read_b64_tr_b16 v[214:215], v13 offset:18688
v_mfma_f32_16x16x32_bf16 v[172:175], v[244:247], a[140:143], v[172:175]
ds_read_b64_tr_b16 v[216:217], v14 offset:16640
ds_read_b64_tr_b16 v[218:219], v14 offset:18688
v_mfma_f32_16x16x32_bf16 v[60:63], v[188:191], a[124:127], v[60:63]
s_add_u32 m0, s49, 36960
s_add_u32 s48, s55, 3072
buffer_load_dwordx4 v3, s[8:11], s48 offen nt lds
v_mfma_f32_16x16x32_bf16 v[124:127], v[188:191], a[132:135], v[124:127]
ds_read_b64_tr_b16 v[220:221], v15 offset:16640
v_mfma_f32_16x16x32_bf16 v[64:67], v[192:195], a[124:127], v[64:67]
ds_read_b64_tr_b16 v[222:223], v15 offset:18688
ds_read_b64_tr_b16 v[224:225], v22 offset:16384
v_mfma_f32_16x16x32_bf16 v[128:131], v[192:195], a[132:135], v[128:131]
ds_read_b64_tr_b16 v[226:227], v22 offset:18432
s_waitcnt lgkmcnt(4)
v_mfma_f32_16x16x32_bf16 v[68:71], v[196:199], a[124:127], v[68:71]
ds_read_b64_tr_b16 v[228:229], v16 offset:16640
ds_read_b64_tr_b16 v[230:231], v16 offset:18688
v_mfma_f32_16x16x32_bf16 v[132:135], v[196:199], a[132:135], v[132:135]
ds_read_b64_tr_b16 v[232:233], v17 offset:16640
v_mfma_f32_16x16x32_bf16 v[72:75], v[200:203], a[124:127], v[72:75]
ds_read_b64_tr_b16 v[234:235], v17 offset:18688
s_add_u32 m0, s49, 38016
s_add_u32 s48, s55, 4096
v_mfma_f32_16x16x32_bf16 v[136:139], v[200:203], a[132:135], v[136:139]
buffer_load_dwordx4 v3, s[8:11], s48 offen nt lds
ds_read_b64_tr_b16 v[236:237], v18 offset:16640
v_mfma_f32_16x16x32_bf16 v[176:179], v[204:207], a[140:143], v[176:179]
ds_read_b64_tr_b16 v[238:239], v18 offset:18688
v_mfma_f32_16x16x32_bf16 v[76:79], v[208:211], a[124:127], v[76:79]
ds_read_b64_tr_b16 v[240:241], v19 offset:16640
ds_read_b64_tr_b16 v[242:243], v19 offset:18688
v_mfma_f32_16x16x32_bf16 v[140:143], v[208:211], a[132:135], v[140:143]
ds_read_b64_tr_b16 v[244:245], v23 offset:16384
v_mfma_f32_16x16x32_bf16 v[80:83], v[212:215], a[124:127], v[80:83]
ds_read_b64_tr_b16 v[246:247], v23 offset:18432
s_add_u32 m0, s49, 39072
s_add_u32 s48, s55, 5120
v_mfma_f32_16x16x32_bf16 v[144:147], v[212:215], a[132:135], v[144:147]
buffer_load_dwordx4 v3, s[8:11], s48 offen nt lds
v_subrev_u32 v12, 67584, v12
v_mfma_f32_16x16x32_bf16 v[84:87], v[216:219], a[124:127], v[84:87]
v_subrev_u32 v13, 67584, v13
v_subrev_u32 v14, 67584, v14
v_mfma_f32_16x16x32_bf16 v[148:151], v[216:219], a[132:135], v[148:151]
v_subrev_u32 v15, 67584, v15
s_waitcnt lgkmcnt(0)
v_mfma_f32_16x16x32_bf16 v[88:91], v[220:223], a[124:127], v[88:91]
v_subrev_u32 v16, 67584, v16
v_subrev_u32 v17, 67584, v17
v_mfma_f32_16x16x32_bf16 v[152:155], v[220:223], a[132:135], v[152:155]
v_subrev_u32 v18, 67584, v18
v_mfma_f32_16x16x32_bf16 v[180:183], v[224:227], a[140:143], v[180:183]
v_subrev_u32 v19, 67584, v19
v_subrev_u32 v20, 67584, v20
v_mfma_f32_16x16x32_bf16 v[92:95], v[228:231], a[124:127], v[92:95]
v_subrev_u32 v21, 67584, v21
v_mfma_f32_16x16x32_bf16 v[156:159], v[228:231], a[132:135], v[156:159]
v_subrev_u32 v22, 67584, v22
v_subrev_u32 v23, 67584, v23
L_stage6:
s_waitcnt vmcnt(7)
s_barrier
ds_read_b128 a[96:99], v24
ds_read_b128 a[104:107], v24 offset:2048
ds_read_b128 a[112:115], v26
v_mfma_f32_16x16x32_bf16 v[96:99], v[232:235], a[124:127], v[96:99]
ds_read_b128 a[100:103], v25
ds_read_b128 a[108:111], v25 offset:2048
ds_read_b128 a[116:119], v27
ds_read_b64_tr_b16 v[188:189], v20
v_mfma_f32_16x16x32_bf16 v[160:163], v[232:235], a[132:135], v[160:163]
ds_read_b64_tr_b16 v[190:191], v20 offset:2048
ds_read_b64_tr_b16 v[192:193], v21
ds_read_b64_tr_b16 v[194:195], v21 offset:2048
v_mfma_f32_16x16x32_bf16 v[100:103], v[236:239], a[124:127], v[100:103]
ds_read_b64_tr_b16 v[196:197], v22
ds_read_b64_tr_b16 v[198:199], v22 offset:2048
ds_read_b64_tr_b16 v[200:201], v23
ds_read_b64_tr_b16 v[202:203], v23 offset:2048
v_mfma_f32_16x16x32_bf16 v[164:167], v[236:239], a[132:135], v[164:167]
ds_read_b64_tr_b16 v[204:205], v20 offset:16384
ds_read_b64_tr_b16 v[206:207], v20 offset:18432
ds_read_b64_tr_b16 v[208:209], v21 offset:16384
v_mfma_f32_16x16x32_bf16 v[104:107], v[240:243], a[124:127], v[104:107]
ds_read_b64_tr_b16 v[210:211], v21 offset:18432
s_add_u32 m0, s49, 40128
s_add_u32 s48, s55, 6144
buffer_load_dwordx4 v3, s[8:11], s48 offen nt lds
ds_read_b64_tr_b16 v[212:213], v22 offset:16384
v_mfma_f32_16x16x32_bf16 v[168:171], v[240:243], a[132:135], v[168:171]
ds_read_b64_tr_b16 v[214:215], v22 offset:18432
ds_read_b64_tr_b16 v[216:217], v23 offset:16384
ds_read_b64_tr_b16 v[218:219], v23 offset:18432
v_mfma_f32_16x16x32_bf16 v[184:187], v[244:247], a[140:143], v[184:187]
ds_read_b64_tr_b16 v[220:221], v12
ds_read_b64_tr_b16 v[222:223], v12 offset:2048
ds_read_b64_tr_b16 v[224:225], v12 offset:16384
ds_read_b64_tr_b16 v[226:227], v12 offset:18432
s_waitcnt lgkmcnt(7)
v_mfma_f32_16x16x32_bf16 v[172:175], v[188:191], a[112:115], v[172:175]
ds_read_b64_tr_b16 v[228:229], v13
ds_read_b64_tr_b16 v[230:231], v13 offset:2048
ds_read_b64_tr_b16 v[232:233], v13 offset:16384
v_mfma_f32_16x16x32_bf16 v[176:179], v[192:195], a[112:115], v[176:179]
ds_read_b64_tr_b16 v[234:235], v13 offset:18432
s_add_u32 m0, s49, 41184
s_add_u32 s48, s55, 7168
buffer_load_dwordx4 v3, s[8:11], s48 offen nt lds
ds_read_b64_tr_b16 v[236:237], v14
v_mfma_f32_16x16x32_bf16 v[180:183], v[196:199], a[112:115], v[180:183]
ds_read_b64_tr_b16 v[238:239], v14 offset:2048
ds_read_b64_tr_b16 v[240:241], v14 offset:16384
ds_read_b64_tr_b16 v[242:243], v14 offset:18432
ds_read_b64_tr_b16 v[244:245], v15
v_mfma_f32_16x16x32_bf16 v[184:187], v[200:203], a[112:115], v[184:187]
ds_read_b64_tr_b16 v[246:247], v15 offset:2048
ds_read_b64_tr_b16 v[188:189], v15 offset:16384
ds_read_b64_tr_b16 v[190:191], v15 offset:18432
v_mfma_f32_16x16x32_bf16 v[172:175], v[204:207], a[116:119], v[172:175]
ds_read_b64_tr_b16 v[192:193], v16
ds_read_b64_tr_b16 v[194:195], v16 offset:2048
ds_read_b64_tr_b16 v[196:197], v16 offset:16384
ds_read_b64_tr_b16 v[198:199], v16 offset:18432
v_mfma_f32_16x16x32_bf16 v[176:179], v[208:211], a[116:119], v[176:179]
s_lshl_b32 s51, s44, 8
s_lshl_b32 s48, s43, 5
s_add_u32 s51, s51, s48
s_mul_i32 s51, s51, 896
s_mul_i32 s48, s3, 7168
s_add_u32 s51, s51, s48
s_add_u32 s48, s51, 6144
buffer_load_dwordx4 a[148:151], v1, s[24:27], s48 offen
s_waitcnt lgkmcnt(0)
v_mfma_f32_16x16x32_bf16 v[180:183], v[212:215], a[116:119], v[180:183]
ds_read_b64_tr_b16 v[200:201], v17
ds_read_b64_tr_b16 v[202:203], v17 offset:2048
ds_read_b64_tr_b16 v[204:205], v17 offset:16384
ds_read_b64_tr_b16 v[206:207], v17 offset:18432
v_mfma_f32_16x16x32_bf16 v[184:187], v[216:219], a[116:119], v[184:187]
v_mul_f32 v172, s52, v172
v_mul_f32 v173, s52, v173
v_mul_f32 v174, s52, v174
v_mul_f32 v175, s52, v175
v_mfma_f32_16x16x32_bf16 v[44:47], v[220:223], a[96:99], v[44:47]
v_mul_f32 v176, s52, v176
v_mul_f32 v177, s52, v177
v_mul_f32 v178, s52, v178
v_mul_f32 v179, s52, v179
v_cvt_pk_bf16_f32 v172, v172, v173
v_mfma_f32_16x16x32_bf16 v[108:111], v[220:223], a[104:107], v[108:111]
v_cvt_pk_bf16_f32 v173, v174, v175
v_cvt_pk_bf16_f32 v174, v176, v177
v_cvt_pk_bf16_f32 v175, v178, v179
s_nop 0
v_permlane32_swap_b32 v172, v174
v_permlane32_swap_b32 v173, v175
v_mfma_f32_16x16x32_bf16 v[44:47], v[224:227], a[100:103], v[44:47]
v_permlane16_swap_b32 v172, v174
v_permlane16_swap_b32 v173, v175
s_lshl_b32 s4, s3, 11
s_add_u32 s4, s4, 121856
v_add_u32 v7, s4, v1
ds_write_b128 v7, v[172:175]
v_mfma_f32_16x16x32_bf16 v[108:111], v[224:227], a[108:111], v[108:111]
v_mul_f32 v180, s52, v180
v_mul_f32 v181, s52, v181
v_mul_f32 v182, s52, v182
v_mul_f32 v183, s52, v183
v_mul_f32 v184, s52, v184
v_mfma_f32_16x16x32_bf16 v[48:51], v[228:231], a[96:99], v[48:51]
v_mul_f32 v185, s52, v185
v_mul_f32 v186, s52, v186
v_mul_f32 v187, s52, v187
v_cvt_pk_bf16_f32 v180, v180, v181
v_cvt_pk_bf16_f32 v181, v182, v183
v_mfma_f32_16x16x32_bf16 v[112:115], v[228:231], a[104:107], v[112:115]
v_cvt_pk_bf16_f32 v182, v184, v185
v_cvt_pk_bf16_f32 v183, v186, v187
s_nop 0
v_permlane32_swap_b32 v180, v182
v_permlane32_swap_b32 v181, v183
s_nop 0
v_permlane16_swap_b32 v180, v182
v_mfma_f32_16x16x32_bf16 v[48:51], v[232:235], a[100:103], v[48:51]
v_permlane16_swap_b32 v181, v183
ds_write_b128 v7, v[180:183] offset:1024
ds_read_b64_tr_b16 v[208:209], v18
ds_read_b64_tr_b16 v[210:211], v18 offset:2048
ds_read_b64_tr_b16 v[212:213], v18 offset:16384
v_mfma_f32_16x16x32_bf16 v[112:115], v[232:235], a[108:111], v[112:115]
ds_read_b64_tr_b16 v[214:215], v18 offset:18432
s_add_u32 m0, s49, 67584
s_add_u32 s48, s55, 32768
buffer_load_dwordx4 v3, s[8:11], s48 offen nt lds
ds_read_b64_tr_b16 v[216:217], v19
ds_read_b64_tr_b16 v[218:219], v19 offset:2048
ds_read_b64_tr_b16 v[220:221], v19 offset:16384
v_mfma_f32_16x16x32_bf16 v[52:55], v[236:239], a[96:99], v[52:55]
ds_read_b64_tr_b16 v[222:223], v19 offset:18432
v_mul_f32 v44, s52, v44
v_mul_f32 v45, s52, v45
v_mul_f32 v46, s52, v46
v_mul_f32 v47, s52, v47
v_mfma_f32_16x16x32_bf16 v[116:119], v[236:239], a[104:107], v[116:119]
v_mul_f32 v48, s52, v48
v_mul_f32 v49, s52, v49
v_mul_f32 v50, s52, v50
v_mul_f32 v51, s52, v51
v_cvt_pk_bf16_f32 v44, v44, v45
v_cvt_pk_bf16_f32 v45, v46, v47
v_mfma_f32_16x16x32_bf16 v[52:55], v[240:243], a[100:103], v[52:55]
v_cvt_pk_bf16_f32 v46, v48, v49
v_cvt_pk_bf16_f32 v47, v50, v51
s_nop 0
v_permlane32_swap_b32 v44, v46
v_permlane32_swap_b32 v45, v47
s_nop 0
v_permlane16_swap_b32 v44, v46
v_mfma_f32_16x16x32_bf16 v[116:119], v[240:243], a[108:111], v[116:119]
v_permlane16_swap_b32 v45, v47
v_accvgpr_write_b32 a0, v44
v_accvgpr_write_b32 a1, v45
v_accvgpr_write_b32 a2, v46
v_accvgpr_write_b32 a3, v47
ds_read_b64_tr_b16 v[224:225], v12 offset:256
v_mfma_f32_16x16x32_bf16 v[56:59], v[244:247], a[96:99], v[56:59]
ds_read_b64_tr_b16 v[226:227], v12 offset:2304
ds_read_b64_tr_b16 v[228:229], v12 offset:16640
ds_read_b64_tr_b16 v[230:231], v12 offset:18688
s_add_u32 m0, s49, 68640
s_add_u32 s48, s55, 33792
buffer_load_dwordx4 v3, s[8:11], s48 offen nt lds
v_mul_f32 v108, s52, v108
v_mul_f32 v109, s52, v109
v_mfma_f32_16x16x32_bf16 v[120:123], v[244:247], a[104:107], v[120:123]
v_mul_f32 v110, s52, v110
v_mul_f32 v111, s52, v111
v_mul_f32 v112, s52, v112
v_mul_f32 v113, s52, v113
v_mul_f32 v114, s52, v114
v_mfma_f32_16x16x32_bf16 v[56:59], v[188:191], a[100:103], v[56:59]
v_mul_f32 v115, s52, v115
v_cvt_pk_bf16_f32 v108, v108, v109
v_cvt_pk_bf16_f32 v109, v110, v111
v_cvt_pk_bf16_f32 v110, v112, v113
v_cvt_pk_bf16_f32 v111, v114, v115
s_nop 0
v_permlane32_swap_b32 v108, v110
v_mfma_f32_16x16x32_bf16 v[120:123], v[188:191], a[108:111], v[120:123]
v_permlane32_swap_b32 v109, v111
v_permlane16_swap_b32 v108, v110
s_nop 0
v_permlane16_swap_b32 v109, v111
v_accvgpr_write_b32 a32, v108
v_accvgpr_write_b32 a33, v109
v_accvgpr_write_b32 a34, v110
v_mfma_f32_16x16x32_bf16 v[60:63], v[192:195], a[96:99], v[60:63]
v_accvgpr_write_b32 a35, v111
ds_read_b64_tr_b16 v[232:233], v13 offset:256
ds_read_b64_tr_b16 v[234:235], v13 offset:2304
ds_read_b64_tr_b16 v[236:237], v13 offset:16640
ds_read_b64_tr_b16 v[238:239], v13 offset:18688
v_mul_f32 v52, s52, v52
v_mfma_f32_16x16x32_bf16 v[124:127], v[192:195], a[104:107], v[124:127]
v_mul_f32 v53, s52, v53
v_mul_f32 v54, s52, v54
v_mul_f32 v55, s52, v55
v_mul_f32 v56, s52, v56
v_mul_f32 v57, s52, v57
v_mul_f32 v58, s52, v58
v_mfma_f32_16x16x32_bf16 v[60:63], v[196:199], a[100:103], v[60:63]
v_mul_f32 v59, s52, v59
v_cvt_pk_bf16_f32 v52, v52, v53
v_cvt_pk_bf16_f32 v53, v54, v55
v_cvt_pk_bf16_f32 v54, v56, v57
v_cvt_pk_bf16_f32 v55, v58, v59
s_nop 0
v_permlane32_swap_b32 v52, v54
v_mfma_f32_16x16x32_bf16 v[124:127], v[196:199], a[108:111], v[124:127]
v_permlane32_swap_b32 v53, v55
v_permlane16_swap_b32 v52, v54
s_nop 0
v_permlane16_swap_b32 v53, v55
v_accvgpr_write_b32 a4, v52
v_accvgpr_write_b32 a5, v53
s_waitcnt lgkmcnt(0)
v_mfma_f32_16x16x32_bf16 v[64:67], v[200:203], a[96:99], v[64:67]
v_accvgpr_write_b32 a6, v54
v_accvgpr_write_b32 a7, v55
ds_read_b64_tr_b16 v[240:241], v14 offset:256
ds_read_b64_tr_b16 v[242:243], v14 offset:2304
ds_read_b64_tr_b16 v[244:245], v14 offset:16640
ds_read_b64_tr_b16 v[246:247], v14 offset:18688
s_add_u32 m0, s49, 69696
s_add_u32 s48, s55, 34816
v_mfma_f32_16x16x32_bf16 v[128:131], v[200:203], a[104:107], v[128:131]
buffer_load_dwordx4 v3, s[8:11], s48 offen nt lds
v_mul_f32 v116, s52, v116
v_mul_f32 v117, s52, v117
v_mul_f32 v118, s52, v118
v_mul_f32 v119, s52, v119
v_mfma_f32_16x16x32_bf16 v[64:67], v[204:207], a[100:103], v[64:67]
v_mul_f32 v120, s52, v120
v_mul_f32 v121, s52, v121
v_mul_f32 v122, s52, v122
v_mul_f32 v123, s52, v123
v_cvt_pk_bf16_f32 v116, v116, v117
v_cvt_pk_bf16_f32 v117, v118, v119
v_mfma_f32_16x16x32_bf16 v[128:131], v[204:207], a[108:111], v[128:131]
v_cvt_pk_bf16_f32 v118, v120, v121
v_cvt_pk_bf16_f32 v119, v122, v123
s_nop 0
v_permlane32_swap_b32 v116, v118
v_permlane32_swap_b32 v117, v119
s_nop 0
v_permlane16_swap_b32 v116, v118
v_permlane16_swap_b32 v117, v119
v_mfma_f32_16x16x32_bf16 v[68:71], v[208:211], a[96:99], v[68:71]
v_accvgpr_write_b32 a36, v116
v_accvgpr_write_b32 a37, v117
v_accvgpr_write_b32 a38, v118
v_accvgpr_write_b32 a39, v119
ds_read_b64_tr_b16 v[188:189], v15 offset:256
ds_read_b64_tr_b16 v[190:191], v15 offset:2304
v_mfma_f32_16x16x32_bf16 v[132:135], v[208:211], a[104:107], v[132:135]
ds_read_b64_tr_b16 v[192:193], v15 offset:16640
ds_read_b64_tr_b16 v[194:195], v15 offset:18688
v_mul_f32 v60, s52, v60
v_mul_f32 v61, s52, v61
v_mul_f32 v62, s52, v62
v_mul_f32 v63, s52, v63
v_mfma_f32_16x16x32_bf16 v[68:71], v[212:215], a[100:103], v[68:71]
v_mul_f32 v64, s52, v64
v_mul_f32 v65, s52, v65
v_mul_f32 v66, s52, v66
v_mul_f32 v67, s52, v67
v_cvt_pk_bf16_f32 v60, v60, v61
v_cvt_pk_bf16_f32 v61, v62, v63
v_mfma_f32_16x16x32_bf16 v[132:135], v[212:215], a[108:111], v[132:135]
v_cvt_pk_bf16_f32 v62, v64, v65
v_cvt_pk_bf16_f32 v63, v66, v67
s_nop 0
v_permlane32_swap_b32 v60, v62
v_permlane32_swap_b32 v61, v63
s_nop 0
v_permlane16_swap_b32 v60, v62
v_mfma_f32_16x16x32_bf16 v[72:75], v[216:219], a[96:99], v[72:75]
v_permlane16_swap_b32 v61, v63
v_accvgpr_write_b32 a8, v60
v_accvgpr_write_b32 a9, v61
v_accvgpr_write_b32 a10, v62
v_accvgpr_write_b32 a11, v63
ds_read_b64_tr_b16 v[196:197], v16 offset:256
v_mfma_f32_16x16x32_bf16 v[136:139], v[216:219], a[104:107], v[136:139]
ds_read_b64_tr_b16 v[198:199], v16 offset:2304
s_add_u32 m0, s49, 70752
s_add_u32 s48, s55, 35840
buffer_load_dwordx4 v3, s[8:11], s48 offen nt lds
ds_read_b64_tr_b16 v[200:201], v16 offset:16640
ds_read_b64_tr_b16 v[202:203], v16 offset:18688
v_mul_f32 v124, s52, v124
v_mul_f32 v125, s52, v125
v_mfma_f32_16x16x32_bf16 v[72:75], v[220:223], a[100:103], v[72:75]
v_mul_f32 v126, s52, v126
v_mul_f32 v127, s52, v127
v_mul_f32 v128, s52, v128
v_mul_f32 v129, s52, v129
v_mul_f32 v130, s52, v130
v_mfma_f32_16x16x32_bf16 v[136:139], v[220:223], a[108:111], v[136:139]
v_mul_f32 v131, s52, v131
v_cvt_pk_bf16_f32 v124, v124, v125
v_cvt_pk_bf16_f32 v125, v126, v127
v_cvt_pk_bf16_f32 v126, v128, v129
v_cvt_pk_bf16_f32 v127, v130, v131
s_nop 0
v_permlane32_swap_b32 v124, v126
v_mfma_f32_16x16x32_bf16 v[76:79], v[224:227], a[96:99], v[76:79]
v_permlane32_swap_b32 v125, v127
v_permlane16_swap_b32 v124, v126
s_nop 0
v_permlane16_swap_b32 v125, v127
v_accvgpr_write_b32 a40, v124
v_accvgpr_write_b32 a41, v125
v_accvgpr_write_b32 a42, v126
v_mfma_f32_16x16x32_bf16 v[140:143], v[224:227], a[104:107], v[140:143]
v_accvgpr_write_b32 a43, v127
ds_read_b64_tr_b16 v[204:205], v17 offset:256
ds_read_b64_tr_b16 v[206:207], v17 offset:2304
ds_read_b64_tr_b16 v[208:209], v17 offset:16640
ds_read_b64_tr_b16 v[210:211], v17 offset:18688
v_mul_f32 v68, s52, v68
v_mfma_f32_16x16x32_bf16 v[76:79], v[228:231], a[100:103], v[76:79]
v_mul_f32 v69, s52, v69
v_mul_f32 v70, s52, v70
v_mul_f32 v71, s52, v71
v_mul_f32 v72, s52, v72
v_mul_f32 v73, s52, v73
v_mul_f32 v74, s52, v74
v_mfma_f32_16x16x32_bf16 v[140:143], v[228:231], a[108:111], v[140:143]
v_mul_f32 v75, s52, v75
v_cvt_pk_bf16_f32 v68, v68, v69
v_cvt_pk_bf16_f32 v69, v70, v71
v_cvt_pk_bf16_f32 v70, v72, v73
v_cvt_pk_bf16_f32 v71, v74, v75
s_nop 0
v_permlane32_swap_b32 v68, v70
v_mfma_f32_16x16x32_bf16 v[80:83], v[232:235], a[96:99], v[80:83]
v_permlane32_swap_b32 v69, v71
v_permlane16_swap_b32 v68, v70
s_nop 0
v_permlane16_swap_b32 v69, v71
v_accvgpr_write_b32 a12, v68
v_accvgpr_write_b32 a13, v69
v_mfma_f32_16x16x32_bf16 v[144:147], v[232:235], a[104:107], v[144:147]
v_accvgpr_write_b32 a14, v70
v_accvgpr_write_b32 a15, v71
ds_read_b64_tr_b16 v[212:213], v18 offset:256
ds_read_b64_tr_b16 v[214:215], v18 offset:2304
s_add_u32 m0, s49, 71808
s_add_u32 s48, s55, 36864
buffer_load_dwordx4 v3, s[8:11], s48 offen nt lds
ds_read_b64_tr_b16 v[216:217], v18 offset:16640
v_mfma_f32_16x16x32_bf16 v[80:83], v[236:239], a[100:103], v[80:83]
ds_read_b64_tr_b16 v[218:219], v18 offset:18688
v_mul_f32 v132, s52, v132
v_mul_f32 v133, s52, v133
v_mul_f32 v134, s52, v134
v_mul_f32 v135, s52, v135
v_mfma_f32_16x16x32_bf16 v[144:147], v[236:239], a[108:111], v[144:147]
v_mul_f32 v136, s52, v136
v_mul_f32 v137, s52, v137
v_mul_f32 v138, s52, v138
v_mul_f32 v139, s52, v139
v_cvt_pk_bf16_f32 v132, v132, v133
v_cvt_pk_bf16_f32 v133, v134, v135
s_waitcnt lgkmcnt(0)
v_mfma_f32_16x16x32_bf16 v[84:87], v[240:243], a[96:99], v[84:87]
v_cvt_pk_bf16_f32 v134, v136, v137
v_cvt_pk_bf16_f32 v135, v138, v139
s_nop 0
v_permlane32_swap_b32 v132, v134
v_permlane32_swap_b32 v133, v135
s_nop 0
v_permlane16_swap_b32 v132, v134
v_permlane16_swap_b32 v133, v135
v_mfma_f32_16x16x32_bf16 v[148:151], v[240:243], a[104:107], v[148:151]
v_accvgpr_write_b32 a44, v132
v_accvgpr_write_b32 a45, v133
v_accvgpr_write_b32 a46, v134
v_accvgpr_write_b32 a47, v135
ds_read_b64_tr_b16 v[220:221], v19 offset:256
ds_read_b64_tr_b16 v[222:223], v19 offset:2304
v_mfma_f32_16x16x32_bf16 v[84:87], v[244:247], a[100:103], v[84:87]
ds_read_b64_tr_b16 v[224:225], v19 offset:16640
ds_read_b64_tr_b16 v[226:227], v19 offset:18688
v_mul_f32 v76, s52, v76
v_mul_f32 v77, s52, v77
v_mul_f32 v78, s52, v78
v_mul_f32 v79, s52, v79
v_mfma_f32_16x16x32_bf16 v[148:151], v[244:247], a[108:111], v[148:151]
v_mul_f32 v80, s52, v80
v_mul_f32 v81, s52, v81
v_mul_f32 v82, s52, v82
v_mul_f32 v83, s52, v83
v_cvt_pk_bf16_f32 v76, v76, v77
v_cvt_pk_bf16_f32 v77, v78, v79
v_mfma_f32_16x16x32_bf16 v[88:91], v[188:191], a[96:99], v[88:91]
v_cvt_pk_bf16_f32 v78, v80, v81
v_cvt_pk_bf16_f32 v79, v82, v83
s_nop 0
v_permlane32_swap_b32 v76, v78
v_permlane32_swap_b32 v77, v79
s_nop 0
v_permlane16_swap_b32 v76, v78
v_mfma_f32_16x16x32_bf16 v[152:155], v[188:191], a[104:107], v[152:155]
v_permlane16_swap_b32 v77, v79
v_accvgpr_write_b32 a16, v76
v_accvgpr_write_b32 a17, v77
v_accvgpr_write_b32 a18, v78
v_accvgpr_write_b32 a19, v79
s_add_u32 m0, s49, 72864
s_add_u32 s48, s55, 37888
buffer_load_dwordx4 v3, s[8:11], s48 offen nt lds
v_mfma_f32_16x16x32_bf16 v[88:91], v[192:195], a[100:103], v[88:91]
v_mul_f32 v140, s52, v140
v_mul_f32 v141, s52, v141
v_mul_f32 v142, s52, v142
v_mul_f32 v143, s52, v143
v_mul_f32 v144, s52, v144
v_mul_f32 v145, s52, v145
v_mfma_f32_16x16x32_bf16 v[152:155], v[192:195], a[108:111], v[152:155]
v_mul_f32 v146, s52, v146
v_mul_f32 v147, s52, v147
v_cvt_pk_bf16_f32 v140, v140, v141
v_cvt_pk_bf16_f32 v141, v142, v143
v_cvt_pk_bf16_f32 v142, v144, v145
v_mfma_f32_16x16x32_bf16 v[92:95], v[196:199], a[96:99], v[92:95]
v_cvt_pk_bf16_f32 v143, v146, v147
v_permlane32_swap_b32 v140, v142
s_nop 0
v_permlane32_swap_b32 v141, v143
v_permlane16_swap_b32 v140, v142
s_nop 0
v_permlane16_swap_b32 v141, v143
v_accvgpr_write_b32 a48, v140
v_mfma_f32_16x16x32_bf16 v[156:159], v[196:199], a[104:107], v[156:159]
v_accvgpr_write_b32 a49, v141
v_accvgpr_write_b32 a50, v142
v_accvgpr_write_b32 a51, v143
v_mul_f32 v84, s52, v84
v_mul_f32 v85, s52, v85
v_mul_f32 v86, s52, v86
v_mfma_f32_16x16x32_bf16 v[92:95], v[200:203], a[100:103], v[92:95]
v_mul_f32 v87, s52, v87
v_mul_f32 v88, s52, v88
v_mul_f32 v89, s52, v89
v_mul_f32 v90, s52, v90
v_mul_f32 v91, s52, v91
v_cvt_pk_bf16_f32 v84, v84, v85
v_mfma_f32_16x16x32_bf16 v[156:159], v[200:203], a[108:111], v[156:159]
v_cvt_pk_bf16_f32 v85, v86, v87
v_cvt_pk_bf16_f32 v86, v88, v89
v_cvt_pk_bf16_f32 v87, v90, v91
s_nop 0
v_permlane32_swap_b32 v84, v86
v_permlane32_swap_b32 v85, v87
s_nop 0
v_permlane16_swap_b32 v84, v86
v_mfma_f32_16x16x32_bf16 v[96:99], v[204:207], a[96:99], v[96:99]
v_permlane16_swap_b32 v85, v87
v_accvgpr_write_b32 a20, v84
v_accvgpr_write_b32 a21, v85
v_accvgpr_write_b32 a22, v86
v_accvgpr_write_b32 a23, v87
v_mul_f32 v148, s52, v148
v_mfma_f32_16x16x32_bf16 v[160:163], v[204:207], a[104:107], v[160:163]
v_mul_f32 v149, s52, v149
v_mul_f32 v150, s52, v150
v_mul_f32 v151, s52, v151
v_mul_f32 v152, s52, v152
v_mul_f32 v153, s52, v153
v_mfma_f32_16x16x32_bf16 v[96:99], v[208:211], a[100:103], v[96:99]
v_mul_f32 v154, s52, v154
v_mul_f32 v155, s52, v155
v_cvt_pk_bf16_f32 v148, v148, v149
v_cvt_pk_bf16_f32 v149, v150, v151
v_cvt_pk_bf16_f32 v150, v152, v153
v_cvt_pk_bf16_f32 v151, v154, v155
v_mfma_f32_16x16x32_bf16 v[160:163], v[208:211], a[108:111], v[160:163]
v_permlane32_swap_b32 v148, v150
v_permlane32_swap_b32 v149, v151
s_nop 0
v_permlane16_swap_b32 v148, v150
v_permlane16_swap_b32 v149, v151
v_accvgpr_write_b32 a52, v148
v_accvgpr_write_b32 a53, v149
v_mfma_f32_16x16x32_bf16 v[100:103], v[212:215], a[96:99], v[100:103]
v_accvgpr_write_b32 a54, v150
v_accvgpr_write_b32 a55, v151
v_mul_f32 v92, s52, v92
v_mul_f32 v93, s52, v93
v_mul_f32 v94, s52, v94
v_mul_f32 v95, s52, v95
v_mfma_f32_16x16x32_bf16 v[164:167], v[212:215], a[104:107], v[164:167]
v_mul_f32 v96, s52, v96
v_mul_f32 v97, s52, v97
v_mul_f32 v98, s52, v98
v_mul_f32 v99, s52, v99
v_cvt_pk_bf16_f32 v92, v92, v93
v_cvt_pk_bf16_f32 v93, v94, v95
v_mfma_f32_16x16x32_bf16 v[100:103], v[216:219], a[100:103], v[100:103]
v_cvt_pk_bf16_f32 v94, v96, v97
v_cvt_pk_bf16_f32 v95, v98, v99
s_nop 0
v_permlane32_swap_b32 v92, v94
v_permlane32_swap_b32 v93, v95
s_nop 0
v_permlane16_swap_b32 v92, v94
v_permlane16_swap_b32 v93, v95
v_accvgpr_write_b32 a24, v92
v_mfma_f32_16x16x32_bf16 v[164:167], v[216:219], a[108:111], v[164:167]
v_accvgpr_write_b32 a25, v93
v_accvgpr_write_b32 a26, v94
v_accvgpr_write_b32 a27, v95
v_mul_f32 v156, s52, v156
v_mul_f32 v157, s52, v157
v_mul_f32 v158, s52, v158
v_mul_f32 v159, s52, v159
s_waitcnt lgkmcnt(0)
v_mfma_f32_16x16x32_bf16 v[104:107], v[220:223], a[96:99], v[104:107]
v_mul_f32 v160, s52, v160
v_mul_f32 v161, s52, v161
v_mul_f32 v162, s52, v162
v_mul_f32 v163, s52, v163
v_cvt_pk_bf16_f32 v156, v156, v157
v_cvt_pk_bf16_f32 v157, v158, v159
v_mfma_f32_16x16x32_bf16 v[168:171], v[220:223], a[104:107], v[168:171]
v_cvt_pk_bf16_f32 v158, v160, v161
v_cvt_pk_bf16_f32 v159, v162, v163
s_nop 0
v_permlane32_swap_b32 v156, v158
v_permlane32_swap_b32 v157, v159
s_nop 0
v_permlane16_swap_b32 v156, v158
v_permlane16_swap_b32 v157, v159
v_accvgpr_write_b32 a56, v156
v_mfma_f32_16x16x32_bf16 v[104:107], v[224:227], a[100:103], v[104:107]
v_accvgpr_write_b32 a57, v157
v_accvgpr_write_b32 a58, v158
v_accvgpr_write_b32 a59, v159
v_mul_f32 v100, s52, v100
v_mul_f32 v101, s52, v101
v_mul_f32 v102, s52, v102
v_mul_f32 v103, s52, v103
v_mfma_f32_16x16x32_bf16 v[168:171], v[224:227], a[108:111], v[168:171]
v_mul_f32 v104, s52, v104
v_mul_f32 v105, s52, v105
v_mul_f32 v106, s52, v106
v_mul_f32 v107, s52, v107
v_cvt_pk_bf16_f32 v100, v100, v101
v_cvt_pk_bf16_f32 v101, v102, v103
v_cvt_pk_bf16_f32 v102, v104, v105
v_cvt_pk_bf16_f32 v103, v106, v107
s_nop 0
v_permlane32_swap_b32 v100, v102
v_permlane32_swap_b32 v101, v103
s_nop 0
v_permlane16_swap_b32 v100, v102
v_permlane16_swap_b32 v101, v103
v_accvgpr_write_b32 a28, v100
v_accvgpr_write_b32 a29, v101
v_accvgpr_write_b32 a30, v102
v_accvgpr_write_b32 a31, v103
v_mul_f32 v164, s52, v164
v_mul_f32 v165, s52, v165
v_mul_f32 v166, s52, v166
v_mul_f32 v167, s52, v167
v_mul_f32 v168, s52, v168
v_mul_f32 v169, s52, v169
v_mul_f32 v170, s52, v170
v_mul_f32 v171, s52, v171
v_cvt_pk_bf16_f32 v164, v164, v165
v_cvt_pk_bf16_f32 v165, v166, v167
v_cvt_pk_bf16_f32 v166, v168, v169
v_cvt_pk_bf16_f32 v167, v170, v171
s_nop 0
v_permlane32_swap_b32 v164, v166
v_permlane32_swap_b32 v165, v167
s_nop 0
v_permlane16_swap_b32 v164, v166
v_permlane16_swap_b32 v165, v167
v_accvgpr_write_b32 a60, v164
v_accvgpr_write_b32 a61, v165
v_accvgpr_write_b32 a62, v166
v_accvgpr_write_b32 a63, v167
v_add_u32 v4, 33792, v4
v_add_u32 v5, 33792, v5
L_stage7:
s_waitcnt vmcnt(7)
s_barrier
ds_read_b128 a[96:99], v4
ds_read_b128 a[100:103], v4 offset:64
ds_read_b128 a[104:107], v4 offset:128
ds_read_b128 a[108:111], v4 offset:192
ds_read_b128 a[112:115], v4 offset:256
ds_read_b128 a[116:119], v4 offset:320
s_waitcnt lgkmcnt(5)
v_mfma_f32_16x16x32_bf16 v[12:15], a[96:99], a[0:3], 0
ds_read_b128 a[120:123], v4 offset:384
ds_read_b128 a[124:127], v4 offset:448
s_waitcnt lgkmcnt(6)
v_mfma_f32_16x16x32_bf16 v[12:15], a[100:103], a[4:7], v[12:15]
v_add_u32 v8, 121856, v1
ds_read_b128 a[64:67], v8
s_waitcnt lgkmcnt(6)
v_mfma_f32_16x16x32_bf16 v[12:15], a[104:107], a[8:11], v[12:15]
ds_read_b128 a[68:71], v8 offset:1024
ds_read_b128 a[72:75], v8 offset:2048
s_waitcnt lgkmcnt(5)
v_mfma_f32_16x16x32_bf16 v[12:15], a[108:111], a[12:15], v[12:15]
ds_read_b128 a[76:79], v8 offset:3072
ds_read_b128 a[80:83], v8 offset:4096
v_mfma_f32_16x16x32_bf16 v[12:15], a[112:115], a[16:19], v[12:15]
ds_read_b128 a[84:87], v8 offset:5120
ds_read_b128 a[88:91], v8 offset:6144
v_mfma_f32_16x16x32_bf16 v[12:15], a[116:119], a[20:23], v[12:15]
ds_read_b128 a[92:95], v8 offset:7168
v_mov_b32 v8, 0x3f803f80
s_waitcnt lgkmcnt(5)
v_mfma_f32_16x16x32_bf16 v[12:15], a[120:123], a[24:27], v[12:15]
v_accvgpr_write_b32 a160, v8
v_accvgpr_write_b32 a161, v8
v_mfma_f32_16x16x32_bf16 v[12:15], a[124:127], a[28:31], v[12:15]
v_accvgpr_write_b32 a162, v8
v_accvgpr_write_b32 a163, v8
s_add_u32 m0, s49, 73920
s_add_u32 s48, s55, 38912
v_mfma_f32_16x16x32_bf16 v[20:23], a[96:99], a[32:35], 0
buffer_load_dwordx4 v3, s[8:11], s48 offen nt lds
ds_read_b128 a[96:99], v4 offset:8448
v_mfma_f32_16x16x32_bf16 v[20:23], a[100:103], a[36:39], v[20:23]
ds_read_b128 a[100:103], v4 offset:8512
s_add_u32 m0, s49, 74976
s_add_u32 s48, s55, 39936
buffer_load_dwordx4 v3, s[8:11], s48 offen nt lds
v_mfma_f32_16x16x32_bf16 v[20:23], a[104:107], a[40:43], v[20:23]
ds_read_b128 a[104:107], v4 offset:8576
v_max3_f32 v6, v12, v13, v14
v_max_f32 v6, v6, v15
v_mov_b32 v7, v6
s_nop 1
v_permlane32_swap_b32 v6, v7
v_mfma_f32_16x16x32_bf16 v[20:23], a[108:111], a[44:47], v[20:23]
v_max_f32 v6, v6, v7
v_mov_b32 v7, v6
s_nop 1
v_permlane16_swap_b32 v6, v7
v_max_f32 v6, v6, v7
v_mfma_f32_16x16x32_bf16 v[20:23], a[112:115], a[48:51], v[20:23]
v_ceil_f32 v6, v6
v_sub_f32 v32, 0, v6
v_sub_f32 v33, 0, v6
v_sub_f32 v34, 0, v6
v_sub_f32 v35, 0, v6
v_mfma_f32_16x16x32_bf16 v[20:23], a[116:119], a[52:55], v[20:23]
v_sub_f32 v12, v12, v6
v_sub_f32 v13, v13, v6
v_sub_f32 v14, v14, v6
v_sub_f32 v15, v15, v6
ds_read_b128 a[108:111], v4 offset:8640
v_mfma_f32_16x16x32_bf16 v[20:23], a[120:123], a[56:59], v[20:23]
ds_read_b128 a[112:115], v4 offset:8704
ds_read_b128 a[116:119], v4 offset:8768
ds_read_b128 a[120:123], v4 offset:8832
v_mfma_f32_16x16x32_bf16 v[20:23], a[124:127], a[60:63], v[20:23]
ds_read_b128 a[124:127], v4 offset:8896
ds_read_b128 a[128:131], v5
ds_read_b128 a[132:135], v5 offset:64
s_waitcnt lgkmcnt(7)
v_mfma_f32_16x16x32_bf16 v[16:19], a[96:99], a[0:3], v[32:35]
s_add_u32 m0, s49, 0
s_add_u32 s48, s55, 65536
buffer_load_dwordx4 v3, s[8:11], s48 offen nt lds
v_mfma_f32_16x16x32_bf16 v[16:19], a[100:103], a[4:7], v[16:19]
v_exp_f32 v12, v12
ds_read_b128 a[136:139], v5 offset:128
v_mfma_f32_16x16x32_bf16 v[16:19], a[104:107], a[8:11], v[16:19]
v_exp_f32 v13, v13
v_max3_f32 v6, v20, v21, v22
v_max_f32 v6, v6, v23
s_waitcnt lgkmcnt(1)
v_mfma_f32_16x16x32_bf16 v[16:19], a[108:111], a[12:15], v[16:19]
v_mov_b32 v7, v6
s_nop 1
v_permlane32_swap_b32 v6, v7
v_max_f32 v6, v6, v7
v_mfma_f32_16x16x32_bf16 v[16:19], a[112:115], a[16:19], v[16:19]
v_mov_b32 v7, v6
s_nop 1
v_permlane16_swap_b32 v6, v7
v_max_f32 v6, v6, v7
v_mfma_f32_16x16x32_bf16 v[16:19], a[116:119], a[20:23], v[16:19]
v_ceil_f32 v6, v6
v_sub_f32 v36, 0, v6
v_sub_f32 v37, 0, v6
v_mfma_f32_16x16x32_bf16 v[16:19], a[120:123], a[24:27], v[16:19]
v_sub_f32 v38, 0, v6
v_sub_f32 v39, 0, v6
v_sub_f32 v20, v20, v6
v_mfma_f32_16x16x32_bf16 v[16:19], a[124:127], a[28:31], v[16:19]
v_sub_f32 v21, v21, v6
v_sub_f32 v22, v22, v6
v_sub_f32 v23, v23, v6
v_mfma_f32_16x16x32_bf16 v[24:27], a[96:99], a[32:35], v[36:39]
ds_read_b128 a[140:143], v5 offset:192
v_exp_f32 v14, v14
v_mfma_f32_16x16x32_bf16 v[24:27], a[100:103], a[36:39], v[24:27]
ds_read_b128 a[144:147], v5 offset:256
v_mfma_f32_16x16x32_bf16 v[24:27], a[104:107], a[40:43], v[24:27]
v_exp_f32 v15, v15
s_waitcnt vmcnt(9)
ds_read_b128 a[148:151], v5 offset:320
v_cvt_pk_bf16_f32 v44, v12, v13
v_mfma_f32_16x16x32_bf16 v[24:27], a[108:111], a[44:47], v[24:27]
ds_read_b128 a[152:155], v5 offset:384
v_cvt_pk_bf16_f32 v45, v14, v15
ds_read_b128 a[156:159], v5 offset:448
v_mfma_f32_16x16x32_bf16 v[24:27], a[112:115], a[48:51], v[24:27]
ds_read_b128 a[96:99], v4 offset:16896
ds_read_b128 a[100:103], v4 offset:16960
v_mfma_f32_16x16x32_bf16 v[24:27], a[116:119], a[52:55], v[24:27]
v_exp_f32 v20, v20
ds_read_b128 a[104:107], v4 offset:17024
s_add_u32 m0, s49, 1056
s_add_u32 s48, s55, 66560
buffer_load_dwordx4 v3, s[8:11], s48 offen nt lds
v_mfma_f32_16x16x32_bf16 v[24:27], a[120:123], a[56:59], v[24:27]
v_exp_f32 v21, v21
v_max3_f32 v6, v16, v17, v18
v_mfma_f32_16x16x32_bf16 v[24:27], a[124:127], a[60:63], v[24:27]
ds_read_b128 a[108:111], v4 offset:17088
v_exp_f32 v22, v22
v_mfma_f32_16x16x32_bf16 v[28:31], a[128:131], a[64:67], 0
v_max_f32 v6, v6, v19
ds_read_b128 a[112:115], v4 offset:17152
v_mfma_f32_16x16x32_bf16 v[28:31], a[132:135], a[68:71], v[28:31]
v_exp_f32 v23, v23
ds_read_b128 a[116:119], v4 offset:17216
s_waitcnt lgkmcnt(3)
v_mfma_f32_16x16x32_bf16 v[28:31], a[136:139], a[72:75], v[28:31]
v_cvt_pk_bf16_f32 v172, v20, v21
v_cmp_lt_f32 vcc, s50, v6
ds_read_b128 a[120:123], v4 offset:17280
v_mfma_f32_16x16x32_bf16 v[28:31], a[140:143], a[76:79], v[28:31]
v_cvt_pk_bf16_f32 v173, v22, v23
ds_read_b128 a[124:127], v4 offset:17344
s_cbranch_vccnz L_rs0
L_rr0:
v_mfma_f32_16x16x32_bf16 v[28:31], a[144:147], a[80:83], v[28:31]
v_exp_f32 v16, v16
s_add_u32 m0, s49, 2112
s_add_u32 s48, s55, 67584
buffer_load_dwordx4 v3, s[8:11], s48 offen nt lds
v_mfma_f32_16x16x32_bf16 v[28:31], a[148:151], a[84:87], v[28:31]
v_exp_f32 v17, v17
v_max3_f32 v8, v24, v25, v26
v_mfma_f32_16x16x32_bf16 v[28:31], a[152:155], a[88:91], v[28:31]
v_exp_f32 v18, v18
v_max_f32 v8, v8, v27
v_mfma_f32_16x16x32_bf16 v[28:31], a[156:159], a[92:95], v[28:31]
v_exp_f32 v19, v19
v_cvt_pk_bf16_f32 v46, v16, v17
v_mfma_f32_16x16x32_bf16 v[12:15], a[96:99], a[0:3], v[32:35]
v_cmp_lt_f32 vcc, s50, v8
v_cvt_pk_bf16_f32 v47, v18, v19
s_cbranch_vccnz L_rs1
L_rr1:
v_mfma_f32_16x16x32_bf16 v[12:15], a[100:103], a[4:7], v[12:15]
v_exp_f32 v24, v24
v_exp_f32 v25, v25
v_mfma_f32_16x16x32_bf16 a[164:167], a[160:163], v[44:47], 0
v_max3_f32 v6, v28, v29, v30
v_max_f32 v6, v6, v31
v_mov_b32 v7, v6
v_mfma_f32_16x16x32_bf16 v[12:15], a[104:107], a[8:11], v[12:15]
v_permlane32_swap_b32 v6, v7
v_max_f32 v6, v6, v7
v_mov_b32 v7, v6
s_waitcnt lgkmcnt(0)
v_mfma_f32_16x16x32_bf16 v[12:15], a[108:111], a[12:15], v[12:15]
v_permlane16_swap_b32 v6, v7
v_max_f32 v6, v6, v7
v_ceil_f32 v6, v6
v_mfma_f32_16x16x32_bf16 v[12:15], a[112:115], a[16:19], v[12:15]
v_sub_f32 v40, 0, v6
v_sub_f32 v41, 0, v6
v_sub_f32 v42, 0, v6
v_mfma_f32_16x16x32_bf16 v[12:15], a[116:119], a[20:23], v[12:15]
v_sub_f32 v43, 0, v6
v_sub_f32 v28, v28, v6
v_sub_f32 v29, v29, v6
v_mfma_f32_16x16x32_bf16 v[12:15], a[120:123], a[24:27], v[12:15]
v_sub_f32 v30, v30, v6
v_sub_f32 v31, v31, v6
s_add_u32 m0, s49, 3168
s_add_u32 s48, s55, 68608
buffer_load_dwordx4 v3, s[8:11], s48 offen nt lds
v_mfma_f32_16x16x32_bf16 v[12:15], a[124:127], a[28:31], v[12:15]
v_exp_f32 v26, v26
v_mfma_f32_16x16x32_bf16 v[20:23], a[96:99], a[32:35], v[36:39]
v_exp_f32 v27, v27
v_cvt_pk_bf16_f32 v174, v24, v25
v_cvt_pk_bf16_f32 v175, v26, v27
v_mfma_f32_16x16x32_bf16 v[20:23], a[100:103], a[36:39], v[20:23]
ds_read_b128 a[96:99], v4 offset:25344
ds_read_b128 a[100:103], v4 offset:25408
v_mfma_f32_16x16x32_bf16 a[168:171], a[160:163], v[172:175], 0
v_exp_f32 v28, v28
v_mfma_f32_16x16x32_bf16 v[20:23], a[104:107], a[40:43], v[20:23]
ds_read_b128 a[104:107], v4 offset:25472
v_mfma_f32_16x16x32_bf16 v[20:23], a[108:111], a[44:47], v[20:23]
v_exp_f32 v29, v29
v_max3_f32 v6, v12, v13, v14
ds_read_b128 a[108:111], v4 offset:25536
s_add_u32 m0, s49, 4224
s_add_u32 s48, s55, 69632
v_mfma_f32_16x16x32_bf16 v[20:23], a[112:115], a[48:51], v[20:23]
buffer_load_dwordx4 v3, s[8:11], s48 offen nt lds
v_mfma_f32_16x16x32_bf16 v[20:23], a[116:119], a[52:55], v[20:23]
v_exp_f32 v30, v30
v_max_f32 v6, v6, v15
ds_read_b128 a[112:115], v4 offset:25600
v_mfma_f32_16x16x32_bf16 v[20:23], a[120:123], a[56:59], v[20:23]
v_exp_f32 v31, v31
ds_read_b128 a[116:119], v4 offset:25664
v_mfma_f32_16x16x32_bf16 v[20:23], a[124:127], a[60:63], v[20:23]
v_cvt_pk_bf16_f32 v11, v28, v29
v_accvgpr_write_b32 a224, v11
s_waitcnt lgkmcnt(2)
v_mfma_f32_16x16x32_bf16 v[16:19], a[96:99], a[0:3], v[32:35]
v_cmp_lt_f32 vcc, s50, v6
ds_read_b128 a[120:123], v4 offset:25728
v_cvt_pk_bf16_f32 v10, v30, v31
v_mfma_f32_16x16x32_bf16 v[16:19], a[100:103], a[4:7], v[16:19]
v_accvgpr_write_b32 a225, v10
ds_read_b128 a[124:127], v4 offset:25792
s_cbranch_vccnz L_rs2
L_rr2:
v_mfma_f32_16x16x32_bf16 v[16:19], a[104:107], a[8:11], v[16:19]
v_exp_f32 v12, v12
v_mfma_f32_16x16x32_bf16 v[16:19], a[108:111], a[12:15], v[16:19]
v_exp_f32 v13, v13
v_max3_f32 v8, v20, v21, v22
s_waitcnt lgkmcnt(1)
v_mfma_f32_16x16x32_bf16 v[16:19], a[112:115], a[16:19], v[16:19]
v_exp_f32 v14, v14
v_max_f32 v8, v8, v23
s_add_u32 m0, s49, 5280
s_add_u32 s48, s55, 70656
v_mfma_f32_16x16x32_bf16 v[16:19], a[116:119], a[20:23], v[16:19]
buffer_load_dwordx4 v3, s[8:11], s48 offen nt lds
v_mfma_f32_16x16x32_bf16 v[16:19], a[120:123], a[24:27], v[16:19]
v_exp_f32 v15, v15
v_cvt_pk_bf16_f32 v48, v12, v13
v_cmp_lt_f32 vcc, s50, v8
s_waitcnt lgkmcnt(0)
v_mfma_f32_16x16x32_bf16 v[16:19], a[124:127], a[28:31], v[16:19]
v_cvt_pk_bf16_f32 v49, v14, v15
v_add_u32 v4, 33792, v4
v_add_u32 v5, 33792, v5
L_stage8:
s_waitcnt vmcnt(6)
s_barrier
v_mfma_f32_16x16x32_bf16 v[24:27], a[96:99], a[32:35], v[36:39]
ds_read_b128 a[96:99], v4
s_add_u32 m0, s49, 6336
s_add_u32 s48, s55, 71680
buffer_load_dwordx4 v3, s[8:11], s48 offen nt lds
v_mfma_f32_16x16x32_bf16 v[24:27], a[100:103], a[36:39], v[24:27]
ds_read_b128 a[100:103], v4 offset:64
s_cbranch_vccnz L_rs3
L_rr3:
v_mfma_f32_16x16x32_bf16 v[24:27], a[104:107], a[40:43], v[24:27]
v_exp_f32 v20, v20
ds_read_b128 a[104:107], v4 offset:128
v_mfma_f32_16x16x32_bf16 v[24:27], a[108:111], a[44:47], v[24:27]
v_exp_f32 v21, v21
v_max3_f32 v6, v16, v17, v18
v_mfma_f32_16x16x32_bf16 v[24:27], a[112:115], a[48:51], v[24:27]
ds_read_b128 a[108:111], v4 offset:192
v_mfma_f32_16x16x32_bf16 v[24:27], a[116:119], a[52:55], v[24:27]
v_exp_f32 v22, v22
v_max_f32 v6, v6, v19
ds_read_b128 a[112:115], v4 offset:256
v_mfma_f32_16x16x32_bf16 v[24:27], a[120:123], a[56:59], v[24:27]
v_exp_f32 v23, v23
v_mfma_f32_16x16x32_bf16 v[24:27], a[124:127], a[60:63], v[24:27]
ds_read_b128 a[116:119], v4 offset:320
v_cvt_pk_bf16_f32 v176, v20, v21
v_cmp_lt_f32 vcc, s50, v6
s_waitcnt lgkmcnt(2)
v_mfma_f32_16x16x32_bf16 v[12:15], a[96:99], a[0:3], v[32:35]
ds_read_b128 a[120:123], v4 offset:384
v_cvt_pk_bf16_f32 v177, v22, v23
v_mfma_f32_16x16x32_bf16 v[12:15], a[100:103], a[4:7], v[12:15]
ds_read_b128 a[124:127], v4 offset:448
s_add_u32 m0, s49, 7392
s_add_u32 s48, s55, 72704
buffer_load_dwordx4 v3, s[8:11], s48 offen nt lds
s_cbranch_vccnz L_rs4
L_rr4:
v_mfma_f32_16x16x32_bf16 v[12:15], a[104:107], a[8:11], v[12:15]
v_exp_f32 v16, v16
v_mfma_f32_16x16x32_bf16 v[12:15], a[108:111], a[12:15], v[12:15]
v_exp_f32 v17, v17
s_waitcnt lgkmcnt(1)
v_mfma_f32_16x16x32_bf16 v[12:15], a[112:115], a[16:19], v[12:15]
v_max3_f32 v8, v24, v25, v26
v_mfma_f32_16x16x32_bf16 v[12:15], a[116:119], a[20:23], v[12:15]
v_exp_f32 v18, v18
v_max_f32 v8, v8, v27
v_mfma_f32_16x16x32_bf16 v[12:15], a[120:123], a[24:27], v[12:15]
v_exp_f32 v19, v19
s_waitcnt lgkmcnt(0)
v_mfma_f32_16x16x32_bf16 v[12:15], a[124:127], a[28:31], v[12:15]
v_cvt_pk_bf16_f32 v50, v16, v17
v_cmp_lt_f32 vcc, s50, v8
v_mfma_f32_16x16x32_bf16 v[20:23], a[96:99], a[32:35], v[36:39]
v_cvt_pk_bf16_f32 v51, v18, v19
ds_read_b128 a[96:99], v4 offset:8448
v_mfma_f32_16x16x32_bf16 v[20:23], a[100:103], a[36:39], v[20:23]
ds_read_b128 a[100:103], v4 offset:8512
s_add_u32 m0, s49, 33792
s_add_u32 s48, s55, 98304
buffer_load_dwordx4 v3, s[8:11], s48 offen nt lds
v_mfma_f32_16x16x32_bf16 a[164:167], a[160:163], v[48:51], a[164:167]
s_cbranch_vccnz L_rs5
L_rr5:
v_exp_f32 v24, v24
v_mfma_f32_16x16x32_bf16 v[20:23], a[104:107], a[40:43], v[20:23]
ds_read_b128 a[104:107], v4 offset:8576
v_mfma_f32_16x16x32_bf16 v[20:23], a[108:111], a[44:47], v[20:23]
v_exp_f32 v25, v25
v_max3_f32 v6, v12, v13, v14
ds_read_b128 a[108:111], v4 offset:8640
v_mfma_f32_16x16x32_bf16 v[20:23], a[112:115], a[48:51], v[20:23]
v_exp_f32 v26, v26
v_mfma_f32_16x16x32_bf16 v[20:23], a[116:119], a[52:55], v[20:23]
v_max_f32 v6, v6, v15
ds_read_b128 a[112:115], v4 offset:8704
v_mfma_f32_16x16x32_bf16 v[20:23], a[120:123], a[56:59], v[20:23]
v_exp_f32 v27, v27
ds_read_b128 a[116:119], v4 offset:8768
v_mfma_f32_16x16x32_bf16 v[20:23], a[124:127], a[60:63], v[20:23]
v_cvt_pk_bf16_f32 v178, v24, v25
v_cmp_lt_f32 vcc, s50, v6
ds_read_b128 a[120:123], v4 offset:8832
s_waitcnt lgkmcnt(3)
v_mfma_f32_16x16x32_bf16 v[16:19], a[96:99], a[0:3], v[32:35]
v_cvt_pk_bf16_f32 v179, v26, v27
ds_read_b128 a[124:127], v4 offset:8896
v_mfma_f32_16x16x32_bf16 v[16:19], a[100:103], a[4:7], v[16:19]
ds_read_b128 a[128:131], v5
ds_read_b128 a[132:135], v5 offset:64
s_cbranch_vccnz L_rs6
L_rr6:
v_mfma_f32_16x16x32_bf16 a[168:171], a[160:163], v[176:179], a[168:171]
v_exp_f32 v12, v12
ds_read_b128 a[136:139], v5 offset:128
s_add_u32 m0, s49, 34848
v_mfma_f32_16x16x32_bf16 v[16:19], a[104:107], a[8:11], v[16:19]
s_add_u32 s48, s55, 99328
buffer_load_dwordx4 v3, s[8:11], s48 offen nt lds
v_mfma_f32_16x16x32_bf16 v[16:19], a[108:111], a[12:15], v[16:19]
v_exp_f32 v13, v13
v_max3_f32 v8, v20, v21, v22
s_waitcnt lgkmcnt(1)
v_mfma_f32_16x16x32_bf16 v[16:19], a[112:115], a[16:19], v[16:19]
ds_read_b128 a[140:143], v5 offset:192
v_exp_f32 v14, v14
v_mfma_f32_16x16x32_bf16 v[16:19], a[116:119], a[20:23], v[16:19]
v_max_f32 v8, v8, v23
ds_read_b128 a[144:147], v5 offset:256
v_mfma_f32_16x16x32_bf16 v[16:19], a[120:123], a[24:27], v[16:19]
v_exp_f32 v15, v15
ds_read_b128 a[148:151], v5 offset:320
v_mfma_f32_16x16x32_bf16 v[16:19], a[124:127], a[28:31], v[16:19]
v_cvt_pk_bf16_f32 v52, v12, v13
v_cmp_lt_f32 vcc, s50, v8
v_mfma_f32_16x16x32_bf16 v[24:27], a[96:99], a[32:35], v[36:39]
ds_read_b128 a[152:155], v5 offset:384
v_cvt_pk_bf16_f32 v53, v14, v15
ds_read_b128 a[156:159], v5 offset:448
v_mfma_f32_16x16x32_bf16 v[24:27], a[100:103], a[36:39], v[24:27]
ds_read_b128 a[96:99], v4 offset:16896
ds_read_b128 a[100:103], v4 offset:16960
s_cbranch_vccnz L_rs7
L_rr7:
v_mfma_f32_16x16x32_bf16 v[24:27], a[104:107], a[40:43], v[24:27]
v_exp_f32 v20, v20
v_mfma_f32_16x16x32_bf16 v[24:27], a[108:111], a[44:47], v[24:27]
ds_read_b128 a[104:107], v4 offset:17024
s_add_u32 m0, s49, 35904
s_add_u32 s48, s55, 100352
buffer_load_dwordx4 v3, s[8:11], s48 offen nt lds
v_mfma_f32_16x16x32_bf16 v[24:27], a[112:115], a[48:51], v[24:27]
v_exp_f32 v21, v21
v_mfma_f32_16x16x32_bf16 v[24:27], a[116:119], a[52:55], v[24:27]
v_max3_f32 v6, v16, v17, v18
ds_read_b128 a[108:111], v4 offset:17088
v_mfma_f32_16x16x32_bf16 v[24:27], a[120:123], a[56:59], v[24:27]
v_exp_f32 v22, v22
v_max_f32 v6, v6, v19
v_mfma_f32_16x16x32_bf16 v[24:27], a[124:127], a[60:63], v[24:27]
ds_read_b128 a[112:115], v4 offset:17152
v_mfma_f32_16x16x32_bf16 v[28:31], a[128:131], a[64:67], v[40:43]
v_exp_f32 v23, v23
ds_read_b128 a[116:119], v4 offset:17216
v_cvt_pk_bf16_f32 v180, v20, v21
v_mfma_f32_16x16x32_bf16 v[28:31], a[132:135], a[68:71], v[28:31]
v_cmp_lt_f32 vcc, s50, v6
ds_read_b128 a[120:123], v4 offset:17280
s_waitcnt lgkmcnt(3)
v_mfma_f32_16x16x32_bf16 v[28:31], a[136:139], a[72:75], v[28:31]
v_cvt_pk_bf16_f32 v181, v22, v23
ds_read_b128 a[124:127], v4 offset:17344
s_cbranch_vccnz L_rs8
L_rr8:
v_mfma_f32_16x16x32_bf16 v[28:31], a[140:143], a[76:79], v[28:31]
v_exp_f32 v16, v16
v_mfma_f32_16x16x32_bf16 v[28:31], a[144:147], a[80:83], v[28:31]
v_exp_f32 v17, v17
v_max3_f32 v8, v24, v25, v26
s_add_u32 m0, s49, 36960
v_mfma_f32_16x16x32_bf16 v[28:31], a[148:151], a[84:87], v[28:31]
s_add_u32 s48, s55, 101376
buffer_load_dwordx4 v3, s[8:11], s48 offen nt lds
v_mfma_f32_16x16x32_bf16 v[28:31], a[152:155], a[88:91], v[28:31]
v_exp_f32 v18, v18
v_max_f32 v8, v8, v27
v_mfma_f32_16x16x32_bf16 v[28:31], a[156:159], a[92:95], v[28:31]
v_exp_f32 v19, v19
v_mfma_f32_16x16x32_bf16 v[12:15], a[96:99], a[0:3], v[32:35]
v_cvt_pk_bf16_f32 v54, v16, v17
v_cmp_lt_f32 vcc, s50, v8
v_cvt_pk_bf16_f32 v55, v18, v19
s_cbranch_vccnz L_rs9
L_rr9:
v_mfma_f32_16x16x32_bf16 v[12:15], a[100:103], a[4:7], v[12:15]
v_mfma_f32_16x16x32_bf16 a[164:167], a[160:163], v[52:55], a[164:167]
v_exp_f32 v24, v24
v_mfma_f32_16x16x32_bf16 v[12:15], a[104:107], a[8:11], v[12:15]
v_exp_f32 v25, v25
v_max3_f32 v6, v28, v29, v30
v_mfma_f32_16x16x32_bf16 v[12:15], a[108:111], a[12:15], v[12:15]
s_add_u32 m0, s49, 38016
s_add_u32 s48, s55, 102400
buffer_load_dwordx4 v3, s[8:11], s48 offen nt lds
s_waitcnt lgkmcnt(0)
v_mfma_f32_16x16x32_bf16 v[12:15], a[112:115], a[16:19], v[12:15]
v_exp_f32 v26, v26
v_mfma_f32_16x16x32_bf16 v[12:15], a[116:119], a[20:23], v[12:15]
v_max_f32 v6, v6, v31
v_mfma_f32_16x16x32_bf16 v[12:15], a[120:123], a[24:27], v[12:15]
v_exp_f32 v27, v27
v_mfma_f32_16x16x32_bf16 v[12:15], a[124:127], a[28:31], v[12:15]
v_cvt_pk_bf16_f32 v182, v24, v25
v_cmp_lt_f32 vcc, s50, v6
v_mfma_f32_16x16x32_bf16 v[20:23], a[96:99], a[32:35], v[36:39]
v_cvt_pk_bf16_f32 v183, v26, v27
ds_read_b128 a[96:99], v4 offset:25344
v_mfma_f32_16x16x32_bf16 v[20:23], a[100:103], a[36:39], v[20:23]
ds_read_b128 a[100:103], v4 offset:25408
s_cbranch_vccnz L_rs10
L_rr10:
v_mfma_f32_16x16x32_bf16 a[168:171], a[160:163], v[180:183], a[168:171]
v_exp_f32 v28, v28
v_mfma_f32_16x16x32_bf16 v[20:23], a[104:107], a[40:43], v[20:23]
ds_read_b128 a[104:107], v4 offset:25472
v_exp_f32 v29, v29
v_mfma_f32_16x16x32_bf16 v[20:23], a[108:111], a[44:47], v[20:23]
v_max3_f32 v6, v12, v13, v14
ds_read_b128 a[108:111], v4 offset:25536
v_mfma_f32_16x16x32_bf16 v[20:23], a[112:115], a[48:51], v[20:23]
v_exp_f32 v30, v30
v_max_f32 v6, v6, v15
v_mfma_f32_16x16x32_bf16 v[20:23], a[116:119], a[52:55], v[20:23]
ds_read_b128 a[112:115], v4 offset:25600
s_add_u32 m0, s49, 39072
s_add_u32 s48, s55, 103424
buffer_load_dwordx4 v3, s[8:11], s48 offen nt lds
v_mfma_f32_16x16x32_bf16 v[20:23], a[120:123], a[56:59], v[20:23]
v_exp_f32 v31, v31
ds_read_b128 a[116:119], v4 offset:25664
v_mfma_f32_16x16x32_bf16 v[20:23], a[124:127], a[60:63], v[20:23]
v_cvt_pk_bf16_f32 v11, v28, v29
v_accvgpr_write_b32 a226, v11
v_cmp_lt_f32 vcc, s50, v6
s_waitcnt lgkmcnt(1)
v_mfma_f32_16x16x32_bf16 v[16:19], a[96:99], a[0:3], v[32:35]
ds_read_b128 a[120:123], v4 offset:25728
v_cvt_pk_bf16_f32 v10, v30, v31
v_accvgpr_write_b32 a227, v10
v_mfma_f32_16x16x32_bf16 v[16:19], a[100:103], a[4:7], v[16:19]
ds_read_b128 a[124:127], v4 offset:25792
s_cbranch_vccnz L_rs11
L_rr11:
v_mfma_f32_16x16x32_bf16 a[172:175], a[160:163], a[224:227], 0
v_exp_f32 v12, v12
v_mfma_f32_16x16x32_bf16 v[16:19], a[104:107], a[8:11], v[16:19]
v_exp_f32 v13, v13
v_max3_f32 v8, v20, v21, v22
v_mfma_f32_16x16x32_bf16 v[16:19], a[108:111], a[12:15], v[16:19]
v_exp_f32 v14, v14
v_mfma_f32_16x16x32_bf16 v[16:19], a[112:115], a[16:19], v[16:19]
v_max_f32 v8, v8, v23
s_waitcnt lgkmcnt(0)
v_mfma_f32_16x16x32_bf16 v[16:19], a[116:119], a[20:23], v[16:19]
v_exp_f32 v15, v15
v_cvt_pk_bf16_f32 v56, v12, v13
v_mfma_f32_16x16x32_bf16 v[16:19], a[120:123], a[24:27], v[16:19]
v_cmp_lt_f32 vcc, s50, v8
v_cvt_pk_bf16_f32 v57, v14, v15
v_mfma_f32_16x16x32_bf16 v[16:19], a[124:127], a[28:31], v[16:19]
v_subrev_u32 v4, 67584, v4
v_subrev_u32 v5, 67584, v5
L_stage9:
s_waitcnt vmcnt(6)
s_barrier
v_mfma_f32_16x16x32_bf16 v[24:27], a[96:99], a[32:35], v[36:39]
ds_read_b128 a[96:99], v4
s_add_u32 m0, s49, 40128
s_add_u32 s48, s55, 104448
buffer_load_dwordx4 v3, s[8:11], s48 offen nt lds
v_mfma_f32_16x16x32_bf16 v[24:27], a[100:103], a[36:39], v[24:27]
ds_read_b128 a[100:103], v4 offset:64
s_cbranch_vccnz L_rs12
L_rr12:
v_mfma_f32_16x16x32_bf16 v[24:27], a[104:107], a[40:43], v[24:27]
v_exp_f32 v20, v20
ds_read_b128 a[104:107], v4 offset:128
v_mfma_f32_16x16x32_bf16 v[24:27], a[108:111], a[44:47], v[24:27]
v_exp_f32 v21, v21
v_max3_f32 v6, v16, v17, v18
v_mfma_f32_16x16x32_bf16 v[24:27], a[112:115], a[48:51], v[24:27]
ds_read_b128 a[108:111], v4 offset:192
v_mfma_f32_16x16x32_bf16 v[24:27], a[116:119], a[52:55], v[24:27]
v_exp_f32 v22, v22
v_max_f32 v6, v6, v19
ds_read_b128 a[112:115], v4 offset:256
v_mfma_f32_16x16x32_bf16 v[24:27], a[120:123], a[56:59], v[24:27]
v_exp_f32 v23, v23
v_mfma_f32_16x16x32_bf16 v[24:27], a[124:127], a[60:63], v[24:27]
ds_read_b128 a[116:119], v4 offset:320
v_cvt_pk_bf16_f32 v184, v20, v21
v_cmp_lt_f32 vcc, s50, v6
s_waitcnt lgkmcnt(2)
v_mfma_f32_16x16x32_bf16 v[12:15], a[96:99], a[0:3], v[32:35]
ds_read_b128 a[120:123], v4 offset:384
v_cvt_pk_bf16_f32 v185, v22, v23
v_mfma_f32_16x16x32_bf16 v[12:15], a[100:103], a[4:7], v[12:15]
ds_read_b128 a[124:127], v4 offset:448
s_add_u32 m0, s49, 41184
s_add_u32 s48, s55, 105472
buffer_load_dwordx4 v3, s[8:11], s48 offen nt lds
s_cbranch_vccnz L_rs13
L_rr13:
v_mfma_f32_16x16x32_bf16 v[12:15], a[104:107], a[8:11], v[12:15]
v_exp_f32 v16, v16
v_mfma_f32_16x16x32_bf16 v[12:15], a[108:111], a[12:15], v[12:15]
v_exp_f32 v17, v17
s_waitcnt lgkmcnt(1)
v_mfma_f32_16x16x32_bf16 v[12:15], a[112:115], a[16:19], v[12:15]
v_max3_f32 v8, v24, v25, v26
v_mfma_f32_16x16x32_bf16 v[12:15], a[116:119], a[20:23], v[12:15]
v_exp_f32 v18, v18
v_max_f32 v8, v8, v27
v_mfma_f32_16x16x32_bf16 v[12:15], a[120:123], a[24:27], v[12:15]
v_exp_f32 v19, v19
s_waitcnt lgkmcnt(0)
v_mfma_f32_16x16x32_bf16 v[12:15], a[124:127], a[28:31], v[12:15]
v_cvt_pk_bf16_f32 v58, v16, v17
v_cmp_lt_f32 vcc, s50, v8
v_mfma_f32_16x16x32_bf16 v[20:23], a[96:99], a[32:35], v[36:39]
v_cvt_pk_bf16_f32 v59, v18, v19
s_add_u32 m0, s49, 67584
s_add_u32 s48, s55, 131072
buffer_load_dwordx4 v3, s[8:11], s48 offen nt lds
v_mfma_f32_16x16x32_bf16 v[20:23], a[100:103], a[36:39], v[20:23]
ds_read_b128 a[96:99], v4 offset:8448
ds_read_b128 a[100:103], v4 offset:8512
s_cbranch_vccnz L_rs14
L_rr14:
v_mfma_f32_16x16x32_bf16 a[164:167], a[160:163], v[56:59], a[164:167]
v_exp_f32 v24, v24
v_mfma_f32_16x16x32_bf16 v[20:23], a[104:107], a[40:43], v[20:23]
ds_read_b128 a[104:107], v4 offset:8576
v_mfma_f32_16x16x32_bf16 v[20:23], a[108:111], a[44:47], v[20:23]
v_exp_f32 v25, v25
v_max3_f32 v6, v12, v13, v14
ds_read_b128 a[108:111], v4 offset:8640
v_mfma_f32_16x16x32_bf16 v[20:23], a[112:115], a[48:51], v[20:23]
v_exp_f32 v26, v26
v_mfma_f32_16x16x32_bf16 v[20:23], a[116:119], a[52:55], v[20:23]
v_max_f32 v6, v6, v15
ds_read_b128 a[112:115], v4 offset:8704
v_mfma_f32_16x16x32_bf16 v[20:23], a[120:123], a[56:59], v[20:23]
v_exp_f32 v27, v27
ds_read_b128 a[116:119], v4 offset:8768
v_mfma_f32_16x16x32_bf16 v[20:23], a[124:127], a[60:63], v[20:23]
v_cvt_pk_bf16_f32 v186, v24, v25
v_cmp_lt_f32 vcc, s50, v6
ds_read_b128 a[120:123], v4 offset:8832
s_waitcnt lgkmcnt(3)
v_mfma_f32_16x16x32_bf16 v[16:19], a[96:99], a[0:3], v[32:35]
v_cvt_pk_bf16_f32 v187, v26, v27
ds_read_b128 a[124:127], v4 offset:8896
buffer_load_dword v9, off, s[36:39], 0 sc1
v_mfma_f32_16x16x32_bf16 v[16:19], a[100:103], a[4:7], v[16:19]
ds_read_b128 a[128:131], v5
ds_read_b128 a[132:135], v5 offset:64
s_cbranch_vccnz L_rs15
L_rr15:
v_mfma_f32_16x16x32_bf16 a[168:171], a[160:163], v[184:187], a[168:171]
v_exp_f32 v12, v12
v_mfma_f32_16x16x32_bf16 v[16:19], a[104:107], a[8:11], v[16:19]
ds_read_b128 a[136:139], v5 offset:128
v_exp_f32 v13, v13
v_mfma_f32_16x16x32_bf16 v[16:19], a[108:111], a[12:15], v[16:19]
v_max3_f32 v8, v20, v21, v22
ds_read_b128 a[140:143], v5 offset:192
s_waitcnt lgkmcnt(2)
v_mfma_f32_16x16x32_bf16 v[16:19], a[112:115], a[16:19], v[16:19]
v_exp_f32 v14, v14
v_max_f32 v8, v8, v23
v_mfma_f32_16x16x32_bf16 v[16:19], a[116:119], a[20:23], v[16:19]
ds_read_b128 a[144:147], v5 offset:256
v_mfma_f32_16x16x32_bf16 v[16:19], a[120:123], a[24:27], v[16:19]
v_exp_f32 v15, v15
ds_read_b128 a[148:151], v5 offset:320
v_cvt_pk_bf16_f32 v60, v12, v13
v_mfma_f32_16x16x32_bf16 v[16:19], a[124:127], a[28:31], v[16:19]
v_cmp_lt_f32 vcc, s50, v8
ds_read_b128 a[152:155], v5 offset:384
v_mfma_f32_16x16x32_bf16 v[24:27], a[96:99], a[32:35], v[36:39]
v_cvt_pk_bf16_f32 v61, v14, v15
ds_read_b128 a[156:159], v5 offset:448
s_add_u32 m0, s49, 68640
s_add_u32 s48, s55, 132096
buffer_load_dwordx4 v3, s[8:11], s48 offen nt lds
v_mfma_f32_16x16x32_bf16 v[24:27], a[100:103], a[36:39], v[24:27]
ds_read_b128 a[96:99], v4 offset:16896
ds_read_b128 a[100:103], v4 offset:16960
s_cbranch_vccnz L_rs16
L_rr16:
v_mfma_f32_16x16x32_bf16 v[24:27], a[104:107], a[40:43], v[24:27]
v_exp_f32 v20, v20
v_mfma_f32_16x16x32_bf16 v[24:27], a[108:111], a[44:47], v[24:27]
ds_read_b128 a[104:107], v4 offset:17024
v_exp_f32 v21, v21
v_mfma_f32_16x16x32_bf16 v[24:27], a[112:115], a[48:51], v[24:27]
v_max3_f32 v6, v16, v17, v18
ds_read_b128 a[108:111], v4 offset:17088
v_mfma_f32_16x16x32_bf16 v[24:27], a[116:119], a[52:55], v[24:27]
v_exp_f32 v22, v22
v_mfma_f32_16x16x32_bf16 v[24:27], a[120:123], a[56:59], v[24:27]
v_max_f32 v6, v6, v19
ds_read_b128 a[112:115], v4 offset:17152
v_mfma_f32_16x16x32_bf16 v[24:27], a[124:127], a[60:63], v[24:27]
v_exp_f32 v23, v23
ds_read_b128 a[116:119], v4 offset:17216
v_mfma_f32_16x16x32_bf16 v[28:31], a[128:131], a[64:67], v[40:43]
v_cvt_pk_bf16_f32 v188, v20, v21
v_cmp_lt_f32 vcc, s50, v6
v_mfma_f32_16x16x32_bf16 v[28:31], a[132:135], a[68:71], v[28:31]
ds_read_b128 a[120:123], v4 offset:17280
s_add_u32 m0, s49, 69696
s_add_u32 s48, s55, 133120
buffer_load_dwordx4 v3, s[8:11], s48 offen nt lds
s_waitcnt lgkmcnt(2)
v_mfma_f32_16x16x32_bf16 v[28:31], a[136:139], a[72:75], v[28:31]
v_cvt_pk_bf16_f32 v189, v22, v23
ds_read_b128 a[124:127], v4 offset:17344
s_cbranch_vccnz L_rs17
L_rr17:
v_mfma_f32_16x16x32_bf16 v[28:31], a[140:143], a[76:79], v[28:31]
v_exp_f32 v16, v16
v_mfma_f32_16x16x32_bf16 v[28:31], a[144:147], a[80:83], v[28:31]
v_exp_f32 v17, v17
v_max3_f32 v8, v24, v25, v26
v_mfma_f32_16x16x32_bf16 v[28:31], a[148:151], a[84:87], v[28:31]
v_exp_f32 v18, v18
v_mfma_f32_16x16x32_bf16 v[28:31], a[152:155], a[88:91], v[28:31]
v_max_f32 v8, v8, v27
v_exp_f32 v19, v19
v_mfma_f32_16x16x32_bf16 v[28:31], a[156:159], a[92:95], v[28:31]
v_cvt_pk_bf16_f32 v62, v16, v17
v_cmp_lt_f32 vcc, s50, v8
s_add_u32 m0, s49, 70752
v_mfma_f32_16x16x32_bf16 v[12:15], a[96:99], a[0:3], v[32:35]
s_add_u32 s48, s55, 134144
buffer_load_dwordx4 v3, s[8:11], s48 offen nt lds
v_cvt_pk_bf16_f32 v63, v18, v19
s_cbranch_vccnz L_rs18
L_rr18:
v_mfma_f32_16x16x32_bf16 v[12:15], a[100:103], a[4:7], v[12:15]
v_mfma_f32_16x16x32_bf16 a[164:167], a[160:163], v[60:63], a[164:167]
v_exp_f32 v24, v24
v_mfma_f32_16x16x32_bf16 v[12:15], a[104:107], a[8:11], v[12:15]
v_exp_f32 v25, v25
v_max3_f32 v6, v28, v29, v30
v_mfma_f32_16x16x32_bf16 v[12:15], a[108:111], a[12:15], v[12:15]
v_mfma_f32_16x16x32_bf16 v[12:15], a[112:115], a[16:19], v[12:15]
v_exp_f32 v26, v26
v_max_f32 v6, v6, v31
s_waitcnt lgkmcnt(0)
v_mfma_f32_16x16x32_bf16 v[12:15], a[116:119], a[20:23], v[12:15]
v_exp_f32 v27, v27
s_add_u32 m0, s49, 71808
v_mfma_f32_16x16x32_bf16 v[12:15], a[120:123], a[24:27], v[12:15]
s_add_u32 s48, s55, 135168
buffer_load_dwordx4 v3, s[8:11], s48 offen nt lds
v_mfma_f32_16x16x32_bf16 v[12:15], a[124:127], a[28:31], v[12:15]
v_cvt_pk_bf16_f32 v190, v24, v25
v_cmp_lt_f32 vcc, s50, v6
v_mfma_f32_16x16x32_bf16 v[20:23], a[96:99], a[32:35], v[36:39]
v_cvt_pk_bf16_f32 v191, v26, v27
ds_read_b128 a[96:99], v4 offset:25344
v_mfma_f32_16x16x32_bf16 v[20:23], a[100:103], a[36:39], v[20:23]
ds_read_b128 a[100:103], v4 offset:25408
s_cbranch_vccnz L_rs19
L_rr19:
v_mfma_f32_16x16x32_bf16 a[168:171], a[160:163], v[188:191], a[168:171]
v_exp_f32 v28, v28
v_mfma_f32_16x16x32_bf16 v[20:23], a[104:107], a[40:43], v[20:23]
ds_read_b128 a[104:107], v4 offset:25472
v_mfma_f32_16x16x32_bf16 v[20:23], a[108:111], a[44:47], v[20:23]
v_exp_f32 v29, v29
v_max3_f32 v6, v12, v13, v14
ds_read_b128 a[108:111], v4 offset:25536
v_mfma_f32_16x16x32_bf16 v[20:23], a[112:115], a[48:51], v[20:23]
v_exp_f32 v30, v30
v_max_f32 v6, v6, v15
v_mfma_f32_16x16x32_bf16 v[20:23], a[116:119], a[52:55], v[20:23]
ds_read_b128 a[112:115], v4 offset:25600
v_mfma_f32_16x16x32_bf16 v[20:23], a[120:123], a[56:59], v[20:23]
v_exp_f32 v31, v31
ds_read_b128 a[116:119], v4 offset:25664
s_add_u32 m0, s49, 72864
s_add_u32 s48, s55, 136192
v_mfma_f32_16x16x32_bf16 v[20:23], a[124:127], a[60:63], v[20:23]
buffer_load_dwordx4 v3, s[8:11], s48 offen nt lds
v_cvt_pk_bf16_f32 v11, v28, v29
v_accvgpr_write_b32 a228, v11
s_waitcnt lgkmcnt(1)
v_mfma_f32_16x16x32_bf16 v[16:19], a[96:99], a[0:3], v[32:35]
v_cmp_lt_f32 vcc, s50, v6
ds_read_b128 a[120:123], v4 offset:25728
v_mfma_f32_16x16x32_bf16 v[16:19], a[100:103], a[4:7], v[16:19]
v_cvt_pk_bf16_f32 v10, v30, v31
v_accvgpr_write_b32 a229, v10
ds_read_b128 a[124:127], v4 offset:25792
s_cbranch_vccnz L_rs20
L_rr20:
v_mfma_f32_16x16x32_bf16 v[16:19], a[104:107], a[8:11], v[16:19]
v_exp_f32 v12, v12
v_mfma_f32_16x16x32_bf16 v[16:19], a[108:111], a[12:15], v[16:19]
v_exp_f32 v13, v13
v_max3_f32 v8, v20, v21, v22
v_mfma_f32_16x16x32_bf16 v[16:19], a[112:115], a[16:19], v[16:19]
v_exp_f32 v14, v14
s_waitcnt lgkmcnt(1)
v_mfma_f32_16x16x32_bf16 v[16:19], a[116:119], a[20:23], v[16:19]
v_max_f32 v8, v8, v23
v_exp_f32 v15, v15
v_mfma_f32_16x16x32_bf16 v[16:19], a[120:123], a[24:27], v[16:19]
v_cvt_pk_bf16_f32 v64, v12, v13
v_cmp_lt_f32 vcc, s50, v8
s_waitcnt lgkmcnt(0)
v_mfma_f32_16x16x32_bf16 v[16:19], a[124:127], a[28:31], v[16:19]
v_cvt_pk_bf16_f32 v65, v14, v15
v_add_u32 v4, 33792, v4
v_add_u32 v5, 33792, v5
L_stage10:
s_waitcnt vmcnt(7)
s_barrier
v_mfma_f32_16x16x32_bf16 v[24:27], a[96:99], a[32:35], v[36:39]
ds_read_b128 a[96:99], v4
s_add_u32 m0, s49, 73920
s_add_u32 s48, s55, 137216
buffer_load_dwordx4 v3, s[8:11], s48 offen nt lds
v_mfma_f32_16x16x32_bf16 v[24:27], a[100:103], a[36:39], v[24:27]
ds_read_b128 a[100:103], v4 offset:64
s_cbranch_vccnz L_rs21
L_rr21:
v_mfma_f32_16x16x32_bf16 v[24:27], a[104:107], a[40:43], v[24:27]
v_exp_f32 v20, v20
ds_read_b128 a[104:107], v4 offset:128
v_mfma_f32_16x16x32_bf16 v[24:27], a[108:111], a[44:47], v[24:27]
v_exp_f32 v21, v21
v_max3_f32 v6, v16, v17, v18
v_mfma_f32_16x16x32_bf16 v[24:27], a[112:115], a[48:51], v[24:27]
ds_read_b128 a[108:111], v4 offset:192
v_mfma_f32_16x16x32_bf16 v[24:27], a[116:119], a[52:55], v[24:27]
v_exp_f32 v22, v22
v_max_f32 v6, v6, v19
ds_read_b128 a[112:115], v4 offset:256
v_mfma_f32_16x16x32_bf16 v[24:27], a[120:123], a[56:59], v[24:27]
v_exp_f32 v23, v23
v_mfma_f32_16x16x32_bf16 v[24:27], a[124:127], a[60:63], v[24:27]
ds_read_b128 a[116:119], v4 offset:320
v_cvt_pk_bf16_f32 v192, v20, v21
v_cmp_lt_f32 vcc, s50, v6
s_waitcnt lgkmcnt(2)
v_mfma_f32_16x16x32_bf16 v[12:15], a[96:99], a[0:3], v[32:35]
ds_read_b128 a[120:123], v4 offset:384
v_cvt_pk_bf16_f32 v193, v22, v23
v_mfma_f32_16x16x32_bf16 v[12:15], a[100:103], a[4:7], v[12:15]
ds_read_b128 a[124:127], v4 offset:448
s_add_u32 m0, s49, 74976
s_add_u32 s48, s55, 138240
buffer_load_dwordx4 v3, s[8:11], s48 offen nt lds
s_cbranch_vccnz L_rs22
L_rr22:
v_mfma_f32_16x16x32_bf16 v[12:15], a[104:107], a[8:11], v[12:15]
v_exp_f32 v16, v16
v_mfma_f32_16x16x32_bf16 v[12:15], a[108:111], a[12:15], v[12:15]
v_exp_f32 v17, v17
s_waitcnt lgkmcnt(1)
v_mfma_f32_16x16x32_bf16 v[12:15], a[112:115], a[16:19], v[12:15]
v_max3_f32 v8, v24, v25, v26
v_mfma_f32_16x16x32_bf16 v[12:15], a[116:119], a[20:23], v[12:15]
v_exp_f32 v18, v18
v_max_f32 v8, v8, v27
v_mfma_f32_16x16x32_bf16 v[12:15], a[120:123], a[24:27], v[12:15]
v_exp_f32 v19, v19
s_waitcnt lgkmcnt(0)
v_mfma_f32_16x16x32_bf16 v[12:15], a[124:127], a[28:31], v[12:15]
v_cvt_pk_bf16_f32 v66, v16, v17
v_cmp_lt_f32 vcc, s50, v8
v_mfma_f32_16x16x32_bf16 v[20:23], a[96:99], a[32:35], v[36:39]
v_cvt_pk_bf16_f32 v67, v18, v19
ds_read_b128 a[96:99], v4 offset:8448
v_mfma_f32_16x16x32_bf16 v[20:23], a[100:103], a[36:39], v[20:23]
ds_read_b128 a[100:103], v4 offset:8512
s_add_u32 m0, s49, 0
s_add_u32 s48, s55, 163840
buffer_load_dwordx4 v3, s[8:11], s48 offen nt lds
v_mfma_f32_16x16x32_bf16 a[164:167], a[160:163], v[64:67], a[164:167]
s_cbranch_vccnz L_rs23
L_rr23:
v_exp_f32 v24, v24
v_mfma_f32_16x16x32_bf16 v[20:23], a[104:107], a[40:43], v[20:23]
ds_read_b128 a[104:107], v4 offset:8576
v_mfma_f32_16x16x32_bf16 v[20:23], a[108:111], a[44:47], v[20:23]
v_exp_f32 v25, v25
v_max3_f32 v6, v12, v13, v14
ds_read_b128 a[108:111], v4 offset:8640
v_mfma_f32_16x16x32_bf16 v[20:23], a[112:115], a[48:51], v[20:23]
v_exp_f32 v26, v26
v_mfma_f32_16x16x32_bf16 v[20:23], a[116:119], a[52:55], v[20:23]
v_max_f32 v6, v6, v15
ds_read_b128 a[112:115], v4 offset:8704
v_mfma_f32_16x16x32_bf16 v[20:23], a[120:123], a[56:59], v[20:23]
v_exp_f32 v27, v27
ds_read_b128 a[116:119], v4 offset:8768
v_mfma_f32_16x16x32_bf16 v[20:23], a[124:127], a[60:63], v[20:23]
v_cvt_pk_bf16_f32 v194, v24, v25
v_cmp_lt_f32 vcc, s50, v6
ds_read_b128 a[120:123], v4 offset:8832
s_waitcnt lgkmcnt(3)
v_mfma_f32_16x16x32_bf16 v[16:19], a[96:99], a[0:3], v[32:35]
v_cvt_pk_bf16_f32 v195, v26, v27
ds_read_b128 a[124:127], v4 offset:8896
v_mfma_f32_16x16x32_bf16 v[16:19], a[100:103], a[4:7], v[16:19]
ds_read_b128 a[128:131], v5
ds_read_b128 a[132:135], v5 offset:64
s_cbranch_vccnz L_rs24
L_rr24:
v_mfma_f32_16x16x32_bf16 a[168:171], a[160:163], v[192:195], a[168:171]
v_exp_f32 v12, v12
ds_read_b128 a[136:139], v5 offset:128
s_add_u32 m0, s49, 1056
v_mfma_f32_16x16x32_bf16 v[16:19], a[104:107], a[8:11], v[16:19]
s_add_u32 s48, s55, 164864
buffer_load_dwordx4 v3, s[8:11], s48 offen nt lds
v_mfma_f32_16x16x32_bf16 v[16:19], a[108:111], a[12:15], v[16:19]
v_exp_f32 v13, v13
v_max3_f32 v8, v20, v21, v22
s_waitcnt lgkmcnt(1)
v_mfma_f32_16x16x32_bf16 v[16:19], a[112:115], a[16:19], v[16:19]
ds_read_b128 a[140:143], v5 offset:192
v_exp_f32 v14, v14
v_mfma_f32_16x16x32_bf16 v[16:19], a[116:119], a[20:23], v[16:19]
v_max_f32 v8, v8, v23
ds_read_b128 a[144:147], v5 offset:256
v_mfma_f32_16x16x32_bf16 v[16:19], a[120:123], a[24:27], v[16:19]
v_exp_f32 v15, v15
ds_read_b128 a[148:151], v5 offset:320
v_mfma_f32_16x16x32_bf16 v[16:19], a[124:127], a[28:31], v[16:19]
v_cvt_pk_bf16_f32 v68, v12, v13
v_cmp_lt_f32 vcc, s50, v8
v_mfma_f32_16x16x32_bf16 v[24:27], a[96:99], a[32:35], v[36:39]
ds_read_b128 a[152:155], v5 offset:384
v_cvt_pk_bf16_f32 v69, v14, v15
ds_read_b128 a[156:159], v5 offset:448
v_mfma_f32_16x16x32_bf16 v[24:27], a[100:103], a[36:39], v[24:27]
ds_read_b128 a[96:99], v4 offset:16896
ds_read_b128 a[100:103], v4 offset:16960
s_cbranch_vccnz L_rs25
L_rr25:
v_mfma_f32_16x16x32_bf16 v[24:27], a[104:107], a[40:43], v[24:27]
v_exp_f32 v20, v20
v_mfma_f32_16x16x32_bf16 v[24:27], a[108:111], a[44:47], v[24:27]
ds_read_b128 a[104:107], v4 offset:17024
s_add_u32 m0, s49, 2112
s_add_u32 s48, s55, 165888
buffer_load_dwordx4 v3, s[8:11], s48 offen nt lds
v_mfma_f32_16x16x32_bf16 v[24:27], a[112:115], a[48:51], v[24:27]
v_exp_f32 v21, v21
v_mfma_f32_16x16x32_bf16 v[24:27], a[116:119], a[52:55], v[24:27]
v_max3_f32 v6, v16, v17, v18
ds_read_b128 a[108:111], v4 offset:17088
v_mfma_f32_16x16x32_bf16 v[24:27], a[120:123], a[56:59], v[24:27]
v_exp_f32 v22, v22
v_max_f32 v6, v6, v19
v_mfma_f32_16x16x32_bf16 v[24:27], a[124:127], a[60:63], v[24:27]
ds_read_b128 a[112:115], v4 offset:17152
v_mfma_f32_16x16x32_bf16 v[28:31], a[128:131], a[64:67], v[40:43]
v_exp_f32 v23, v23
ds_read_b128 a[116:119], v4 offset:17216
v_cvt_pk_bf16_f32 v196, v20, v21
v_mfma_f32_16x16x32_bf16 v[28:31], a[132:135], a[68:71], v[28:31]
v_cmp_lt_f32 vcc, s50, v6
ds_read_b128 a[120:123], v4 offset:17280
s_waitcnt lgkmcnt(3)
v_mfma_f32_16x16x32_bf16 v[28:31], a[136:139], a[72:75], v[28:31]
v_cvt_pk_bf16_f32 v197, v22, v23
ds_read_b128 a[124:127], v4 offset:17344
s_cbranch_vccnz L_rs26
L_rr26:
v_mfma_f32_16x16x32_bf16 v[28:31], a[140:143], a[76:79], v[28:31]
v_exp_f32 v16, v16
v_mfma_f32_16x16x32_bf16 v[28:31], a[144:147], a[80:83], v[28:31]
v_exp_f32 v17, v17
v_max3_f32 v8, v24, v25, v26
s_add_u32 m0, s49, 3168
v_mfma_f32_16x16x32_bf16 v[28:31], a[148:151], a[84:87], v[28:31]
s_add_u32 s48, s55, 166912
buffer_load_dwordx4 v3, s[8:11], s48 offen nt lds
v_mfma_f32_16x16x32_bf16 v[28:31], a[152:155], a[88:91], v[28:31]
v_exp_f32 v18, v18
v_max_f32 v8, v8, v27
v_mfma_f32_16x16x32_bf16 v[28:31], a[156:159], a[92:95], v[28:31]
v_exp_f32 v19, v19
v_mfma_f32_16x16x32_bf16 v[12:15], a[96:99], a[0:3], v[32:35]
v_cvt_pk_bf16_f32 v70, v16, v17
v_cmp_lt_f32 vcc, s50, v8
v_cvt_pk_bf16_f32 v71, v18, v19
s_cbranch_vccnz L_rs27
L_rr27:
v_mfma_f32_16x16x32_bf16 v[12:15], a[100:103], a[4:7], v[12:15]
v_mfma_f32_16x16x32_bf16 a[164:167], a[160:163], v[68:71], a[164:167]
v_exp_f32 v24, v24
v_mfma_f32_16x16x32_bf16 v[12:15], a[104:107], a[8:11], v[12:15]
v_exp_f32 v25, v25
v_max3_f32 v6, v28, v29, v30
v_mfma_f32_16x16x32_bf16 v[12:15], a[108:111], a[12:15], v[12:15]
s_add_u32 m0, s49, 4224
s_add_u32 s48, s55, 167936
buffer_load_dwordx4 v3, s[8:11], s48 offen nt lds
s_waitcnt lgkmcnt(0)
v_mfma_f32_16x16x32_bf16 v[12:15], a[112:115], a[16:19], v[12:15]
v_exp_f32 v26, v26
v_mfma_f32_16x16x32_bf16 v[12:15], a[116:119], a[20:23], v[12:15]
v_max_f32 v6, v6, v31
v_mfma_f32_16x16x32_bf16 v[12:15], a[120:123], a[24:27], v[12:15]
v_exp_f32 v27, v27
v_mfma_f32_16x16x32_bf16 v[12:15], a[124:127], a[28:31], v[12:15]
v_cvt_pk_bf16_f32 v198, v24, v25
v_cmp_lt_f32 vcc, s50, v6
v_mfma_f32_16x16x32_bf16 v[20:23], a[96:99], a[32:35], v[36:39]
v_cvt_pk_bf16_f32 v199, v26, v27
ds_read_b128 a[96:99], v4 offset:25344
v_mfma_f32_16x16x32_bf16 v[20:23], a[100:103], a[36:39], v[20:23]
ds_read_b128 a[100:103], v4 offset:25408
s_cbranch_vccnz L_rs28
L_rr28:
v_mfma_f32_16x16x32_bf16 a[168:171], a[160:163], v[196:199], a[168:171]
v_exp_f32 v28, v28
v_mfma_f32_16x16x32_bf16 v[20:23], a[104:107], a[40:43], v[20:23]
ds_read_b128 a[104:107], v4 offset:25472
v_exp_f32 v29, v29
v_mfma_f32_16x16x32_bf16 v[20:23], a[108:111], a[44:47], v[20:23]
v_max3_f32 v6, v12, v13, v14
ds_read_b128 a[108:111], v4 offset:25536
v_mfma_f32_16x16x32_bf16 v[20:23], a[112:115], a[48:51], v[20:23]
v_exp_f32 v30, v30
v_max_f32 v6, v6, v15
v_mfma_f32_16x16x32_bf16 v[20:23], a[116:119], a[52:55], v[20:23]
ds_read_b128 a[112:115], v4 offset:25600
s_add_u32 m0, s49, 5280
s_add_u32 s48, s55, 168960
buffer_load_dwordx4 v3, s[8:11], s48 offen nt lds
v_mfma_f32_16x16x32_bf16 v[20:23], a[120:123], a[56:59], v[20:23]
v_exp_f32 v31, v31
ds_read_b128 a[116:119], v4 offset:25664
v_mfma_f32_16x16x32_bf16 v[20:23], a[124:127], a[60:63], v[20:23]
v_cvt_pk_bf16_f32 v11, v28, v29
v_accvgpr_write_b32 a230, v11
v_cmp_lt_f32 vcc, s50, v6
s_waitcnt lgkmcnt(1)
v_mfma_f32_16x16x32_bf16 v[16:19], a[96:99], a[0:3], v[32:35]
ds_read_b128 a[120:123], v4 offset:25728
v_cvt_pk_bf16_f32 v10, v30, v31
v_accvgpr_write_b32 a231, v10
v_mfma_f32_16x16x32_bf16 v[16:19], a[100:103], a[4:7], v[16:19]
ds_read_b128 a[124:127], v4 offset:25792
s_cbranch_vccnz L_rs29
L_rr29:
v_mfma_f32_16x16x32_bf16 a[172:175], a[160:163], a[228:231], a[172:175]
v_exp_f32 v12, v12
v_mfma_f32_16x16x32_bf16 v[16:19], a[104:107], a[8:11], v[16:19]
v_exp_f32 v13, v13
v_max3_f32 v8, v20, v21, v22
v_mfma_f32_16x16x32_bf16 v[16:19], a[108:111], a[12:15], v[16:19]
v_exp_f32 v14, v14
v_mfma_f32_16x16x32_bf16 v[16:19], a[112:115], a[16:19], v[16:19]
v_max_f32 v8, v8, v23
s_waitcnt lgkmcnt(0)
v_mfma_f32_16x16x32_bf16 v[16:19], a[116:119], a[20:23], v[16:19]
v_exp_f32 v15, v15
v_cvt_pk_bf16_f32 v72, v12, v13
v_mfma_f32_16x16x32_bf16 v[16:19], a[120:123], a[24:27], v[16:19]
v_cmp_lt_f32 vcc, s50, v8
v_cvt_pk_bf16_f32 v73, v14, v15
v_mfma_f32_16x16x32_bf16 v[16:19], a[124:127], a[28:31], v[16:19]
v_add_u32 v4, 33792, v4
v_add_u32 v5, 33792, v5
L_stage11:
s_waitcnt vmcnt(6)
s_barrier
v_mfma_f32_16x16x32_bf16 v[24:27], a[96:99], a[32:35], v[36:39]
ds_read_b128 a[96:99], v4
s_add_u32 m0, s49, 6336
s_add_u32 s48, s55, 169984
buffer_load_dwordx4 v3, s[8:11], s48 offen nt lds
v_mfma_f32_16x16x32_bf16 v[24:27], a[100:103], a[36:39], v[24:27]
ds_read_b128 a[100:103], v4 offset:64
s_cbranch_vccnz L_rs30
L_rr30:
v_mfma_f32_16x16x32_bf16 v[24:27], a[104:107], a[40:43], v[24:27]
v_exp_f32 v20, v20
ds_read_b128 a[104:107], v4 offset:128
v_mfma_f32_16x16x32_bf16 v[24:27], a[108:111], a[44:47], v[24:27]
v_exp_f32 v21, v21
v_max3_f32 v6, v16, v17, v18
v_mfma_f32_16x16x32_bf16 v[24:27], a[112:115], a[48:51], v[24:27]
ds_read_b128 a[108:111], v4 offset:192
v_mfma_f32_16x16x32_bf16 v[24:27], a[116:119], a[52:55], v[24:27]
v_exp_f32 v22, v22
v_max_f32 v6, v6, v19
ds_read_b128 a[112:115], v4 offset:256
v_mfma_f32_16x16x32_bf16 v[24:27], a[120:123], a[56:59], v[24:27]
v_exp_f32 v23, v23
v_mfma_f32_16x16x32_bf16 v[24:27], a[124:127], a[60:63], v[24:27]
ds_read_b128 a[116:119], v4 offset:320
v_cvt_pk_bf16_f32 v200, v20, v21
v_cmp_lt_f32 vcc, s50, v6
s_waitcnt lgkmcnt(2)
v_mfma_f32_16x16x32_bf16 v[12:15], a[96:99], a[0:3], v[32:35]
ds_read_b128 a[120:123], v4 offset:384
v_cvt_pk_bf16_f32 v201, v22, v23
v_mfma_f32_16x16x32_bf16 v[12:15], a[100:103], a[4:7], v[12:15]
ds_read_b128 a[124:127], v4 offset:448
s_add_u32 m0, s49, 7392
s_add_u32 s48, s55, 171008
buffer_load_dwordx4 v3, s[8:11], s48 offen nt lds
s_cbranch_vccnz L_rs31
L_rr31:
v_mfma_f32_16x16x32_bf16 v[12:15], a[104:107], a[8:11], v[12:15]
v_exp_f32 v16, v16
v_mfma_f32_16x16x32_bf16 v[12:15], a[108:111], a[12:15], v[12:15]
v_exp_f32 v17, v17
s_waitcnt lgkmcnt(1)
v_mfma_f32_16x16x32_bf16 v[12:15], a[112:115], a[16:19], v[12:15]
v_max3_f32 v8, v24, v25, v26
v_mfma_f32_16x16x32_bf16 v[12:15], a[116:119], a[20:23], v[12:15]
v_exp_f32 v18, v18
v_max_f32 v8, v8, v27
v_mfma_f32_16x16x32_bf16 v[12:15], a[120:123], a[24:27], v[12:15]
v_exp_f32 v19, v19
s_waitcnt lgkmcnt(0)
v_mfma_f32_16x16x32_bf16 v[12:15], a[124:127], a[28:31], v[12:15]
v_cvt_pk_bf16_f32 v74, v16, v17
v_cmp_lt_f32 vcc, s50, v8
v_mfma_f32_16x16x32_bf16 v[20:23], a[96:99], a[32:35], v[36:39]
v_cvt_pk_bf16_f32 v75, v18, v19
s_add_u32 m0, s49, 33792
s_add_u32 s48, s55, 196608
buffer_load_dwordx4 v3, s[8:11], s48 offen nt lds
v_mfma_f32_16x16x32_bf16 v[20:23], a[100:103], a[36:39], v[20:23]
ds_read_b128 a[96:99], v4 offset:8448
ds_read_b128 a[100:103], v4 offset:8512
s_cbranch_vccnz L_rs32
L_rr32:
v_mfma_f32_16x16x32_bf16 a[164:167], a[160:163], v[72:75], a[164:167]
v_exp_f32 v24, v24
v_mfma_f32_16x16x32_bf16 v[20:23], a[104:107], a[40:43], v[20:23]
ds_read_b128 a[104:107], v4 offset:8576
v_exp_f32 v25, v25
v_mfma_f32_16x16x32_bf16 v[20:23], a[108:111], a[44:47], v[20:23]
v_max3_f32 v6, v12, v13, v14
ds_read_b128 a[108:111], v4 offset:8640
v_mfma_f32_16x16x32_bf16 v[20:23], a[112:115], a[48:51], v[20:23]
v_exp_f32 v26, v26
v_max_f32 v6, v6, v15
ds_read_b128 a[112:115], v4 offset:8704
v_mfma_f32_16x16x32_bf16 v[20:23], a[116:119], a[52:55], v[20:23]
v_exp_f32 v27, v27
ds_read_b128 a[116:119], v4 offset:8768
v_mfma_f32_16x16x32_bf16 v[20:23], a[120:123], a[56:59], v[20:23]
v_cvt_pk_bf16_f32 v202, v24, v25
v_cmp_lt_f32 vcc, s50, v6
ds_read_b128 a[120:123], v4 offset:8832
v_mfma_f32_16x16x32_bf16 v[20:23], a[124:127], a[60:63], v[20:23]
v_cvt_pk_bf16_f32 v203, v26, v27
ds_read_b128 a[124:127], v4 offset:8896
v_readfirstlane_b32 s67, v9
s_cmp_lg_u32 s67, 0
s_cbranch_scc1 L_non_ok
s_mov_b32 s95, 0
L_non_spin:
s_sleep 8
buffer_load_dword v9, off, s[36:39], 0 sc1
s_waitcnt vmcnt(0)
v_readfirstlane_b32 s67, v9
s_add_u32 s95, s95, 1
s_cmp_gt_u32 s95, 100000
s_cbranch_scc1 L_non_ok
s_cmp_eq_u32 s67, 0
s_cbranch_scc1 L_non_spin
L_non_ok:
ds_read_b128 a[128:131], v5
s_waitcnt lgkmcnt(1)
v_mfma_f32_16x16x32_bf16 v[16:19], a[96:99], a[0:3], v[32:35]
ds_read_b128 a[132:135], v5 offset:64
v_mfma_f32_16x16x32_bf16 v[16:19], a[100:103], a[4:7], v[16:19]
s_cbranch_vccnz L_rs33
L_rr33:
v_exp_f32 v12, v12
v_mfma_f32_16x16x32_bf16 a[168:171], a[160:163], v[200:203], a[168:171]
ds_read_b128 a[136:139], v5 offset:128
v_mfma_f32_16x16x32_bf16 v[16:19], a[104:107], a[8:11], v[16:19]
v_exp_f32 v13, v13
v_max3_f32 v8, v20, v21, v22
ds_read_b128 a[140:143], v5 offset:192
v_mfma_f32_16x16x32_bf16 v[16:19], a[108:111], a[12:15], v[16:19]
v_exp_f32 v14, v14
v_mfma_f32_16x16x32_bf16 v[16:19], a[112:115], a[16:19], v[16:19]
v_max_f32 v8, v8, v23
ds_read_b128 a[144:147], v5 offset:256
v_mfma_f32_16x16x32_bf16 v[16:19], a[116:119], a[20:23], v[16:19]
v_exp_f32 v15, v15
ds_read_b128 a[148:151], v5 offset:320
v_mfma_f32_16x16x32_bf16 v[16:19], a[120:123], a[24:27], v[16:19]
v_cvt_pk_bf16_f32 v76, v12, v13
v_cmp_lt_f32 vcc, s50, v8
v_mfma_f32_16x16x32_bf16 v[16:19], a[124:127], a[28:31], v[16:19]
ds_read_b128 a[152:155], v5 offset:384
v_cvt_pk_bf16_f32 v77, v14, v15
v_mfma_f32_16x16x32_bf16 v[24:27], a[96:99], a[32:35], v[36:39]
ds_read_b128 a[156:159], v5 offset:448
s_add_u32 m0, s49, 34848
s_add_u32 s48, s55, 197632
buffer_load_dwordx4 v3, s[8:11], s48 offen nt lds
v_mfma_f32_16x16x32_bf16 v[24:27], a[100:103], a[36:39], v[24:27]
ds_read_b128 a[96:99], v4 offset:16896
ds_read_b128 a[100:103], v4 offset:16960
s_cbranch_vccnz L_rs34
L_rr34:
v_mfma_f32_16x16x32_bf16 v[24:27], a[104:107], a[40:43], v[24:27]
v_exp_f32 v20, v20
v_mfma_f32_16x16x32_bf16 v[24:27], a[108:111], a[44:47], v[24:27]
ds_read_b128 a[104:107], v4 offset:17024
v_exp_f32 v21, v21
v_mfma_f32_16x16x32_bf16 v[24:27], a[112:115], a[48:51], v[24:27]
v_max3_f32 v6, v16, v17, v18
ds_read_b128 a[108:111], v4 offset:17088
v_mfma_f32_16x16x32_bf16 v[24:27], a[116:119], a[52:55], v[24:27]
v_exp_f32 v22, v22
v_mfma_f32_16x16x32_bf16 v[24:27], a[120:123], a[56:59], v[24:27]
v_max_f32 v6, v6, v19
ds_read_b128 a[112:115], v4 offset:17152
v_mfma_f32_16x16x32_bf16 v[24:27], a[124:127], a[60:63], v[24:27]
v_exp_f32 v23, v23
ds_read_b128 a[116:119], v4 offset:17216
s_waitcnt lgkmcnt(3)
v_mfma_f32_16x16x32_bf16 v[28:31], a[128:131], a[64:67], v[40:43]
v_cvt_pk_bf16_f32 v204, v20, v21
v_cmp_lt_f32 vcc, s50, v6
v_mfma_f32_16x16x32_bf16 v[28:31], a[132:135], a[68:71], v[28:31]
ds_read_b128 a[120:123], v4 offset:17280
s_add_u32 m0, s49, 35904
s_add_u32 s48, s55, 198656
buffer_load_dwordx4 v3, s[8:11], s48 offen nt lds
v_mfma_f32_16x16x32_bf16 v[28:31], a[136:139], a[72:75], v[28:31]
v_cvt_pk_bf16_f32 v205, v22, v23
ds_read_b128 a[124:127], v4 offset:17344
s_cbranch_vccnz L_rs35
L_rr35:
v_mfma_f32_16x16x32_bf16 v[28:31], a[140:143], a[76:79], v[28:31]
v_exp_f32 v16, v16
v_mfma_f32_16x16x32_bf16 v[28:31], a[144:147], a[80:83], v[28:31]
v_exp_f32 v17, v17
v_max3_f32 v8, v24, v25, v26
v_mfma_f32_16x16x32_bf16 v[28:31], a[148:151], a[84:87], v[28:31]
v_exp_f32 v18, v18
v_mfma_f32_16x16x32_bf16 v[28:31], a[152:155], a[88:91], v[28:31]
v_max_f32 v8, v8, v27
v_exp_f32 v19, v19
v_mfma_f32_16x16x32_bf16 v[28:31], a[156:159], a[92:95], v[28:31]
v_cvt_pk_bf16_f32 v78, v16, v17
v_cmp_lt_f32 vcc, s50, v8
s_add_u32 m0, s49, 36960
v_mfma_f32_16x16x32_bf16 v[12:15], a[96:99], a[0:3], v[32:35]
s_add_u32 s48, s55, 199680
buffer_load_dwordx4 v3, s[8:11], s48 offen nt lds
v_cvt_pk_bf16_f32 v79, v18, v19
s_cbranch_vccnz L_rs36
L_rr36:
v_mfma_f32_16x16x32_bf16 v[12:15], a[100:103], a[4:7], v[12:15]
v_mfma_f32_16x16x32_bf16 a[164:167], a[160:163], v[76:79], a[164:167]
v_exp_f32 v24, v24
v_mfma_f32_16x16x32_bf16 v[12:15], a[104:107], a[8:11], v[12:15]
v_exp_f32 v25, v25
v_max3_f32 v6, v28, v29, v30
s_waitcnt lgkmcnt(0)
v_mfma_f32_16x16x32_bf16 v[12:15], a[108:111], a[12:15], v[12:15]
v_mfma_f32_16x16x32_bf16 v[12:15], a[112:115], a[16:19], v[12:15]
v_exp_f32 v26, v26
v_max_f32 v6, v6, v31
v_mfma_f32_16x16x32_bf16 v[12:15], a[116:119], a[20:23], v[12:15]
v_exp_f32 v27, v27
s_add_u32 m0, s49, 38016
v_mfma_f32_16x16x32_bf16 v[12:15], a[120:123], a[24:27], v[12:15]
s_add_u32 s48, s55, 200704
buffer_load_dwordx4 v3, s[8:11], s48 offen nt lds
v_mfma_f32_16x16x32_bf16 v[12:15], a[124:127], a[28:31], v[12:15]
v_cvt_pk_bf16_f32 v206, v24, v25
v_cmp_lt_f32 vcc, s50, v6
v_mfma_f32_16x16x32_bf16 v[20:23], a[96:99], a[32:35], v[36:39]
v_cvt_pk_bf16_f32 v207, v26, v27
ds_read_b128 a[96:99], v4 offset:25344
v_mfma_f32_16x16x32_bf16 v[20:23], a[100:103], a[36:39], v[20:23]
ds_read_b128 a[100:103], v4 offset:25408
s_cbranch_vccnz L_rs37
L_rr37:
v_mfma_f32_16x16x32_bf16 a[168:171], a[160:163], v[204:207], a[168:171]
v_exp_f32 v28, v28
v_mfma_f32_16x16x32_bf16 v[20:23], a[104:107], a[40:43], v[20:23]
ds_read_b128 a[104:107], v4 offset:25472
v_mfma_f32_16x16x32_bf16 v[20:23], a[108:111], a[44:47], v[20:23]
v_exp_f32 v29, v29
v_max3_f32 v6, v12, v13, v14
ds_read_b128 a[108:111], v4 offset:25536
v_mfma_f32_16x16x32_bf16 v[20:23], a[112:115], a[48:51], v[20:23]
v_exp_f32 v30, v30
v_max_f32 v6, v6, v15
v_mfma_f32_16x16x32_bf16 v[20:23], a[116:119], a[52:55], v[20:23]
ds_read_b128 a[112:115], v4 offset:25600
v_mfma_f32_16x16x32_bf16 v[20:23], a[120:123], a[56:59], v[20:23]
v_exp_f32 v31, v31
ds_read_b128 a[116:119], v4 offset:25664
s_add_u32 m0, s49, 39072
s_add_u32 s48, s55, 201728
v_mfma_f32_16x16x32_bf16 v[20:23], a[124:127], a[60:63], v[20:23]
buffer_load_dwordx4 v3, s[8:11], s48 offen nt lds
v_cvt_pk_bf16_f32 v11, v28, v29
v_accvgpr_write_b32 a232, v11
s_waitcnt lgkmcnt(1)
v_mfma_f32_16x16x32_bf16 v[16:19], a[96:99], a[0:3], v[32:35]
v_cmp_lt_f32 vcc, s50, v6
ds_read_b128 a[120:123], v4 offset:25728
v_mfma_f32_16x16x32_bf16 v[16:19], a[100:103], a[4:7], v[16:19]
v_cvt_pk_bf16_f32 v10, v30, v31
v_accvgpr_write_b32 a233, v10
ds_read_b128 a[124:127], v4 offset:25792
s_cbranch_vccnz L_rs38
L_rr38:
v_mfma_f32_16x16x32_bf16 v[16:19], a[104:107], a[8:11], v[16:19]
v_exp_f32 v12, v12
v_mfma_f32_16x16x32_bf16 v[16:19], a[108:111], a[12:15], v[16:19]
v_exp_f32 v13, v13
v_max3_f32 v8, v20, v21, v22
v_mfma_f32_16x16x32_bf16 v[16:19], a[112:115], a[16:19], v[16:19]
v_exp_f32 v14, v14
s_waitcnt lgkmcnt(1)
v_mfma_f32_16x16x32_bf16 v[16:19], a[116:119], a[20:23], v[16:19]
v_max_f32 v8, v8, v23
v_exp_f32 v15, v15
v_mfma_f32_16x16x32_bf16 v[16:19], a[120:123], a[24:27], v[16:19]
v_cvt_pk_bf16_f32 v80, v12, v13
v_cmp_lt_f32 vcc, s50, v8
s_waitcnt lgkmcnt(0)
v_mfma_f32_16x16x32_bf16 v[16:19], a[124:127], a[28:31], v[16:19]
v_cvt_pk_bf16_f32 v81, v14, v15
v_subrev_u32 v4, 67584, v4
v_subrev_u32 v5, 67584, v5
L_stage12:
s_waitcnt vmcnt(6)
s_barrier
v_mfma_f32_16x16x32_bf16 v[24:27], a[96:99], a[32:35], v[36:39]
ds_read_b128 a[96:99], v4
s_add_u32 m0, s49, 40128
s_add_u32 s48, s55, 202752
buffer_load_dwordx4 v3, s[8:11], s48 offen nt lds
v_mfma_f32_16x16x32_bf16 v[24:27], a[100:103], a[36:39], v[24:27]
ds_read_b128 a[100:103], v4 offset:64
s_cbranch_vccnz L_rs39
L_rr39:
v_mfma_f32_16x16x32_bf16 v[24:27], a[104:107], a[40:43], v[24:27]
v_exp_f32 v20, v20
ds_read_b128 a[104:107], v4 offset:128
v_mfma_f32_16x16x32_bf16 v[24:27], a[108:111], a[44:47], v[24:27]
v_exp_f32 v21, v21
v_max3_f32 v6, v16, v17, v18
v_mfma_f32_16x16x32_bf16 v[24:27], a[112:115], a[48:51], v[24:27]
ds_read_b128 a[108:111], v4 offset:192
v_mfma_f32_16x16x32_bf16 v[24:27], a[116:119], a[52:55], v[24:27]
v_exp_f32 v22, v22
v_max_f32 v6, v6, v19
ds_read_b128 a[112:115], v4 offset:256
v_mfma_f32_16x16x32_bf16 v[24:27], a[120:123], a[56:59], v[24:27]
v_exp_f32 v23, v23
v_mfma_f32_16x16x32_bf16 v[24:27], a[124:127], a[60:63], v[24:27]
ds_read_b128 a[116:119], v4 offset:320
v_cvt_pk_bf16_f32 v208, v20, v21
v_cmp_lt_f32 vcc, s50, v6
s_waitcnt lgkmcnt(2)
v_mfma_f32_16x16x32_bf16 v[12:15], a[96:99], a[0:3], v[32:35]
ds_read_b128 a[120:123], v4 offset:384
v_cvt_pk_bf16_f32 v209, v22, v23
v_mfma_f32_16x16x32_bf16 v[12:15], a[100:103], a[4:7], v[12:15]
ds_read_b128 a[124:127], v4 offset:448
s_add_u32 m0, s49, 41184
s_add_u32 s48, s55, 203776
buffer_load_dwordx4 v3, s[8:11], s48 offen nt lds
s_cbranch_vccnz L_rs40
L_rr40:
v_mfma_f32_16x16x32_bf16 v[12:15], a[104:107], a[8:11], v[12:15]
v_exp_f32 v16, v16
v_mfma_f32_16x16x32_bf16 v[12:15], a[108:111], a[12:15], v[12:15]
v_exp_f32 v17, v17
s_waitcnt lgkmcnt(1)
v_mfma_f32_16x16x32_bf16 v[12:15], a[112:115], a[16:19], v[12:15]
v_max3_f32 v8, v24, v25, v26
v_mfma_f32_16x16x32_bf16 v[12:15], a[116:119], a[20:23], v[12:15]
v_exp_f32 v18, v18
v_max_f32 v8, v8, v27
v_mfma_f32_16x16x32_bf16 v[12:15], a[120:123], a[24:27], v[12:15]
v_exp_f32 v19, v19
s_waitcnt lgkmcnt(0)
v_mfma_f32_16x16x32_bf16 v[12:15], a[124:127], a[28:31], v[12:15]
v_cvt_pk_bf16_f32 v82, v16, v17
v_cmp_lt_f32 vcc, s50, v8
v_mfma_f32_16x16x32_bf16 v[20:23], a[96:99], a[32:35], v[36:39]
v_cvt_pk_bf16_f32 v83, v18, v19
ds_read_b128 a[96:99], v4 offset:8448
v_mfma_f32_16x16x32_bf16 v[20:23], a[100:103], a[36:39], v[20:23]
ds_read_b128 a[100:103], v4 offset:8512
s_add_u32 m0, s49, 67584
s_add_u32 s48, s55, 229376
buffer_load_dwordx4 v3, s[8:11], s48 offen nt lds
v_mfma_f32_16x16x32_bf16 a[164:167], a[160:163], v[80:83], a[164:167]
s_cbranch_vccnz L_rs41
L_rr41:
v_exp_f32 v24, v24
v_mfma_f32_16x16x32_bf16 v[20:23], a[104:107], a[40:43], v[20:23]
ds_read_b128 a[104:107], v4 offset:8576
v_mfma_f32_16x16x32_bf16 v[20:23], a[108:111], a[44:47], v[20:23]
v_exp_f32 v25, v25
v_max3_f32 v6, v12, v13, v14
ds_read_b128 a[108:111], v4 offset:8640
v_mfma_f32_16x16x32_bf16 v[20:23], a[112:115], a[48:51], v[20:23]
v_exp_f32 v26, v26
v_mfma_f32_16x16x32_bf16 v[20:23], a[116:119], a[52:55], v[20:23]
v_max_f32 v6, v6, v15
ds_read_b128 a[112:115], v4 offset:8704
v_mfma_f32_16x16x32_bf16 v[20:23], a[120:123], a[56:59], v[20:23]
v_exp_f32 v27, v27
ds_read_b128 a[116:119], v4 offset:8768
v_mfma_f32_16x16x32_bf16 v[20:23], a[124:127], a[60:63], v[20:23]
v_cvt_pk_bf16_f32 v210, v24, v25
v_cmp_lt_f32 vcc, s50, v6
ds_read_b128 a[120:123], v4 offset:8832
s_waitcnt lgkmcnt(3)
v_mfma_f32_16x16x32_bf16 v[16:19], a[96:99], a[0:3], v[32:35]
v_cvt_pk_bf16_f32 v211, v26, v27
ds_read_b128 a[124:127], v4 offset:8896
v_mfma_f32_16x16x32_bf16 v[16:19], a[100:103], a[4:7], v[16:19]
ds_read_b128 a[128:131], v5
ds_read_b128 a[132:135], v5 offset:64
s_cbranch_vccnz L_rs42
L_rr42:
v_mfma_f32_16x16x32_bf16 a[168:171], a[160:163], v[208:211], a[168:171]
v_exp_f32 v12, v12
ds_read_b128 a[136:139], v5 offset:128
s_add_u32 m0, s49, 68640
v_mfma_f32_16x16x32_bf16 v[16:19], a[104:107], a[8:11], v[16:19]
s_add_u32 s48, s55, 230400
buffer_load_dwordx4 v3, s[8:11], s48 offen nt lds
v_mfma_f32_16x16x32_bf16 v[16:19], a[108:111], a[12:15], v[16:19]
v_exp_f32 v13, v13
v_max3_f32 v8, v20, v21, v22
s_waitcnt lgkmcnt(1)
v_mfma_f32_16x16x32_bf16 v[16:19], a[112:115], a[16:19], v[16:19]
ds_read_b128 a[140:143], v5 offset:192
v_exp_f32 v14, v14
v_mfma_f32_16x16x32_bf16 v[16:19], a[116:119], a[20:23], v[16:19]
v_max_f32 v8, v8, v23
ds_read_b128 a[144:147], v5 offset:256
v_mfma_f32_16x16x32_bf16 v[16:19], a[120:123], a[24:27], v[16:19]
v_exp_f32 v15, v15
ds_read_b128 a[148:151], v5 offset:320
v_mfma_f32_16x16x32_bf16 v[16:19], a[124:127], a[28:31], v[16:19]
v_cvt_pk_bf16_f32 v84, v12, v13
v_cmp_lt_f32 vcc, s50, v8
v_mfma_f32_16x16x32_bf16 v[24:27], a[96:99], a[32:35], v[36:39]
ds_read_b128 a[152:155], v5 offset:384
v_cvt_pk_bf16_f32 v85, v14, v15
ds_read_b128 a[156:159], v5 offset:448
v_mfma_f32_16x16x32_bf16 v[24:27], a[100:103], a[36:39], v[24:27]
ds_read_b128 a[96:99], v4 offset:16896
ds_read_b128 a[100:103], v4 offset:16960
s_cbranch_vccnz L_rs43
L_rr43:
v_mfma_f32_16x16x32_bf16 v[24:27], a[104:107], a[40:43], v[24:27]
v_exp_f32 v20, v20
v_mfma_f32_16x16x32_bf16 v[24:27], a[108:111], a[44:47], v[24:27]
ds_read_b128 a[104:107], v4 offset:17024
s_add_u32 m0, s49, 69696
s_add_u32 s48, s55, 231424
buffer_load_dwordx4 v3, s[8:11], s48 offen nt lds
v_mfma_f32_16x16x32_bf16 v[24:27], a[112:115], a[48:51], v[24:27]
v_exp_f32 v21, v21
v_mfma_f32_16x16x32_bf16 v[24:27], a[116:119], a[52:55], v[24:27]
v_max3_f32 v6, v16, v17, v18
ds_read_b128 a[108:111], v4 offset:17088
v_mfma_f32_16x16x32_bf16 v[24:27], a[120:123], a[56:59], v[24:27]
v_exp_f32 v22, v22
v_max_f32 v6, v6, v19
v_mfma_f32_16x16x32_bf16 v[24:27], a[124:127], a[60:63], v[24:27]
ds_read_b128 a[112:115], v4 offset:17152
v_mfma_f32_16x16x32_bf16 v[28:31], a[128:131], a[64:67], v[40:43]
v_exp_f32 v23, v23
ds_read_b128 a[116:119], v4 offset:17216
v_cvt_pk_bf16_f32 v212, v20, v21
v_mfma_f32_16x16x32_bf16 v[28:31], a[132:135], a[68:71], v[28:31]
v_cmp_lt_f32 vcc, s50, v6
ds_read_b128 a[120:123], v4 offset:17280
s_waitcnt lgkmcnt(3)
v_mfma_f32_16x16x32_bf16 v[28:31], a[136:139], a[72:75], v[28:31]
v_cvt_pk_bf16_f32 v213, v22, v23
ds_read_b128 a[124:127], v4 offset:17344
s_cbranch_vccnz L_rs44
L_rr44:
v_mfma_f32_16x16x32_bf16 v[28:31], a[140:143], a[76:79], v[28:31]
v_exp_f32 v16, v16
v_mfma_f32_16x16x32_bf16 v[28:31], a[144:147], a[80:83], v[28:31]
v_exp_f32 v17, v17
v_max3_f32 v8, v24, v25, v26
s_add_u32 m0, s49, 70752
v_mfma_f32_16x16x32_bf16 v[28:31], a[148:151], a[84:87], v[28:31]
s_add_u32 s48, s55, 232448
buffer_load_dwordx4 v3, s[8:11], s48 offen nt lds
v_mfma_f32_16x16x32_bf16 v[28:31], a[152:155], a[88:91], v[28:31]
v_exp_f32 v18, v18
v_max_f32 v8, v8, v27
v_mfma_f32_16x16x32_bf16 v[28:31], a[156:159], a[92:95], v[28:31]
v_exp_f32 v19, v19
v_mfma_f32_16x16x32_bf16 v[12:15], a[96:99], a[0:3], v[32:35]
v_cvt_pk_bf16_f32 v86, v16, v17
v_cmp_lt_f32 vcc, s50, v8
v_cvt_pk_bf16_f32 v87, v18, v19
s_cbranch_vccnz L_rs45
L_rr45:
v_mfma_f32_16x16x32_bf16 v[12:15], a[100:103], a[4:7], v[12:15]
v_mfma_f32_16x16x32_bf16 a[164:167], a[160:163], v[84:87], a[164:167]
v_exp_f32 v24, v24
v_mfma_f32_16x16x32_bf16 v[12:15], a[104:107], a[8:11], v[12:15]
v_exp_f32 v25, v25
v_max3_f32 v6, v28, v29, v30
v_mfma_f32_16x16x32_bf16 v[12:15], a[108:111], a[12:15], v[12:15]
s_add_u32 m0, s49, 71808
s_add_u32 s48, s55, 233472
buffer_load_dwordx4 v3, s[8:11], s48 offen nt lds
s_waitcnt lgkmcnt(0)
v_mfma_f32_16x16x32_bf16 v[12:15], a[112:115], a[16:19], v[12:15]
v_exp_f32 v26, v26
v_mfma_f32_16x16x32_bf16 v[12:15], a[116:119], a[20:23], v[12:15]
v_max_f32 v6, v6, v31
v_mfma_f32_16x16x32_bf16 v[12:15], a[120:123], a[24:27], v[12:15]
v_exp_f32 v27, v27
v_mfma_f32_16x16x32_bf16 v[12:15], a[124:127], a[28:31], v[12:15]
v_cvt_pk_bf16_f32 v214, v24, v25
v_cmp_lt_f32 vcc, s50, v6
v_mfma_f32_16x16x32_bf16 v[20:23], a[96:99], a[32:35], v[36:39]
v_cvt_pk_bf16_f32 v215, v26, v27
ds_read_b128 a[96:99], v4 offset:25344
v_mfma_f32_16x16x32_bf16 v[20:23], a[100:103], a[36:39], v[20:23]
ds_read_b128 a[100:103], v4 offset:25408
s_cbranch_vccnz L_rs46
L_rr46:
v_mfma_f32_16x16x32_bf16 a[168:171], a[160:163], v[212:215], a[168:171]
v_exp_f32 v28, v28
v_mfma_f32_16x16x32_bf16 v[20:23], a[104:107], a[40:43], v[20:23]
ds_read_b128 a[104:107], v4 offset:25472
v_exp_f32 v29, v29
v_mfma_f32_16x16x32_bf16 v[20:23], a[108:111], a[44:47], v[20:23]
v_max3_f32 v6, v12, v13, v14
ds_read_b128 a[108:111], v4 offset:25536
v_mfma_f32_16x16x32_bf16 v[20:23], a[112:115], a[48:51], v[20:23]
v_exp_f32 v30, v30
v_max_f32 v6, v6, v15
v_mfma_f32_16x16x32_bf16 v[20:23], a[116:119], a[52:55], v[20:23]
ds_read_b128 a[112:115], v4 offset:25600
s_add_u32 m0, s49, 72864
s_add_u32 s48, s55, 234496
buffer_load_dwordx4 v3, s[8:11], s48 offen nt lds
v_mfma_f32_16x16x32_bf16 v[20:23], a[120:123], a[56:59], v[20:23]
v_exp_f32 v31, v31
ds_read_b128 a[116:119], v4 offset:25664
v_mfma_f32_16x16x32_bf16 v[20:23], a[124:127], a[60:63], v[20:23]
v_cvt_pk_bf16_f32 v11, v28, v29
v_accvgpr_write_b32 a234, v11
v_cmp_lt_f32 vcc, s50, v6
s_waitcnt lgkmcnt(1)
v_mfma_f32_16x16x32_bf16 v[16:19], a[96:99], a[0:3], v[32:35]
ds_read_b128 a[120:123], v4 offset:25728
v_cvt_pk_bf16_f32 v10, v30, v31
v_accvgpr_write_b32 a235, v10
v_mfma_f32_16x16x32_bf16 v[16:19], a[100:103], a[4:7], v[16:19]
ds_read_b128 a[124:127], v4 offset:25792
s_cbranch_vccnz L_rs47
L_rr47:
v_mfma_f32_16x16x32_bf16 a[172:175], a[160:163], a[232:235], a[172:175]
v_exp_f32 v12, v12
v_mfma_f32_16x16x32_bf16 v[16:19], a[104:107], a[8:11], v[16:19]
v_exp_f32 v13, v13
v_max3_f32 v8, v20, v21, v22
v_mfma_f32_16x16x32_bf16 v[16:19], a[108:111], a[12:15], v[16:19]
v_exp_f32 v14, v14
v_mfma_f32_16x16x32_bf16 v[16:19], a[112:115], a[16:19], v[16:19]
v_max_f32 v8, v8, v23
s_waitcnt lgkmcnt(0)
v_mfma_f32_16x16x32_bf16 v[16:19], a[116:119], a[20:23], v[16:19]
v_exp_f32 v15, v15
v_cvt_pk_bf16_f32 v88, v12, v13
v_mfma_f32_16x16x32_bf16 v[16:19], a[120:123], a[24:27], v[16:19]
v_cmp_lt_f32 vcc, s50, v8
v_cvt_pk_bf16_f32 v89, v14, v15
v_mfma_f32_16x16x32_bf16 v[16:19], a[124:127], a[28:31], v[16:19]
v_add_u32 v4, 33792, v4
v_add_u32 v5, 33792, v5
L_stage13:
s_waitcnt vmcnt(6)
s_barrier
v_mfma_f32_16x16x32_bf16 v[24:27], a[96:99], a[32:35], v[36:39]
ds_read_b128 a[96:99], v4
s_add_u32 m0, s49, 73920
s_add_u32 s48, s55, 235520
buffer_load_dwordx4 v3, s[8:11], s48 offen nt lds
v_mfma_f32_16x16x32_bf16 v[24:27], a[100:103], a[36:39], v[24:27]
ds_read_b128 a[100:103], v4 offset:64
s_cbranch_vccnz L_rs48
L_rr48:
v_mfma_f32_16x16x32_bf16 v[24:27], a[104:107], a[40:43], v[24:27]
v_exp_f32 v20, v20
ds_read_b128 a[104:107], v4 offset:128
v_mfma_f32_16x16x32_bf16 v[24:27], a[108:111], a[44:47], v[24:27]
v_exp_f32 v21, v21
v_max3_f32 v6, v16, v17, v18
v_mfma_f32_16x16x32_bf16 v[24:27], a[112:115], a[48:51], v[24:27]
ds_read_b128 a[108:111], v4 offset:192
v_mfma_f32_16x16x32_bf16 v[24:27], a[116:119], a[52:55], v[24:27]
v_exp_f32 v22, v22
v_max_f32 v6, v6, v19
ds_read_b128 a[112:115], v4 offset:256
v_mfma_f32_16x16x32_bf16 v[24:27], a[120:123], a[56:59], v[24:27]
v_exp_f32 v23, v23
v_mfma_f32_16x16x32_bf16 v[24:27], a[124:127], a[60:63], v[24:27]
ds_read_b128 a[116:119], v4 offset:320
v_cvt_pk_bf16_f32 v216, v20, v21
v_cmp_lt_f32 vcc, s50, v6
s_waitcnt lgkmcnt(2)
v_mfma_f32_16x16x32_bf16 v[12:15], a[96:99], a[0:3], v[32:35]
ds_read_b128 a[120:123], v4 offset:384
v_cvt_pk_bf16_f32 v217, v22, v23
v_mfma_f32_16x16x32_bf16 v[12:15], a[100:103], a[4:7], v[12:15]
ds_read_b128 a[124:127], v4 offset:448
s_add_u32 m0, s49, 74976
s_add_u32 s48, s55, 236544
buffer_load_dwordx4 v3, s[8:11], s48 offen nt lds
s_cbranch_vccnz L_rs49
L_rr49:
v_mfma_f32_16x16x32_bf16 v[12:15], a[104:107], a[8:11], v[12:15]
v_exp_f32 v16, v16
v_mfma_f32_16x16x32_bf16 v[12:15], a[108:111], a[12:15], v[12:15]
v_exp_f32 v17, v17
s_waitcnt lgkmcnt(1)
v_mfma_f32_16x16x32_bf16 v[12:15], a[112:115], a[16:19], v[12:15]
v_max3_f32 v8, v24, v25, v26
v_mfma_f32_16x16x32_bf16 v[12:15], a[116:119], a[20:23], v[12:15]
v_exp_f32 v18, v18
v_max_f32 v8, v8, v27
v_mfma_f32_16x16x32_bf16 v[12:15], a[120:123], a[24:27], v[12:15]
v_exp_f32 v19, v19
s_waitcnt lgkmcnt(0)
v_mfma_f32_16x16x32_bf16 v[12:15], a[124:127], a[28:31], v[12:15]
v_cvt_pk_bf16_f32 v90, v16, v17
v_cmp_lt_f32 vcc, s50, v8
v_mfma_f32_16x16x32_bf16 v[20:23], a[96:99], a[32:35], v[36:39]
v_cvt_pk_bf16_f32 v91, v18, v19
ds_read_b128 a[96:99], v4 offset:8448
v_mfma_f32_16x16x32_bf16 v[20:23], a[100:103], a[36:39], v[20:23]
ds_read_b128 a[100:103], v4 offset:8512
s_add_u32 m0, s49, 0
s_add_u32 s48, s55, 262144
buffer_load_dwordx4 v3, s[8:11], s48 offen nt lds
v_mfma_f32_16x16x32_bf16 a[164:167], a[160:163], v[88:91], a[164:167]
s_cbranch_vccnz L_rs50
L_rr50:
v_exp_f32 v24, v24
v_mfma_f32_16x16x32_bf16 v[20:23], a[104:107], a[40:43], v[20:23]
ds_read_b128 a[104:107], v4 offset:8576
v_mfma_f32_16x16x32_bf16 v[20:23], a[108:111], a[44:47], v[20:23]
v_exp_f32 v25, v25
v_max3_f32 v6, v12, v13, v14
ds_read_b128 a[108:111], v4 offset:8640
v_mfma_f32_16x16x32_bf16 v[20:23], a[112:115], a[48:51], v[20:23]
v_exp_f32 v26, v26
v_mfma_f32_16x16x32_bf16 v[20:23], a[116:119], a[52:55], v[20:23]
v_max_f32 v6, v6, v15
ds_read_b128 a[112:115], v4 offset:8704
v_mfma_f32_16x16x32_bf16 v[20:23], a[120:123], a[56:59], v[20:23]
v_exp_f32 v27, v27
ds_read_b128 a[116:119], v4 offset:8768
v_mfma_f32_16x16x32_bf16 v[20:23], a[124:127], a[60:63], v[20:23]
v_cvt_pk_bf16_f32 v218, v24, v25
v_cmp_lt_f32 vcc, s50, v6
ds_read_b128 a[120:123], v4 offset:8832
s_waitcnt lgkmcnt(3)
v_mfma_f32_16x16x32_bf16 v[16:19], a[96:99], a[0:3], v[32:35]
v_cvt_pk_bf16_f32 v219, v26, v27
ds_read_b128 a[124:127], v4 offset:8896
v_mfma_f32_16x16x32_bf16 v[16:19], a[100:103], a[4:7], v[16:19]
ds_read_b128 a[128:131], v5
ds_read_b128 a[132:135], v5 offset:64
s_cbranch_vccnz L_rs51
L_rr51:
v_mfma_f32_16x16x32_bf16 a[168:171], a[160:163], v[216:219], a[168:171]
v_exp_f32 v12, v12
ds_read_b128 a[136:139], v5 offset:128
s_add_u32 m0, s49, 1056
v_mfma_f32_16x16x32_bf16 v[16:19], a[104:107], a[8:11], v[16:19]
s_add_u32 s48, s55, 263168
buffer_load_dwordx4 v3, s[8:11], s48 offen nt lds
v_mfma_f32_16x16x32_bf16 v[16:19], a[108:111], a[12:15], v[16:19]
v_exp_f32 v13, v13
v_max3_f32 v8, v20, v21, v22
s_waitcnt lgkmcnt(1)
v_mfma_f32_16x16x32_bf16 v[16:19], a[112:115], a[16:19], v[16:19]
ds_read_b128 a[140:143], v5 offset:192
v_exp_f32 v14, v14
v_mfma_f32_16x16x32_bf16 v[16:19], a[116:119], a[20:23], v[16:19]
v_max_f32 v8, v8, v23
ds_read_b128 a[144:147], v5 offset:256
v_mfma_f32_16x16x32_bf16 v[16:19], a[120:123], a[24:27], v[16:19]
v_exp_f32 v15, v15
ds_read_b128 a[148:151], v5 offset:320
v_mfma_f32_16x16x32_bf16 v[16:19], a[124:127], a[28:31], v[16:19]
v_cvt_pk_bf16_f32 v92, v12, v13
v_cmp_lt_f32 vcc, s50, v8
v_mfma_f32_16x16x32_bf16 v[24:27], a[96:99], a[32:35], v[36:39]
ds_read_b128 a[152:155], v5 offset:384
v_cvt_pk_bf16_f32 v93, v14, v15
ds_read_b128 a[156:159], v5 offset:448
v_mfma_f32_16x16x32_bf16 v[24:27], a[100:103], a[36:39], v[24:27]
ds_read_b128 a[96:99], v4 offset:16896
ds_read_b128 a[100:103], v4 offset:16960
s_cbranch_vccnz L_rs52
L_rr52:
v_mfma_f32_16x16x32_bf16 v[24:27], a[104:107], a[40:43], v[24:27]
v_exp_f32 v20, v20
v_mfma_f32_16x16x32_bf16 v[24:27], a[108:111], a[44:47], v[24:27]
ds_read_b128 a[104:107], v4 offset:17024
s_add_u32 m0, s49, 2112
s_add_u32 s48, s55, 264192
buffer_load_dwordx4 v3, s[8:11], s48 offen nt lds
v_mfma_f32_16x16x32_bf16 v[24:27], a[112:115], a[48:51], v[24:27]
v_exp_f32 v21, v21
v_mfma_f32_16x16x32_bf16 v[24:27], a[116:119], a[52:55], v[24:27]
v_max3_f32 v6, v16, v17, v18
ds_read_b128 a[108:111], v4 offset:17088
v_mfma_f32_16x16x32_bf16 v[24:27], a[120:123], a[56:59], v[24:27]
v_exp_f32 v22, v22
v_max_f32 v6, v6, v19
v_mfma_f32_16x16x32_bf16 v[24:27], a[124:127], a[60:63], v[24:27]
ds_read_b128 a[112:115], v4 offset:17152
v_mfma_f32_16x16x32_bf16 v[28:31], a[128:131], a[64:67], v[40:43]
v_exp_f32 v23, v23
ds_read_b128 a[116:119], v4 offset:17216
v_cvt_pk_bf16_f32 v220, v20, v21
v_mfma_f32_16x16x32_bf16 v[28:31], a[132:135], a[68:71], v[28:31]
v_cmp_lt_f32 vcc, s50, v6
ds_read_b128 a[120:123], v4 offset:17280
s_waitcnt lgkmcnt(3)
v_mfma_f32_16x16x32_bf16 v[28:31], a[136:139], a[72:75], v[28:31]
v_cvt_pk_bf16_f32 v221, v22, v23
ds_read_b128 a[124:127], v4 offset:17344
s_cbranch_vccnz L_rs53
L_rr53:
v_mfma_f32_16x16x32_bf16 v[28:31], a[140:143], a[76:79], v[28:31]
v_exp_f32 v16, v16
v_mfma_f32_16x16x32_bf16 v[28:31], a[144:147], a[80:83], v[28:31]
v_exp_f32 v17, v17
v_max3_f32 v8, v24, v25, v26
s_add_u32 m0, s49, 3168
v_mfma_f32_16x16x32_bf16 v[28:31], a[148:151], a[84:87], v[28:31]
s_add_u32 s48, s55, 265216
buffer_load_dwordx4 v3, s[8:11], s48 offen nt lds
v_mfma_f32_16x16x32_bf16 v[28:31], a[152:155], a[88:91], v[28:31]
v_exp_f32 v18, v18
v_max_f32 v8, v8, v27
v_mfma_f32_16x16x32_bf16 v[28:31], a[156:159], a[92:95], v[28:31]
v_exp_f32 v19, v19
v_mfma_f32_16x16x32_bf16 v[12:15], a[96:99], a[0:3], v[32:35]
v_cvt_pk_bf16_f32 v94, v16, v17
v_cmp_lt_f32 vcc, s50, v8
v_cvt_pk_bf16_f32 v95, v18, v19
s_cbranch_vccnz L_rs54
L_rr54:
v_mfma_f32_16x16x32_bf16 v[12:15], a[100:103], a[4:7], v[12:15]
v_mfma_f32_16x16x32_bf16 a[164:167], a[160:163], v[92:95], a[164:167]
v_exp_f32 v24, v24
v_mfma_f32_16x16x32_bf16 v[12:15], a[104:107], a[8:11], v[12:15]
v_exp_f32 v25, v25
v_max3_f32 v6, v28, v29, v30
v_mfma_f32_16x16x32_bf16 v[12:15], a[108:111], a[12:15], v[12:15]
s_add_u32 m0, s49, 4224
s_add_u32 s48, s55, 266240
buffer_load_dwordx4 v3, s[8:11], s48 offen nt lds
s_waitcnt lgkmcnt(0)
v_mfma_f32_16x16x32_bf16 v[12:15], a[112:115], a[16:19], v[12:15]
v_exp_f32 v26, v26
v_mfma_f32_16x16x32_bf16 v[12:15], a[116:119], a[20:23], v[12:15]
v_max_f32 v6, v6, v31
v_mfma_f32_16x16x32_bf16 v[12:15], a[120:123], a[24:27], v[12:15]
v_exp_f32 v27, v27
v_mfma_f32_16x16x32_bf16 v[12:15], a[124:127], a[28:31], v[12:15]
v_cvt_pk_bf16_f32 v222, v24, v25
v_cmp_lt_f32 vcc, s50, v6
v_mfma_f32_16x16x32_bf16 v[20:23], a[96:99], a[32:35], v[36:39]
v_cvt_pk_bf16_f32 v223, v26, v27
ds_read_b128 a[96:99], v4 offset:25344
v_mfma_f32_16x16x32_bf16 v[20:23], a[100:103], a[36:39], v[20:23]
ds_read_b128 a[100:103], v4 offset:25408
s_cbranch_vccnz L_rs55
L_rr55:
v_mfma_f32_16x16x32_bf16 a[168:171], a[160:163], v[220:223], a[168:171]
v_exp_f32 v28, v28
v_mfma_f32_16x16x32_bf16 v[20:23], a[104:107], a[40:43], v[20:23]
ds_read_b128 a[104:107], v4 offset:25472
v_mfma_f32_16x16x32_bf16 v[20:23], a[108:111], a[44:47], v[20:23]
v_exp_f32 v29, v29
v_max3_f32 v6, v12, v13, v14
ds_read_b128 a[108:111], v4 offset:25536
v_mfma_f32_16x16x32_bf16 v[20:23], a[112:115], a[48:51], v[20:23]
v_exp_f32 v30, v30
v_max_f32 v6, v6, v15
v_mfma_f32_16x16x32_bf16 v[20:23], a[116:119], a[52:55], v[20:23]
ds_read_b128 a[112:115], v4 offset:25600
s_add_u32 m0, s49, 5280
s_add_u32 s48, s55, 267264
buffer_load_dwordx4 v3, s[8:11], s48 offen nt lds
v_mfma_f32_16x16x32_bf16 v[20:23], a[120:123], a[56:59], v[20:23]
v_exp_f32 v31, v31
v_mfma_f32_16x16x32_bf16 v[20:23], a[124:127], a[60:63], v[20:23]
ds_read_b128 a[116:119], v4 offset:25664
v_cvt_pk_bf16_f32 v11, v28, v29
v_accvgpr_write_b32 a236, v11
s_waitcnt lgkmcnt(1)
v_mfma_f32_16x16x32_bf16 v[16:19], a[96:99], a[0:3], v[32:35]
v_cmp_lt_f32 vcc, s50, v6
ds_read_b128 a[120:123], v4 offset:25728
v_mfma_f32_16x16x32_bf16 v[16:19], a[100:103], a[4:7], v[16:19]
v_cvt_pk_bf16_f32 v10, v30, v31
v_accvgpr_write_b32 a237, v10
ds_read_b128 a[124:127], v4 offset:25792
s_cbranch_vccnz L_rs56
L_rr56:
v_mfma_f32_16x16x32_bf16 v[16:19], a[104:107], a[8:11], v[16:19]
v_exp_f32 v12, v12
v_mfma_f32_16x16x32_bf16 v[16:19], a[108:111], a[12:15], v[16:19]
v_exp_f32 v13, v13
v_max3_f32 v8, v20, v21, v22
v_mfma_f32_16x16x32_bf16 v[16:19], a[112:115], a[16:19], v[16:19]
v_exp_f32 v14, v14
s_waitcnt lgkmcnt(1)
v_mfma_f32_16x16x32_bf16 v[16:19], a[116:119], a[20:23], v[16:19]
v_max_f32 v8, v8, v23
v_exp_f32 v15, v15
v_mfma_f32_16x16x32_bf16 v[16:19], a[120:123], a[24:27], v[16:19]
v_cvt_pk_bf16_f32 v96, v12, v13
v_cmp_lt_f32 vcc, s50, v8
s_waitcnt lgkmcnt(0)
v_mfma_f32_16x16x32_bf16 v[16:19], a[124:127], a[28:31], v[16:19]
v_cvt_pk_bf16_f32 v97, v14, v15
v_add_u32 v4, 33792, v4
v_add_u32 v5, 33792, v5
L_stage14:
s_waitcnt vmcnt(6)
s_barrier
v_mfma_f32_16x16x32_bf16 v[24:27], a[96:99], a[32:35], v[36:39]
ds_read_b128 a[96:99], v4
s_add_u32 m0, s49, 6336
s_add_u32 s48, s55, 268288
buffer_load_dwordx4 v3, s[8:11], s48 offen nt lds
v_mfma_f32_16x16x32_bf16 v[24:27], a[100:103], a[36:39], v[24:27]
ds_read_b128 a[100:103], v4 offset:64
s_cbranch_vccnz L_rs57
L_rr57:
v_mfma_f32_16x16x32_bf16 v[24:27], a[104:107], a[40:43], v[24:27]
v_exp_f32 v20, v20
ds_read_b128 a[104:107], v4 offset:128
v_mfma_f32_16x16x32_bf16 v[24:27], a[108:111], a[44:47], v[24:27]
v_exp_f32 v21, v21
v_max3_f32 v6, v16, v17, v18
v_mfma_f32_16x16x32_bf16 v[24:27], a[112:115], a[48:51], v[24:27]
ds_read_b128 a[108:111], v4 offset:192
v_mfma_f32_16x16x32_bf16 v[24:27], a[116:119], a[52:55], v[24:27]
v_exp_f32 v22, v22
v_max_f32 v6, v6, v19
ds_read_b128 a[112:115], v4 offset:256
v_mfma_f32_16x16x32_bf16 v[24:27], a[120:123], a[56:59], v[24:27]
v_exp_f32 v23, v23
v_mfma_f32_16x16x32_bf16 v[24:27], a[124:127], a[60:63], v[24:27]
ds_read_b128 a[116:119], v4 offset:320
v_cvt_pk_bf16_f32 v224, v20, v21
v_cmp_lt_f32 vcc, s50, v6
s_waitcnt lgkmcnt(2)
v_mfma_f32_16x16x32_bf16 v[12:15], a[96:99], a[0:3], v[32:35]
ds_read_b128 a[120:123], v4 offset:384
v_cvt_pk_bf16_f32 v225, v22, v23
v_mfma_f32_16x16x32_bf16 v[12:15], a[100:103], a[4:7], v[12:15]
ds_read_b128 a[124:127], v4 offset:448
s_add_u32 m0, s49, 7392
s_add_u32 s48, s55, 269312
buffer_load_dwordx4 v3, s[8:11], s48 offen nt lds
s_cbranch_vccnz L_rs58
L_rr58:
v_mfma_f32_16x16x32_bf16 v[12:15], a[104:107], a[8:11], v[12:15]
v_exp_f32 v16, v16
v_mfma_f32_16x16x32_bf16 v[12:15], a[108:111], a[12:15], v[12:15]
v_exp_f32 v17, v17
s_waitcnt lgkmcnt(1)
v_mfma_f32_16x16x32_bf16 v[12:15], a[112:115], a[16:19], v[12:15]
v_max3_f32 v8, v24, v25, v26
v_mfma_f32_16x16x32_bf16 v[12:15], a[116:119], a[20:23], v[12:15]
v_exp_f32 v18, v18
v_max_f32 v8, v8, v27
v_mfma_f32_16x16x32_bf16 v[12:15], a[120:123], a[24:27], v[12:15]
v_exp_f32 v19, v19
s_waitcnt lgkmcnt(0)
v_mfma_f32_16x16x32_bf16 v[12:15], a[124:127], a[28:31], v[12:15]
v_cvt_pk_bf16_f32 v98, v16, v17
v_cmp_lt_f32 vcc, s50, v8
v_mfma_f32_16x16x32_bf16 v[20:23], a[96:99], a[32:35], v[36:39]
v_cvt_pk_bf16_f32 v99, v18, v19
ds_read_b128 a[96:99], v4 offset:8448
v_mfma_f32_16x16x32_bf16 v[20:23], a[100:103], a[36:39], v[20:23]
ds_read_b128 a[100:103], v4 offset:8512
s_add_u32 m0, s49, 33792
s_add_u32 s48, s55, 294912
buffer_load_dwordx4 v3, s[8:11], s48 offen nt lds
v_mfma_f32_16x16x32_bf16 a[164:167], a[160:163], v[96:99], a[164:167]
s_cbranch_vccnz L_rs59
L_rr59:
v_exp_f32 v24, v24
v_mfma_f32_16x16x32_bf16 v[20:23], a[104:107], a[40:43], v[20:23]
ds_read_b128 a[104:107], v4 offset:8576
v_mfma_f32_16x16x32_bf16 v[20:23], a[108:111], a[44:47], v[20:23]
v_exp_f32 v25, v25
v_max3_f32 v6, v12, v13, v14
ds_read_b128 a[108:111], v4 offset:8640
v_mfma_f32_16x16x32_bf16 v[20:23], a[112:115], a[48:51], v[20:23]
v_exp_f32 v26, v26
v_mfma_f32_16x16x32_bf16 v[20:23], a[116:119], a[52:55], v[20:23]
v_max_f32 v6, v6, v15
ds_read_b128 a[112:115], v4 offset:8704
v_mfma_f32_16x16x32_bf16 v[20:23], a[120:123], a[56:59], v[20:23]
v_exp_f32 v27, v27
ds_read_b128 a[116:119], v4 offset:8768
v_mfma_f32_16x16x32_bf16 v[20:23], a[124:127], a[60:63], v[20:23]
v_cvt_pk_bf16_f32 v226, v24, v25
v_cmp_lt_f32 vcc, s50, v6
ds_read_b128 a[120:123], v4 offset:8832
s_waitcnt lgkmcnt(3)
v_mfma_f32_16x16x32_bf16 v[16:19], a[96:99], a[0:3], v[32:35]
v_cvt_pk_bf16_f32 v227, v26, v27
ds_read_b128 a[124:127], v4 offset:8896
v_mfma_f32_16x16x32_bf16 v[16:19], a[100:103], a[4:7], v[16:19]
ds_read_b128 a[128:131], v5
ds_read_b128 a[132:135], v5 offset:64
s_cbranch_vccnz L_rs60
L_rr60:
v_mfma_f32_16x16x32_bf16 a[168:171], a[160:163], v[224:227], a[168:171]
v_exp_f32 v12, v12
ds_read_b128 a[136:139], v5 offset:128
s_add_u32 m0, s49, 34848
v_mfma_f32_16x16x32_bf16 v[16:19], a[104:107], a[8:11], v[16:19]
s_add_u32 s48, s55, 295936
buffer_load_dwordx4 v3, s[8:11], s48 offen nt lds
v_mfma_f32_16x16x32_bf16 v[16:19], a[108:111], a[12:15], v[16:19]
v_exp_f32 v13, v13
v_max3_f32 v8, v20, v21, v22
s_waitcnt lgkmcnt(1)
v_mfma_f32_16x16x32_bf16 v[16:19], a[112:115], a[16:19], v[16:19]
ds_read_b128 a[140:143], v5 offset:192
v_exp_f32 v14, v14
v_mfma_f32_16x16x32_bf16 v[16:19], a[116:119], a[20:23], v[16:19]
v_max_f32 v8, v8, v23
ds_read_b128 a[144:147], v5 offset:256
v_mfma_f32_16x16x32_bf16 v[16:19], a[120:123], a[24:27], v[16:19]
v_exp_f32 v15, v15
ds_read_b128 a[148:151], v5 offset:320
v_mfma_f32_16x16x32_bf16 v[16:19], a[124:127], a[28:31], v[16:19]
v_cvt_pk_bf16_f32 v100, v12, v13
v_cmp_lt_f32 vcc, s50, v8
v_mfma_f32_16x16x32_bf16 v[24:27], a[96:99], a[32:35], v[36:39]
ds_read_b128 a[152:155], v5 offset:384
v_cvt_pk_bf16_f32 v101, v14, v15
ds_read_b128 a[156:159], v5 offset:448
v_mfma_f32_16x16x32_bf16 v[24:27], a[100:103], a[36:39], v[24:27]
ds_read_b128 a[96:99], v4 offset:16896
ds_read_b128 a[100:103], v4 offset:16960
s_cbranch_vccnz L_rs61
L_rr61:
v_mfma_f32_16x16x32_bf16 v[24:27], a[104:107], a[40:43], v[24:27]
v_exp_f32 v20, v20
v_mfma_f32_16x16x32_bf16 v[24:27], a[108:111], a[44:47], v[24:27]
ds_read_b128 a[104:107], v4 offset:17024
s_add_u32 m0, s49, 35904
s_add_u32 s48, s55, 296960
buffer_load_dwordx4 v3, s[8:11], s48 offen nt lds
v_mfma_f32_16x16x32_bf16 v[24:27], a[112:115], a[48:51], v[24:27]
v_exp_f32 v21, v21
v_mfma_f32_16x16x32_bf16 v[24:27], a[116:119], a[52:55], v[24:27]
v_max3_f32 v6, v16, v17, v18
ds_read_b128 a[108:111], v4 offset:17088
v_mfma_f32_16x16x32_bf16 v[24:27], a[120:123], a[56:59], v[24:27]
v_exp_f32 v22, v22
v_max_f32 v6, v6, v19
v_mfma_f32_16x16x32_bf16 v[24:27], a[124:127], a[60:63], v[24:27]
ds_read_b128 a[112:115], v4 offset:17152
v_mfma_f32_16x16x32_bf16 v[28:31], a[128:131], a[64:67], v[40:43]
v_exp_f32 v23, v23
ds_read_b128 a[116:119], v4 offset:17216
v_cvt_pk_bf16_f32 v228, v20, v21
v_mfma_f32_16x16x32_bf16 v[28:31], a[132:135], a[68:71], v[28:31]
v_cmp_lt_f32 vcc, s50, v6
ds_read_b128 a[120:123], v4 offset:17280
s_waitcnt lgkmcnt(3)
v_mfma_f32_16x16x32_bf16 v[28:31], a[136:139], a[72:75], v[28:31]
v_cvt_pk_bf16_f32 v229, v22, v23
ds_read_b128 a[124:127], v4 offset:17344
s_cbranch_vccnz L_rs62
L_rr62:
v_mfma_f32_16x16x32_bf16 v[28:31], a[140:143], a[76:79], v[28:31]
v_exp_f32 v16, v16
v_mfma_f32_16x16x32_bf16 v[28:31], a[144:147], a[80:83], v[28:31]
v_exp_f32 v17, v17
v_max3_f32 v8, v24, v25, v26
s_add_u32 m0, s49, 36960
v_mfma_f32_16x16x32_bf16 v[28:31], a[148:151], a[84:87], v[28:31]
s_add_u32 s48, s55, 297984
buffer_load_dwordx4 v3, s[8:11], s48 offen nt lds
v_mfma_f32_16x16x32_bf16 v[28:31], a[152:155], a[88:91], v[28:31]
v_exp_f32 v18, v18
v_max_f32 v8, v8, v27
v_mfma_f32_16x16x32_bf16 v[28:31], a[156:159], a[92:95], v[28:31]
v_exp_f32 v19, v19
v_mfma_f32_16x16x32_bf16 v[12:15], a[96:99], a[0:3], v[32:35]
v_cvt_pk_bf16_f32 v102, v16, v17
v_cmp_lt_f32 vcc, s50, v8
v_cvt_pk_bf16_f32 v103, v18, v19
s_cbranch_vccnz L_rs63
L_rr63:
v_mfma_f32_16x16x32_bf16 v[12:15], a[100:103], a[4:7], v[12:15]
v_mfma_f32_16x16x32_bf16 a[164:167], a[160:163], v[100:103], a[164:167]
v_exp_f32 v24, v24
v_mfma_f32_16x16x32_bf16 v[12:15], a[104:107], a[8:11], v[12:15]
v_exp_f32 v25, v25
v_max3_f32 v6, v28, v29, v30
v_mfma_f32_16x16x32_bf16 v[12:15], a[108:111], a[12:15], v[12:15]
s_add_u32 m0, s49, 38016
s_add_u32 s48, s55, 299008
buffer_load_dwordx4 v3, s[8:11], s48 offen nt lds
s_waitcnt lgkmcnt(0)
v_mfma_f32_16x16x32_bf16 v[12:15], a[112:115], a[16:19], v[12:15]
v_exp_f32 v26, v26
v_mfma_f32_16x16x32_bf16 v[12:15], a[116:119], a[20:23], v[12:15]
v_max_f32 v6, v6, v31
v_mfma_f32_16x16x32_bf16 v[12:15], a[120:123], a[24:27], v[12:15]
v_exp_f32 v27, v27
v_mfma_f32_16x16x32_bf16 v[12:15], a[124:127], a[28:31], v[12:15]
v_cvt_pk_bf16_f32 v230, v24, v25
v_cmp_lt_f32 vcc, s50, v6
v_mfma_f32_16x16x32_bf16 v[20:23], a[96:99], a[32:35], v[36:39]
v_cvt_pk_bf16_f32 v231, v26, v27
ds_read_b128 a[96:99], v4 offset:25344
v_mfma_f32_16x16x32_bf16 v[20:23], a[100:103], a[36:39], v[20:23]
ds_read_b128 a[100:103], v4 offset:25408
s_cbranch_vccnz L_rs64
L_rr64:
v_mfma_f32_16x16x32_bf16 a[168:171], a[160:163], v[228:231], a[168:171]
v_exp_f32 v28, v28
v_mfma_f32_16x16x32_bf16 v[20:23], a[104:107], a[40:43], v[20:23]
ds_read_b128 a[104:107], v4 offset:25472
v_exp_f32 v29, v29
v_mfma_f32_16x16x32_bf16 v[20:23], a[108:111], a[44:47], v[20:23]
v_max3_f32 v6, v12, v13, v14
ds_read_b128 a[108:111], v4 offset:25536
v_mfma_f32_16x16x32_bf16 v[20:23], a[112:115], a[48:51], v[20:23]
v_exp_f32 v30, v30
v_max_f32 v6, v6, v15
v_mfma_f32_16x16x32_bf16 v[20:23], a[116:119], a[52:55], v[20:23]
ds_read_b128 a[112:115], v4 offset:25600
s_add_u32 m0, s49, 39072
s_add_u32 s48, s55, 300032
buffer_load_dwordx4 v3, s[8:11], s48 offen nt lds
v_mfma_f32_16x16x32_bf16 v[20:23], a[120:123], a[56:59], v[20:23]
v_exp_f32 v31, v31
ds_read_b128 a[116:119], v4 offset:25664
v_mfma_f32_16x16x32_bf16 v[20:23], a[124:127], a[60:63], v[20:23]
v_cvt_pk_bf16_f32 v11, v28, v29
v_accvgpr_write_b32 a238, v11
v_cmp_lt_f32 vcc, s50, v6
s_waitcnt lgkmcnt(1)
v_mfma_f32_16x16x32_bf16 v[16:19], a[96:99], a[0:3], v[32:35]
ds_read_b128 a[120:123], v4 offset:25728
v_cvt_pk_bf16_f32 v10, v30, v31
v_accvgpr_write_b32 a239, v10
v_mfma_f32_16x16x32_bf16 v[16:19], a[100:103], a[4:7], v[16:19]
ds_read_b128 a[124:127], v4 offset:25792
s_cbranch_vccnz L_rs65
L_rr65:
v_mfma_f32_16x16x32_bf16 a[172:175], a[160:163], a[236:239], a[172:175]
v_exp_f32 v12, v12
v_mfma_f32_16x16x32_bf16 v[16:19], a[104:107], a[8:11], v[16:19]
v_exp_f32 v13, v13
v_max3_f32 v8, v20, v21, v22
v_mfma_f32_16x16x32_bf16 v[16:19], a[108:111], a[12:15], v[16:19]
v_exp_f32 v14, v14
v_mfma_f32_16x16x32_bf16 v[16:19], a[112:115], a[16:19], v[16:19]
v_max_f32 v8, v8, v23
s_waitcnt lgkmcnt(0)
v_mfma_f32_16x16x32_bf16 v[16:19], a[116:119], a[20:23], v[16:19]
v_exp_f32 v15, v15
v_cvt_pk_bf16_f32 v104, v12, v13
v_mfma_f32_16x16x32_bf16 v[16:19], a[120:123], a[24:27], v[16:19]
v_cmp_lt_f32 vcc, s50, v8
v_cvt_pk_bf16_f32 v105, v14, v15
v_mfma_f32_16x16x32_bf16 v[16:19], a[124:127], a[28:31], v[16:19]
v_subrev_u32 v4, 67584, v4
v_subrev_u32 v5, 67584, v5
L_stage15:
s_waitcnt vmcnt(6)
s_barrier
v_mfma_f32_16x16x32_bf16 v[24:27], a[96:99], a[32:35], v[36:39]
ds_read_b128 a[96:99], v4
s_add_u32 m0, s49, 40128
s_add_u32 s48, s55, 301056
buffer_load_dwordx4 v3, s[8:11], s48 offen nt lds
v_mfma_f32_16x16x32_bf16 v[24:27], a[100:103], a[36:39], v[24:27]
ds_read_b128 a[100:103], v4 offset:64
s_cbranch_vccnz L_rs66
L_rr66:
v_mfma_f32_16x16x32_bf16 v[24:27], a[104:107], a[40:43], v[24:27]
v_exp_f32 v20, v20
ds_read_b128 a[104:107], v4 offset:128
v_mfma_f32_16x16x32_bf16 v[24:27], a[108:111], a[44:47], v[24:27]
v_exp_f32 v21, v21
v_max3_f32 v6, v16, v17, v18
v_mfma_f32_16x16x32_bf16 v[24:27], a[112:115], a[48:51], v[24:27]
ds_read_b128 a[108:111], v4 offset:192
v_mfma_f32_16x16x32_bf16 v[24:27], a[116:119], a[52:55], v[24:27]
v_exp_f32 v22, v22
v_max_f32 v6, v6, v19
ds_read_b128 a[112:115], v4 offset:256
v_mfma_f32_16x16x32_bf16 v[24:27], a[120:123], a[56:59], v[24:27]
v_exp_f32 v23, v23
v_mfma_f32_16x16x32_bf16 v[24:27], a[124:127], a[60:63], v[24:27]
ds_read_b128 a[116:119], v4 offset:320
v_cvt_pk_bf16_f32 v232, v20, v21
v_cmp_lt_f32 vcc, s50, v6
s_waitcnt lgkmcnt(2)
v_mfma_f32_16x16x32_bf16 v[12:15], a[96:99], a[0:3], v[32:35]
ds_read_b128 a[120:123], v4 offset:384
v_cvt_pk_bf16_f32 v233, v22, v23
v_mfma_f32_16x16x32_bf16 v[12:15], a[100:103], a[4:7], v[12:15]
ds_read_b128 a[124:127], v4 offset:448
s_add_u32 m0, s49, 41184
s_add_u32 s48, s55, 302080
buffer_load_dwordx4 v3, s[8:11], s48 offen nt lds
s_cbranch_vccnz L_rs67
L_rr67:
v_mfma_f32_16x16x32_bf16 v[12:15], a[104:107], a[8:11], v[12:15]
v_exp_f32 v16, v16
v_mfma_f32_16x16x32_bf16 v[12:15], a[108:111], a[12:15], v[12:15]
v_exp_f32 v17, v17
s_waitcnt lgkmcnt(1)
v_mfma_f32_16x16x32_bf16 v[12:15], a[112:115], a[16:19], v[12:15]
v_max3_f32 v8, v24, v25, v26
v_mfma_f32_16x16x32_bf16 v[12:15], a[116:119], a[20:23], v[12:15]
v_exp_f32 v18, v18
v_max_f32 v8, v8, v27
v_mfma_f32_16x16x32_bf16 v[12:15], a[120:123], a[24:27], v[12:15]
v_exp_f32 v19, v19
s_waitcnt lgkmcnt(0)
v_mfma_f32_16x16x32_bf16 v[12:15], a[124:127], a[28:31], v[12:15]
v_cvt_pk_bf16_f32 v106, v16, v17
v_cmp_lt_f32 vcc, s50, v8
v_mfma_f32_16x16x32_bf16 v[20:23], a[96:99], a[32:35], v[36:39]
v_cvt_pk_bf16_f32 v107, v18, v19
ds_read_b128 a[96:99], v4 offset:8448
v_mfma_f32_16x16x32_bf16 v[20:23], a[100:103], a[36:39], v[20:23]
ds_read_b128 a[100:103], v4 offset:8512
s_add_u32 m0, s49, 67584
s_add_u32 s48, s55, 327680
buffer_load_dwordx4 v3, s[8:11], s48 offen nt lds
v_mfma_f32_16x16x32_bf16 a[164:167], a[160:163], v[104:107], a[164:167]
s_cbranch_vccnz L_rs68
L_rr68:
v_exp_f32 v24, v24
v_mfma_f32_16x16x32_bf16 v[20:23], a[104:107], a[40:43], v[20:23]
ds_read_b128 a[104:107], v4 offset:8576
v_mfma_f32_16x16x32_bf16 v[20:23], a[108:111], a[44:47], v[20:23]
v_exp_f32 v25, v25
v_max3_f32 v6, v12, v13, v14
ds_read_b128 a[108:111], v4 offset:8640
v_mfma_f32_16x16x32_bf16 v[20:23], a[112:115], a[48:51], v[20:23]
v_exp_f32 v26, v26
v_mfma_f32_16x16x32_bf16 v[20:23], a[116:119], a[52:55], v[20:23]
v_max_f32 v6, v6, v15
ds_read_b128 a[112:115], v4 offset:8704
v_mfma_f32_16x16x32_bf16 v[20:23], a[120:123], a[56:59], v[20:23]
v_exp_f32 v27, v27
ds_read_b128 a[116:119], v4 offset:8768
v_mfma_f32_16x16x32_bf16 v[20:23], a[124:127], a[60:63], v[20:23]
v_cvt_pk_bf16_f32 v234, v24, v25
v_cmp_lt_f32 vcc, s50, v6
ds_read_b128 a[120:123], v4 offset:8832
s_waitcnt lgkmcnt(3)
v_mfma_f32_16x16x32_bf16 v[16:19], a[96:99], a[0:3], v[32:35]
v_cvt_pk_bf16_f32 v235, v26, v27
ds_read_b128 a[124:127], v4 offset:8896
v_mfma_f32_16x16x32_bf16 v[16:19], a[100:103], a[4:7], v[16:19]
ds_read_b128 a[128:131], v5
ds_read_b128 a[132:135], v5 offset:64
s_cbranch_vccnz L_rs69
L_rr69:
v_mfma_f32_16x16x32_bf16 a[168:171], a[160:163], v[232:235], a[168:171]
v_exp_f32 v12, v12
ds_read_b128 a[136:139], v5 offset:128
s_add_u32 m0, s49, 68640
v_mfma_f32_16x16x32_bf16 v[16:19], a[104:107], a[8:11], v[16:19]
s_add_u32 s48, s55, 328704
buffer_load_dwordx4 v3, s[8:11], s48 offen nt lds
v_mfma_f32_16x16x32_bf16 v[16:19], a[108:111], a[12:15], v[16:19]
v_exp_f32 v13, v13
v_max3_f32 v8, v20, v21, v22
s_waitcnt lgkmcnt(1)
v_mfma_f32_16x16x32_bf16 v[16:19], a[112:115], a[16:19], v[16:19]
ds_read_b128 a[140:143], v5 offset:192
v_exp_f32 v14, v14
v_mfma_f32_16x16x32_bf16 v[16:19], a[116:119], a[20:23], v[16:19]
v_max_f32 v8, v8, v23
ds_read_b128 a[144:147], v5 offset:256
v_mfma_f32_16x16x32_bf16 v[16:19], a[120:123], a[24:27], v[16:19]
v_exp_f32 v15, v15
ds_read_b128 a[148:151], v5 offset:320
v_mfma_f32_16x16x32_bf16 v[16:19], a[124:127], a[28:31], v[16:19]
v_cvt_pk_bf16_f32 v108, v12, v13
v_cmp_lt_f32 vcc, s50, v8
v_mfma_f32_16x16x32_bf16 v[24:27], a[96:99], a[32:35], v[36:39]
ds_read_b128 a[152:155], v5 offset:384
v_cvt_pk_bf16_f32 v109, v14, v15
ds_read_b128 a[156:159], v5 offset:448
v_mfma_f32_16x16x32_bf16 v[24:27], a[100:103], a[36:39], v[24:27]
ds_read_b128 a[96:99], v4 offset:16896
ds_read_b128 a[100:103], v4 offset:16960
s_cbranch_vccnz L_rs70
L_rr70:
v_mfma_f32_16x16x32_bf16 v[24:27], a[104:107], a[40:43], v[24:27]
v_exp_f32 v20, v20
v_mfma_f32_16x16x32_bf16 v[24:27], a[108:111], a[44:47], v[24:27]
ds_read_b128 a[104:107], v4 offset:17024
s_add_u32 m0, s49, 69696
s_add_u32 s48, s55, 329728
buffer_load_dwordx4 v3, s[8:11], s48 offen nt lds
v_mfma_f32_16x16x32_bf16 v[24:27], a[112:115], a[48:51], v[24:27]
v_exp_f32 v21, v21
v_mfma_f32_16x16x32_bf16 v[24:27], a[116:119], a[52:55], v[24:27]
v_max3_f32 v6, v16, v17, v18
ds_read_b128 a[108:111], v4 offset:17088
v_mfma_f32_16x16x32_bf16 v[24:27], a[120:123], a[56:59], v[24:27]
v_exp_f32 v22, v22
v_max_f32 v6, v6, v19
v_mfma_f32_16x16x32_bf16 v[24:27], a[124:127], a[60:63], v[24:27]
ds_read_b128 a[112:115], v4 offset:17152
v_mfma_f32_16x16x32_bf16 v[28:31], a[128:131], a[64:67], v[40:43]
v_exp_f32 v23, v23
ds_read_b128 a[116:119], v4 offset:17216
v_cvt_pk_bf16_f32 v236, v20, v21
v_mfma_f32_16x16x32_bf16 v[28:31], a[132:135], a[68:71], v[28:31]
v_cmp_lt_f32 vcc, s50, v6
ds_read_b128 a[120:123], v4 offset:17280
s_waitcnt lgkmcnt(3)
v_mfma_f32_16x16x32_bf16 v[28:31], a[136:139], a[72:75], v[28:31]
v_cvt_pk_bf16_f32 v237, v22, v23
ds_read_b128 a[124:127], v4 offset:17344
s_cbranch_vccnz L_rs71
L_rr71:
v_mfma_f32_16x16x32_bf16 v[28:31], a[140:143], a[76:79], v[28:31]
v_exp_f32 v16, v16
v_mfma_f32_16x16x32_bf16 v[28:31], a[144:147], a[80:83], v[28:31]
v_exp_f32 v17, v17
v_max3_f32 v8, v24, v25, v26
s_add_u32 m0, s49, 70752
v_mfma_f32_16x16x32_bf16 v[28:31], a[148:151], a[84:87], v[28:31]
s_add_u32 s48, s55, 330752
buffer_load_dwordx4 v3, s[8:11], s48 offen nt lds
v_mfma_f32_16x16x32_bf16 v[28:31], a[152:155], a[88:91], v[28:31]
v_exp_f32 v18, v18
v_max_f32 v8, v8, v27
v_mfma_f32_16x16x32_bf16 v[28:31], a[156:159], a[92:95], v[28:31]
v_exp_f32 v19, v19
v_mfma_f32_16x16x32_bf16 v[12:15], a[96:99], a[0:3], v[32:35]
v_cvt_pk_bf16_f32 v110, v16, v17
v_cmp_lt_f32 vcc, s50, v8
v_cvt_pk_bf16_f32 v111, v18, v19
s_cbranch_vccnz L_rs72
L_rr72:
v_mfma_f32_16x16x32_bf16 v[12:15], a[100:103], a[4:7], v[12:15]
v_mfma_f32_16x16x32_bf16 a[164:167], a[160:163], v[108:111], a[164:167]
v_exp_f32 v24, v24
v_mfma_f32_16x16x32_bf16 v[12:15], a[104:107], a[8:11], v[12:15]
v_exp_f32 v25, v25
v_max3_f32 v6, v28, v29, v30
v_mfma_f32_16x16x32_bf16 v[12:15], a[108:111], a[12:15], v[12:15]
s_add_u32 m0, s49, 71808
s_add_u32 s48, s55, 331776
buffer_load_dwordx4 v3, s[8:11], s48 offen nt lds
s_waitcnt lgkmcnt(0)
v_mfma_f32_16x16x32_bf16 v[12:15], a[112:115], a[16:19], v[12:15]
v_exp_f32 v26, v26
v_mfma_f32_16x16x32_bf16 v[12:15], a[116:119], a[20:23], v[12:15]
v_max_f32 v6, v6, v31
v_mfma_f32_16x16x32_bf16 v[12:15], a[120:123], a[24:27], v[12:15]
v_exp_f32 v27, v27
v_mfma_f32_16x16x32_bf16 v[12:15], a[124:127], a[28:31], v[12:15]
v_cvt_pk_bf16_f32 v238, v24, v25
v_cmp_lt_f32 vcc, s50, v6
v_mfma_f32_16x16x32_bf16 v[20:23], a[96:99], a[32:35], v[36:39]
v_cvt_pk_bf16_f32 v239, v26, v27
ds_read_b128 a[96:99], v4 offset:25344
v_mfma_f32_16x16x32_bf16 v[20:23], a[100:103], a[36:39], v[20:23]
ds_read_b128 a[100:103], v4 offset:25408
s_cbranch_vccnz L_rs73
L_rr73:
v_mfma_f32_16x16x32_bf16 a[168:171], a[160:163], v[236:239], a[168:171]
v_exp_f32 v28, v28
v_mfma_f32_16x16x32_bf16 v[20:23], a[104:107], a[40:43], v[20:23]
ds_read_b128 a[104:107], v4 offset:25472
v_mfma_f32_16x16x32_bf16 v[20:23], a[108:111], a[44:47], v[20:23]
v_exp_f32 v29, v29
v_max3_f32 v6, v12, v13, v14
ds_read_b128 a[108:111], v4 offset:25536
v_mfma_f32_16x16x32_bf16 v[20:23], a[112:115], a[48:51], v[20:23]
v_exp_f32 v30, v30
v_max_f32 v6, v6, v15
v_mfma_f32_16x16x32_bf16 v[20:23], a[116:119], a[52:55], v[20:23]
ds_read_b128 a[112:115], v4 offset:25600
s_add_u32 m0, s49, 72864
s_add_u32 s48, s55, 332800
buffer_load_dwordx4 v3, s[8:11], s48 offen nt lds
v_mfma_f32_16x16x32_bf16 v[20:23], a[120:123], a[56:59], v[20:23]
v_exp_f32 v31, v31
v_mfma_f32_16x16x32_bf16 v[20:23], a[124:127], a[60:63], v[20:23]
ds_read_b128 a[116:119], v4 offset:25664
v_cvt_pk_bf16_f32 v11, v28, v29
v_accvgpr_write_b32 a240, v11
s_waitcnt lgkmcnt(1)
v_mfma_f32_16x16x32_bf16 v[16:19], a[96:99], a[0:3], v[32:35]
v_cmp_lt_f32 vcc, s50, v6
ds_read_b128 a[120:123], v4 offset:25728
v_mfma_f32_16x16x32_bf16 v[16:19], a[100:103], a[4:7], v[16:19]
v_cvt_pk_bf16_f32 v10, v30, v31
v_accvgpr_write_b32 a241, v10
ds_read_b128 a[124:127], v4 offset:25792
s_cbranch_vccnz L_rs74
L_rr74:
v_mfma_f32_16x16x32_bf16 v[16:19], a[104:107], a[8:11], v[16:19]
v_exp_f32 v12, v12
v_mfma_f32_16x16x32_bf16 v[16:19], a[108:111], a[12:15], v[16:19]
v_exp_f32 v13, v13
v_max3_f32 v8, v20, v21, v22
v_mfma_f32_16x16x32_bf16 v[16:19], a[112:115], a[16:19], v[16:19]
v_exp_f32 v14, v14
s_waitcnt lgkmcnt(1)
v_mfma_f32_16x16x32_bf16 v[16:19], a[116:119], a[20:23], v[16:19]
v_max_f32 v8, v8, v23
v_exp_f32 v15, v15
v_mfma_f32_16x16x32_bf16 v[16:19], a[120:123], a[24:27], v[16:19]
v_cvt_pk_bf16_f32 v112, v12, v13
v_cmp_lt_f32 vcc, s50, v8
s_waitcnt lgkmcnt(0)
v_mfma_f32_16x16x32_bf16 v[16:19], a[124:127], a[28:31], v[16:19]
v_cvt_pk_bf16_f32 v113, v14, v15
v_add_u32 v4, 33792, v4
v_add_u32 v5, 33792, v5
L_stage16:
s_waitcnt vmcnt(6)
s_barrier
v_mfma_f32_16x16x32_bf16 v[24:27], a[96:99], a[32:35], v[36:39]
ds_read_b128 a[96:99], v4
s_add_u32 m0, s49, 73920
s_add_u32 s48, s55, 333824
buffer_load_dwordx4 v3, s[8:11], s48 offen nt lds
v_mfma_f32_16x16x32_bf16 v[24:27], a[100:103], a[36:39], v[24:27]
ds_read_b128 a[100:103], v4 offset:64
s_cbranch_vccnz L_rs75
L_rr75:
v_mfma_f32_16x16x32_bf16 v[24:27], a[104:107], a[40:43], v[24:27]
v_exp_f32 v20, v20
ds_read_b128 a[104:107], v4 offset:128
v_mfma_f32_16x16x32_bf16 v[24:27], a[108:111], a[44:47], v[24:27]
v_exp_f32 v21, v21
v_max3_f32 v6, v16, v17, v18
v_mfma_f32_16x16x32_bf16 v[24:27], a[112:115], a[48:51], v[24:27]
ds_read_b128 a[108:111], v4 offset:192
v_mfma_f32_16x16x32_bf16 v[24:27], a[116:119], a[52:55], v[24:27]
v_exp_f32 v22, v22
v_max_f32 v6, v6, v19
ds_read_b128 a[112:115], v4 offset:256
v_mfma_f32_16x16x32_bf16 v[24:27], a[120:123], a[56:59], v[24:27]
v_exp_f32 v23, v23
v_mfma_f32_16x16x32_bf16 v[24:27], a[124:127], a[60:63], v[24:27]
ds_read_b128 a[116:119], v4 offset:320
v_cvt_pk_bf16_f32 v240, v20, v21
v_cmp_lt_f32 vcc, s50, v6
s_waitcnt lgkmcnt(2)
v_mfma_f32_16x16x32_bf16 v[12:15], a[96:99], a[0:3], v[32:35]
ds_read_b128 a[120:123], v4 offset:384
v_cvt_pk_bf16_f32 v241, v22, v23
v_mfma_f32_16x16x32_bf16 v[12:15], a[100:103], a[4:7], v[12:15]
ds_read_b128 a[124:127], v4 offset:448
s_add_u32 m0, s49, 74976
s_add_u32 s48, s55, 334848
buffer_load_dwordx4 v3, s[8:11], s48 offen nt lds
s_cbranch_vccnz L_rs76
L_rr76:
v_mfma_f32_16x16x32_bf16 v[12:15], a[104:107], a[8:11], v[12:15]
v_exp_f32 v16, v16
v_mfma_f32_16x16x32_bf16 v[12:15], a[108:111], a[12:15], v[12:15]
v_exp_f32 v17, v17
s_waitcnt lgkmcnt(1)
v_mfma_f32_16x16x32_bf16 v[12:15], a[112:115], a[16:19], v[12:15]
v_max3_f32 v8, v24, v25, v26
v_mfma_f32_16x16x32_bf16 v[12:15], a[116:119], a[20:23], v[12:15]
v_exp_f32 v18, v18
v_max_f32 v8, v8, v27
v_mfma_f32_16x16x32_bf16 v[12:15], a[120:123], a[24:27], v[12:15]
v_exp_f32 v19, v19
s_waitcnt lgkmcnt(0)
v_mfma_f32_16x16x32_bf16 v[12:15], a[124:127], a[28:31], v[12:15]
v_cvt_pk_bf16_f32 v114, v16, v17
v_cmp_lt_f32 vcc, s50, v8
v_mfma_f32_16x16x32_bf16 v[20:23], a[96:99], a[32:35], v[36:39]
v_cvt_pk_bf16_f32 v115, v18, v19
ds_read_b128 a[96:99], v4 offset:8448
v_mfma_f32_16x16x32_bf16 v[20:23], a[100:103], a[36:39], v[20:23]
ds_read_b128 a[100:103], v4 offset:8512
s_add_u32 m0, s49, 0
s_add_u32 s48, s55, 360448
buffer_load_dwordx4 v3, s[8:11], s48 offen nt lds
v_mfma_f32_16x16x32_bf16 a[164:167], a[160:163], v[112:115], a[164:167]
s_cbranch_vccnz L_rs77
L_rr77:
v_exp_f32 v24, v24
v_mfma_f32_16x16x32_bf16 v[20:23], a[104:107], a[40:43], v[20:23]
ds_read_b128 a[104:107], v4 offset:8576
v_mfma_f32_16x16x32_bf16 v[20:23], a[108:111], a[44:47], v[20:23]
v_exp_f32 v25, v25
v_max3_f32 v6, v12, v13, v14
ds_read_b128 a[108:111], v4 offset:8640
v_mfma_f32_16x16x32_bf16 v[20:23], a[112:115], a[48:51], v[20:23]
v_exp_f32 v26, v26
v_mfma_f32_16x16x32_bf16 v[20:23], a[116:119], a[52:55], v[20:23]
v_max_f32 v6, v6, v15
ds_read_b128 a[112:115], v4 offset:8704
v_mfma_f32_16x16x32_bf16 v[20:23], a[120:123], a[56:59], v[20:23]
v_exp_f32 v27, v27
ds_read_b128 a[116:119], v4 offset:8768
v_mfma_f32_16x16x32_bf16 v[20:23], a[124:127], a[60:63], v[20:23]
v_cvt_pk_bf16_f32 v242, v24, v25
v_cmp_lt_f32 vcc, s50, v6
ds_read_b128 a[120:123], v4 offset:8832
s_waitcnt lgkmcnt(3)
v_mfma_f32_16x16x32_bf16 v[16:19], a[96:99], a[0:3], v[32:35]
v_cvt_pk_bf16_f32 v243, v26, v27
ds_read_b128 a[124:127], v4 offset:8896
v_mfma_f32_16x16x32_bf16 v[16:19], a[100:103], a[4:7], v[16:19]
ds_read_b128 a[128:131], v5
ds_read_b128 a[132:135], v5 offset:64
s_cbranch_vccnz L_rs78
L_rr78:
v_mfma_f32_16x16x32_bf16 a[168:171], a[160:163], v[240:243], a[168:171]
v_exp_f32 v12, v12
ds_read_b128 a[136:139], v5 offset:128
s_add_u32 m0, s49, 1056
v_mfma_f32_16x16x32_bf16 v[16:19], a[104:107], a[8:11], v[16:19]
s_add_u32 s48, s55, 361472
buffer_load_dwordx4 v3, s[8:11], s48 offen nt lds
v_mfma_f32_16x16x32_bf16 v[16:19], a[108:111], a[12:15], v[16:19]
v_exp_f32 v13, v13
v_max3_f32 v8, v20, v21, v22
s_waitcnt lgkmcnt(1)
v_mfma_f32_16x16x32_bf16 v[16:19], a[112:115], a[16:19], v[16:19]
ds_read_b128 a[140:143], v5 offset:192
v_exp_f32 v14, v14
v_mfma_f32_16x16x32_bf16 v[16:19], a[116:119], a[20:23], v[16:19]
v_max_f32 v8, v8, v23
ds_read_b128 a[144:147], v5 offset:256
v_mfma_f32_16x16x32_bf16 v[16:19], a[120:123], a[24:27], v[16:19]
v_exp_f32 v15, v15
ds_read_b128 a[148:151], v5 offset:320
v_mfma_f32_16x16x32_bf16 v[16:19], a[124:127], a[28:31], v[16:19]
v_cvt_pk_bf16_f32 v116, v12, v13
v_cmp_lt_f32 vcc, s50, v8
v_mfma_f32_16x16x32_bf16 v[24:27], a[96:99], a[32:35], v[36:39]
ds_read_b128 a[152:155], v5 offset:384
v_cvt_pk_bf16_f32 v117, v14, v15
ds_read_b128 a[156:159], v5 offset:448
v_mfma_f32_16x16x32_bf16 v[24:27], a[100:103], a[36:39], v[24:27]
ds_read_b128 a[96:99], v4 offset:16896
ds_read_b128 a[100:103], v4 offset:16960
s_cbranch_vccnz L_rs79
L_rr79:
v_mfma_f32_16x16x32_bf16 v[24:27], a[104:107], a[40:43], v[24:27]
v_exp_f32 v20, v20
v_mfma_f32_16x16x32_bf16 v[24:27], a[108:111], a[44:47], v[24:27]
ds_read_b128 a[104:107], v4 offset:17024
s_add_u32 m0, s49, 2112
s_add_u32 s48, s55, 362496
buffer_load_dwordx4 v3, s[8:11], s48 offen nt lds
v_mfma_f32_16x16x32_bf16 v[24:27], a[112:115], a[48:51], v[24:27]
v_exp_f32 v21, v21
v_mfma_f32_16x16x32_bf16 v[24:27], a[116:119], a[52:55], v[24:27]
v_max3_f32 v6, v16, v17, v18
ds_read_b128 a[108:111], v4 offset:17088
v_mfma_f32_16x16x32_bf16 v[24:27], a[120:123], a[56:59], v[24:27]
v_exp_f32 v22, v22
v_max_f32 v6, v6, v19
v_mfma_f32_16x16x32_bf16 v[24:27], a[124:127], a[60:63], v[24:27]
ds_read_b128 a[112:115], v4 offset:17152
v_mfma_f32_16x16x32_bf16 v[28:31], a[128:131], a[64:67], v[40:43]
v_exp_f32 v23, v23
ds_read_b128 a[116:119], v4 offset:17216
v_cvt_pk_bf16_f32 v244, v20, v21
v_mfma_f32_16x16x32_bf16 v[28:31], a[132:135], a[68:71], v[28:31]
v_cmp_lt_f32 vcc, s50, v6
ds_read_b128 a[120:123], v4 offset:17280
s_waitcnt lgkmcnt(3)
v_mfma_f32_16x16x32_bf16 v[28:31], a[136:139], a[72:75], v[28:31]
v_cvt_pk_bf16_f32 v245, v22, v23
ds_read_b128 a[124:127], v4 offset:17344
s_cbranch_vccnz L_rs80
L_rr80:
v_mfma_f32_16x16x32_bf16 v[28:31], a[140:143], a[76:79], v[28:31]
v_exp_f32 v16, v16
v_mfma_f32_16x16x32_bf16 v[28:31], a[144:147], a[80:83], v[28:31]
v_exp_f32 v17, v17
v_max3_f32 v8, v24, v25, v26
s_add_u32 m0, s49, 3168
v_mfma_f32_16x16x32_bf16 v[28:31], a[148:151], a[84:87], v[28:31]
s_add_u32 s48, s55, 363520
buffer_load_dwordx4 v3, s[8:11], s48 offen nt lds
v_mfma_f32_16x16x32_bf16 v[28:31], a[152:155], a[88:91], v[28:31]
v_exp_f32 v18, v18
v_max_f32 v8, v8, v27
v_mfma_f32_16x16x32_bf16 v[28:31], a[156:159], a[92:95], v[28:31]
v_exp_f32 v19, v19
v_mfma_f32_16x16x32_bf16 v[12:15], a[96:99], a[0:3], v[32:35]
v_cvt_pk_bf16_f32 v118, v16, v17
v_cmp_lt_f32 vcc, s50, v8
v_cvt_pk_bf16_f32 v119, v18, v19
s_cbranch_vccnz L_rs81
L_rr81:
v_mfma_f32_16x16x32_bf16 v[12:15], a[100:103], a[4:7], v[12:15]
v_mfma_f32_16x16x32_bf16 a[164:167], a[160:163], v[116:119], a[164:167]
v_exp_f32 v24, v24
v_mfma_f32_16x16x32_bf16 v[12:15], a[104:107], a[8:11], v[12:15]
v_exp_f32 v25, v25
v_max3_f32 v6, v28, v29, v30
v_mfma_f32_16x16x32_bf16 v[12:15], a[108:111], a[12:15], v[12:15]
s_add_u32 m0, s49, 4224
s_add_u32 s48, s55, 364544
buffer_load_dwordx4 v3, s[8:11], s48 offen nt lds
s_waitcnt lgkmcnt(0)
v_mfma_f32_16x16x32_bf16 v[12:15], a[112:115], a[16:19], v[12:15]
v_exp_f32 v26, v26
v_mfma_f32_16x16x32_bf16 v[12:15], a[116:119], a[20:23], v[12:15]
v_max_f32 v6, v6, v31
v_mfma_f32_16x16x32_bf16 v[12:15], a[120:123], a[24:27], v[12:15]
v_exp_f32 v27, v27
v_mfma_f32_16x16x32_bf16 v[12:15], a[124:127], a[28:31], v[12:15]
v_cvt_pk_bf16_f32 v246, v24, v25
v_cmp_lt_f32 vcc, s50, v6
v_mfma_f32_16x16x32_bf16 v[20:23], a[96:99], a[32:35], v[36:39]
v_cvt_pk_bf16_f32 v247, v26, v27
ds_read_b128 a[96:99], v4 offset:25344
v_mfma_f32_16x16x32_bf16 v[20:23], a[100:103], a[36:39], v[20:23]
ds_read_b128 a[100:103], v4 offset:25408
s_cbranch_vccnz L_rs82
L_rr82:
v_mfma_f32_16x16x32_bf16 a[168:171], a[160:163], v[244:247], a[168:171]
v_exp_f32 v28, v28
v_mfma_f32_16x16x32_bf16 v[20:23], a[104:107], a[40:43], v[20:23]
ds_read_b128 a[104:107], v4 offset:25472
v_exp_f32 v29, v29
v_mfma_f32_16x16x32_bf16 v[20:23], a[108:111], a[44:47], v[20:23]
v_max3_f32 v6, v12, v13, v14
ds_read_b128 a[108:111], v4 offset:25536
v_mfma_f32_16x16x32_bf16 v[20:23], a[112:115], a[48:51], v[20:23]
v_exp_f32 v30, v30
v_max_f32 v6, v6, v15
v_mfma_f32_16x16x32_bf16 v[20:23], a[116:119], a[52:55], v[20:23]
ds_read_b128 a[112:115], v4 offset:25600
s_add_u32 m0, s49, 5280
s_add_u32 s48, s55, 365568
buffer_load_dwordx4 v3, s[8:11], s48 offen nt lds
v_mfma_f32_16x16x32_bf16 v[20:23], a[120:123], a[56:59], v[20:23]
v_exp_f32 v31, v31
ds_read_b128 a[116:119], v4 offset:25664
v_mfma_f32_16x16x32_bf16 v[20:23], a[124:127], a[60:63], v[20:23]
v_cvt_pk_bf16_f32 v11, v28, v29
v_accvgpr_write_b32 a242, v11
v_cmp_lt_f32 vcc, s50, v6
s_waitcnt lgkmcnt(1)
v_mfma_f32_16x16x32_bf16 v[16:19], a[96:99], a[0:3], v[32:35]
ds_read_b128 a[120:123], v4 offset:25728
v_cvt_pk_bf16_f32 v10, v30, v31
v_accvgpr_write_b32 a243, v10
v_mfma_f32_16x16x32_bf16 v[16:19], a[100:103], a[4:7], v[16:19]
ds_read_b128 a[124:127], v4 offset:25792
s_cbranch_vccnz L_rs83
L_rr83:
v_mfma_f32_16x16x32_bf16 a[172:175], a[160:163], a[240:243], a[172:175]
v_exp_f32 v12, v12
v_mfma_f32_16x16x32_bf16 v[16:19], a[104:107], a[8:11], v[16:19]
v_exp_f32 v13, v13
v_max3_f32 v8, v20, v21, v22
v_mfma_f32_16x16x32_bf16 v[16:19], a[108:111], a[12:15], v[16:19]
v_exp_f32 v14, v14
v_mfma_f32_16x16x32_bf16 v[16:19], a[112:115], a[16:19], v[16:19]
v_max_f32 v8, v8, v23
s_waitcnt lgkmcnt(0)
v_mfma_f32_16x16x32_bf16 v[16:19], a[116:119], a[20:23], v[16:19]
v_exp_f32 v15, v15
v_cvt_pk_bf16_f32 v120, v12, v13
v_mfma_f32_16x16x32_bf16 v[16:19], a[120:123], a[24:27], v[16:19]
v_cmp_lt_f32 vcc, s50, v8
v_cvt_pk_bf16_f32 v121, v14, v15
v_mfma_f32_16x16x32_bf16 v[16:19], a[124:127], a[28:31], v[16:19]
v_add_u32 v4, 33792, v4
v_add_u32 v5, 33792, v5
L_stage17:
s_waitcnt vmcnt(6)
s_barrier
v_mfma_f32_16x16x32_bf16 v[24:27], a[96:99], a[32:35], v[36:39]
ds_read_b128 a[96:99], v4
s_add_u32 m0, s49, 6336
s_add_u32 s48, s55, 366592
buffer_load_dwordx4 v3, s[8:11], s48 offen nt lds
v_mfma_f32_16x16x32_bf16 v[24:27], a[100:103], a[36:39], v[24:27]
ds_read_b128 a[100:103], v4 offset:64
s_cbranch_vccnz L_rs84
L_rr84:
v_mfma_f32_16x16x32_bf16 v[24:27], a[104:107], a[40:43], v[24:27]
v_exp_f32 v20, v20
ds_read_b128 a[104:107], v4 offset:128
v_mfma_f32_16x16x32_bf16 v[24:27], a[108:111], a[44:47], v[24:27]
v_exp_f32 v21, v21
v_max3_f32 v6, v16, v17, v18
v_mfma_f32_16x16x32_bf16 v[24:27], a[112:115], a[48:51], v[24:27]
ds_read_b128 a[108:111], v4 offset:192
v_mfma_f32_16x16x32_bf16 v[24:27], a[116:119], a[52:55], v[24:27]
v_exp_f32 v22, v22
v_max_f32 v6, v6, v19
ds_read_b128 a[112:115], v4 offset:256
v_mfma_f32_16x16x32_bf16 v[24:27], a[120:123], a[56:59], v[24:27]
v_exp_f32 v23, v23
v_mfma_f32_16x16x32_bf16 v[24:27], a[124:127], a[60:63], v[24:27]
ds_read_b128 a[116:119], v4 offset:320
v_cvt_pk_bf16_f32 v248, v20, v21
v_cmp_lt_f32 vcc, s50, v6
s_waitcnt lgkmcnt(2)
v_mfma_f32_16x16x32_bf16 v[12:15], a[96:99], a[0:3], v[32:35]
ds_read_b128 a[120:123], v4 offset:384
v_cvt_pk_bf16_f32 v249, v22, v23
v_mfma_f32_16x16x32_bf16 v[12:15], a[100:103], a[4:7], v[12:15]
ds_read_b128 a[124:127], v4 offset:448
s_add_u32 m0, s49, 7392
s_add_u32 s48, s55, 367616
buffer_load_dwordx4 v3, s[8:11], s48 offen nt lds
s_cbranch_vccnz L_rs85
L_rr85:
v_mfma_f32_16x16x32_bf16 v[12:15], a[104:107], a[8:11], v[12:15]
v_exp_f32 v16, v16
v_mfma_f32_16x16x32_bf16 v[12:15], a[108:111], a[12:15], v[12:15]
v_exp_f32 v17, v17
s_waitcnt lgkmcnt(1)
v_mfma_f32_16x16x32_bf16 v[12:15], a[112:115], a[16:19], v[12:15]
v_max3_f32 v8, v24, v25, v26
v_mfma_f32_16x16x32_bf16 v[12:15], a[116:119], a[20:23], v[12:15]
v_exp_f32 v18, v18
v_max_f32 v8, v8, v27
v_mfma_f32_16x16x32_bf16 v[12:15], a[120:123], a[24:27], v[12:15]
v_exp_f32 v19, v19
s_waitcnt lgkmcnt(0)
v_mfma_f32_16x16x32_bf16 v[12:15], a[124:127], a[28:31], v[12:15]
v_cvt_pk_bf16_f32 v122, v16, v17
v_cmp_lt_f32 vcc, s50, v8
v_mfma_f32_16x16x32_bf16 v[20:23], a[96:99], a[32:35], v[36:39]
v_cvt_pk_bf16_f32 v123, v18, v19
ds_read_b128 a[96:99], v4 offset:8448
v_mfma_f32_16x16x32_bf16 v[20:23], a[100:103], a[36:39], v[20:23]
ds_read_b128 a[100:103], v4 offset:8512
s_add_u32 m0, s49, 33792
s_add_u32 s48, s55, 393216
buffer_load_dwordx4 v3, s[8:11], s48 offen nt lds
v_mfma_f32_16x16x32_bf16 a[164:167], a[160:163], v[120:123], a[164:167]
s_cbranch_vccnz L_rs86
L_rr86:
v_exp_f32 v24, v24
v_mfma_f32_16x16x32_bf16 v[20:23], a[104:107], a[40:43], v[20:23]
ds_read_b128 a[104:107], v4 offset:8576
v_mfma_f32_16x16x32_bf16 v[20:23], a[108:111], a[44:47], v[20:23]
v_exp_f32 v25, v25
v_max3_f32 v6, v12, v13, v14
ds_read_b128 a[108:111], v4 offset:8640
v_mfma_f32_16x16x32_bf16 v[20:23], a[112:115], a[48:51], v[20:23]
v_exp_f32 v26, v26
v_mfma_f32_16x16x32_bf16 v[20:23], a[116:119], a[52:55], v[20:23]
v_max_f32 v6, v6, v15
ds_read_b128 a[112:115], v4 offset:8704
v_mfma_f32_16x16x32_bf16 v[20:23], a[120:123], a[56:59], v[20:23]
v_exp_f32 v27, v27
ds_read_b128 a[116:119], v4 offset:8768
v_mfma_f32_16x16x32_bf16 v[20:23], a[124:127], a[60:63], v[20:23]
v_cvt_pk_bf16_f32 v250, v24, v25
v_cmp_lt_f32 vcc, s50, v6
ds_read_b128 a[120:123], v4 offset:8832
s_waitcnt lgkmcnt(3)
v_mfma_f32_16x16x32_bf16 v[16:19], a[96:99], a[0:3], v[32:35]
v_cvt_pk_bf16_f32 v251, v26, v27
ds_read_b128 a[124:127], v4 offset:8896
v_mfma_f32_16x16x32_bf16 v[16:19], a[100:103], a[4:7], v[16:19]
ds_read_b128 a[128:131], v5
ds_read_b128 a[132:135], v5 offset:64
s_cbranch_vccnz L_rs87
L_rr87:
v_mfma_f32_16x16x32_bf16 a[168:171], a[160:163], v[248:251], a[168:171]
v_exp_f32 v12, v12
ds_read_b128 a[136:139], v5 offset:128
s_add_u32 m0, s49, 34848
v_mfma_f32_16x16x32_bf16 v[16:19], a[104:107], a[8:11], v[16:19]
s_add_u32 s48, s55, 394240
buffer_load_dwordx4 v3, s[8:11], s48 offen nt lds
v_mfma_f32_16x16x32_bf16 v[16:19], a[108:111], a[12:15], v[16:19]
v_exp_f32 v13, v13
v_max3_f32 v8, v20, v21, v22
s_waitcnt lgkmcnt(1)
v_mfma_f32_16x16x32_bf16 v[16:19], a[112:115], a[16:19], v[16:19]
ds_read_b128 a[140:143], v5 offset:192
v_exp_f32 v14, v14
v_mfma_f32_16x16x32_bf16 v[16:19], a[116:119], a[20:23], v[16:19]
v_max_f32 v8, v8, v23
ds_read_b128 a[144:147], v5 offset:256
v_mfma_f32_16x16x32_bf16 v[16:19], a[120:123], a[24:27], v[16:19]
v_exp_f32 v15, v15
ds_read_b128 a[148:151], v5 offset:320
v_mfma_f32_16x16x32_bf16 v[16:19], a[124:127], a[28:31], v[16:19]
v_cvt_pk_bf16_f32 v124, v12, v13
v_cmp_lt_f32 vcc, s50, v8
v_mfma_f32_16x16x32_bf16 v[24:27], a[96:99], a[32:35], v[36:39]
ds_read_b128 a[152:155], v5 offset:384
v_cvt_pk_bf16_f32 v125, v14, v15
ds_read_b128 a[156:159], v5 offset:448
v_mfma_f32_16x16x32_bf16 v[24:27], a[100:103], a[36:39], v[24:27]
ds_read_b128 a[96:99], v4 offset:16896
ds_read_b128 a[100:103], v4 offset:16960
s_cbranch_vccnz L_rs88
L_rr88:
v_mfma_f32_16x16x32_bf16 v[24:27], a[104:107], a[40:43], v[24:27]
v_exp_f32 v20, v20
v_mfma_f32_16x16x32_bf16 v[24:27], a[108:111], a[44:47], v[24:27]
ds_read_b128 a[104:107], v4 offset:17024
s_add_u32 m0, s49, 35904
s_add_u32 s48, s55, 395264
buffer_load_dwordx4 v3, s[8:11], s48 offen nt lds
v_mfma_f32_16x16x32_bf16 v[24:27], a[112:115], a[48:51], v[24:27]
v_exp_f32 v21, v21
v_mfma_f32_16x16x32_bf16 v[24:27], a[116:119], a[52:55], v[24:27]
v_max3_f32 v6, v16, v17, v18
ds_read_b128 a[108:111], v4 offset:17088
v_mfma_f32_16x16x32_bf16 v[24:27], a[120:123], a[56:59], v[24:27]
v_exp_f32 v22, v22
v_max_f32 v6, v6, v19
v_mfma_f32_16x16x32_bf16 v[24:27], a[124:127], a[60:63], v[24:27]
ds_read_b128 a[112:115], v4 offset:17152
v_mfma_f32_16x16x32_bf16 v[28:31], a[128:131], a[64:67], v[40:43]
v_exp_f32 v23, v23
ds_read_b128 a[116:119], v4 offset:17216
v_cvt_pk_bf16_f32 v252, v20, v21
v_mfma_f32_16x16x32_bf16 v[28:31], a[132:135], a[68:71], v[28:31]
v_cmp_lt_f32 vcc, s50, v6
ds_read_b128 a[120:123], v4 offset:17280
s_waitcnt lgkmcnt(3)
v_mfma_f32_16x16x32_bf16 v[28:31], a[136:139], a[72:75], v[28:31]
v_cvt_pk_bf16_f32 v253, v22, v23
ds_read_b128 a[124:127], v4 offset:17344
s_cbranch_vccnz L_rs89
L_rr89:
v_mfma_f32_16x16x32_bf16 v[28:31], a[140:143], a[76:79], v[28:31]
v_exp_f32 v16, v16
v_mfma_f32_16x16x32_bf16 v[28:31], a[144:147], a[80:83], v[28:31]
v_exp_f32 v17, v17
v_max3_f32 v8, v24, v25, v26
s_add_u32 m0, s49, 36960
v_mfma_f32_16x16x32_bf16 v[28:31], a[148:151], a[84:87], v[28:31]
s_add_u32 s48, s55, 396288
buffer_load_dwordx4 v3, s[8:11], s48 offen nt lds
v_mfma_f32_16x16x32_bf16 v[28:31], a[152:155], a[88:91], v[28:31]
v_exp_f32 v18, v18
v_max_f32 v8, v8, v27
v_mfma_f32_16x16x32_bf16 v[28:31], a[156:159], a[92:95], v[28:31]
v_exp_f32 v19, v19
v_mfma_f32_16x16x32_bf16 v[12:15], a[96:99], a[0:3], v[32:35]
v_cvt_pk_bf16_f32 v126, v16, v17
v_cmp_lt_f32 vcc, s50, v8
v_cvt_pk_bf16_f32 v127, v18, v19
s_cbranch_vccnz L_rs90
L_rr90:
v_mfma_f32_16x16x32_bf16 v[12:15], a[100:103], a[4:7], v[12:15]
v_mfma_f32_16x16x32_bf16 a[164:167], a[160:163], v[124:127], a[164:167]
v_exp_f32 v24, v24
v_mfma_f32_16x16x32_bf16 v[12:15], a[104:107], a[8:11], v[12:15]
v_exp_f32 v25, v25
v_max3_f32 v6, v28, v29, v30
v_mfma_f32_16x16x32_bf16 v[12:15], a[108:111], a[12:15], v[12:15]
s_add_u32 m0, s49, 38016
s_add_u32 s48, s55, 397312
buffer_load_dwordx4 v3, s[8:11], s48 offen nt lds
s_waitcnt lgkmcnt(0)
v_mfma_f32_16x16x32_bf16 v[12:15], a[112:115], a[16:19], v[12:15]
v_exp_f32 v26, v26
v_mfma_f32_16x16x32_bf16 v[12:15], a[116:119], a[20:23], v[12:15]
v_max_f32 v6, v6, v31
v_mfma_f32_16x16x32_bf16 v[12:15], a[120:123], a[24:27], v[12:15]
v_exp_f32 v27, v27
v_mfma_f32_16x16x32_bf16 v[12:15], a[124:127], a[28:31], v[12:15]
v_cvt_pk_bf16_f32 v254, v24, v25
v_cmp_lt_f32 vcc, s50, v6
v_mfma_f32_16x16x32_bf16 v[20:23], a[96:99], a[32:35], v[36:39]
v_cvt_pk_bf16_f32 v255, v26, v27
ds_read_b128 a[96:99], v4 offset:25344
v_mfma_f32_16x16x32_bf16 v[20:23], a[100:103], a[36:39], v[20:23]
ds_read_b128 a[100:103], v4 offset:25408
s_cbranch_vccnz L_rs91
L_rr91:
v_mfma_f32_16x16x32_bf16 a[168:171], a[160:163], v[252:255], a[168:171]
v_exp_f32 v28, v28
v_mfma_f32_16x16x32_bf16 v[20:23], a[104:107], a[40:43], v[20:23]
ds_read_b128 a[104:107], v4 offset:25472
v_mfma_f32_16x16x32_bf16 v[20:23], a[108:111], a[44:47], v[20:23]
v_exp_f32 v29, v29
v_max3_f32 v6, v12, v13, v14
ds_read_b128 a[108:111], v4 offset:25536
v_mfma_f32_16x16x32_bf16 v[20:23], a[112:115], a[48:51], v[20:23]
v_exp_f32 v30, v30
v_max_f32 v6, v6, v15
v_mfma_f32_16x16x32_bf16 v[20:23], a[116:119], a[52:55], v[20:23]
ds_read_b128 a[112:115], v4 offset:25600
s_add_u32 m0, s49, 39072
s_add_u32 s48, s55, 398336
buffer_load_dwordx4 v3, s[8:11], s48 offen nt lds
v_mfma_f32_16x16x32_bf16 v[20:23], a[120:123], a[56:59], v[20:23]
v_exp_f32 v31, v31
v_mfma_f32_16x16x32_bf16 v[20:23], a[124:127], a[60:63], v[20:23]
ds_read_b128 a[116:119], v4 offset:25664
v_cvt_pk_bf16_f32 v11, v28, v29
v_accvgpr_write_b32 a244, v11
s_waitcnt lgkmcnt(1)
v_mfma_f32_16x16x32_bf16 v[16:19], a[96:99], a[0:3], v[32:35]
v_cmp_lt_f32 vcc, s50, v6
ds_read_b128 a[120:123], v4 offset:25728
v_mfma_f32_16x16x32_bf16 v[16:19], a[100:103], a[4:7], v[16:19]
v_cvt_pk_bf16_f32 v10, v30, v31
v_accvgpr_write_b32 a245, v10
ds_read_b128 a[124:127], v4 offset:25792
s_cbranch_vccnz L_rs92
L_rr92:
v_mfma_f32_16x16x32_bf16 v[16:19], a[104:107], a[8:11], v[16:19]
v_exp_f32 v12, v12
v_mfma_f32_16x16x32_bf16 v[16:19], a[108:111], a[12:15], v[16:19]
v_exp_f32 v13, v13
v_max3_f32 v8, v20, v21, v22
v_mfma_f32_16x16x32_bf16 v[16:19], a[112:115], a[16:19], v[16:19]
v_exp_f32 v14, v14
s_waitcnt lgkmcnt(1)
v_mfma_f32_16x16x32_bf16 v[16:19], a[116:119], a[20:23], v[16:19]
v_max_f32 v8, v8, v23
v_exp_f32 v15, v15
v_mfma_f32_16x16x32_bf16 v[16:19], a[120:123], a[24:27], v[16:19]
v_cvt_pk_bf16_f32 v128, v12, v13
v_cmp_lt_f32 vcc, s50, v8
s_waitcnt lgkmcnt(0)
v_mfma_f32_16x16x32_bf16 v[16:19], a[124:127], a[28:31], v[16:19]
v_cvt_pk_bf16_f32 v129, v14, v15
v_subrev_u32 v4, 67584, v4
v_subrev_u32 v5, 67584, v5
L_stage18:
s_waitcnt vmcnt(6)
s_barrier
v_mfma_f32_16x16x32_bf16 v[24:27], a[96:99], a[32:35], v[36:39]
ds_read_b128 a[96:99], v4
s_add_u32 m0, s49, 40128
s_add_u32 s48, s55, 399360
buffer_load_dwordx4 v3, s[8:11], s48 offen nt lds
v_mfma_f32_16x16x32_bf16 v[24:27], a[100:103], a[36:39], v[24:27]
ds_read_b128 a[100:103], v4 offset:64
s_cbranch_vccnz L_rs93
L_rr93:
v_mfma_f32_16x16x32_bf16 v[24:27], a[104:107], a[40:43], v[24:27]
v_exp_f32 v20, v20
ds_read_b128 a[104:107], v4 offset:128
v_mfma_f32_16x16x32_bf16 v[24:27], a[108:111], a[44:47], v[24:27]
v_exp_f32 v21, v21
v_max3_f32 v6, v16, v17, v18
ds_read_b128 a[108:111], v4 offset:192
v_mfma_f32_16x16x32_bf16 v[24:27], a[112:115], a[48:51], v[24:27]
v_exp_f32 v22, v22
v_mfma_f32_16x16x32_bf16 v[24:27], a[116:119], a[52:55], v[24:27]
v_max_f32 v6, v6, v19
ds_read_b128 a[112:115], v4 offset:256
v_mfma_f32_16x16x32_bf16 v[24:27], a[120:123], a[56:59], v[24:27]
v_exp_f32 v23, v23
ds_read_b128 a[116:119], v4 offset:320
v_cvt_pk_bf16_f32 v11, v20, v21
v_mfma_f32_16x16x32_bf16 v[24:27], a[124:127], a[60:63], v[24:27]
v_accvgpr_write_b32 a180, v11
v_cmp_lt_f32 vcc, s50, v6
s_waitcnt lgkmcnt(2)
v_mfma_f32_16x16x32_bf16 v[12:15], a[96:99], a[0:3], v[32:35]
ds_read_b128 a[120:123], v4 offset:384
v_cvt_pk_bf16_f32 v10, v22, v23
v_accvgpr_write_b32 a181, v10
v_mfma_f32_16x16x32_bf16 v[12:15], a[100:103], a[4:7], v[12:15]
ds_read_b128 a[124:127], v4 offset:448
s_add_u32 m0, s49, 41184
s_add_u32 s48, s55, 400384
buffer_load_dwordx4 v3, s[8:11], s48 offen nt lds
s_cbranch_vccnz L_rs94
L_rr94:
v_mfma_f32_16x16x32_bf16 v[12:15], a[104:107], a[8:11], v[12:15]
v_exp_f32 v16, v16
v_mfma_f32_16x16x32_bf16 v[12:15], a[108:111], a[12:15], v[12:15]
v_exp_f32 v17, v17
s_waitcnt lgkmcnt(1)
v_mfma_f32_16x16x32_bf16 v[12:15], a[112:115], a[16:19], v[12:15]
v_max3_f32 v8, v24, v25, v26
v_mfma_f32_16x16x32_bf16 v[12:15], a[116:119], a[20:23], v[12:15]
v_exp_f32 v18, v18
v_max_f32 v8, v8, v27
v_mfma_f32_16x16x32_bf16 v[12:15], a[120:123], a[24:27], v[12:15]
v_exp_f32 v19, v19
s_waitcnt lgkmcnt(0)
v_mfma_f32_16x16x32_bf16 v[12:15], a[124:127], a[28:31], v[12:15]
v_cvt_pk_bf16_f32 v130, v16, v17
v_cmp_lt_f32 vcc, s50, v8
v_mfma_f32_16x16x32_bf16 v[20:23], a[96:99], a[32:35], v[36:39]
v_cvt_pk_bf16_f32 v131, v18, v19
ds_read_b128 a[96:99], v4 offset:8448
v_mfma_f32_16x16x32_bf16 v[20:23], a[100:103], a[36:39], v[20:23]
ds_read_b128 a[100:103], v4 offset:8512
s_add_u32 m0, s49, 67584
s_add_u32 s48, s55, 425984
buffer_load_dwordx4 v3, s[8:11], s48 offen nt lds
v_mfma_f32_16x16x32_bf16 a[164:167], a[160:163], v[128:131], a[164:167]
s_cbranch_vccnz L_rs95
L_rr95:
v_exp_f32 v24, v24
v_mfma_f32_16x16x32_bf16 v[20:23], a[104:107], a[40:43], v[20:23]
ds_read_b128 a[104:107], v4 offset:8576
v_mfma_f32_16x16x32_bf16 v[20:23], a[108:111], a[44:47], v[20:23]
v_exp_f32 v25, v25
v_max3_f32 v6, v12, v13, v14
ds_read_b128 a[108:111], v4 offset:8640
v_mfma_f32_16x16x32_bf16 v[20:23], a[112:115], a[48:51], v[20:23]
v_exp_f32 v26, v26
v_max_f32 v6, v6, v15
v_mfma_f32_16x16x32_bf16 v[20:23], a[116:119], a[52:55], v[20:23]
ds_read_b128 a[112:115], v4 offset:8704
v_mfma_f32_16x16x32_bf16 v[20:23], a[120:123], a[56:59], v[20:23]
v_exp_f32 v27, v27
ds_read_b128 a[116:119], v4 offset:8768
v_cvt_pk_bf16_f32 v11, v24, v25
v_mfma_f32_16x16x32_bf16 v[20:23], a[124:127], a[60:63], v[20:23]
v_accvgpr_write_b32 a182, v11
v_cmp_lt_f32 vcc, s50, v6
s_waitcnt lgkmcnt(2)
v_mfma_f32_16x16x32_bf16 v[16:19], a[96:99], a[0:3], v[32:35]
ds_read_b128 a[120:123], v4 offset:8832
v_cvt_pk_bf16_f32 v10, v26, v27
v_accvgpr_write_b32 a183, v10
v_mfma_f32_16x16x32_bf16 v[16:19], a[100:103], a[4:7], v[16:19]
ds_read_b128 a[124:127], v4 offset:8896
ds_read_b128 a[128:131], v5
ds_read_b128 a[132:135], v5 offset:64
v_mfma_f32_16x16x32_bf16 a[168:171], a[160:163], a[180:183], a[168:171]
s_cbranch_vccnz L_rs96
L_rr96:
v_exp_f32 v12, v12
v_mfma_f32_16x16x32_bf16 v[16:19], a[104:107], a[8:11], v[16:19]
ds_read_b128 a[136:139], v5 offset:128
s_add_u32 m0, s49, 68640
s_add_u32 s48, s55, 427008
buffer_load_dwordx4 v3, s[8:11], s48 offen nt lds
v_mfma_f32_16x16x32_bf16 v[16:19], a[108:111], a[12:15], v[16:19]
v_exp_f32 v13, v13
v_max3_f32 v8, v20, v21, v22
s_waitcnt lgkmcnt(1)
v_mfma_f32_16x16x32_bf16 v[16:19], a[112:115], a[16:19], v[16:19]
ds_read_b128 a[140:143], v5 offset:192
v_mfma_f32_16x16x32_bf16 v[16:19], a[116:119], a[20:23], v[16:19]
v_exp_f32 v14, v14
v_max_f32 v8, v8, v23
ds_read_b128 a[144:147], v5 offset:256
v_mfma_f32_16x16x32_bf16 v[16:19], a[120:123], a[24:27], v[16:19]
v_exp_f32 v15, v15
v_mfma_f32_16x16x32_bf16 v[16:19], a[124:127], a[28:31], v[16:19]
ds_read_b128 a[148:151], v5 offset:320
v_cvt_pk_bf16_f32 v132, v12, v13
v_cmp_lt_f32 vcc, s50, v8
v_mfma_f32_16x16x32_bf16 v[24:27], a[96:99], a[32:35], v[36:39]
ds_read_b128 a[152:155], v5 offset:384
v_cvt_pk_bf16_f32 v133, v14, v15
v_mfma_f32_16x16x32_bf16 v[24:27], a[100:103], a[36:39], v[24:27]
ds_read_b128 a[156:159], v5 offset:448
ds_read_b128 a[96:99], v4 offset:16896
ds_read_b128 a[100:103], v4 offset:16960
s_cbranch_vccnz L_rs97
L_rr97:
v_mfma_f32_16x16x32_bf16 v[24:27], a[104:107], a[40:43], v[24:27]
v_exp_f32 v20, v20
v_mfma_f32_16x16x32_bf16 v[24:27], a[108:111], a[44:47], v[24:27]
ds_read_b128 a[104:107], v4 offset:17024
s_add_u32 m0, s49, 69696
s_add_u32 s48, s55, 428032
buffer_load_dwordx4 v3, s[8:11], s48 offen nt lds
v_mfma_f32_16x16x32_bf16 v[24:27], a[112:115], a[48:51], v[24:27]
v_exp_f32 v21, v21
v_max3_f32 v6, v16, v17, v18
v_mfma_f32_16x16x32_bf16 v[24:27], a[116:119], a[52:55], v[24:27]
ds_read_b128 a[108:111], v4 offset:17088
v_mfma_f32_16x16x32_bf16 v[24:27], a[120:123], a[56:59], v[24:27]
v_exp_f32 v22, v22
v_max_f32 v6, v6, v19
ds_read_b128 a[112:115], v4 offset:17152
v_mfma_f32_16x16x32_bf16 v[24:27], a[124:127], a[60:63], v[24:27]
v_exp_f32 v23, v23
v_mfma_f32_16x16x32_bf16 v[28:31], a[128:131], a[64:67], v[40:43]
ds_read_b128 a[116:119], v4 offset:17216
v_cvt_pk_bf16_f32 v11, v20, v21
v_accvgpr_write_b32 a184, v11
v_mfma_f32_16x16x32_bf16 v[28:31], a[132:135], a[68:71], v[28:31]
v_cmp_lt_f32 vcc, s50, v6
ds_read_b128 a[120:123], v4 offset:17280
s_waitcnt lgkmcnt(2)
v_mfma_f32_16x16x32_bf16 v[28:31], a[136:139], a[72:75], v[28:31]
v_cvt_pk_bf16_f32 v10, v22, v23
v_accvgpr_write_b32 a185, v10
ds_read_b128 a[124:127], v4 offset:17344
v_mfma_f32_16x16x32_bf16 v[28:31], a[140:143], a[76:79], v[28:31]
s_cbranch_vccnz L_rs98
L_rr98:
v_exp_f32 v16, v16
v_mfma_f32_16x16x32_bf16 v[28:31], a[144:147], a[80:83], v[28:31]
v_exp_f32 v17, v17
v_mfma_f32_16x16x32_bf16 v[28:31], a[148:151], a[84:87], v[28:31]
v_max3_f32 v8, v24, v25, v26
s_add_u32 m0, s49, 70752
s_add_u32 s48, s55, 429056
buffer_load_dwordx4 v3, s[8:11], s48 offen nt lds
v_mfma_f32_16x16x32_bf16 v[28:31], a[152:155], a[88:91], v[28:31]
v_exp_f32 v18, v18
v_max_f32 v8, v8, v27
v_mfma_f32_16x16x32_bf16 v[28:31], a[156:159], a[92:95], v[28:31]
v_exp_f32 v19, v19
v_mfma_f32_16x16x32_bf16 v[12:15], a[96:99], a[0:3], v[32:35]
v_cvt_pk_bf16_f32 v134, v16, v17
v_cmp_lt_f32 vcc, s50, v8
v_cvt_pk_bf16_f32 v135, v18, v19
s_cbranch_vccnz L_rs99
L_rr99:
v_mfma_f32_16x16x32_bf16 v[12:15], a[100:103], a[4:7], v[12:15]
v_mfma_f32_16x16x32_bf16 a[164:167], a[160:163], v[132:135], a[164:167]
v_exp_f32 v24, v24
v_mfma_f32_16x16x32_bf16 v[12:15], a[104:107], a[8:11], v[12:15]
v_exp_f32 v25, v25
v_max3_f32 v6, v28, v29, v30
s_add_u32 m0, s49, 71808
s_add_u32 s48, s55, 430080
v_mfma_f32_16x16x32_bf16 v[12:15], a[108:111], a[12:15], v[12:15]
buffer_load_dwordx4 v3, s[8:11], s48 offen nt lds
v_mfma_f32_16x16x32_bf16 v[12:15], a[112:115], a[16:19], v[12:15]
v_exp_f32 v26, v26
v_max_f32 v6, v6, v31
s_waitcnt lgkmcnt(0)
v_mfma_f32_16x16x32_bf16 v[12:15], a[116:119], a[20:23], v[12:15]
v_exp_f32 v27, v27
v_mfma_f32_16x16x32_bf16 v[12:15], a[120:123], a[24:27], v[12:15]
v_cvt_pk_bf16_f32 v11, v24, v25
v_mfma_f32_16x16x32_bf16 v[12:15], a[124:127], a[28:31], v[12:15]
v_accvgpr_write_b32 a186, v11
v_cmp_lt_f32 vcc, s50, v6
v_mfma_f32_16x16x32_bf16 v[20:23], a[96:99], a[32:35], v[36:39]
v_cvt_pk_bf16_f32 v10, v26, v27
v_accvgpr_write_b32 a187, v10
v_mfma_f32_16x16x32_bf16 v[20:23], a[100:103], a[36:39], v[20:23]
ds_read_b128 a[96:99], v4 offset:25344
ds_read_b128 a[100:103], v4 offset:25408
s_cbranch_vccnz L_rs100
L_rr100:
v_mfma_f32_16x16x32_bf16 a[168:171], a[160:163], a[184:187], a[168:171]
v_exp_f32 v28, v28
v_mfma_f32_16x16x32_bf16 v[20:23], a[104:107], a[40:43], v[20:23]
ds_read_b128 a[104:107], v4 offset:25472
v_exp_f32 v29, v29
v_mfma_f32_16x16x32_bf16 v[20:23], a[108:111], a[44:47], v[20:23]
v_max3_f32 v6, v12, v13, v14
ds_read_b128 a[108:111], v4 offset:25536
v_mfma_f32_16x16x32_bf16 v[20:23], a[112:115], a[48:51], v[20:23]
v_exp_f32 v30, v30
v_max_f32 v6, v6, v15
v_mfma_f32_16x16x32_bf16 v[20:23], a[116:119], a[52:55], v[20:23]
ds_read_b128 a[112:115], v4 offset:25600
s_add_u32 m0, s49, 72864
s_add_u32 s48, s55, 431104
buffer_load_dwordx4 v3, s[8:11], s48 offen nt lds
v_mfma_f32_16x16x32_bf16 v[20:23], a[120:123], a[56:59], v[20:23]
v_exp_f32 v31, v31
ds_read_b128 a[116:119], v4 offset:25664
v_mfma_f32_16x16x32_bf16 v[20:23], a[124:127], a[60:63], v[20:23]
v_cvt_pk_bf16_f32 v11, v28, v29
v_accvgpr_write_b32 a246, v11
v_cmp_lt_f32 vcc, s50, v6
s_waitcnt lgkmcnt(1)
v_mfma_f32_16x16x32_bf16 v[16:19], a[96:99], a[0:3], v[32:35]
ds_read_b128 a[120:123], v4 offset:25728
v_cvt_pk_bf16_f32 v10, v30, v31
v_accvgpr_write_b32 a247, v10
v_mfma_f32_16x16x32_bf16 v[16:19], a[100:103], a[4:7], v[16:19]
ds_read_b128 a[124:127], v4 offset:25792
s_cbranch_vccnz L_rs101
L_rr101:
v_mfma_f32_16x16x32_bf16 a[172:175], a[160:163], a[244:247], a[172:175]
v_exp_f32 v12, v12
v_mfma_f32_16x16x32_bf16 v[16:19], a[104:107], a[8:11], v[16:19]
v_exp_f32 v13, v13
v_max3_f32 v8, v20, v21, v22
v_mfma_f32_16x16x32_bf16 v[16:19], a[108:111], a[12:15], v[16:19]
v_exp_f32 v14, v14
v_mfma_f32_16x16x32_bf16 v[16:19], a[112:115], a[16:19], v[16:19]
v_max_f32 v8, v8, v23
s_waitcnt lgkmcnt(0)
v_mfma_f32_16x16x32_bf16 v[16:19], a[116:119], a[20:23], v[16:19]
v_exp_f32 v15, v15
v_cvt_pk_bf16_f32 v136, v12, v13
v_mfma_f32_16x16x32_bf16 v[16:19], a[120:123], a[24:27], v[16:19]
v_cmp_lt_f32 vcc, s50, v8
v_cvt_pk_bf16_f32 v137, v14, v15
v_mfma_f32_16x16x32_bf16 v[16:19], a[124:127], a[28:31], v[16:19]
v_add_u32 v4, 33792, v4
v_add_u32 v5, 33792, v5
L_stage19:
s_waitcnt vmcnt(6)
s_barrier
v_mfma_f32_16x16x32_bf16 v[24:27], a[96:99], a[32:35], v[36:39]
ds_read_b128 a[96:99], v4
s_add_u32 m0, s49, 73920
s_add_u32 s48, s55, 432128
buffer_load_dwordx4 v3, s[8:11], s48 offen nt lds
v_mfma_f32_16x16x32_bf16 v[24:27], a[100:103], a[36:39], v[24:27]
ds_read_b128 a[100:103], v4 offset:64
s_cbranch_vccnz L_rs102
L_rr102:
v_mfma_f32_16x16x32_bf16 v[24:27], a[104:107], a[40:43], v[24:27]
v_exp_f32 v20, v20
ds_read_b128 a[104:107], v4 offset:128
v_mfma_f32_16x16x32_bf16 v[24:27], a[108:111], a[44:47], v[24:27]
v_exp_f32 v21, v21
v_max3_f32 v6, v16, v17, v18
ds_read_b128 a[108:111], v4 offset:192
v_mfma_f32_16x16x32_bf16 v[24:27], a[112:115], a[48:51], v[24:27]
v_exp_f32 v22, v22
v_mfma_f32_16x16x32_bf16 v[24:27], a[116:119], a[52:55], v[24:27]
v_max_f32 v6, v6, v19
ds_read_b128 a[112:115], v4 offset:256
v_mfma_f32_16x16x32_bf16 v[24:27], a[120:123], a[56:59], v[24:27]
v_exp_f32 v23, v23
ds_read_b128 a[116:119], v4 offset:320
v_cvt_pk_bf16_f32 v11, v20, v21
v_mfma_f32_16x16x32_bf16 v[24:27], a[124:127], a[60:63], v[24:27]
v_accvgpr_write_b32 a188, v11
v_cmp_lt_f32 vcc, s50, v6
s_waitcnt lgkmcnt(2)
v_mfma_f32_16x16x32_bf16 v[12:15], a[96:99], a[0:3], v[32:35]
ds_read_b128 a[120:123], v4 offset:384
v_cvt_pk_bf16_f32 v10, v22, v23
v_accvgpr_write_b32 a189, v10
v_mfma_f32_16x16x32_bf16 v[12:15], a[100:103], a[4:7], v[12:15]
ds_read_b128 a[124:127], v4 offset:448
s_add_u32 m0, s49, 74976
s_add_u32 s48, s55, 433152
buffer_load_dwordx4 v3, s[8:11], s48 offen nt lds
s_cbranch_vccnz L_rs103
L_rr103:
v_mfma_f32_16x16x32_bf16 v[12:15], a[104:107], a[8:11], v[12:15]
v_exp_f32 v16, v16
v_mfma_f32_16x16x32_bf16 v[12:15], a[108:111], a[12:15], v[12:15]
v_exp_f32 v17, v17
s_waitcnt lgkmcnt(1)
v_mfma_f32_16x16x32_bf16 v[12:15], a[112:115], a[16:19], v[12:15]
v_max3_f32 v8, v24, v25, v26
v_mfma_f32_16x16x32_bf16 v[12:15], a[116:119], a[20:23], v[12:15]
v_exp_f32 v18, v18
v_max_f32 v8, v8, v27
v_mfma_f32_16x16x32_bf16 v[12:15], a[120:123], a[24:27], v[12:15]
v_exp_f32 v19, v19
s_waitcnt lgkmcnt(0)
v_mfma_f32_16x16x32_bf16 v[12:15], a[124:127], a[28:31], v[12:15]
v_cvt_pk_bf16_f32 v138, v16, v17
v_cmp_lt_f32 vcc, s50, v8
v_mfma_f32_16x16x32_bf16 v[20:23], a[96:99], a[32:35], v[36:39]
v_cvt_pk_bf16_f32 v139, v18, v19
ds_read_b128 a[96:99], v4 offset:8448
v_mfma_f32_16x16x32_bf16 v[20:23], a[100:103], a[36:39], v[20:23]
ds_read_b128 a[100:103], v4 offset:8512
s_add_u32 m0, s49, 0
s_add_u32 s48, s55, 458752
buffer_load_dwordx4 v3, s[8:11], s48 offen nt lds
v_mfma_f32_16x16x32_bf16 a[164:167], a[160:163], v[136:139], a[164:167]
s_cbranch_vccnz L_rs104
L_rr104:
v_exp_f32 v24, v24
v_mfma_f32_16x16x32_bf16 v[20:23], a[104:107], a[40:43], v[20:23]
ds_read_b128 a[104:107], v4 offset:8576
v_mfma_f32_16x16x32_bf16 v[20:23], a[108:111], a[44:47], v[20:23]
v_exp_f32 v25, v25
v_max3_f32 v6, v12, v13, v14
ds_read_b128 a[108:111], v4 offset:8640
v_mfma_f32_16x16x32_bf16 v[20:23], a[112:115], a[48:51], v[20:23]
v_exp_f32 v26, v26
v_max_f32 v6, v6, v15
v_mfma_f32_16x16x32_bf16 v[20:23], a[116:119], a[52:55], v[20:23]
ds_read_b128 a[112:115], v4 offset:8704
v_mfma_f32_16x16x32_bf16 v[20:23], a[120:123], a[56:59], v[20:23]
v_exp_f32 v27, v27
ds_read_b128 a[116:119], v4 offset:8768
v_cvt_pk_bf16_f32 v11, v24, v25
v_mfma_f32_16x16x32_bf16 v[20:23], a[124:127], a[60:63], v[20:23]
v_accvgpr_write_b32 a190, v11
v_cmp_lt_f32 vcc, s50, v6
s_waitcnt lgkmcnt(2)
v_mfma_f32_16x16x32_bf16 v[16:19], a[96:99], a[0:3], v[32:35]
ds_read_b128 a[120:123], v4 offset:8832
v_cvt_pk_bf16_f32 v10, v26, v27
v_accvgpr_write_b32 a191, v10
v_mfma_f32_16x16x32_bf16 v[16:19], a[100:103], a[4:7], v[16:19]
ds_read_b128 a[124:127], v4 offset:8896
ds_read_b128 a[128:131], v5
ds_read_b128 a[132:135], v5 offset:64
v_mfma_f32_16x16x32_bf16 a[168:171], a[160:163], a[188:191], a[168:171]
s_cbranch_vccnz L_rs105
L_rr105:
v_exp_f32 v12, v12
v_mfma_f32_16x16x32_bf16 v[16:19], a[104:107], a[8:11], v[16:19]
ds_read_b128 a[136:139], v5 offset:128
s_add_u32 m0, s49, 1056
s_add_u32 s48, s55, 459776
buffer_load_dwordx4 v3, s[8:11], s48 offen nt lds
v_mfma_f32_16x16x32_bf16 v[16:19], a[108:111], a[12:15], v[16:19]
v_exp_f32 v13, v13
v_max3_f32 v8, v20, v21, v22
s_waitcnt lgkmcnt(1)
v_mfma_f32_16x16x32_bf16 v[16:19], a[112:115], a[16:19], v[16:19]
ds_read_b128 a[140:143], v5 offset:192
v_mfma_f32_16x16x32_bf16 v[16:19], a[116:119], a[20:23], v[16:19]
v_exp_f32 v14, v14
v_max_f32 v8, v8, v23
ds_read_b128 a[144:147], v5 offset:256
v_mfma_f32_16x16x32_bf16 v[16:19], a[120:123], a[24:27], v[16:19]
v_exp_f32 v15, v15
v_mfma_f32_16x16x32_bf16 v[16:19], a[124:127], a[28:31], v[16:19]
ds_read_b128 a[148:151], v5 offset:320
v_cvt_pk_bf16_f32 v140, v12, v13
v_cmp_lt_f32 vcc, s50, v8
v_mfma_f32_16x16x32_bf16 v[24:27], a[96:99], a[32:35], v[36:39]
ds_read_b128 a[152:155], v5 offset:384
v_cvt_pk_bf16_f32 v141, v14, v15
v_mfma_f32_16x16x32_bf16 v[24:27], a[100:103], a[36:39], v[24:27]
ds_read_b128 a[156:159], v5 offset:448
ds_read_b128 a[96:99], v4 offset:16896
ds_read_b128 a[100:103], v4 offset:16960
s_cbranch_vccnz L_rs106
L_rr106:
v_mfma_f32_16x16x32_bf16 v[24:27], a[104:107], a[40:43], v[24:27]
v_exp_f32 v20, v20
v_mfma_f32_16x16x32_bf16 v[24:27], a[108:111], a[44:47], v[24:27]
ds_read_b128 a[104:107], v4 offset:17024
s_add_u32 m0, s49, 2112
s_add_u32 s48, s55, 460800
buffer_load_dwordx4 v3, s[8:11], s48 offen nt lds
v_mfma_f32_16x16x32_bf16 v[24:27], a[112:115], a[48:51], v[24:27]
v_exp_f32 v21, v21
v_max3_f32 v6, v16, v17, v18
v_mfma_f32_16x16x32_bf16 v[24:27], a[116:119], a[52:55], v[24:27]
ds_read_b128 a[108:111], v4 offset:17088
v_mfma_f32_16x16x32_bf16 v[24:27], a[120:123], a[56:59], v[24:27]
v_exp_f32 v22, v22
v_max_f32 v6, v6, v19
ds_read_b128 a[112:115], v4 offset:17152
v_mfma_f32_16x16x32_bf16 v[24:27], a[124:127], a[60:63], v[24:27]
v_exp_f32 v23, v23
v_mfma_f32_16x16x32_bf16 v[28:31], a[128:131], a[64:67], v[40:43]
ds_read_b128 a[116:119], v4 offset:17216
v_cvt_pk_bf16_f32 v11, v20, v21
v_accvgpr_write_b32 a192, v11
v_mfma_f32_16x16x32_bf16 v[28:31], a[132:135], a[68:71], v[28:31]
v_cmp_lt_f32 vcc, s50, v6
ds_read_b128 a[120:123], v4 offset:17280
s_waitcnt lgkmcnt(2)
v_mfma_f32_16x16x32_bf16 v[28:31], a[136:139], a[72:75], v[28:31]
v_cvt_pk_bf16_f32 v10, v22, v23
v_accvgpr_write_b32 a193, v10
ds_read_b128 a[124:127], v4 offset:17344
v_mfma_f32_16x16x32_bf16 v[28:31], a[140:143], a[76:79], v[28:31]
s_cbranch_vccnz L_rs107
L_rr107:
v_exp_f32 v16, v16
v_mfma_f32_16x16x32_bf16 v[28:31], a[144:147], a[80:83], v[28:31]
v_exp_f32 v17, v17
v_mfma_f32_16x16x32_bf16 v[28:31], a[148:151], a[84:87], v[28:31]
v_max3_f32 v8, v24, v25, v26
s_add_u32 m0, s49, 3168
s_add_u32 s48, s55, 461824
buffer_load_dwordx4 v3, s[8:11], s48 offen nt lds
v_mfma_f32_16x16x32_bf16 v[28:31], a[152:155], a[88:91], v[28:31]
v_exp_f32 v18, v18
v_max_f32 v8, v8, v27
v_mfma_f32_16x16x32_bf16 v[28:31], a[156:159], a[92:95], v[28:31]
v_exp_f32 v19, v19
v_mfma_f32_16x16x32_bf16 v[12:15], a[96:99], a[0:3], v[32:35]
v_cvt_pk_bf16_f32 v142, v16, v17
v_cmp_lt_f32 vcc, s50, v8
v_cvt_pk_bf16_f32 v143, v18, v19
s_cbranch_vccnz L_rs108
L_rr108:
v_mfma_f32_16x16x32_bf16 v[12:15], a[100:103], a[4:7], v[12:15]
v_mfma_f32_16x16x32_bf16 a[164:167], a[160:163], v[140:143], a[164:167]
v_exp_f32 v24, v24
v_mfma_f32_16x16x32_bf16 v[12:15], a[104:107], a[8:11], v[12:15]
v_exp_f32 v25, v25
v_max3_f32 v6, v28, v29, v30
s_add_u32 m0, s49, 4224
s_add_u32 s48, s55, 462848
v_mfma_f32_16x16x32_bf16 v[12:15], a[108:111], a[12:15], v[12:15]
buffer_load_dwordx4 v3, s[8:11], s48 offen nt lds
v_mfma_f32_16x16x32_bf16 v[12:15], a[112:115], a[16:19], v[12:15]
v_exp_f32 v26, v26
v_max_f32 v6, v6, v31
s_waitcnt lgkmcnt(0)
v_mfma_f32_16x16x32_bf16 v[12:15], a[116:119], a[20:23], v[12:15]
v_exp_f32 v27, v27
v_mfma_f32_16x16x32_bf16 v[12:15], a[120:123], a[24:27], v[12:15]
v_cvt_pk_bf16_f32 v11, v24, v25
v_mfma_f32_16x16x32_bf16 v[12:15], a[124:127], a[28:31], v[12:15]
v_accvgpr_write_b32 a194, v11
v_cmp_lt_f32 vcc, s50, v6
v_mfma_f32_16x16x32_bf16 v[20:23], a[96:99], a[32:35], v[36:39]
v_cvt_pk_bf16_f32 v10, v26, v27
v_accvgpr_write_b32 a195, v10
v_mfma_f32_16x16x32_bf16 v[20:23], a[100:103], a[36:39], v[20:23]
ds_read_b128 a[96:99], v4 offset:25344
ds_read_b128 a[100:103], v4 offset:25408
s_cbranch_vccnz L_rs109
L_rr109:
v_mfma_f32_16x16x32_bf16 a[168:171], a[160:163], a[192:195], a[168:171]
v_exp_f32 v28, v28
v_mfma_f32_16x16x32_bf16 v[20:23], a[104:107], a[40:43], v[20:23]
ds_read_b128 a[104:107], v4 offset:25472
v_mfma_f32_16x16x32_bf16 v[20:23], a[108:111], a[44:47], v[20:23]
v_exp_f32 v29, v29
v_max3_f32 v6, v12, v13, v14
ds_read_b128 a[108:111], v4 offset:25536
v_mfma_f32_16x16x32_bf16 v[20:23], a[112:115], a[48:51], v[20:23]
v_exp_f32 v30, v30
v_max_f32 v6, v6, v15
v_mfma_f32_16x16x32_bf16 v[20:23], a[116:119], a[52:55], v[20:23]
ds_read_b128 a[112:115], v4 offset:25600
s_add_u32 m0, s49, 5280
s_add_u32 s48, s55, 463872
buffer_load_dwordx4 v3, s[8:11], s48 offen nt lds
v_mfma_f32_16x16x32_bf16 v[20:23], a[120:123], a[56:59], v[20:23]
v_exp_f32 v31, v31
v_mfma_f32_16x16x32_bf16 v[20:23], a[124:127], a[60:63], v[20:23]
ds_read_b128 a[116:119], v4 offset:25664
v_cvt_pk_bf16_f32 v11, v28, v29
v_accvgpr_write_b32 a248, v11
s_waitcnt lgkmcnt(1)
v_mfma_f32_16x16x32_bf16 v[16:19], a[96:99], a[0:3], v[32:35]
v_cmp_lt_f32 vcc, s50, v6
ds_read_b128 a[120:123], v4 offset:25728
v_mfma_f32_16x16x32_bf16 v[16:19], a[100:103], a[4:7], v[16:19]
v_cvt_pk_bf16_f32 v10, v30, v31
v_accvgpr_write_b32 a249, v10
ds_read_b128 a[124:127], v4 offset:25792
s_cbranch_vccnz L_rs110
L_rr110:
v_mfma_f32_16x16x32_bf16 v[16:19], a[104:107], a[8:11], v[16:19]
v_exp_f32 v12, v12
v_mfma_f32_16x16x32_bf16 v[16:19], a[108:111], a[12:15], v[16:19]
v_exp_f32 v13, v13
v_max3_f32 v8, v20, v21, v22
v_mfma_f32_16x16x32_bf16 v[16:19], a[112:115], a[16:19], v[16:19]
v_exp_f32 v14, v14
s_waitcnt lgkmcnt(1)
v_mfma_f32_16x16x32_bf16 v[16:19], a[116:119], a[20:23], v[16:19]
v_max_f32 v8, v8, v23
v_exp_f32 v15, v15
v_mfma_f32_16x16x32_bf16 v[16:19], a[120:123], a[24:27], v[16:19]
v_cvt_pk_bf16_f32 v144, v12, v13
v_cmp_lt_f32 vcc, s50, v8
s_waitcnt lgkmcnt(0)
v_mfma_f32_16x16x32_bf16 v[16:19], a[124:127], a[28:31], v[16:19]
v_cvt_pk_bf16_f32 v145, v14, v15
v_add_u32 v4, 33792, v4
v_add_u32 v5, 33792, v5
L_stage20:
s_waitcnt vmcnt(6)
s_barrier
v_mfma_f32_16x16x32_bf16 v[24:27], a[96:99], a[32:35], v[36:39]
ds_read_b128 a[96:99], v4
s_add_u32 m0, s49, 6336
s_add_u32 s48, s55, 464896
buffer_load_dwordx4 v3, s[8:11], s48 offen nt lds
v_mfma_f32_16x16x32_bf16 v[24:27], a[100:103], a[36:39], v[24:27]
ds_read_b128 a[100:103], v4 offset:64
s_cbranch_vccnz L_rs111
L_rr111:
v_mfma_f32_16x16x32_bf16 v[24:27], a[104:107], a[40:43], v[24:27]
v_exp_f32 v20, v20
ds_read_b128 a[104:107], v4 offset:128
v_mfma_f32_16x16x32_bf16 v[24:27], a[108:111], a[44:47], v[24:27]
v_exp_f32 v21, v21
v_max3_f32 v6, v16, v17, v18
ds_read_b128 a[108:111], v4 offset:192
v_mfma_f32_16x16x32_bf16 v[24:27], a[112:115], a[48:51], v[24:27]
v_exp_f32 v22, v22
v_mfma_f32_16x16x32_bf16 v[24:27], a[116:119], a[52:55], v[24:27]
v_max_f32 v6, v6, v19
ds_read_b128 a[112:115], v4 offset:256
v_mfma_f32_16x16x32_bf16 v[24:27], a[120:123], a[56:59], v[24:27]
v_exp_f32 v23, v23
ds_read_b128 a[116:119], v4 offset:320
v_cvt_pk_bf16_f32 v11, v20, v21
v_mfma_f32_16x16x32_bf16 v[24:27], a[124:127], a[60:63], v[24:27]
v_accvgpr_write_b32 a196, v11
v_cmp_lt_f32 vcc, s50, v6
s_waitcnt lgkmcnt(2)
v_mfma_f32_16x16x32_bf16 v[12:15], a[96:99], a[0:3], v[32:35]
ds_read_b128 a[120:123], v4 offset:384
v_cvt_pk_bf16_f32 v10, v22, v23
v_accvgpr_write_b32 a197, v10
v_mfma_f32_16x16x32_bf16 v[12:15], a[100:103], a[4:7], v[12:15]
ds_read_b128 a[124:127], v4 offset:448
s_add_u32 m0, s49, 7392
s_add_u32 s48, s55, 465920
buffer_load_dwordx4 v3, s[8:11], s48 offen nt lds
s_cbranch_vccnz L_rs112
L_rr112:
v_mfma_f32_16x16x32_bf16 v[12:15], a[104:107], a[8:11], v[12:15]
v_exp_f32 v16, v16
v_mfma_f32_16x16x32_bf16 v[12:15], a[108:111], a[12:15], v[12:15]
v_exp_f32 v17, v17
s_waitcnt lgkmcnt(1)
v_mfma_f32_16x16x32_bf16 v[12:15], a[112:115], a[16:19], v[12:15]
v_max3_f32 v8, v24, v25, v26
v_mfma_f32_16x16x32_bf16 v[12:15], a[116:119], a[20:23], v[12:15]
v_exp_f32 v18, v18
v_max_f32 v8, v8, v27
v_mfma_f32_16x16x32_bf16 v[12:15], a[120:123], a[24:27], v[12:15]
v_exp_f32 v19, v19
s_waitcnt lgkmcnt(0)
v_mfma_f32_16x16x32_bf16 v[12:15], a[124:127], a[28:31], v[12:15]
v_cvt_pk_bf16_f32 v146, v16, v17
v_cmp_lt_f32 vcc, s50, v8
v_mfma_f32_16x16x32_bf16 v[20:23], a[96:99], a[32:35], v[36:39]
v_cvt_pk_bf16_f32 v147, v18, v19
ds_read_b128 a[96:99], v4 offset:8448
v_mfma_f32_16x16x32_bf16 v[20:23], a[100:103], a[36:39], v[20:23]
ds_read_b128 a[100:103], v4 offset:8512
s_add_u32 m0, s49, 33792
s_add_u32 s48, s55, 491520
buffer_load_dwordx4 v3, s[8:11], s48 offen nt lds
v_mfma_f32_16x16x32_bf16 a[164:167], a[160:163], v[144:147], a[164:167]
s_cbranch_vccnz L_rs113
L_rr113:
v_exp_f32 v24, v24
v_mfma_f32_16x16x32_bf16 v[20:23], a[104:107], a[40:43], v[20:23]
ds_read_b128 a[104:107], v4 offset:8576
v_mfma_f32_16x16x32_bf16 v[20:23], a[108:111], a[44:47], v[20:23]
v_exp_f32 v25, v25
v_max3_f32 v6, v12, v13, v14
ds_read_b128 a[108:111], v4 offset:8640
v_mfma_f32_16x16x32_bf16 v[20:23], a[112:115], a[48:51], v[20:23]
v_exp_f32 v26, v26
v_max_f32 v6, v6, v15
v_mfma_f32_16x16x32_bf16 v[20:23], a[116:119], a[52:55], v[20:23]
ds_read_b128 a[112:115], v4 offset:8704
v_mfma_f32_16x16x32_bf16 v[20:23], a[120:123], a[56:59], v[20:23]
v_exp_f32 v27, v27
ds_read_b128 a[116:119], v4 offset:8768
v_cvt_pk_bf16_f32 v11, v24, v25
v_mfma_f32_16x16x32_bf16 v[20:23], a[124:127], a[60:63], v[20:23]
v_accvgpr_write_b32 a198, v11
v_cmp_lt_f32 vcc, s50, v6
s_waitcnt lgkmcnt(2)
v_mfma_f32_16x16x32_bf16 v[16:19], a[96:99], a[0:3], v[32:35]
ds_read_b128 a[120:123], v4 offset:8832
v_cvt_pk_bf16_f32 v10, v26, v27
v_accvgpr_write_b32 a199, v10
v_mfma_f32_16x16x32_bf16 v[16:19], a[100:103], a[4:7], v[16:19]
ds_read_b128 a[124:127], v4 offset:8896
ds_read_b128 a[128:131], v5
ds_read_b128 a[132:135], v5 offset:64
v_mfma_f32_16x16x32_bf16 a[168:171], a[160:163], a[196:199], a[168:171]
s_cbranch_vccnz L_rs114
L_rr114:
v_exp_f32 v12, v12
v_mfma_f32_16x16x32_bf16 v[16:19], a[104:107], a[8:11], v[16:19]
ds_read_b128 a[136:139], v5 offset:128
s_add_u32 m0, s49, 34848
s_add_u32 s48, s55, 492544
buffer_load_dwordx4 v3, s[8:11], s48 offen nt lds
v_mfma_f32_16x16x32_bf16 v[16:19], a[108:111], a[12:15], v[16:19]
v_exp_f32 v13, v13
v_max3_f32 v8, v20, v21, v22
s_waitcnt lgkmcnt(1)
v_mfma_f32_16x16x32_bf16 v[16:19], a[112:115], a[16:19], v[16:19]
ds_read_b128 a[140:143], v5 offset:192
v_mfma_f32_16x16x32_bf16 v[16:19], a[116:119], a[20:23], v[16:19]
v_exp_f32 v14, v14
v_max_f32 v8, v8, v23
ds_read_b128 a[144:147], v5 offset:256
v_mfma_f32_16x16x32_bf16 v[16:19], a[120:123], a[24:27], v[16:19]
v_exp_f32 v15, v15
v_mfma_f32_16x16x32_bf16 v[16:19], a[124:127], a[28:31], v[16:19]
ds_read_b128 a[148:151], v5 offset:320
v_cvt_pk_bf16_f32 v148, v12, v13
v_cmp_lt_f32 vcc, s50, v8
v_mfma_f32_16x16x32_bf16 v[24:27], a[96:99], a[32:35], v[36:39]
ds_read_b128 a[152:155], v5 offset:384
v_cvt_pk_bf16_f32 v149, v14, v15
v_mfma_f32_16x16x32_bf16 v[24:27], a[100:103], a[36:39], v[24:27]
ds_read_b128 a[156:159], v5 offset:448
ds_read_b128 a[96:99], v4 offset:16896
ds_read_b128 a[100:103], v4 offset:16960
s_cbranch_vccnz L_rs115
L_rr115:
v_mfma_f32_16x16x32_bf16 v[24:27], a[104:107], a[40:43], v[24:27]
v_exp_f32 v20, v20
v_mfma_f32_16x16x32_bf16 v[24:27], a[108:111], a[44:47], v[24:27]
ds_read_b128 a[104:107], v4 offset:17024
s_add_u32 m0, s49, 35904
s_add_u32 s48, s55, 493568
buffer_load_dwordx4 v3, s[8:11], s48 offen nt lds
v_mfma_f32_16x16x32_bf16 v[24:27], a[112:115], a[48:51], v[24:27]
v_exp_f32 v21, v21
v_max3_f32 v6, v16, v17, v18
v_mfma_f32_16x16x32_bf16 v[24:27], a[116:119], a[52:55], v[24:27]
ds_read_b128 a[108:111], v4 offset:17088
v_mfma_f32_16x16x32_bf16 v[24:27], a[120:123], a[56:59], v[24:27]
v_exp_f32 v22, v22
v_max_f32 v6, v6, v19
ds_read_b128 a[112:115], v4 offset:17152
v_mfma_f32_16x16x32_bf16 v[24:27], a[124:127], a[60:63], v[24:27]
v_exp_f32 v23, v23
v_mfma_f32_16x16x32_bf16 v[28:31], a[128:131], a[64:67], v[40:43]
ds_read_b128 a[116:119], v4 offset:17216
v_cvt_pk_bf16_f32 v11, v20, v21
v_accvgpr_write_b32 a200, v11
v_mfma_f32_16x16x32_bf16 v[28:31], a[132:135], a[68:71], v[28:31]
v_cmp_lt_f32 vcc, s50, v6
ds_read_b128 a[120:123], v4 offset:17280
s_waitcnt lgkmcnt(2)
v_mfma_f32_16x16x32_bf16 v[28:31], a[136:139], a[72:75], v[28:31]
v_cvt_pk_bf16_f32 v10, v22, v23
v_accvgpr_write_b32 a201, v10
ds_read_b128 a[124:127], v4 offset:17344
v_mfma_f32_16x16x32_bf16 v[28:31], a[140:143], a[76:79], v[28:31]
s_cbranch_vccnz L_rs116
L_rr116:
v_exp_f32 v16, v16
v_mfma_f32_16x16x32_bf16 v[28:31], a[144:147], a[80:83], v[28:31]
v_exp_f32 v17, v17
v_mfma_f32_16x16x32_bf16 v[28:31], a[148:151], a[84:87], v[28:31]
v_max3_f32 v8, v24, v25, v26
s_add_u32 m0, s49, 36960
s_add_u32 s48, s55, 494592
buffer_load_dwordx4 v3, s[8:11], s48 offen nt lds
v_mfma_f32_16x16x32_bf16 v[28:31], a[152:155], a[88:91], v[28:31]
v_exp_f32 v18, v18
v_max_f32 v8, v8, v27
v_mfma_f32_16x16x32_bf16 v[28:31], a[156:159], a[92:95], v[28:31]
v_exp_f32 v19, v19
v_mfma_f32_16x16x32_bf16 v[12:15], a[96:99], a[0:3], v[32:35]
v_cvt_pk_bf16_f32 v150, v16, v17
v_cmp_lt_f32 vcc, s50, v8
v_cvt_pk_bf16_f32 v151, v18, v19
s_cbranch_vccnz L_rs117
L_rr117:
v_mfma_f32_16x16x32_bf16 v[12:15], a[100:103], a[4:7], v[12:15]
v_mfma_f32_16x16x32_bf16 a[164:167], a[160:163], v[148:151], a[164:167]
v_exp_f32 v24, v24
v_mfma_f32_16x16x32_bf16 v[12:15], a[104:107], a[8:11], v[12:15]
v_exp_f32 v25, v25
v_max3_f32 v6, v28, v29, v30
s_add_u32 m0, s49, 38016
s_add_u32 s48, s55, 495616
v_mfma_f32_16x16x32_bf16 v[12:15], a[108:111], a[12:15], v[12:15]
buffer_load_dwordx4 v3, s[8:11], s48 offen nt lds
v_mfma_f32_16x16x32_bf16 v[12:15], a[112:115], a[16:19], v[12:15]
v_exp_f32 v26, v26
v_max_f32 v6, v6, v31
s_waitcnt lgkmcnt(0)
v_mfma_f32_16x16x32_bf16 v[12:15], a[116:119], a[20:23], v[12:15]
v_exp_f32 v27, v27
v_mfma_f32_16x16x32_bf16 v[12:15], a[120:123], a[24:27], v[12:15]
v_cvt_pk_bf16_f32 v11, v24, v25
v_mfma_f32_16x16x32_bf16 v[12:15], a[124:127], a[28:31], v[12:15]
v_accvgpr_write_b32 a202, v11
v_cmp_lt_f32 vcc, s50, v6
v_mfma_f32_16x16x32_bf16 v[20:23], a[96:99], a[32:35], v[36:39]
v_cvt_pk_bf16_f32 v10, v26, v27
v_accvgpr_write_b32 a203, v10
v_mfma_f32_16x16x32_bf16 v[20:23], a[100:103], a[36:39], v[20:23]
ds_read_b128 a[96:99], v4 offset:25344
ds_read_b128 a[100:103], v4 offset:25408
s_cbranch_vccnz L_rs118
L_rr118:
v_mfma_f32_16x16x32_bf16 a[168:171], a[160:163], a[200:203], a[168:171]
v_exp_f32 v28, v28
v_mfma_f32_16x16x32_bf16 v[20:23], a[104:107], a[40:43], v[20:23]
ds_read_b128 a[104:107], v4 offset:25472
v_exp_f32 v29, v29
v_mfma_f32_16x16x32_bf16 v[20:23], a[108:111], a[44:47], v[20:23]
v_max3_f32 v6, v12, v13, v14
ds_read_b128 a[108:111], v4 offset:25536
v_mfma_f32_16x16x32_bf16 v[20:23], a[112:115], a[48:51], v[20:23]
v_exp_f32 v30, v30
v_max_f32 v6, v6, v15
v_mfma_f32_16x16x32_bf16 v[20:23], a[116:119], a[52:55], v[20:23]
ds_read_b128 a[112:115], v4 offset:25600
s_add_u32 m0, s49, 39072
s_add_u32 s48, s55, 496640
buffer_load_dwordx4 v3, s[8:11], s48 offen nt lds
v_mfma_f32_16x16x32_bf16 v[20:23], a[120:123], a[56:59], v[20:23]
v_exp_f32 v31, v31
ds_read_b128 a[116:119], v4 offset:25664
v_mfma_f32_16x16x32_bf16 v[20:23], a[124:127], a[60:63], v[20:23]
v_cvt_pk_bf16_f32 v11, v28, v29
v_accvgpr_write_b32 a250, v11
v_cmp_lt_f32 vcc, s50, v6
s_waitcnt lgkmcnt(1)
v_mfma_f32_16x16x32_bf16 v[16:19], a[96:99], a[0:3], v[32:35]
ds_read_b128 a[120:123], v4 offset:25728
v_cvt_pk_bf16_f32 v10, v30, v31
v_accvgpr_write_b32 a251, v10
v_mfma_f32_16x16x32_bf16 v[16:19], a[100:103], a[4:7], v[16:19]
ds_read_b128 a[124:127], v4 offset:25792
s_cbranch_vccnz L_rs119
L_rr119:
v_mfma_f32_16x16x32_bf16 a[172:175], a[160:163], a[248:251], a[172:175]
v_exp_f32 v12, v12
v_mfma_f32_16x16x32_bf16 v[16:19], a[104:107], a[8:11], v[16:19]
v_exp_f32 v13, v13
v_max3_f32 v8, v20, v21, v22
v_mfma_f32_16x16x32_bf16 v[16:19], a[108:111], a[12:15], v[16:19]
v_exp_f32 v14, v14
v_mfma_f32_16x16x32_bf16 v[16:19], a[112:115], a[16:19], v[16:19]
v_max_f32 v8, v8, v23
s_waitcnt lgkmcnt(0)
v_mfma_f32_16x16x32_bf16 v[16:19], a[116:119], a[20:23], v[16:19]
v_exp_f32 v15, v15
v_cvt_pk_bf16_f32 v152, v12, v13
v_mfma_f32_16x16x32_bf16 v[16:19], a[120:123], a[24:27], v[16:19]
v_cmp_lt_f32 vcc, s50, v8
v_cvt_pk_bf16_f32 v153, v14, v15
v_mfma_f32_16x16x32_bf16 v[16:19], a[124:127], a[28:31], v[16:19]
v_subrev_u32 v4, 67584, v4
v_subrev_u32 v5, 67584, v5
L_stage21:
s_waitcnt vmcnt(6)
s_barrier
v_mfma_f32_16x16x32_bf16 v[24:27], a[96:99], a[32:35], v[36:39]
ds_read_b128 a[96:99], v4
s_add_u32 m0, s49, 40128
s_add_u32 s48, s55, 497664
buffer_load_dwordx4 v3, s[8:11], s48 offen nt lds
v_mfma_f32_16x16x32_bf16 v[24:27], a[100:103], a[36:39], v[24:27]
ds_read_b128 a[100:103], v4 offset:64
s_cbranch_vccnz L_rs120
L_rr120:
v_mfma_f32_16x16x32_bf16 v[24:27], a[104:107], a[40:43], v[24:27]
v_exp_f32 v20, v20
ds_read_b128 a[104:107], v4 offset:128
v_mfma_f32_16x16x32_bf16 v[24:27], a[108:111], a[44:47], v[24:27]
v_exp_f32 v21, v21
v_max3_f32 v6, v16, v17, v18
ds_read_b128 a[108:111], v4 offset:192
v_mfma_f32_16x16x32_bf16 v[24:27], a[112:115], a[48:51], v[24:27]
v_exp_f32 v22, v22
v_mfma_f32_16x16x32_bf16 v[24:27], a[116:119], a[52:55], v[24:27]
v_max_f32 v6, v6, v19
ds_read_b128 a[112:115], v4 offset:256
v_mfma_f32_16x16x32_bf16 v[24:27], a[120:123], a[56:59], v[24:27]
v_exp_f32 v23, v23
ds_read_b128 a[116:119], v4 offset:320
v_cvt_pk_bf16_f32 v11, v20, v21
v_mfma_f32_16x16x32_bf16 v[24:27], a[124:127], a[60:63], v[24:27]
v_accvgpr_write_b32 a204, v11
v_cmp_lt_f32 vcc, s50, v6
s_waitcnt lgkmcnt(2)
v_mfma_f32_16x16x32_bf16 v[12:15], a[96:99], a[0:3], v[32:35]
ds_read_b128 a[120:123], v4 offset:384
v_cvt_pk_bf16_f32 v10, v22, v23
v_accvgpr_write_b32 a205, v10
v_mfma_f32_16x16x32_bf16 v[12:15], a[100:103], a[4:7], v[12:15]
ds_read_b128 a[124:127], v4 offset:448
s_add_u32 m0, s49, 41184
s_add_u32 s48, s55, 498688
buffer_load_dwordx4 v3, s[8:11], s48 offen nt lds
s_cbranch_vccnz L_rs121
L_rr121:
v_mfma_f32_16x16x32_bf16 v[12:15], a[104:107], a[8:11], v[12:15]
v_exp_f32 v16, v16
v_mfma_f32_16x16x32_bf16 v[12:15], a[108:111], a[12:15], v[12:15]
v_exp_f32 v17, v17
s_waitcnt lgkmcnt(1)
v_mfma_f32_16x16x32_bf16 v[12:15], a[112:115], a[16:19], v[12:15]
v_max3_f32 v8, v24, v25, v26
v_mfma_f32_16x16x32_bf16 v[12:15], a[116:119], a[20:23], v[12:15]
v_exp_f32 v18, v18
v_max_f32 v8, v8, v27
v_mfma_f32_16x16x32_bf16 v[12:15], a[120:123], a[24:27], v[12:15]
v_exp_f32 v19, v19
s_waitcnt lgkmcnt(0)
v_mfma_f32_16x16x32_bf16 v[12:15], a[124:127], a[28:31], v[12:15]
v_cvt_pk_bf16_f32 v154, v16, v17
v_cmp_lt_f32 vcc, s50, v8
v_mfma_f32_16x16x32_bf16 v[20:23], a[96:99], a[32:35], v[36:39]
v_cvt_pk_bf16_f32 v155, v18, v19
ds_read_b128 a[96:99], v4 offset:8448
v_mfma_f32_16x16x32_bf16 v[20:23], a[100:103], a[36:39], v[20:23]
ds_read_b128 a[100:103], v4 offset:8512
s_add_u32 m0, s49, 67584
s_add_u32 s48, s56, 0
buffer_load_dwordx4 v2, s[12:15], s48 offen nt lds
v_mfma_f32_16x16x32_bf16 a[164:167], a[160:163], v[152:155], a[164:167]
s_cbranch_vccnz L_rs122
L_rr122:
v_exp_f32 v24, v24
v_mfma_f32_16x16x32_bf16 v[20:23], a[104:107], a[40:43], v[20:23]
ds_read_b128 a[104:107], v4 offset:8576
v_mfma_f32_16x16x32_bf16 v[20:23], a[108:111], a[44:47], v[20:23]
v_exp_f32 v25, v25
v_max3_f32 v6, v12, v13, v14
ds_read_b128 a[108:111], v4 offset:8640
v_mfma_f32_16x16x32_bf16 v[20:23], a[112:115], a[48:51], v[20:23]
v_exp_f32 v26, v26
v_max_f32 v6, v6, v15
v_mfma_f32_16x16x32_bf16 v[20:23], a[116:119], a[52:55], v[20:23]
ds_read_b128 a[112:115], v4 offset:8704
v_mfma_f32_16x16x32_bf16 v[20:23], a[120:123], a[56:59], v[20:23]
v_exp_f32 v27, v27
ds_read_b128 a[116:119], v4 offset:8768
v_cvt_pk_bf16_f32 v11, v24, v25
v_mfma_f32_16x16x32_bf16 v[20:23], a[124:127], a[60:63], v[20:23]
v_accvgpr_write_b32 a206, v11
v_cmp_lt_f32 vcc, s50, v6
s_waitcnt lgkmcnt(2)
v_mfma_f32_16x16x32_bf16 v[16:19], a[96:99], a[0:3], v[32:35]
ds_read_b128 a[120:123], v4 offset:8832
v_cvt_pk_bf16_f32 v10, v26, v27
v_accvgpr_write_b32 a207, v10
v_mfma_f32_16x16x32_bf16 v[16:19], a[100:103], a[4:7], v[16:19]
ds_read_b128 a[124:127], v4 offset:8896
ds_read_b128 a[128:131], v5
ds_read_b128 a[132:135], v5 offset:64
v_mfma_f32_16x16x32_bf16 a[168:171], a[160:163], a[204:207], a[168:171]
s_cbranch_vccnz L_rs123
L_rr123:
v_exp_f32 v12, v12
v_mfma_f32_16x16x32_bf16 v[16:19], a[104:107], a[8:11], v[16:19]
ds_read_b128 a[136:139], v5 offset:128
s_add_u32 m0, s49, 68640
s_add_u32 s48, s56, 4096
buffer_load_dwordx4 v2, s[12:15], s48 offen nt lds
v_mfma_f32_16x16x32_bf16 v[16:19], a[108:111], a[12:15], v[16:19]
v_exp_f32 v13, v13
v_max3_f32 v8, v20, v21, v22
s_waitcnt lgkmcnt(1)
v_mfma_f32_16x16x32_bf16 v[16:19], a[112:115], a[16:19], v[16:19]
ds_read_b128 a[140:143], v5 offset:192
v_mfma_f32_16x16x32_bf16 v[16:19], a[116:119], a[20:23], v[16:19]
v_exp_f32 v14, v14
v_max_f32 v8, v8, v23
ds_read_b128 a[144:147], v5 offset:256
v_mfma_f32_16x16x32_bf16 v[16:19], a[120:123], a[24:27], v[16:19]
v_exp_f32 v15, v15
v_mfma_f32_16x16x32_bf16 v[16:19], a[124:127], a[28:31], v[16:19]
ds_read_b128 a[148:151], v5 offset:320
v_cvt_pk_bf16_f32 v156, v12, v13
v_cmp_lt_f32 vcc, s50, v8
v_mfma_f32_16x16x32_bf16 v[24:27], a[96:99], a[32:35], v[36:39]
ds_read_b128 a[152:155], v5 offset:384
v_cvt_pk_bf16_f32 v157, v14, v15
v_mfma_f32_16x16x32_bf16 v[24:27], a[100:103], a[36:39], v[24:27]
ds_read_b128 a[156:159], v5 offset:448
ds_read_b128 a[96:99], v4 offset:16896
ds_read_b128 a[100:103], v4 offset:16960
s_cbranch_vccnz L_rs124
L_rr124:
v_mfma_f32_16x16x32_bf16 v[24:27], a[104:107], a[40:43], v[24:27]
v_exp_f32 v20, v20
v_mfma_f32_16x16x32_bf16 v[24:27], a[108:111], a[44:47], v[24:27]
ds_read_b128 a[104:107], v4 offset:17024
s_add_u32 m0, s49, 69696
s_add_u32 s48, s56, 8192
buffer_load_dwordx4 v2, s[12:15], s48 offen nt lds
v_mfma_f32_16x16x32_bf16 v[24:27], a[112:115], a[48:51], v[24:27]
v_exp_f32 v21, v21
v_max3_f32 v6, v16, v17, v18
v_mfma_f32_16x16x32_bf16 v[24:27], a[116:119], a[52:55], v[24:27]
ds_read_b128 a[108:111], v4 offset:17088
v_mfma_f32_16x16x32_bf16 v[24:27], a[120:123], a[56:59], v[24:27]
v_exp_f32 v22, v22
v_max_f32 v6, v6, v19
ds_read_b128 a[112:115], v4 offset:17152
v_mfma_f32_16x16x32_bf16 v[24:27], a[124:127], a[60:63], v[24:27]
v_exp_f32 v23, v23
v_mfma_f32_16x16x32_bf16 v[28:31], a[128:131], a[64:67], v[40:43]
ds_read_b128 a[116:119], v4 offset:17216
v_cvt_pk_bf16_f32 v11, v20, v21
v_accvgpr_write_b32 a208, v11
v_mfma_f32_16x16x32_bf16 v[28:31], a[132:135], a[68:71], v[28:31]
v_cmp_lt_f32 vcc, s50, v6
ds_read_b128 a[120:123], v4 offset:17280
s_waitcnt lgkmcnt(2)
v_mfma_f32_16x16x32_bf16 v[28:31], a[136:139], a[72:75], v[28:31]
v_cvt_pk_bf16_f32 v10, v22, v23
v_accvgpr_write_b32 a209, v10
ds_read_b128 a[124:127], v4 offset:17344
v_mfma_f32_16x16x32_bf16 v[28:31], a[140:143], a[76:79], v[28:31]
s_cbranch_vccnz L_rs125
L_rr125:
v_exp_f32 v16, v16
v_mfma_f32_16x16x32_bf16 v[28:31], a[144:147], a[80:83], v[28:31]
v_exp_f32 v17, v17
v_mfma_f32_16x16x32_bf16 v[28:31], a[148:151], a[84:87], v[28:31]
v_max3_f32 v8, v24, v25, v26
s_add_u32 m0, s49, 70752
s_add_u32 s48, s56, 12288
buffer_load_dwordx4 v2, s[12:15], s48 offen nt lds
v_mfma_f32_16x16x32_bf16 v[28:31], a[152:155], a[88:91], v[28:31]
v_exp_f32 v18, v18
v_max_f32 v8, v8, v27
v_mfma_f32_16x16x32_bf16 v[28:31], a[156:159], a[92:95], v[28:31]
v_exp_f32 v19, v19
v_mfma_f32_16x16x32_bf16 v[12:15], a[96:99], a[0:3], v[32:35]
v_cvt_pk_bf16_f32 v158, v16, v17
v_cmp_lt_f32 vcc, s50, v8
v_cvt_pk_bf16_f32 v159, v18, v19
s_cbranch_vccnz L_rs126
L_rr126:
v_mfma_f32_16x16x32_bf16 v[12:15], a[100:103], a[4:7], v[12:15]
v_mfma_f32_16x16x32_bf16 a[164:167], a[160:163], v[156:159], a[164:167]
v_exp_f32 v24, v24
v_mfma_f32_16x16x32_bf16 v[12:15], a[104:107], a[8:11], v[12:15]
v_exp_f32 v25, v25
v_max3_f32 v6, v28, v29, v30
s_add_u32 m0, s49, 71808
s_add_u32 s48, s56, 16384
v_mfma_f32_16x16x32_bf16 v[12:15], a[108:111], a[12:15], v[12:15]
buffer_load_dwordx4 v2, s[12:15], s48 offen nt lds
v_mfma_f32_16x16x32_bf16 v[12:15], a[112:115], a[16:19], v[12:15]
v_exp_f32 v26, v26
v_max_f32 v6, v6, v31
s_waitcnt lgkmcnt(0)
v_mfma_f32_16x16x32_bf16 v[12:15], a[116:119], a[20:23], v[12:15]
v_exp_f32 v27, v27
v_mfma_f32_16x16x32_bf16 v[12:15], a[120:123], a[24:27], v[12:15]
v_cvt_pk_bf16_f32 v11, v24, v25
v_mfma_f32_16x16x32_bf16 v[12:15], a[124:127], a[28:31], v[12:15]
v_accvgpr_write_b32 a210, v11
v_cmp_lt_f32 vcc, s50, v6
v_mfma_f32_16x16x32_bf16 v[20:23], a[96:99], a[32:35], v[36:39]
v_cvt_pk_bf16_f32 v10, v26, v27
v_accvgpr_write_b32 a211, v10
v_mfma_f32_16x16x32_bf16 v[20:23], a[100:103], a[36:39], v[20:23]
ds_read_b128 a[96:99], v4 offset:25344
ds_read_b128 a[100:103], v4 offset:25408
s_cbranch_vccnz L_rs127
L_rr127:
v_mfma_f32_16x16x32_bf16 a[168:171], a[160:163], a[208:211], a[168:171]
v_exp_f32 v28, v28
v_mfma_f32_16x16x32_bf16 v[20:23], a[104:107], a[40:43], v[20:23]
ds_read_b128 a[104:107], v4 offset:25472
v_mfma_f32_16x16x32_bf16 v[20:23], a[108:111], a[44:47], v[20:23]
v_exp_f32 v29, v29
v_max3_f32 v6, v12, v13, v14
ds_read_b128 a[108:111], v4 offset:25536
v_mfma_f32_16x16x32_bf16 v[20:23], a[112:115], a[48:51], v[20:23]
v_exp_f32 v30, v30
v_max_f32 v6, v6, v15
v_mfma_f32_16x16x32_bf16 v[20:23], a[116:119], a[52:55], v[20:23]
ds_read_b128 a[112:115], v4 offset:25600
s_add_u32 m0, s49, 72864
s_add_u32 s48, s56, 20480
buffer_load_dwordx4 v2, s[12:15], s48 offen nt lds
v_mfma_f32_16x16x32_bf16 v[20:23], a[120:123], a[56:59], v[20:23]
v_exp_f32 v31, v31
v_mfma_f32_16x16x32_bf16 v[20:23], a[124:127], a[60:63], v[20:23]
ds_read_b128 a[116:119], v4 offset:25664
v_cvt_pk_bf16_f32 v11, v28, v29
v_accvgpr_write_b32 a252, v11
s_waitcnt lgkmcnt(1)
v_mfma_f32_16x16x32_bf16 v[16:19], a[96:99], a[0:3], v[32:35]
v_cmp_lt_f32 vcc, s50, v6
ds_read_b128 a[120:123], v4 offset:25728
v_mfma_f32_16x16x32_bf16 v[16:19], a[100:103], a[4:7], v[16:19]
v_cvt_pk_bf16_f32 v10, v30, v31
v_accvgpr_write_b32 a253, v10
ds_read_b128 a[124:127], v4 offset:25792
s_cbranch_vccnz L_rs128
L_rr128:
v_mfma_f32_16x16x32_bf16 v[16:19], a[104:107], a[8:11], v[16:19]
v_exp_f32 v12, v12
v_mfma_f32_16x16x32_bf16 v[16:19], a[108:111], a[12:15], v[16:19]
v_exp_f32 v13, v13
v_max3_f32 v8, v20, v21, v22
v_mfma_f32_16x16x32_bf16 v[16:19], a[112:115], a[16:19], v[16:19]
v_exp_f32 v14, v14
s_waitcnt lgkmcnt(1)
v_mfma_f32_16x16x32_bf16 v[16:19], a[116:119], a[20:23], v[16:19]
v_max_f32 v8, v8, v23
v_exp_f32 v15, v15
v_mfma_f32_16x16x32_bf16 v[16:19], a[120:123], a[24:27], v[16:19]
v_cvt_pk_bf16_f32 v160, v12, v13
v_cmp_lt_f32 vcc, s50, v8
s_waitcnt lgkmcnt(0)
v_mfma_f32_16x16x32_bf16 v[16:19], a[124:127], a[28:31], v[16:19]
v_cvt_pk_bf16_f32 v161, v14, v15
v_add_u32 v4, 33792, v4
v_add_u32 v5, 33792, v5
L_stage22:
s_waitcnt vmcnt(6)
s_barrier
v_mfma_f32_16x16x32_bf16 v[24:27], a[96:99], a[32:35], v[36:39]
ds_read_b128 a[96:99], v4
s_add_u32 m0, s49, 73920
s_add_u32 s48, s56, 24576
buffer_load_dwordx4 v2, s[12:15], s48 offen nt lds
v_mfma_f32_16x16x32_bf16 v[24:27], a[100:103], a[36:39], v[24:27]
ds_read_b128 a[100:103], v4 offset:64
s_cbranch_vccnz L_rs129
L_rr129:
v_mfma_f32_16x16x32_bf16 v[24:27], a[104:107], a[40:43], v[24:27]
v_exp_f32 v20, v20
ds_read_b128 a[104:107], v4 offset:128
v_mfma_f32_16x16x32_bf16 v[24:27], a[108:111], a[44:47], v[24:27]
v_exp_f32 v21, v21
v_max3_f32 v6, v16, v17, v18
ds_read_b128 a[108:111], v4 offset:192
v_mfma_f32_16x16x32_bf16 v[24:27], a[112:115], a[48:51], v[24:27]
v_exp_f32 v22, v22
v_mfma_f32_16x16x32_bf16 v[24:27], a[116:119], a[52:55], v[24:27]
v_max_f32 v6, v6, v19
ds_read_b128 a[112:115], v4 offset:256
v_mfma_f32_16x16x32_bf16 v[24:27], a[120:123], a[56:59], v[24:27]
v_exp_f32 v23, v23
ds_read_b128 a[116:119], v4 offset:320
v_cvt_pk_bf16_f32 v11, v20, v21
v_mfma_f32_16x16x32_bf16 v[24:27], a[124:127], a[60:63], v[24:27]
v_accvgpr_write_b32 a212, v11
v_cmp_lt_f32 vcc, s50, v6
s_waitcnt lgkmcnt(2)
v_mfma_f32_16x16x32_bf16 v[12:15], a[96:99], a[0:3], v[32:35]
ds_read_b128 a[120:123], v4 offset:384
v_cvt_pk_bf16_f32 v10, v22, v23
v_accvgpr_write_b32 a213, v10
v_mfma_f32_16x16x32_bf16 v[12:15], a[100:103], a[4:7], v[12:15]
ds_read_b128 a[124:127], v4 offset:448
s_add_u32 m0, s49, 74976
s_add_u32 s48, s56, 28672
buffer_load_dwordx4 v2, s[12:15], s48 offen nt lds
s_cbranch_vccnz L_rs130
L_rr130:
v_mfma_f32_16x16x32_bf16 v[12:15], a[104:107], a[8:11], v[12:15]
v_exp_f32 v16, v16
v_mfma_f32_16x16x32_bf16 v[12:15], a[108:111], a[12:15], v[12:15]
v_exp_f32 v17, v17
s_waitcnt lgkmcnt(1)
v_mfma_f32_16x16x32_bf16 v[12:15], a[112:115], a[16:19], v[12:15]
v_max3_f32 v8, v24, v25, v26
v_mfma_f32_16x16x32_bf16 v[12:15], a[116:119], a[20:23], v[12:15]
v_exp_f32 v18, v18
v_max_f32 v8, v8, v27
v_mfma_f32_16x16x32_bf16 v[12:15], a[120:123], a[24:27], v[12:15]
v_exp_f32 v19, v19
s_waitcnt lgkmcnt(0)
v_mfma_f32_16x16x32_bf16 v[12:15], a[124:127], a[28:31], v[12:15]
v_cvt_pk_bf16_f32 v162, v16, v17
v_cmp_lt_f32 vcc, s50, v8
v_mfma_f32_16x16x32_bf16 v[20:23], a[96:99], a[32:35], v[36:39]
v_cvt_pk_bf16_f32 v163, v18, v19
ds_read_b128 a[96:99], v4 offset:8448
v_mfma_f32_16x16x32_bf16 v[20:23], a[100:103], a[36:39], v[20:23]
ds_read_b128 a[100:103], v4 offset:8512
s_add_u32 m0, s49, 0
s_add_u32 s48, s56, 131072
buffer_load_dwordx4 v2, s[12:15], s48 offen nt lds
v_mfma_f32_16x16x32_bf16 a[164:167], a[160:163], v[160:163], a[164:167]
s_cbranch_vccnz L_rs131
L_rr131:
v_exp_f32 v24, v24
v_mfma_f32_16x16x32_bf16 v[20:23], a[104:107], a[40:43], v[20:23]
ds_read_b128 a[104:107], v4 offset:8576
v_mfma_f32_16x16x32_bf16 v[20:23], a[108:111], a[44:47], v[20:23]
v_exp_f32 v25, v25
v_max3_f32 v6, v12, v13, v14
ds_read_b128 a[108:111], v4 offset:8640
v_mfma_f32_16x16x32_bf16 v[20:23], a[112:115], a[48:51], v[20:23]
v_exp_f32 v26, v26
v_max_f32 v6, v6, v15
v_mfma_f32_16x16x32_bf16 v[20:23], a[116:119], a[52:55], v[20:23]
ds_read_b128 a[112:115], v4 offset:8704
v_mfma_f32_16x16x32_bf16 v[20:23], a[120:123], a[56:59], v[20:23]
v_exp_f32 v27, v27
ds_read_b128 a[116:119], v4 offset:8768
v_cvt_pk_bf16_f32 v11, v24, v25
v_mfma_f32_16x16x32_bf16 v[20:23], a[124:127], a[60:63], v[20:23]
v_accvgpr_write_b32 a214, v11
v_cmp_lt_f32 vcc, s50, v6
s_waitcnt lgkmcnt(2)
v_mfma_f32_16x16x32_bf16 v[16:19], a[96:99], a[0:3], v[32:35]
ds_read_b128 a[120:123], v4 offset:8832
v_cvt_pk_bf16_f32 v10, v26, v27
v_accvgpr_write_b32 a215, v10
v_mfma_f32_16x16x32_bf16 v[16:19], a[100:103], a[4:7], v[16:19]
ds_read_b128 a[124:127], v4 offset:8896
ds_read_b128 a[128:131], v5
ds_read_b128 a[132:135], v5 offset:64
v_mfma_f32_16x16x32_bf16 a[168:171], a[160:163], a[212:215], a[168:171]
s_cbranch_vccnz L_rs132
L_rr132:
v_exp_f32 v12, v12
v_mfma_f32_16x16x32_bf16 v[16:19], a[104:107], a[8:11], v[16:19]
ds_read_b128 a[136:139], v5 offset:128
s_add_u32 m0, s49, 1056
s_add_u32 s48, s56, 135168
buffer_load_dwordx4 v2, s[12:15], s48 offen nt lds
v_mfma_f32_16x16x32_bf16 v[16:19], a[108:111], a[12:15], v[16:19]
v_exp_f32 v13, v13
v_max3_f32 v8, v20, v21, v22
s_waitcnt lgkmcnt(1)
v_mfma_f32_16x16x32_bf16 v[16:19], a[112:115], a[16:19], v[16:19]
ds_read_b128 a[140:143], v5 offset:192
v_mfma_f32_16x16x32_bf16 v[16:19], a[116:119], a[20:23], v[16:19]
v_exp_f32 v14, v14
v_max_f32 v8, v8, v23
ds_read_b128 a[144:147], v5 offset:256
v_mfma_f32_16x16x32_bf16 v[16:19], a[120:123], a[24:27], v[16:19]
v_exp_f32 v15, v15
v_mfma_f32_16x16x32_bf16 v[16:19], a[124:127], a[28:31], v[16:19]
ds_read_b128 a[148:151], v5 offset:320
v_cvt_pk_bf16_f32 v164, v12, v13
v_cmp_lt_f32 vcc, s50, v8
v_mfma_f32_16x16x32_bf16 v[24:27], a[96:99], a[32:35], v[36:39]
ds_read_b128 a[152:155], v5 offset:384
v_cvt_pk_bf16_f32 v165, v14, v15
v_mfma_f32_16x16x32_bf16 v[24:27], a[100:103], a[36:39], v[24:27]
ds_read_b128 a[156:159], v5 offset:448
ds_read_b128 a[96:99], v4 offset:16896
ds_read_b128 a[100:103], v4 offset:16960
s_cbranch_vccnz L_rs133
L_rr133:
v_mfma_f32_16x16x32_bf16 v[24:27], a[104:107], a[40:43], v[24:27]
v_exp_f32 v20, v20
v_mfma_f32_16x16x32_bf16 v[24:27], a[108:111], a[44:47], v[24:27]
ds_read_b128 a[104:107], v4 offset:17024
s_add_u32 m0, s49, 2112
s_add_u32 s48, s56, 139264
buffer_load_dwordx4 v2, s[12:15], s48 offen nt lds
v_mfma_f32_16x16x32_bf16 v[24:27], a[112:115], a[48:51], v[24:27]
v_exp_f32 v21, v21
v_max3_f32 v6, v16, v17, v18
v_mfma_f32_16x16x32_bf16 v[24:27], a[116:119], a[52:55], v[24:27]
ds_read_b128 a[108:111], v4 offset:17088
v_mfma_f32_16x16x32_bf16 v[24:27], a[120:123], a[56:59], v[24:27]
v_exp_f32 v22, v22
v_max_f32 v6, v6, v19
ds_read_b128 a[112:115], v4 offset:17152
v_mfma_f32_16x16x32_bf16 v[24:27], a[124:127], a[60:63], v[24:27]
v_exp_f32 v23, v23
v_mfma_f32_16x16x32_bf16 v[28:31], a[128:131], a[64:67], v[40:43]
ds_read_b128 a[116:119], v4 offset:17216
v_cvt_pk_bf16_f32 v11, v20, v21
v_accvgpr_write_b32 a216, v11
v_mfma_f32_16x16x32_bf16 v[28:31], a[132:135], a[68:71], v[28:31]
v_cmp_lt_f32 vcc, s50, v6
ds_read_b128 a[120:123], v4 offset:17280
s_waitcnt lgkmcnt(2)
v_mfma_f32_16x16x32_bf16 v[28:31], a[136:139], a[72:75], v[28:31]
v_cvt_pk_bf16_f32 v10, v22, v23
v_accvgpr_write_b32 a217, v10
ds_read_b128 a[124:127], v4 offset:17344
v_mfma_f32_16x16x32_bf16 v[28:31], a[140:143], a[76:79], v[28:31]
s_cbranch_vccnz L_rs134
L_rr134:
v_exp_f32 v16, v16
v_mfma_f32_16x16x32_bf16 v[28:31], a[144:147], a[80:83], v[28:31]
v_exp_f32 v17, v17
v_mfma_f32_16x16x32_bf16 v[28:31], a[148:151], a[84:87], v[28:31]
v_max3_f32 v8, v24, v25, v26
s_add_u32 m0, s49, 3168
s_add_u32 s48, s56, 143360
buffer_load_dwordx4 v2, s[12:15], s48 offen nt lds
v_mfma_f32_16x16x32_bf16 v[28:31], a[152:155], a[88:91], v[28:31]
v_exp_f32 v18, v18
v_max_f32 v8, v8, v27
v_mfma_f32_16x16x32_bf16 v[28:31], a[156:159], a[92:95], v[28:31]
v_exp_f32 v19, v19
v_mfma_f32_16x16x32_bf16 v[12:15], a[96:99], a[0:3], v[32:35]
v_cvt_pk_bf16_f32 v166, v16, v17
v_cmp_lt_f32 vcc, s50, v8
v_cvt_pk_bf16_f32 v167, v18, v19
s_cbranch_vccnz L_rs135
L_rr135:
v_mfma_f32_16x16x32_bf16 v[12:15], a[100:103], a[4:7], v[12:15]
v_mfma_f32_16x16x32_bf16 a[164:167], a[160:163], v[164:167], a[164:167]
v_exp_f32 v24, v24
v_mfma_f32_16x16x32_bf16 v[12:15], a[104:107], a[8:11], v[12:15]
v_exp_f32 v25, v25
v_max3_f32 v6, v28, v29, v30
s_add_u32 m0, s49, 4224
s_add_u32 s48, s56, 147456
v_mfma_f32_16x16x32_bf16 v[12:15], a[108:111], a[12:15], v[12:15]
buffer_load_dwordx4 v2, s[12:15], s48 offen nt lds
v_mfma_f32_16x16x32_bf16 v[12:15], a[112:115], a[16:19], v[12:15]
v_exp_f32 v26, v26
v_max_f32 v6, v6, v31
s_waitcnt lgkmcnt(0)
v_mfma_f32_16x16x32_bf16 v[12:15], a[116:119], a[20:23], v[12:15]
v_exp_f32 v27, v27
v_mfma_f32_16x16x32_bf16 v[12:15], a[120:123], a[24:27], v[12:15]
v_cvt_pk_bf16_f32 v11, v24, v25
v_mfma_f32_16x16x32_bf16 v[12:15], a[124:127], a[28:31], v[12:15]
v_accvgpr_write_b32 a218, v11
v_cmp_lt_f32 vcc, s50, v6
v_mfma_f32_16x16x32_bf16 v[20:23], a[96:99], a[32:35], v[36:39]
v_cvt_pk_bf16_f32 v10, v26, v27
v_accvgpr_write_b32 a219, v10
v_mfma_f32_16x16x32_bf16 v[20:23], a[100:103], a[36:39], v[20:23]
ds_read_b128 a[96:99], v4 offset:25344
ds_read_b128 a[100:103], v4 offset:25408
s_cbranch_vccnz L_rs136
L_rr136:
v_mfma_f32_16x16x32_bf16 a[168:171], a[160:163], a[216:219], a[168:171]
v_exp_f32 v28, v28
v_mfma_f32_16x16x32_bf16 v[20:23], a[104:107], a[40:43], v[20:23]
ds_read_b128 a[104:107], v4 offset:25472
v_exp_f32 v29, v29
v_mfma_f32_16x16x32_bf16 v[20:23], a[108:111], a[44:47], v[20:23]
v_max3_f32 v6, v12, v13, v14
ds_read_b128 a[108:111], v4 offset:25536
v_mfma_f32_16x16x32_bf16 v[20:23], a[112:115], a[48:51], v[20:23]
v_exp_f32 v30, v30
v_max_f32 v6, v6, v15
v_mfma_f32_16x16x32_bf16 v[20:23], a[116:119], a[52:55], v[20:23]
ds_read_b128 a[112:115], v4 offset:25600
s_add_u32 m0, s49, 5280
s_add_u32 s48, s56, 151552
buffer_load_dwordx4 v2, s[12:15], s48 offen nt lds
v_mfma_f32_16x16x32_bf16 v[20:23], a[120:123], a[56:59], v[20:23]
v_exp_f32 v31, v31
ds_read_b128 a[116:119], v4 offset:25664
v_mfma_f32_16x16x32_bf16 v[20:23], a[124:127], a[60:63], v[20:23]
v_cvt_pk_bf16_f32 v11, v28, v29
v_accvgpr_write_b32 a254, v11
v_cmp_lt_f32 vcc, s50, v6
s_waitcnt lgkmcnt(1)
v_mfma_f32_16x16x32_bf16 v[16:19], a[96:99], a[0:3], v[32:35]
ds_read_b128 a[120:123], v4 offset:25728
v_cvt_pk_bf16_f32 v10, v30, v31
v_accvgpr_write_b32 a255, v10
v_mfma_f32_16x16x32_bf16 v[16:19], a[100:103], a[4:7], v[16:19]
ds_read_b128 a[124:127], v4 offset:25792
s_cbranch_vccnz L_rs137
L_rr137:
v_mfma_f32_16x16x32_bf16 a[172:175], a[160:163], a[252:255], a[172:175]
v_exp_f32 v12, v12
v_mfma_f32_16x16x32_bf16 v[16:19], a[104:107], a[8:11], v[16:19]
v_mfma_f32_16x16x32_bf16 v[16:19], a[108:111], a[12:15], v[16:19]
v_exp_f32 v13, v13
v_max3_f32 v8, v20, v21, v22
v_mfma_f32_16x16x32_bf16 v[16:19], a[112:115], a[16:19], v[16:19]
s_waitcnt lgkmcnt(1)
v_mfma_f32_16x16x32_bf16 v[16:19], a[116:119], a[20:23], v[16:19]
v_exp_f32 v14, v14
v_max_f32 v8, v8, v23
v_mfma_f32_16x16x32_bf16 v[16:19], a[120:123], a[24:27], v[16:19]
v_exp_f32 v15, v15
s_waitcnt lgkmcnt(0)
v_mfma_f32_16x16x32_bf16 v[16:19], a[124:127], a[28:31], v[16:19]
v_cvt_pk_bf16_f32 v168, v12, v13
v_mfma_f32_16x16x32_bf16 v[24:27], a[96:99], a[32:35], v[36:39]
v_cmp_lt_f32 vcc, s50, v8
v_cvt_pk_bf16_f32 v169, v14, v15
v_mfma_f32_16x16x32_bf16 v[24:27], a[100:103], a[36:39], v[24:27]
s_cbranch_vccnz L_rs138
L_rr138:
v_exp_f32 v20, v20
v_mfma_f32_16x16x32_bf16 v[24:27], a[104:107], a[40:43], v[24:27]
v_exp_f32 v21, v21
v_max3_f32 v6, v16, v17, v18
v_mfma_f32_16x16x32_bf16 v[24:27], a[108:111], a[44:47], v[24:27]
v_exp_f32 v22, v22
v_max_f32 v6, v6, v19
v_mfma_f32_16x16x32_bf16 v[24:27], a[112:115], a[48:51], v[24:27]
v_exp_f32 v23, v23
v_cvt_pk_bf16_f32 v11, v20, v21
v_accvgpr_write_b32 a220, v11
v_cmp_lt_f32 vcc, s50, v6
v_mfma_f32_16x16x32_bf16 v[24:27], a[116:119], a[52:55], v[24:27]
v_cvt_pk_bf16_f32 v10, v22, v23
v_accvgpr_write_b32 a221, v10
s_nop 7
s_cbranch_vccnz L_rs139
L_rr139:
v_mfma_f32_16x16x32_bf16 v[24:27], a[120:123], a[56:59], v[24:27]
v_exp_f32 v16, v16
v_exp_f32 v17, v17
v_mfma_f32_16x16x32_bf16 v[24:27], a[124:127], a[60:63], v[24:27]
s_nop 7
v_max3_f32 v8, v24, v25, v26
v_exp_f32 v18, v18
v_max_f32 v8, v8, v27
v_exp_f32 v19, v19
v_cvt_pk_bf16_f32 v170, v16, v17
v_cmp_lt_f32 vcc, s50, v8
v_cvt_pk_bf16_f32 v171, v18, v19
s_nop 1
v_mfma_f32_16x16x32_bf16 a[164:167], a[160:163], v[168:171], a[164:167]
s_cbranch_vccnz L_rs140
L_rr140:
v_exp_f32 v24, v24
v_exp_f32 v25, v25
v_exp_f32 v26, v26
v_exp_f32 v27, v27
v_cvt_pk_bf16_f32 v11, v24, v25
v_accvgpr_write_b32 a222, v11
v_cvt_pk_bf16_f32 v10, v26, v27
v_accvgpr_write_b32 a223, v10
s_nop 1
v_mfma_f32_16x16x32_bf16 a[168:171], a[160:163], a[220:223], a[168:171]
v_mov_b32 v10, v40
v_lshrrev_b32 v12, 4, v0
v_bfe_u32 v13, v0, 2, 2
v_and_b32 v14, 3, v0
v_and_b32 v15, 1, v12
v_lshl_add_u32 v15, v15, 2, v13
v_lshrrev_b32 v7, 1, v12
v_mul_u32_u24 v7, 1056, v7
v_lshl_add_u32 v7, v15, 7, v7
v_lshl_add_u32 v7, v14, 3, v7
v_add_u32 v7, 67584, v7
v_lshrrev_b32 v15, 1, v15
s_mul_i32 s4, s3, 2112
v_xor_b32 v8, 0, v15
v_lshl_add_u32 v32, v8, 5, v7
v_add_u32 v36, s4, v32
v_xor_b32 v8, 1, v15
v_lshl_add_u32 v33, v8, 5, v7
v_add_u32 v37, s4, v33
v_xor_b32 v8, 2, v15
v_lshl_add_u32 v34, v8, 5, v7
v_add_u32 v38, s4, v34
v_xor_b32 v8, 3, v15
v_lshl_add_u32 v35, v8, 5, v7
v_add_u32 v39, s4, v35
v_lshrrev_b32 v7, 1, v1
s_lshl_b32 s4, s3, 9
s_add_u32 s4, s4, 134144
v_add_u32 v8, s4, v7
v_accvgpr_read_b32 v11, a172
ds_write_b64 v8, v[10:11]
v_mov_b32 v9, v10
v_accvgpr_read_b32 v7, a164
v_accvgpr_read_b32 v8, a168
v_rcp_f32 v4, v7
v_rcp_f32 v5, v8
L_stage23:
s_waitcnt vmcnt(6)
s_waitcnt lgkmcnt(0)
s_barrier
v_lshrrev_b32 v7, 1, v1
v_add_u32 v7, 134144, v7
ds_read_b64 v[12:13], v7
ds_read_b64 v[14:15], v7 offset:512
ds_read_b64 v[16:17], v7 offset:1024
ds_read_b64 v[18:19], v7 offset:1536
s_waitcnt lgkmcnt(2)
v_min_f32 v8, v12, v14
s_waitcnt lgkmcnt(0)
v_min3_f32 v8, v8, v16, v18
v_sub_f32 v12, v8, v12
v_cvt_i32_f32 v12, v12
v_ldexp_f32 v13, v13, v12
v_sub_f32 v14, v8, v14
v_cvt_i32_f32 v14, v14
v_ldexp_f32 v15, v15, v14
v_sub_f32 v16, v8, v16
v_cvt_i32_f32 v16, v16
v_ldexp_f32 v17, v17, v16
v_sub_f32 v18, v8, v18
v_cvt_i32_f32 v18, v18
v_ldexp_f32 v19, v19, v18
v_add_f32 v13, v13, v15
v_add_f32 v17, v17, v19
v_add_f32 v13, v13, v17
v_rcp_f32 v13, v13
v_sub_f32 v8, v8, v9
v_cvt_i32_f32 v8, v8
v_ldexp_f32 v6, v13, v8
ds_read_b64_tr_b16 a[48:49], v32
ds_read_b64_tr_b16 a[50:51], v32 offset:2112
ds_read_b64_tr_b16 a[52:53], v33
ds_read_b64_tr_b16 a[54:55], v33 offset:2112
ds_read_b64_tr_b16 a[56:57], v34
ds_read_b64_tr_b16 a[58:59], v34 offset:2112
s_waitcnt lgkmcnt(4)
v_mfma_f32_16x16x32_bf16 a[0:3], a[48:51], v[44:47], 0
ds_read_b64_tr_b16 a[60:61], v35
ds_read_b64_tr_b16 a[62:63], v35 offset:2112
v_mfma_f32_16x16x32_bf16 a[16:19], a[48:51], v[172:175], 0
ds_read_b64_tr_b16 a[64:65], v32 offset:4224
s_waitcnt lgkmcnt(5)
v_mfma_f32_16x16x32_bf16 a[4:7], a[52:55], v[44:47], 0
ds_read_b64_tr_b16 a[66:67], v32 offset:6336
ds_read_b64_tr_b16 a[68:69], v33 offset:4224
v_mfma_f32_16x16x32_bf16 a[20:23], a[52:55], v[172:175], 0
ds_read_b64_tr_b16 a[70:71], v33 offset:6336
s_waitcnt lgkmcnt(6)
v_mfma_f32_16x16x32_bf16 a[8:11], a[56:59], v[44:47], 0
ds_read_b64_tr_b16 a[72:73], v34 offset:4224
v_mfma_f32_16x16x32_bf16 a[24:27], a[56:59], v[172:175], 0
ds_read_b64_tr_b16 a[74:75], v34 offset:6336
ds_read_b64_tr_b16 a[76:77], v35 offset:4224
s_waitcnt lgkmcnt(6)
v_mfma_f32_16x16x32_bf16 a[12:15], a[60:63], v[44:47], 0
ds_read_b64_tr_b16 a[78:79], v35 offset:6336
v_mfma_f32_16x16x32_bf16 a[28:31], a[60:63], v[172:175], 0
ds_read_b64_tr_b16 a[80:81], v36
ds_read_b64_tr_b16 a[82:83], v36 offset:8448
s_waitcnt lgkmcnt(6)
v_mfma_f32_16x16x32_bf16 a[0:3], a[64:67], v[48:51], a[0:3]
s_add_u32 m0, s49, 6336
s_add_u32 s48, s56, 155648
buffer_load_dwordx4 v2, s[12:15], s48 offen nt lds
v_mfma_f32_16x16x32_bf16 a[16:19], a[64:67], v[176:179], a[16:19]
ds_read_b64_tr_b16 a[84:85], v37
v_mfma_f32_16x16x32_bf16 a[4:7], a[68:71], v[48:51], a[4:7]
ds_read_b64_tr_b16 a[86:87], v37 offset:8448
v_mfma_f32_16x16x32_bf16 a[20:23], a[68:71], v[176:179], a[20:23]
ds_read_b64_tr_b16 a[48:49], v32 offset:8448
ds_read_b64_tr_b16 a[50:51], v32 offset:10560
s_waitcnt lgkmcnt(4)
v_mfma_f32_16x16x32_bf16 a[8:11], a[72:75], v[48:51], a[8:11]
ds_read_b64_tr_b16 a[52:53], v33 offset:8448
v_mfma_f32_16x16x32_bf16 a[24:27], a[72:75], v[176:179], a[24:27]
ds_read_b64_tr_b16 a[54:55], v33 offset:10560
ds_read_b64_tr_b16 a[56:57], v34 offset:8448
v_mfma_f32_16x16x32_bf16 a[12:15], a[76:79], v[48:51], a[12:15]
ds_read_b64_tr_b16 a[58:59], v34 offset:10560
v_mfma_f32_16x16x32_bf16 a[28:31], a[76:79], v[176:179], a[28:31]
ds_read_b64_tr_b16 a[60:61], v35 offset:8448
ds_read_b64_tr_b16 a[62:63], v35 offset:10560
v_mfma_f32_16x16x32_bf16 a[32:35], a[80:83], a[224:227], 0
s_add_u32 m0, s49, 7392
s_add_u32 s48, s56, 159744
s_waitcnt lgkmcnt(4)
v_mfma_f32_16x16x32_bf16 a[36:39], a[84:87], a[224:227], 0
buffer_load_dwordx4 v2, s[12:15], s48 offen nt lds
ds_read_b64_tr_b16 a[64:65], v32 offset:12672
v_mfma_f32_16x16x32_bf16 a[0:3], a[48:51], v[52:55], a[0:3]
ds_read_b64_tr_b16 a[66:67], v32 offset:14784
v_mfma_f32_16x16x32_bf16 a[16:19], a[48:51], v[180:183], a[16:19]
ds_read_b64_tr_b16 a[68:69], v33 offset:12672
ds_read_b64_tr_b16 a[70:71], v33 offset:14784
v_mfma_f32_16x16x32_bf16 a[4:7], a[52:55], v[52:55], a[4:7]
ds_read_b64_tr_b16 a[72:73], v34 offset:12672
v_mfma_f32_16x16x32_bf16 a[20:23], a[52:55], v[180:183], a[20:23]
ds_read_b64_tr_b16 a[74:75], v34 offset:14784
ds_read_b64_tr_b16 a[76:77], v35 offset:12672
s_waitcnt lgkmcnt(6)
v_mfma_f32_16x16x32_bf16 a[8:11], a[56:59], v[52:55], a[8:11]
ds_read_b64_tr_b16 a[78:79], v35 offset:14784
v_mfma_f32_16x16x32_bf16 a[24:27], a[56:59], v[180:183], a[24:27]
ds_read_b64_tr_b16 a[80:81], v38
v_mfma_f32_16x16x32_bf16 a[12:15], a[60:63], v[52:55], a[12:15]
ds_read_b64_tr_b16 a[82:83], v38 offset:8448
s_add_u32 m0, s49, 33792
s_add_u32 s48, s56, 262144
v_mfma_f32_16x16x32_bf16 a[28:31], a[60:63], v[180:183], a[28:31]
buffer_load_dwordx4 v2, s[12:15], s48 offen nt lds
ds_read_b64_tr_b16 a[84:85], v39
s_waitcnt lgkmcnt(3)
v_mfma_f32_16x16x32_bf16 a[0:3], a[64:67], v[56:59], a[0:3]
ds_read_b64_tr_b16 a[86:87], v39 offset:8448
v_mfma_f32_16x16x32_bf16 a[16:19], a[64:67], v[184:187], a[16:19]
ds_read_b64_tr_b16 a[48:49], v32 offset:16896
ds_read_b64_tr_b16 a[50:51], v32 offset:19008
v_mfma_f32_16x16x32_bf16 a[4:7], a[68:71], v[56:59], a[4:7]
ds_read_b64_tr_b16 a[52:53], v33 offset:16896
v_mfma_f32_16x16x32_bf16 a[20:23], a[68:71], v[184:187], a[20:23]
ds_read_b64_tr_b16 a[54:55], v33 offset:19008
v_mfma_f32_16x16x32_bf16 a[8:11], a[72:75], v[56:59], a[8:11]
ds_read_b64_tr_b16 a[56:57], v34 offset:16896
ds_read_b64_tr_b16 a[58:59], v34 offset:19008
s_add_u32 m0, s49, 34848
v_mfma_f32_16x16x32_bf16 a[24:27], a[72:75], v[184:187], a[24:27]
s_add_u32 s48, s56, 266240
buffer_load_dwordx4 v2, s[12:15], s48 offen nt lds
v_mfma_f32_16x16x32_bf16 a[12:15], a[76:79], v[56:59], a[12:15]
ds_read_b64_tr_b16 a[60:61], v35 offset:16896
v_mfma_f32_16x16x32_bf16 a[28:31], a[76:79], v[184:187], a[28:31]
ds_read_b64_tr_b16 a[62:63], v35 offset:19008
ds_read_b64_tr_b16 a[64:65], v32 offset:21120
s_waitcnt lgkmcnt(3)
v_mfma_f32_16x16x32_bf16 a[40:43], a[80:83], a[224:227], 0
ds_read_b64_tr_b16 a[66:67], v32 offset:23232
v_mfma_f32_16x16x32_bf16 a[44:47], a[84:87], a[224:227], 0
ds_read_b64_tr_b16 a[68:69], v33 offset:21120
v_mfma_f32_16x16x32_bf16 a[0:3], a[48:51], v[60:63], a[0:3]
ds_read_b64_tr_b16 a[70:71], v33 offset:23232
ds_read_b64_tr_b16 a[72:73], v34 offset:21120
v_mfma_f32_16x16x32_bf16 a[16:19], a[48:51], v[188:191], a[16:19]
ds_read_b64_tr_b16 a[74:75], v34 offset:23232
v_mfma_f32_16x16x32_bf16 a[4:7], a[52:55], v[60:63], a[4:7]
ds_read_b64_tr_b16 a[76:77], v35 offset:21120
ds_read_b64_tr_b16 a[78:79], v35 offset:23232
v_mfma_f32_16x16x32_bf16 a[20:23], a[52:55], v[188:191], a[20:23]
s_add_u32 m0, s49, 35904
s_add_u32 s48, s56, 270336
buffer_load_dwordx4 v2, s[12:15], s48 offen nt lds
v_mfma_f32_16x16x32_bf16 a[8:11], a[56:59], v[60:63], a[8:11]
ds_read_b64_tr_b16 a[80:81], v36 offset:16896
v_mfma_f32_16x16x32_bf16 a[24:27], a[56:59], v[188:191], a[24:27]
ds_read_b64_tr_b16 a[82:83], v36 offset:25344
s_waitcnt lgkmcnt(3)
v_mfma_f32_16x16x32_bf16 a[12:15], a[60:63], v[60:63], a[12:15]
ds_read_b64_tr_b16 a[84:85], v37 offset:16896
ds_read_b64_tr_b16 a[86:87], v37 offset:25344
v_mfma_f32_16x16x32_bf16 a[28:31], a[60:63], v[188:191], a[28:31]
ds_read_b64_tr_b16 a[48:49], v32 offset:25344
v_mfma_f32_16x16x32_bf16 a[0:3], a[64:67], v[64:67], a[0:3]
ds_read_b64_tr_b16 a[50:51], v32 offset:27456
ds_read_b64_tr_b16 a[52:53], v33 offset:25344
v_mfma_f32_16x16x32_bf16 a[16:19], a[64:67], v[192:195], a[16:19]
ds_read_b64_tr_b16 a[54:55], v33 offset:27456
s_add_u32 m0, s49, 36960
v_mfma_f32_16x16x32_bf16 a[4:7], a[68:71], v[64:67], a[4:7]
s_add_u32 s48, s56, 274432
buffer_load_dwordx4 v2, s[12:15], s48 offen nt lds
v_mfma_f32_16x16x32_bf16 a[20:23], a[68:71], v[192:195], a[20:23]
ds_read_b64_tr_b16 a[56:57], v34 offset:25344
v_mfma_f32_16x16x32_bf16 a[8:11], a[72:75], v[64:67], a[8:11]
ds_read_b64_tr_b16 a[58:59], v34 offset:27456
ds_read_b64_tr_b16 a[60:61], v35 offset:25344
v_mfma_f32_16x16x32_bf16 a[24:27], a[72:75], v[192:195], a[24:27]
ds_read_b64_tr_b16 a[62:63], v35 offset:27456
s_waitcnt lgkmcnt(4)
v_mfma_f32_16x16x32_bf16 a[12:15], a[76:79], v[64:67], a[12:15]
ds_read_b64_tr_b16 a[64:65], v32 offset:29568
ds_read_b64_tr_b16 a[66:67], v32 offset:31680
v_mfma_f32_16x16x32_bf16 a[28:31], a[76:79], v[192:195], a[28:31]
ds_read_b64_tr_b16 a[68:69], v33 offset:29568
v_mfma_f32_16x16x32_bf16 a[32:35], a[80:83], a[228:231], a[32:35]
ds_read_b64_tr_b16 a[70:71], v33 offset:31680
v_mfma_f32_16x16x32_bf16 a[36:39], a[84:87], a[228:231], a[36:39]
ds_read_b64_tr_b16 a[72:73], v34 offset:29568
ds_read_b64_tr_b16 a[74:75], v34 offset:31680
s_add_u32 m0, s49, 38016
v_mfma_f32_16x16x32_bf16 a[0:3], a[48:51], v[68:71], a[0:3]
s_add_u32 s48, s56, 278528
buffer_load_dwordx4 v2, s[12:15], s48 offen nt lds
v_mfma_f32_16x16x32_bf16 a[16:19], a[48:51], v[196:199], a[16:19]
ds_read_b64_tr_b16 a[76:77], v35 offset:29568
v_mfma_f32_16x16x32_bf16 a[4:7], a[52:55], v[68:71], a[4:7]
ds_read_b64_tr_b16 a[78:79], v35 offset:31680
ds_read_b64_tr_b16 a[80:81], v38 offset:16896
v_mfma_f32_16x16x32_bf16 a[20:23], a[52:55], v[196:199], a[20:23]
ds_read_b64_tr_b16 a[82:83], v38 offset:25344
s_waitcnt lgkmcnt(4)
v_mfma_f32_16x16x32_bf16 a[8:11], a[56:59], v[68:71], a[8:11]
ds_read_b64_tr_b16 a[84:85], v39 offset:16896
v_mfma_f32_16x16x32_bf16 a[24:27], a[56:59], v[196:199], a[24:27]
ds_read_b64_tr_b16 a[86:87], v39 offset:25344
s_add_u32 m0, s49, 39072
s_add_u32 s48, s56, 282624
v_mfma_f32_16x16x32_bf16 a[12:15], a[60:63], v[68:71], a[12:15]
buffer_load_dwordx4 v2, s[12:15], s48 offen nt lds
v_subrev_u32 v32, 67584, v32
v_mfma_f32_16x16x32_bf16 a[28:31], a[60:63], v[196:199], a[28:31]
v_subrev_u32 v33, 67584, v33
v_mfma_f32_16x16x32_bf16 a[0:3], a[64:67], v[72:75], a[0:3]
v_subrev_u32 v34, 67584, v34
v_subrev_u32 v35, 67584, v35
v_mfma_f32_16x16x32_bf16 a[16:19], a[64:67], v[200:203], a[16:19]
v_subrev_u32 v36, 67584, v36
v_mfma_f32_16x16x32_bf16 a[4:7], a[68:71], v[72:75], a[4:7]
v_subrev_u32 v37, 67584, v37
v_mfma_f32_16x16x32_bf16 a[20:23], a[68:71], v[200:203], a[20:23]
v_subrev_u32 v38, 67584, v38
v_subrev_u32 v39, 67584, v39
L_stage24:
s_waitcnt vmcnt(6)
s_waitcnt lgkmcnt(0)
s_barrier
ds_read_b64_tr_b16 a[48:49], v32
v_mfma_f32_16x16x32_bf16 a[8:11], a[72:75], v[72:75], a[8:11]
ds_read_b64_tr_b16 a[50:51], v32 offset:2112
ds_read_b64_tr_b16 a[52:53], v33
v_mfma_f32_16x16x32_bf16 a[24:27], a[72:75], v[200:203], a[24:27]
ds_read_b64_tr_b16 a[54:55], v33 offset:2112
v_mfma_f32_16x16x32_bf16 a[12:15], a[76:79], v[72:75], a[12:15]
ds_read_b64_tr_b16 a[56:57], v34
v_mfma_f32_16x16x32_bf16 a[28:31], a[76:79], v[200:203], a[28:31]
ds_read_b64_tr_b16 a[58:59], v34 offset:2112
ds_read_b64_tr_b16 a[60:61], v35
v_mfma_f32_16x16x32_bf16 a[40:43], a[80:83], a[228:231], a[40:43]
ds_read_b64_tr_b16 a[62:63], v35 offset:2112
v_mfma_f32_16x16x32_bf16 a[44:47], a[84:87], a[228:231], a[44:47]
ds_read_b64_tr_b16 a[64:65], v32 offset:4224
s_waitcnt lgkmcnt(5)
v_mfma_f32_16x16x32_bf16 a[0:3], a[48:51], v[76:79], a[0:3]
ds_read_b64_tr_b16 a[66:67], v32 offset:6336
s_add_u32 m0, s49, 40128
s_add_u32 s48, s56, 286720
v_mfma_f32_16x16x32_bf16 a[16:19], a[48:51], v[204:207], a[16:19]
buffer_load_dwordx4 v2, s[12:15], s48 offen nt lds
ds_read_b64_tr_b16 a[68:69], v33 offset:4224
v_mfma_f32_16x16x32_bf16 a[4:7], a[52:55], v[76:79], a[4:7]
ds_read_b64_tr_b16 a[70:71], v33 offset:6336
v_mfma_f32_16x16x32_bf16 a[20:23], a[52:55], v[204:207], a[20:23]
ds_read_b64_tr_b16 a[72:73], v34 offset:4224
s_waitcnt lgkmcnt(3)
v_mfma_f32_16x16x32_bf16 a[8:11], a[56:59], v[76:79], a[8:11]
ds_read_b64_tr_b16 a[74:75], v34 offset:6336
ds_read_b64_tr_b16 a[76:77], v35 offset:4224
v_mfma_f32_16x16x32_bf16 a[24:27], a[56:59], v[204:207], a[24:27]
ds_read_b64_tr_b16 a[78:79], v35 offset:6336
v_mfma_f32_16x16x32_bf16 a[12:15], a[60:63], v[76:79], a[12:15]
ds_read_b64_tr_b16 a[80:81], v36
v_mfma_f32_16x16x32_bf16 a[28:31], a[60:63], v[204:207], a[28:31]
ds_read_b64_tr_b16 a[82:83], v36 offset:8448
ds_read_b64_tr_b16 a[84:85], v37
v_mfma_f32_16x16x32_bf16 a[0:3], a[64:67], v[80:83], a[0:3]
ds_read_b64_tr_b16 a[86:87], v37 offset:8448
v_mfma_f32_16x16x32_bf16 a[16:19], a[64:67], v[208:211], a[16:19]
ds_read_b64_tr_b16 a[48:49], v32 offset:8448
ds_read_b64_tr_b16 a[50:51], v32 offset:10560
s_waitcnt lgkmcnt(6)
v_mfma_f32_16x16x32_bf16 a[4:7], a[68:71], v[80:83], a[4:7]
s_add_u32 m0, s49, 41184
s_add_u32 s48, s56, 290816
v_mfma_f32_16x16x32_bf16 a[20:23], a[68:71], v[208:211], a[20:23]
buffer_load_dwordx4 v2, s[12:15], s48 offen nt lds
ds_read_b64_tr_b16 a[52:53], v33 offset:8448
v_mfma_f32_16x16x32_bf16 a[8:11], a[72:75], v[80:83], a[8:11]
ds_read_b64_tr_b16 a[54:55], v33 offset:10560
v_mfma_f32_16x16x32_bf16 a[24:27], a[72:75], v[208:211], a[24:27]
ds_read_b64_tr_b16 a[56:57], v34 offset:8448
ds_read_b64_tr_b16 a[58:59], v34 offset:10560
v_mfma_f32_16x16x32_bf16 a[12:15], a[76:79], v[80:83], a[12:15]
ds_read_b64_tr_b16 a[60:61], v35 offset:8448
v_mfma_f32_16x16x32_bf16 a[28:31], a[76:79], v[208:211], a[28:31]
ds_read_b64_tr_b16 a[62:63], v35 offset:10560
s_waitcnt lgkmcnt(5)
v_mfma_f32_16x16x32_bf16 a[32:35], a[80:83], a[232:235], a[32:35]
ds_read_b64_tr_b16 a[64:65], v32 offset:12672
ds_read_b64_tr_b16 a[66:67], v32 offset:14784
v_mfma_f32_16x16x32_bf16 a[36:39], a[84:87], a[232:235], a[36:39]
s_add_u32 m0, s49, 67584
s_add_u32 s48, s56, 393216
buffer_load_dwordx4 v2, s[12:15], s48 offen nt lds
v_mfma_f32_16x16x32_bf16 a[0:3], a[48:51], v[84:87], a[0:3]
ds_read_b64_tr_b16 a[68:69], v33 offset:12672
v_mfma_f32_16x16x32_bf16 a[16:19], a[48:51], v[212:215], a[16:19]
ds_read_b64_tr_b16 a[70:71], v33 offset:14784
s_waitcnt lgkmcnt(3)
v_mfma_f32_16x16x32_bf16 a[4:7], a[52:55], v[84:87], a[4:7]
ds_read_b64_tr_b16 a[72:73], v34 offset:12672
ds_read_b64_tr_b16 a[74:75], v34 offset:14784
v_mfma_f32_16x16x32_bf16 a[20:23], a[52:55], v[212:215], a[20:23]
ds_read_b64_tr_b16 a[76:77], v35 offset:12672
v_mfma_f32_16x16x32_bf16 a[8:11], a[56:59], v[84:87], a[8:11]
ds_read_b64_tr_b16 a[78:79], v35 offset:14784
v_mfma_f32_16x16x32_bf16 a[24:27], a[56:59], v[212:215], a[24:27]
ds_read_b64_tr_b16 a[80:81], v38
ds_read_b64_tr_b16 a[82:83], v38 offset:8448
v_mfma_f32_16x16x32_bf16 a[12:15], a[60:63], v[84:87], a[12:15]
ds_read_b64_tr_b16 a[84:85], v39
v_mfma_f32_16x16x32_bf16 a[28:31], a[60:63], v[212:215], a[28:31]
ds_read_b64_tr_b16 a[86:87], v39 offset:8448
s_add_u32 m0, s49, 68640
s_add_u32 s48, s56, 397312
s_waitcnt lgkmcnt(4)
v_mfma_f32_16x16x32_bf16 a[0:3], a[64:67], v[88:91], a[0:3]
buffer_load_dwordx4 v2, s[12:15], s48 offen nt lds
v_mfma_f32_16x16x32_bf16 a[16:19], a[64:67], v[216:219], a[16:19]
ds_read_b64_tr_b16 a[48:49], v32 offset:16896
ds_read_b64_tr_b16 a[50:51], v32 offset:19008
v_mfma_f32_16x16x32_bf16 a[4:7], a[68:71], v[88:91], a[4:7]
ds_read_b64_tr_b16 a[52:53], v33 offset:16896
v_mfma_f32_16x16x32_bf16 a[20:23], a[68:71], v[216:219], a[20:23]
ds_read_b64_tr_b16 a[54:55], v33 offset:19008
v_mfma_f32_16x16x32_bf16 a[8:11], a[72:75], v[88:91], a[8:11]
ds_read_b64_tr_b16 a[56:57], v34 offset:16896
ds_read_b64_tr_b16 a[58:59], v34 offset:19008
v_mfma_f32_16x16x32_bf16 a[24:27], a[72:75], v[216:219], a[24:27]
ds_read_b64_tr_b16 a[60:61], v35 offset:16896
v_mfma_f32_16x16x32_bf16 a[12:15], a[76:79], v[88:91], a[12:15]
ds_read_b64_tr_b16 a[62:63], v35 offset:19008
s_add_u32 m0, s49, 69696
s_add_u32 s48, s56, 401408
v_mfma_f32_16x16x32_bf16 a[28:31], a[76:79], v[216:219], a[28:31]
buffer_load_dwordx4 v2, s[12:15], s48 offen nt lds
s_waitcnt lgkmcnt(3)
v_mfma_f32_16x16x32_bf16 a[40:43], a[80:83], a[232:235], a[40:43]
ds_read_b64_tr_b16 a[64:65], v32 offset:21120
ds_read_b64_tr_b16 a[66:67], v32 offset:23232
v_mfma_f32_16x16x32_bf16 a[44:47], a[84:87], a[232:235], a[44:47]
ds_read_b64_tr_b16 a[68:69], v33 offset:21120
v_mfma_f32_16x16x32_bf16 a[0:3], a[48:51], v[92:95], a[0:3]
ds_read_b64_tr_b16 a[70:71], v33 offset:23232
ds_read_b64_tr_b16 a[72:73], v34 offset:21120
v_mfma_f32_16x16x32_bf16 a[16:19], a[48:51], v[220:223], a[16:19]
ds_read_b64_tr_b16 a[74:75], v34 offset:23232
v_mfma_f32_16x16x32_bf16 a[4:7], a[52:55], v[92:95], a[4:7]
ds_read_b64_tr_b16 a[76:77], v35 offset:21120
v_mfma_f32_16x16x32_bf16 a[20:23], a[52:55], v[220:223], a[20:23]
ds_read_b64_tr_b16 a[78:79], v35 offset:23232
ds_read_b64_tr_b16 a[80:81], v36 offset:16896
s_waitcnt lgkmcnt(6)
v_mfma_f32_16x16x32_bf16 a[8:11], a[56:59], v[92:95], a[8:11]
ds_read_b64_tr_b16 a[82:83], v36 offset:25344
s_add_u32 m0, s49, 70752
s_add_u32 s48, s56, 405504
v_mfma_f32_16x16x32_bf16 a[24:27], a[56:59], v[220:223], a[24:27]
buffer_load_dwordx4 v2, s[12:15], s48 offen nt lds
v_mfma_f32_16x16x32_bf16 a[12:15], a[60:63], v[92:95], a[12:15]
ds_read_b64_tr_b16 a[84:85], v37 offset:16896
v_mfma_f32_16x16x32_bf16 a[28:31], a[60:63], v[220:223], a[28:31]
ds_read_b64_tr_b16 a[86:87], v37 offset:25344
ds_read_b64_tr_b16 a[48:49], v32 offset:25344
v_mfma_f32_16x16x32_bf16 a[0:3], a[64:67], v[96:99], a[0:3]
ds_read_b64_tr_b16 a[50:51], v32 offset:27456
v_mfma_f32_16x16x32_bf16 a[16:19], a[64:67], v[224:227], a[16:19]
ds_read_b64_tr_b16 a[52:53], v33 offset:25344
s_waitcnt lgkmcnt(5)
v_mfma_f32_16x16x32_bf16 a[4:7], a[68:71], v[96:99], a[4:7]
ds_read_b64_tr_b16 a[54:55], v33 offset:27456
ds_read_b64_tr_b16 a[56:57], v34 offset:25344
v_mfma_f32_16x16x32_bf16 a[20:23], a[68:71], v[224:227], a[20:23]
ds_read_b64_tr_b16 a[58:59], v34 offset:27456
v_mfma_f32_16x16x32_bf16 a[8:11], a[72:75], v[96:99], a[8:11]
ds_read_b64_tr_b16 a[60:61], v35 offset:25344
ds_read_b64_tr_b16 a[62:63], v35 offset:27456
v_mfma_f32_16x16x32_bf16 a[24:27], a[72:75], v[224:227], a[24:27]
s_add_u32 m0, s49, 71808
s_add_u32 s48, s56, 409600
v_mfma_f32_16x16x32_bf16 a[12:15], a[76:79], v[96:99], a[12:15]
buffer_load_dwordx4 v2, s[12:15], s48 offen nt lds
ds_read_b64_tr_b16 a[64:65], v32 offset:29568
v_mfma_f32_16x16x32_bf16 a[28:31], a[76:79], v[224:227], a[28:31]
ds_read_b64_tr_b16 a[66:67], v32 offset:31680
v_mfma_f32_16x16x32_bf16 a[32:35], a[80:83], a[236:239], a[32:35]
ds_read_b64_tr_b16 a[68:69], v33 offset:29568
s_waitcnt lgkmcnt(3)
v_mfma_f32_16x16x32_bf16 a[36:39], a[84:87], a[236:239], a[36:39]
ds_read_b64_tr_b16 a[70:71], v33 offset:31680
ds_read_b64_tr_b16 a[72:73], v34 offset:29568
v_mfma_f32_16x16x32_bf16 a[0:3], a[48:51], v[100:103], a[0:3]
ds_read_b64_tr_b16 a[74:75], v34 offset:31680
v_mfma_f32_16x16x32_bf16 a[16:19], a[48:51], v[228:231], a[16:19]
ds_read_b64_tr_b16 a[76:77], v35 offset:29568
ds_read_b64_tr_b16 a[78:79], v35 offset:31680
v_mfma_f32_16x16x32_bf16 a[4:7], a[52:55], v[100:103], a[4:7]
ds_read_b64_tr_b16 a[80:81], v38 offset:16896
v_mfma_f32_16x16x32_bf16 a[20:23], a[52:55], v[228:231], a[20:23]
ds_read_b64_tr_b16 a[82:83], v38 offset:25344
s_add_u32 m0, s49, 72864
s_add_u32 s48, s56, 413696
v_mfma_f32_16x16x32_bf16 a[8:11], a[56:59], v[100:103], a[8:11]
buffer_load_dwordx4 v2, s[12:15], s48 offen nt lds
v_mfma_f32_16x16x32_bf16 a[24:27], a[56:59], v[228:231], a[24:27]
ds_read_b64_tr_b16 a[84:85], v39 offset:16896
ds_read_b64_tr_b16 a[86:87], v39 offset:25344
v_mfma_f32_16x16x32_bf16 a[12:15], a[60:63], v[100:103], a[12:15]
v_add_u32 v32, 33792, v32
v_mfma_f32_16x16x32_bf16 a[28:31], a[60:63], v[228:231], a[28:31]
v_add_u32 v33, 33792, v33
s_waitcnt lgkmcnt(2)
v_mfma_f32_16x16x32_bf16 a[0:3], a[64:67], v[104:107], a[0:3]
v_add_u32 v34, 33792, v34
v_add_u32 v35, 33792, v35
v_mfma_f32_16x16x32_bf16 a[16:19], a[64:67], v[232:235], a[16:19]
v_add_u32 v36, 33792, v36
v_mfma_f32_16x16x32_bf16 a[4:7], a[68:71], v[104:107], a[4:7]
v_add_u32 v37, 33792, v37
v_mfma_f32_16x16x32_bf16 a[20:23], a[68:71], v[232:235], a[20:23]
v_add_u32 v38, 33792, v38
v_add_u32 v39, 33792, v39
L_stage25:
s_waitcnt vmcnt(6)
s_waitcnt lgkmcnt(0)
s_barrier
ds_read_b64_tr_b16 a[48:49], v32
v_mfma_f32_16x16x32_bf16 a[8:11], a[72:75], v[104:107], a[8:11]
ds_read_b64_tr_b16 a[50:51], v32 offset:2112
ds_read_b64_tr_b16 a[52:53], v33
v_mfma_f32_16x16x32_bf16 a[24:27], a[72:75], v[232:235], a[24:27]
ds_read_b64_tr_b16 a[54:55], v33 offset:2112
v_mfma_f32_16x16x32_bf16 a[12:15], a[76:79], v[104:107], a[12:15]
ds_read_b64_tr_b16 a[56:57], v34
v_mfma_f32_16x16x32_bf16 a[28:31], a[76:79], v[232:235], a[28:31]
ds_read_b64_tr_b16 a[58:59], v34 offset:2112
ds_read_b64_tr_b16 a[60:61], v35
v_mfma_f32_16x16x32_bf16 a[40:43], a[80:83], a[236:239], a[40:43]
ds_read_b64_tr_b16 a[62:63], v35 offset:2112
v_mfma_f32_16x16x32_bf16 a[44:47], a[84:87], a[236:239], a[44:47]
ds_read_b64_tr_b16 a[64:65], v32 offset:4224
s_waitcnt lgkmcnt(5)
v_mfma_f32_16x16x32_bf16 a[0:3], a[48:51], v[108:111], a[0:3]
ds_read_b64_tr_b16 a[66:67], v32 offset:6336
s_add_u32 m0, s49, 73920
s_add_u32 s48, s56, 417792
v_mfma_f32_16x16x32_bf16 a[16:19], a[48:51], v[236:239], a[16:19]
buffer_load_dwordx4 v2, s[12:15], s48 offen nt lds
ds_read_b64_tr_b16 a[68:69], v33 offset:4224
v_mfma_f32_16x16x32_bf16 a[4:7], a[52:55], v[108:111], a[4:7]
ds_read_b64_tr_b16 a[70:71], v33 offset:6336
v_mfma_f32_16x16x32_bf16 a[20:23], a[52:55], v[236:239], a[20:23]
ds_read_b64_tr_b16 a[72:73], v34 offset:4224
s_waitcnt lgkmcnt(3)
v_mfma_f32_16x16x32_bf16 a[8:11], a[56:59], v[108:111], a[8:11]
ds_read_b64_tr_b16 a[74:75], v34 offset:6336
ds_read_b64_tr_b16 a[76:77], v35 offset:4224
v_mfma_f32_16x16x32_bf16 a[24:27], a[56:59], v[236:239], a[24:27]
ds_read_b64_tr_b16 a[78:79], v35 offset:6336
v_mfma_f32_16x16x32_bf16 a[12:15], a[60:63], v[108:111], a[12:15]
ds_read_b64_tr_b16 a[80:81], v36
v_mfma_f32_16x16x32_bf16 a[28:31], a[60:63], v[236:239], a[28:31]
ds_read_b64_tr_b16 a[82:83], v36 offset:8448
ds_read_b64_tr_b16 a[84:85], v37
v_mfma_f32_16x16x32_bf16 a[0:3], a[64:67], v[112:115], a[0:3]
ds_read_b64_tr_b16 a[86:87], v37 offset:8448
v_mfma_f32_16x16x32_bf16 a[16:19], a[64:67], v[240:243], a[16:19]
ds_read_b64_tr_b16 a[48:49], v32 offset:8448
ds_read_b64_tr_b16 a[50:51], v32 offset:10560
s_waitcnt lgkmcnt(6)
v_mfma_f32_16x16x32_bf16 a[4:7], a[68:71], v[112:115], a[4:7]
s_add_u32 m0, s49, 74976
s_add_u32 s48, s56, 421888
v_mfma_f32_16x16x32_bf16 a[20:23], a[68:71], v[240:243], a[20:23]
buffer_load_dwordx4 v2, s[12:15], s48 offen nt lds
ds_read_b64_tr_b16 a[52:53], v33 offset:8448
v_mfma_f32_16x16x32_bf16 a[8:11], a[72:75], v[112:115], a[8:11]
ds_read_b64_tr_b16 a[54:55], v33 offset:10560
v_mfma_f32_16x16x32_bf16 a[24:27], a[72:75], v[240:243], a[24:27]
ds_read_b64_tr_b16 a[56:57], v34 offset:8448
ds_read_b64_tr_b16 a[58:59], v34 offset:10560
v_mfma_f32_16x16x32_bf16 a[12:15], a[76:79], v[112:115], a[12:15]
ds_read_b64_tr_b16 a[60:61], v35 offset:8448
v_mfma_f32_16x16x32_bf16 a[28:31], a[76:79], v[240:243], a[28:31]
ds_read_b64_tr_b16 a[62:63], v35 offset:10560
s_waitcnt lgkmcnt(5)
v_mfma_f32_16x16x32_bf16 a[32:35], a[80:83], a[240:243], a[32:35]
ds_read_b64_tr_b16 a[64:65], v32 offset:12672
ds_read_b64_tr_b16 a[66:67], v32 offset:14784
v_mfma_f32_16x16x32_bf16 a[36:39], a[84:87], a[240:243], a[36:39]
s_add_u32 m0, s49, 0
s_add_u32 s48, s56, 128
buffer_load_dwordx4 v2, s[12:15], s48 offen nt lds
v_mfma_f32_16x16x32_bf16 a[0:3], a[48:51], v[116:119], a[0:3]
ds_read_b64_tr_b16 a[68:69], v33 offset:12672
v_mfma_f32_16x16x32_bf16 a[16:19], a[48:51], v[244:247], a[16:19]
ds_read_b64_tr_b16 a[70:71], v33 offset:14784
s_waitcnt lgkmcnt(3)
v_mfma_f32_16x16x32_bf16 a[4:7], a[52:55], v[116:119], a[4:7]
ds_read_b64_tr_b16 a[72:73], v34 offset:12672
ds_read_b64_tr_b16 a[74:75], v34 offset:14784
v_mfma_f32_16x16x32_bf16 a[20:23], a[52:55], v[244:247], a[20:23]
ds_read_b64_tr_b16 a[76:77], v35 offset:12672
v_mfma_f32_16x16x32_bf16 a[8:11], a[56:59], v[116:119], a[8:11]
ds_read_b64_tr_b16 a[78:79], v35 offset:14784
v_mfma_f32_16x16x32_bf16 a[24:27], a[56:59], v[244:247], a[24:27]
ds_read_b64_tr_b16 a[80:81], v38
ds_read_b64_tr_b16 a[82:83], v38 offset:8448
v_mfma_f32_16x16x32_bf16 a[12:15], a[60:63], v[116:119], a[12:15]
ds_read_b64_tr_b16 a[84:85], v39
v_mfma_f32_16x16x32_bf16 a[28:31], a[60:63], v[244:247], a[28:31]
ds_read_b64_tr_b16 a[86:87], v39 offset:8448
s_add_u32 m0, s49, 1056
s_add_u32 s48, s56, 4224
s_waitcnt lgkmcnt(4)
v_mfma_f32_16x16x32_bf16 a[0:3], a[64:67], v[120:123], a[0:3]
buffer_load_dwordx4 v2, s[12:15], s48 offen nt lds
v_mfma_f32_16x16x32_bf16 a[16:19], a[64:67], v[248:251], a[16:19]
ds_read_b64_tr_b16 a[48:49], v32 offset:16896
ds_read_b64_tr_b16 a[50:51], v32 offset:19008
v_mfma_f32_16x16x32_bf16 a[4:7], a[68:71], v[120:123], a[4:7]
ds_read_b64_tr_b16 a[52:53], v33 offset:16896
v_mfma_f32_16x16x32_bf16 a[20:23], a[68:71], v[248:251], a[20:23]
ds_read_b64_tr_b16 a[54:55], v33 offset:19008
v_mfma_f32_16x16x32_bf16 a[8:11], a[72:75], v[120:123], a[8:11]
ds_read_b64_tr_b16 a[56:57], v34 offset:16896
ds_read_b64_tr_b16 a[58:59], v34 offset:19008
v_mfma_f32_16x16x32_bf16 a[24:27], a[72:75], v[248:251], a[24:27]
ds_read_b64_tr_b16 a[60:61], v35 offset:16896
v_mfma_f32_16x16x32_bf16 a[12:15], a[76:79], v[120:123], a[12:15]
ds_read_b64_tr_b16 a[62:63], v35 offset:19008
s_add_u32 m0, s49, 2112
s_add_u32 s48, s56, 8320
v_mfma_f32_16x16x32_bf16 a[28:31], a[76:79], v[248:251], a[28:31]
buffer_load_dwordx4 v2, s[12:15], s48 offen nt lds
s_waitcnt lgkmcnt(3)
v_mfma_f32_16x16x32_bf16 a[40:43], a[80:83], a[240:243], a[40:43]
ds_read_b64_tr_b16 a[64:65], v32 offset:21120
ds_read_b64_tr_b16 a[66:67], v32 offset:23232
v_mfma_f32_16x16x32_bf16 a[44:47], a[84:87], a[240:243], a[44:47]
ds_read_b64_tr_b16 a[68:69], v33 offset:21120
v_mfma_f32_16x16x32_bf16 a[0:3], a[48:51], v[124:127], a[0:3]
ds_read_b64_tr_b16 a[70:71], v33 offset:23232
ds_read_b64_tr_b16 a[72:73], v34 offset:21120
v_mfma_f32_16x16x32_bf16 a[16:19], a[48:51], v[252:255], a[16:19]
ds_read_b64_tr_b16 a[74:75], v34 offset:23232
v_mfma_f32_16x16x32_bf16 a[4:7], a[52:55], v[124:127], a[4:7]
ds_read_b64_tr_b16 a[76:77], v35 offset:21120
v_mfma_f32_16x16x32_bf16 a[20:23], a[52:55], v[252:255], a[20:23]
ds_read_b64_tr_b16 a[78:79], v35 offset:23232
ds_read_b64_tr_b16 a[80:81], v36 offset:16896
s_waitcnt lgkmcnt(6)
v_mfma_f32_16x16x32_bf16 a[8:11], a[56:59], v[124:127], a[8:11]
ds_read_b64_tr_b16 a[82:83], v36 offset:25344
s_add_u32 m0, s49, 3168
s_add_u32 s48, s56, 12416
v_mfma_f32_16x16x32_bf16 a[24:27], a[56:59], v[252:255], a[24:27]
buffer_load_dwordx4 v2, s[12:15], s48 offen nt lds
v_mfma_f32_16x16x32_bf16 a[12:15], a[60:63], v[124:127], a[12:15]
ds_read_b64_tr_b16 a[84:85], v37 offset:16896
v_mfma_f32_16x16x32_bf16 a[28:31], a[60:63], v[252:255], a[28:31]
ds_read_b64_tr_b16 a[86:87], v37 offset:25344
ds_read_b64_tr_b16 a[48:49], v32 offset:25344
v_mfma_f32_16x16x32_bf16 a[0:3], a[64:67], v[128:131], a[0:3]
ds_read_b64_tr_b16 a[50:51], v32 offset:27456
v_mfma_f32_16x16x32_bf16 a[16:19], a[64:67], a[180:183], a[16:19]
ds_read_b64_tr_b16 a[52:53], v33 offset:25344
s_waitcnt lgkmcnt(5)
v_mfma_f32_16x16x32_bf16 a[4:7], a[68:71], v[128:131], a[4:7]
ds_read_b64_tr_b16 a[54:55], v33 offset:27456
ds_read_b64_tr_b16 a[56:57], v34 offset:25344
v_mfma_f32_16x16x32_bf16 a[20:23], a[68:71], a[180:183], a[20:23]
ds_read_b64_tr_b16 a[58:59], v34 offset:27456
v_mfma_f32_16x16x32_bf16 a[8:11], a[72:75], v[128:131], a[8:11]
ds_read_b64_tr_b16 a[60:61], v35 offset:25344
ds_read_b64_tr_b16 a[62:63], v35 offset:27456
v_mfma_f32_16x16x32_bf16 a[24:27], a[72:75], a[180:183], a[24:27]
s_add_u32 m0, s49, 4224
s_add_u32 s48, s56, 16512
v_mfma_f32_16x16x32_bf16 a[12:15], a[76:79], v[128:131], a[12:15]
buffer_load_dwordx4 v2, s[12:15], s48 offen nt lds
ds_read_b64_tr_b16 a[64:65], v32 offset:29568
v_mfma_f32_16x16x32_bf16 a[28:31], a[76:79], a[180:183], a[28:31]
ds_read_b64_tr_b16 a[66:67], v32 offset:31680
v_mfma_f32_16x16x32_bf16 a[32:35], a[80:83], a[244:247], a[32:35]
ds_read_b64_tr_b16 a[68:69], v33 offset:29568
s_waitcnt lgkmcnt(3)
v_mfma_f32_16x16x32_bf16 a[36:39], a[84:87], a[244:247], a[36:39]
ds_read_b64_tr_b16 a[70:71], v33 offset:31680
ds_read_b64_tr_b16 a[72:73], v34 offset:29568
v_mfma_f32_16x16x32_bf16 a[0:3], a[48:51], v[132:135], a[0:3]
ds_read_b64_tr_b16 a[74:75], v34 offset:31680
v_mfma_f32_16x16x32_bf16 a[16:19], a[48:51], a[184:187], a[16:19]
ds_read_b64_tr_b16 a[76:77], v35 offset:29568
ds_read_b64_tr_b16 a[78:79], v35 offset:31680
v_mfma_f32_16x16x32_bf16 a[4:7], a[52:55], v[132:135], a[4:7]
ds_read_b64_tr_b16 a[80:81], v38 offset:16896
v_mfma_f32_16x16x32_bf16 a[20:23], a[52:55], a[184:187], a[20:23]
ds_read_b64_tr_b16 a[82:83], v38 offset:25344
s_add_u32 m0, s49, 5280
s_add_u32 s48, s56, 20608
v_mfma_f32_16x16x32_bf16 a[8:11], a[56:59], v[132:135], a[8:11]
buffer_load_dwordx4 v2, s[12:15], s48 offen nt lds
v_mfma_f32_16x16x32_bf16 a[24:27], a[56:59], a[184:187], a[24:27]
ds_read_b64_tr_b16 a[84:85], v39 offset:16896
ds_read_b64_tr_b16 a[86:87], v39 offset:25344
v_mfma_f32_16x16x32_bf16 a[12:15], a[60:63], v[132:135], a[12:15]
v_add_u32 v32, 33792, v32
v_mfma_f32_16x16x32_bf16 a[28:31], a[60:63], a[184:187], a[28:31]
v_add_u32 v33, 33792, v33
s_waitcnt lgkmcnt(2)
v_mfma_f32_16x16x32_bf16 a[0:3], a[64:67], v[136:139], a[0:3]
v_add_u32 v34, 33792, v34
v_add_u32 v35, 33792, v35
v_mfma_f32_16x16x32_bf16 a[16:19], a[64:67], a[188:191], a[16:19]
v_add_u32 v36, 33792, v36
v_mfma_f32_16x16x32_bf16 a[4:7], a[68:71], v[136:139], a[4:7]
v_add_u32 v37, 33792, v37
v_mfma_f32_16x16x32_bf16 a[20:23], a[68:71], a[188:191], a[20:23]
v_add_u32 v38, 33792, v38
v_add_u32 v39, 33792, v39
L_stage26:
s_waitcnt vmcnt(6)
s_waitcnt lgkmcnt(0)
s_barrier
ds_read_b64_tr_b16 a[48:49], v32
v_mfma_f32_16x16x32_bf16 a[8:11], a[72:75], v[136:139], a[8:11]
ds_read_b64_tr_b16 a[50:51], v32 offset:2112
ds_read_b64_tr_b16 a[52:53], v33
v_mfma_f32_16x16x32_bf16 a[24:27], a[72:75], a[188:191], a[24:27]
ds_read_b64_tr_b16 a[54:55], v33 offset:2112
v_mfma_f32_16x16x32_bf16 a[12:15], a[76:79], v[136:139], a[12:15]
ds_read_b64_tr_b16 a[56:57], v34
v_mfma_f32_16x16x32_bf16 a[28:31], a[76:79], a[188:191], a[28:31]
ds_read_b64_tr_b16 a[58:59], v34 offset:2112
ds_read_b64_tr_b16 a[60:61], v35
v_mfma_f32_16x16x32_bf16 a[40:43], a[80:83], a[244:247], a[40:43]
ds_read_b64_tr_b16 a[62:63], v35 offset:2112
v_mfma_f32_16x16x32_bf16 a[44:47], a[84:87], a[244:247], a[44:47]
ds_read_b64_tr_b16 a[64:65], v32 offset:4224
s_waitcnt lgkmcnt(5)
v_mfma_f32_16x16x32_bf16 a[0:3], a[48:51], v[140:143], a[0:3]
ds_read_b64_tr_b16 a[66:67], v32 offset:6336
s_add_u32 m0, s49, 6336
s_add_u32 s48, s56, 24704
v_mfma_f32_16x16x32_bf16 a[16:19], a[48:51], a[192:195], a[16:19]
buffer_load_dwordx4 v2, s[12:15], s48 offen nt lds
ds_read_b64_tr_b16 a[68:69], v33 offset:4224
v_mfma_f32_16x16x32_bf16 a[4:7], a[52:55], v[140:143], a[4:7]
ds_read_b64_tr_b16 a[70:71], v33 offset:6336
v_mfma_f32_16x16x32_bf16 a[20:23], a[52:55], a[192:195], a[20:23]
ds_read_b64_tr_b16 a[72:73], v34 offset:4224
s_waitcnt lgkmcnt(3)
v_mfma_f32_16x16x32_bf16 a[8:11], a[56:59], v[140:143], a[8:11]
ds_read_b64_tr_b16 a[74:75], v34 offset:6336
ds_read_b64_tr_b16 a[76:77], v35 offset:4224
v_mfma_f32_16x16x32_bf16 a[24:27], a[56:59], a[192:195], a[24:27]
ds_read_b64_tr_b16 a[78:79], v35 offset:6336
v_mfma_f32_16x16x32_bf16 a[12:15], a[60:63], v[140:143], a[12:15]
ds_read_b64_tr_b16 a[80:81], v36
v_mfma_f32_16x16x32_bf16 a[28:31], a[60:63], a[192:195], a[28:31]
ds_read_b64_tr_b16 a[82:83], v36 offset:8448
ds_read_b64_tr_b16 a[84:85], v37
v_mfma_f32_16x16x32_bf16 a[0:3], a[64:67], v[144:147], a[0:3]
ds_read_b64_tr_b16 a[86:87], v37 offset:8448
v_mfma_f32_16x16x32_bf16 a[16:19], a[64:67], a[196:199], a[16:19]
ds_read_b64_tr_b16 a[48:49], v32 offset:8448
ds_read_b64_tr_b16 a[50:51], v32 offset:10560
s_waitcnt lgkmcnt(6)
v_mfma_f32_16x16x32_bf16 a[4:7], a[68:71], v[144:147], a[4:7]
s_add_u32 m0, s49, 7392
s_add_u32 s48, s56, 28800
v_mfma_f32_16x16x32_bf16 a[20:23], a[68:71], a[196:199], a[20:23]
buffer_load_dwordx4 v2, s[12:15], s48 offen nt lds
ds_read_b64_tr_b16 a[52:53], v33 offset:8448
v_mfma_f32_16x16x32_bf16 a[8:11], a[72:75], v[144:147], a[8:11]
ds_read_b64_tr_b16 a[54:55], v33 offset:10560
v_mfma_f32_16x16x32_bf16 a[24:27], a[72:75], a[196:199], a[24:27]
ds_read_b64_tr_b16 a[56:57], v34 offset:8448
ds_read_b64_tr_b16 a[58:59], v34 offset:10560
v_mfma_f32_16x16x32_bf16 a[12:15], a[76:79], v[144:147], a[12:15]
ds_read_b64_tr_b16 a[60:61], v35 offset:8448
v_mfma_f32_16x16x32_bf16 a[28:31], a[76:79], a[196:199], a[28:31]
ds_read_b64_tr_b16 a[62:63], v35 offset:10560
s_waitcnt lgkmcnt(5)
v_mfma_f32_16x16x32_bf16 a[32:35], a[80:83], a[248:251], a[32:35]
ds_read_b64_tr_b16 a[64:65], v32 offset:12672
ds_read_b64_tr_b16 a[66:67], v32 offset:14784
v_mfma_f32_16x16x32_bf16 a[36:39], a[84:87], a[248:251], a[36:39]
s_add_u32 m0, s49, 33792
s_add_u32 s48, s56, 131200
buffer_load_dwordx4 v2, s[12:15], s48 offen nt lds
v_mfma_f32_16x16x32_bf16 a[0:3], a[48:51], v[148:151], a[0:3]
ds_read_b64_tr_b16 a[68:69], v33 offset:12672
v_mfma_f32_16x16x32_bf16 a[16:19], a[48:51], a[200:203], a[16:19]
ds_read_b64_tr_b16 a[70:71], v33 offset:14784
s_waitcnt lgkmcnt(3)
v_mfma_f32_16x16x32_bf16 a[4:7], a[52:55], v[148:151], a[4:7]
ds_read_b64_tr_b16 a[72:73], v34 offset:12672
ds_read_b64_tr_b16 a[74:75], v34 offset:14784
v_mfma_f32_16x16x32_bf16 a[20:23], a[52:55], a[200:203], a[20:23]
ds_read_b64_tr_b16 a[76:77], v35 offset:12672
v_mfma_f32_16x16x32_bf16 a[8:11], a[56:59], v[148:151], a[8:11]
ds_read_b64_tr_b16 a[78:79], v35 offset:14784
v_mfma_f32_16x16x32_bf16 a[24:27], a[56:59], a[200:203], a[24:27]
ds_read_b64_tr_b16 a[80:81], v38
ds_read_b64_tr_b16 a[82:83], v38 offset:8448
v_mfma_f32_16x16x32_bf16 a[12:15], a[60:63], v[148:151], a[12:15]
ds_read_b64_tr_b16 a[84:85], v39
v_mfma_f32_16x16x32_bf16 a[28:31], a[60:63], a[200:203], a[28:31]
ds_read_b64_tr_b16 a[86:87], v39 offset:8448
s_add_u32 m0, s49, 34848
s_add_u32 s48, s56, 135296
s_waitcnt lgkmcnt(4)
v_mfma_f32_16x16x32_bf16 a[0:3], a[64:67], v[152:155], a[0:3]
buffer_load_dwordx4 v2, s[12:15], s48 offen nt lds
v_mfma_f32_16x16x32_bf16 a[16:19], a[64:67], a[204:207], a[16:19]
ds_read_b64_tr_b16 a[48:49], v32 offset:16896
ds_read_b64_tr_b16 a[50:51], v32 offset:19008
v_mfma_f32_16x16x32_bf16 a[4:7], a[68:71], v[152:155], a[4:7]
ds_read_b64_tr_b16 a[52:53], v33 offset:16896
v_mfma_f32_16x16x32_bf16 a[20:23], a[68:71], a[204:207], a[20:23]
ds_read_b64_tr_b16 a[54:55], v33 offset:19008
v_mfma_f32_16x16x32_bf16 a[8:11], a[72:75], v[152:155], a[8:11]
ds_read_b64_tr_b16 a[56:57], v34 offset:16896
ds_read_b64_tr_b16 a[58:59], v34 offset:19008
v_mfma_f32_16x16x32_bf16 a[24:27], a[72:75], a[204:207], a[24:27]
ds_read_b64_tr_b16 a[60:61], v35 offset:16896
v_mfma_f32_16x16x32_bf16 a[12:15], a[76:79], v[152:155], a[12:15]
ds_read_b64_tr_b16 a[62:63], v35 offset:19008
s_add_u32 m0, s49, 35904
s_add_u32 s48, s56, 139392
v_mfma_f32_16x16x32_bf16 a[28:31], a[76:79], a[204:207], a[28:31]
buffer_load_dwordx4 v2, s[12:15], s48 offen nt lds
s_waitcnt lgkmcnt(3)
v_mfma_f32_16x16x32_bf16 a[40:43], a[80:83], a[248:251], a[40:43]
ds_read_b64_tr_b16 a[64:65], v32 offset:21120
ds_read_b64_tr_b16 a[66:67], v32 offset:23232
v_mfma_f32_16x16x32_bf16 a[44:47], a[84:87], a[248:251], a[44:47]
ds_read_b64_tr_b16 a[68:69], v33 offset:21120
v_mfma_f32_16x16x32_bf16 a[0:3], a[48:51], v[156:159], a[0:3]
ds_read_b64_tr_b16 a[70:71], v33 offset:23232
ds_read_b64_tr_b16 a[72:73], v34 offset:21120
v_mfma_f32_16x16x32_bf16 a[16:19], a[48:51], a[208:211], a[16:19]
ds_read_b64_tr_b16 a[74:75], v34 offset:23232
v_mfma_f32_16x16x32_bf16 a[4:7], a[52:55], v[156:159], a[4:7]
ds_read_b64_tr_b16 a[76:77], v35 offset:21120
v_mfma_f32_16x16x32_bf16 a[20:23], a[52:55], a[208:211], a[20:23]
ds_read_b64_tr_b16 a[78:79], v35 offset:23232
ds_read_b64_tr_b16 a[80:81], v36 offset:16896
s_waitcnt lgkmcnt(6)
v_mfma_f32_16x16x32_bf16 a[8:11], a[56:59], v[156:159], a[8:11]
ds_read_b64_tr_b16 a[82:83], v36 offset:25344
s_add_u32 m0, s49, 36960
s_add_u32 s48, s56, 143488
v_mfma_f32_16x16x32_bf16 a[24:27], a[56:59], a[208:211], a[24:27]
buffer_load_dwordx4 v2, s[12:15], s48 offen nt lds
v_mfma_f32_16x16x32_bf16 a[12:15], a[60:63], v[156:159], a[12:15]
ds_read_b64_tr_b16 a[84:85], v37 offset:16896
v_mfma_f32_16x16x32_bf16 a[28:31], a[60:63], a[208:211], a[28:31]
ds_read_b64_tr_b16 a[86:87], v37 offset:25344
ds_read_b64_tr_b16 a[48:49], v32 offset:25344
v_mfma_f32_16x16x32_bf16 a[0:3], a[64:67], v[160:163], a[0:3]
ds_read_b64_tr_b16 a[50:51], v32 offset:27456
v_mfma_f32_16x16x32_bf16 a[16:19], a[64:67], a[212:215], a[16:19]
ds_read_b64_tr_b16 a[52:53], v33 offset:25344
s_waitcnt lgkmcnt(5)
v_mfma_f32_16x16x32_bf16 a[4:7], a[68:71], v[160:163], a[4:7]
ds_read_b64_tr_b16 a[54:55], v33 offset:27456
ds_read_b64_tr_b16 a[56:57], v34 offset:25344
v_mfma_f32_16x16x32_bf16 a[20:23], a[68:71], a[212:215], a[20:23]
ds_read_b64_tr_b16 a[58:59], v34 offset:27456
v_mfma_f32_16x16x32_bf16 a[8:11], a[72:75], v[160:163], a[8:11]
ds_read_b64_tr_b16 a[60:61], v35 offset:25344
ds_read_b64_tr_b16 a[62:63], v35 offset:27456
v_mfma_f32_16x16x32_bf16 a[24:27], a[72:75], a[212:215], a[24:27]
s_add_u32 m0, s49, 38016
s_add_u32 s48, s56, 147584
v_mfma_f32_16x16x32_bf16 a[12:15], a[76:79], v[160:163], a[12:15]
buffer_load_dwordx4 v2, s[12:15], s48 offen nt lds
ds_read_b64_tr_b16 a[64:65], v32 offset:29568
v_mfma_f32_16x16x32_bf16 a[28:31], a[76:79], a[212:215], a[28:31]
ds_read_b64_tr_b16 a[66:67], v32 offset:31680
v_mfma_f32_16x16x32_bf16 a[32:35], a[80:83], a[252:255], a[32:35]
ds_read_b64_tr_b16 a[68:69], v33 offset:29568
s_waitcnt lgkmcnt(3)
v_mfma_f32_16x16x32_bf16 a[36:39], a[84:87], a[252:255], a[36:39]
ds_read_b64_tr_b16 a[70:71], v33 offset:31680
ds_read_b64_tr_b16 a[72:73], v34 offset:29568
v_mfma_f32_16x16x32_bf16 a[0:3], a[48:51], v[164:167], a[0:3]
ds_read_b64_tr_b16 a[74:75], v34 offset:31680
v_mfma_f32_16x16x32_bf16 a[16:19], a[48:51], a[216:219], a[16:19]
ds_read_b64_tr_b16 a[76:77], v35 offset:29568
ds_read_b64_tr_b16 a[78:79], v35 offset:31680
v_mfma_f32_16x16x32_bf16 a[4:7], a[52:55], v[164:167], a[4:7]
ds_read_b64_tr_b16 a[80:81], v38 offset:16896
v_mfma_f32_16x16x32_bf16 a[20:23], a[52:55], a[216:219], a[20:23]
ds_read_b64_tr_b16 a[82:83], v38 offset:25344
s_add_u32 m0, s49, 39072
s_add_u32 s48, s56, 151680
v_mfma_f32_16x16x32_bf16 a[8:11], a[56:59], v[164:167], a[8:11]
buffer_load_dwordx4 v2, s[12:15], s48 offen nt lds
v_mfma_f32_16x16x32_bf16 a[24:27], a[56:59], a[216:219], a[24:27]
ds_read_b64_tr_b16 a[84:85], v39 offset:16896
ds_read_b64_tr_b16 a[86:87], v39 offset:25344
v_mfma_f32_16x16x32_bf16 a[12:15], a[60:63], v[164:167], a[12:15]
v_subrev_u32 v32, 67584, v32
v_mfma_f32_16x16x32_bf16 a[28:31], a[60:63], a[216:219], a[28:31]
v_subrev_u32 v33, 67584, v33
s_waitcnt lgkmcnt(2)
v_mfma_f32_16x16x32_bf16 a[0:3], a[64:67], v[168:171], a[0:3]
v_subrev_u32 v34, 67584, v34
v_subrev_u32 v35, 67584, v35
v_mfma_f32_16x16x32_bf16 a[16:19], a[64:67], a[220:223], a[16:19]
v_subrev_u32 v36, 67584, v36
v_mfma_f32_16x16x32_bf16 a[4:7], a[68:71], v[168:171], a[4:7]
v_subrev_u32 v37, 67584, v37
v_mfma_f32_16x16x32_bf16 a[20:23], a[68:71], a[220:223], a[20:23]
v_subrev_u32 v38, 67584, v38
v_subrev_u32 v39, 67584, v39
L_stage27:
s_waitcnt vmcnt(6)
s_waitcnt lgkmcnt(0)
s_barrier
ds_read_b64_tr_b16 a[48:49], v32
ds_read_b64_tr_b16 a[50:51], v32 offset:2112
ds_read_b64_tr_b16 a[52:53], v33
ds_read_b64_tr_b16 a[54:55], v33 offset:2112
v_mfma_f32_16x16x32_bf16 a[8:11], a[72:75], v[168:171], a[8:11]
ds_read_b64_tr_b16 a[56:57], v34
ds_read_b64_tr_b16 a[58:59], v34 offset:2112
ds_read_b64_tr_b16 a[60:61], v35
ds_read_b64_tr_b16 a[62:63], v35 offset:2112
v_mfma_f32_16x16x32_bf16 a[24:27], a[72:75], a[220:223], a[24:27]
ds_read_b64_tr_b16 a[64:65], v32 offset:4224
ds_read_b64_tr_b16 a[66:67], v32 offset:6336
s_add_u32 m0, s49, 40128
s_add_u32 s48, s56, 155776
buffer_load_dwordx4 v2, s[12:15], s48 offen nt lds
v_mfma_f32_16x16x32_bf16 a[12:15], a[76:79], v[168:171], a[12:15]
ds_read_b64_tr_b16 a[68:69], v33 offset:4224
ds_read_b64_tr_b16 a[70:71], v33 offset:6336
ds_read_b64_tr_b16 a[72:73], v34 offset:4224
ds_read_b64_tr_b16 a[74:75], v34 offset:6336
v_mfma_f32_16x16x32_bf16 a[28:31], a[76:79], a[220:223], a[28:31]
ds_read_b64_tr_b16 a[76:77], v35 offset:4224
ds_read_b64_tr_b16 a[78:79], v35 offset:6336
v_accvgpr_read_b32 v12, a0
v_accvgpr_read_b32 v13, a1
v_accvgpr_read_b32 v14, a2
v_accvgpr_read_b32 v15, a3
v_mul_f32 v12, v12, v4
v_mul_f32 v13, v13, v4
v_mul_f32 v14, v14, v4
v_mul_f32 v15, v15, v4
v_cvt_pk_bf16_f32 v16, v12, v13
v_cvt_pk_bf16_f32 v17, v14, v15
v_accvgpr_write_b32 a104, v16
v_mfma_f32_16x16x32_bf16 a[40:43], a[80:83], a[252:255], a[40:43]
v_accvgpr_write_b32 a105, v17
v_accvgpr_read_b32 v18, a4
v_accvgpr_read_b32 v19, a5
v_accvgpr_read_b32 v20, a6
v_accvgpr_read_b32 v21, a7
v_mul_f32 v18, v18, v4
v_mul_f32 v19, v19, v4
v_mul_f32 v20, v20, v4
v_mul_f32 v21, v21, v4
v_cvt_pk_bf16_f32 v22, v18, v19
v_cvt_pk_bf16_f32 v23, v20, v21
v_accvgpr_write_b32 a106, v22
v_accvgpr_write_b32 a107, v23
v_accvgpr_read_b32 v12, a8
v_mfma_f32_16x16x32_bf16 a[44:47], a[84:87], a[252:255], a[44:47]
v_accvgpr_read_b32 v13, a9
v_accvgpr_read_b32 v14, a10
v_accvgpr_read_b32 v15, a11
v_mul_f32 v12, v12, v4
v_mul_f32 v13, v13, v4
v_mul_f32 v14, v14, v4
v_mul_f32 v15, v15, v4
v_cvt_pk_bf16_f32 v16, v12, v13
v_cvt_pk_bf16_f32 v17, v14, v15
v_accvgpr_write_b32 a108, v16
v_accvgpr_write_b32 a109, v17
v_accvgpr_read_b32 v18, a12
v_accvgpr_read_b32 v19, a13
s_waitcnt lgkmcnt(0)
v_mfma_f32_16x16x32_bf16 a[0:3], a[48:51], v[44:47], 0
v_accvgpr_read_b32 v20, a14
v_accvgpr_read_b32 v21, a15
v_mul_f32 v18, v18, v4
v_mul_f32 v19, v19, v4
v_mul_f32 v20, v20, v4
v_mul_f32 v21, v21, v4
v_cvt_pk_bf16_f32 v22, v18, v19
v_cvt_pk_bf16_f32 v23, v20, v21
v_accvgpr_write_b32 a110, v22
v_accvgpr_write_b32 a111, v23
v_accvgpr_read_b32 v12, a16
v_accvgpr_read_b32 v13, a17
v_accvgpr_read_b32 v14, a18
v_accvgpr_read_b32 v15, a19
v_mfma_f32_16x16x32_bf16 a[16:19], a[48:51], v[172:175], 0
v_mul_f32 v12, v12, v5
v_mul_f32 v13, v13, v5
v_mul_f32 v14, v14, v5
v_mul_f32 v15, v15, v5
v_cvt_pk_bf16_f32 v16, v12, v13
v_cvt_pk_bf16_f32 v17, v14, v15
v_accvgpr_write_b32 a112, v16
v_accvgpr_write_b32 a113, v17
v_mfma_f32_16x16x32_bf16 a[4:7], a[52:55], v[44:47], 0
v_accvgpr_read_b32 v18, a20
v_accvgpr_read_b32 v19, a21
v_accvgpr_read_b32 v20, a22
v_accvgpr_read_b32 v21, a23
v_mul_f32 v18, v18, v5
v_mul_f32 v19, v19, v5
v_mul_f32 v20, v20, v5
v_mul_f32 v21, v21, v5
v_cvt_pk_bf16_f32 v22, v18, v19
v_mfma_f32_16x16x32_bf16 a[20:23], a[52:55], v[172:175], 0
v_cvt_pk_bf16_f32 v23, v20, v21
v_accvgpr_write_b32 a114, v22
v_accvgpr_write_b32 a115, v23
v_accvgpr_read_b32 v12, a24
v_accvgpr_read_b32 v13, a25
v_accvgpr_read_b32 v14, a26
v_accvgpr_read_b32 v15, a27
v_mul_f32 v12, v12, v5
v_mfma_f32_16x16x32_bf16 a[8:11], a[56:59], v[44:47], 0
v_mul_f32 v13, v13, v5
v_mul_f32 v14, v14, v5
v_mul_f32 v15, v15, v5
v_cvt_pk_bf16_f32 v16, v12, v13
v_cvt_pk_bf16_f32 v17, v14, v15
v_accvgpr_write_b32 a116, v16
v_accvgpr_write_b32 a117, v17
v_accvgpr_read_b32 v18, a28
v_mfma_f32_16x16x32_bf16 a[24:27], a[56:59], v[172:175], 0
v_accvgpr_read_b32 v19, a29
v_accvgpr_read_b32 v20, a30
v_accvgpr_read_b32 v21, a31
v_mul_f32 v18, v18, v5
v_mul_f32 v19, v19, v5
v_mul_f32 v20, v20, v5
v_mul_f32 v21, v21, v5
v_cvt_pk_bf16_f32 v22, v18, v19
v_cvt_pk_bf16_f32 v23, v20, v21
v_mfma_f32_16x16x32_bf16 a[12:15], a[60:63], v[44:47], 0
v_accvgpr_write_b32 a118, v22
v_accvgpr_write_b32 a119, v23
s_lshl_b32 s4, s3, 12
s_add_u32 s4, s4, 138240
v_add_u32 v7, s4, v1
v_accvgpr_read_b32 v24, a32
v_accvgpr_read_b32 v25, a33
v_accvgpr_read_b32 v26, a34
v_accvgpr_read_b32 v27, a35
v_mfma_f32_16x16x32_bf16 a[28:31], a[60:63], v[172:175], 0
v_mul_f32 v24, v24, v6
v_mul_f32 v25, v25, v6
v_mul_f32 v26, v26, v6
v_mul_f32 v27, v27, v6
ds_write_b128 v7, v[24:27]
v_accvgpr_read_b32 v28, a36
v_accvgpr_read_b32 v29, a37
v_accvgpr_read_b32 v30, a38
v_accvgpr_read_b32 v31, a39
v_mfma_f32_16x16x32_bf16 a[0:3], a[64:67], v[48:51], a[0:3]
v_mul_f32 v28, v28, v6
v_mul_f32 v29, v29, v6
v_mul_f32 v30, v30, v6
v_mul_f32 v31, v31, v6
ds_write_b128 v7, v[28:31] offset:1024
v_accvgpr_read_b32 v24, a40
v_accvgpr_read_b32 v25, a41
v_accvgpr_read_b32 v26, a42
v_mfma_f32_16x16x32_bf16 a[16:19], a[64:67], v[176:179], a[16:19]
v_accvgpr_read_b32 v27, a43
v_mul_f32 v24, v24, v6
v_mul_f32 v25, v25, v6
v_mul_f32 v26, v26, v6
v_mul_f32 v27, v27, v6
ds_write_b128 v7, v[24:27] offset:2048
v_accvgpr_read_b32 v28, a44
v_accvgpr_read_b32 v29, a45
v_mfma_f32_16x16x32_bf16 a[4:7], a[68:71], v[48:51], a[4:7]
v_accvgpr_read_b32 v30, a46
v_accvgpr_read_b32 v31, a47
v_mul_f32 v28, v28, v6
v_mul_f32 v29, v29, v6
v_mul_f32 v30, v30, v6
v_mul_f32 v31, v31, v6
ds_write_b128 v7, v[28:31] offset:3072
ds_read_b64_tr_b16 a[80:81], v36
ds_read_b64_tr_b16 a[82:83], v36 offset:8448
v_mfma_f32_16x16x32_bf16 a[20:23], a[68:71], v[176:179], a[20:23]
ds_read_b64_tr_b16 a[84:85], v37
ds_read_b64_tr_b16 a[86:87], v37 offset:8448
v_mfma_f32_16x16x32_bf16 a[8:11], a[72:75], v[48:51], a[8:11]
ds_read_b64_tr_b16 a[48:49], v32 offset:8448
ds_read_b64_tr_b16 a[50:51], v32 offset:10560
s_add_u32 m0, s49, 41184
v_mfma_f32_16x16x32_bf16 a[24:27], a[72:75], v[176:179], a[24:27]
s_add_u32 s48, s56, 159872
buffer_load_dwordx4 v2, s[12:15], s48 offen nt lds
v_mfma_f32_16x16x32_bf16 a[12:15], a[76:79], v[48:51], a[12:15]
ds_read_b64_tr_b16 a[52:53], v33 offset:8448
ds_read_b64_tr_b16 a[54:55], v33 offset:10560
v_mfma_f32_16x16x32_bf16 a[28:31], a[76:79], v[176:179], a[28:31]
ds_read_b64_tr_b16 a[56:57], v34 offset:8448
s_waitcnt lgkmcnt(3)
v_mfma_f32_16x16x32_bf16 a[32:35], a[80:83], a[224:227], 0
ds_read_b64_tr_b16 a[58:59], v34 offset:10560
ds_read_b64_tr_b16 a[60:61], v35 offset:8448
v_mfma_f32_16x16x32_bf16 a[36:39], a[84:87], a[224:227], 0
ds_read_b64_tr_b16 a[62:63], v35 offset:10560
v_mfma_f32_16x16x32_bf16 a[0:3], a[48:51], v[52:55], a[0:3]
ds_read_b64_tr_b16 a[64:65], v32 offset:12672
ds_read_b64_tr_b16 a[66:67], v32 offset:14784
v_mfma_f32_16x16x32_bf16 a[16:19], a[48:51], v[180:183], a[16:19]
s_add_u32 m0, s49, 67584
s_add_u32 s48, s56, 262272
s_waitcnt lgkmcnt(4)
v_mfma_f32_16x16x32_bf16 a[4:7], a[52:55], v[52:55], a[4:7]
buffer_load_dwordx4 v2, s[12:15], s48 offen nt lds
ds_read_b64_tr_b16 a[68:69], v33 offset:12672
v_mfma_f32_16x16x32_bf16 a[20:23], a[52:55], v[180:183], a[20:23]
ds_read_b64_tr_b16 a[70:71], v33 offset:14784
v_mfma_f32_16x16x32_bf16 a[8:11], a[56:59], v[52:55], a[8:11]
ds_read_b64_tr_b16 a[72:73], v34 offset:12672
ds_read_b64_tr_b16 a[74:75], v34 offset:14784
v_mfma_f32_16x16x32_bf16 a[24:27], a[56:59], v[180:183], a[24:27]
ds_read_b64_tr_b16 a[76:77], v35 offset:12672
s_waitcnt lgkmcnt(5)
v_mfma_f32_16x16x32_bf16 a[12:15], a[60:63], v[52:55], a[12:15]
ds_read_b64_tr_b16 a[78:79], v35 offset:14784
ds_read_b64_tr_b16 a[80:81], v38
v_mfma_f32_16x16x32_bf16 a[28:31], a[60:63], v[180:183], a[28:31]
ds_read_b64_tr_b16 a[82:83], v38 offset:8448
v_mfma_f32_16x16x32_bf16 a[0:3], a[64:67], v[56:59], a[0:3]
ds_read_b64_tr_b16 a[84:85], v39
v_mfma_f32_16x16x32_bf16 a[16:19], a[64:67], v[184:187], a[16:19]
ds_read_b64_tr_b16 a[86:87], v39 offset:8448
s_add_u32 m0, s49, 68640
s_add_u32 s48, s56, 266368
s_waitcnt lgkmcnt(4)
v_mfma_f32_16x16x32_bf16 a[4:7], a[68:71], v[56:59], a[4:7]
buffer_load_dwordx4 v2, s[12:15], s48 offen nt lds
ds_read_b64_tr_b16 a[48:49], v32 offset:16896
v_mfma_f32_16x16x32_bf16 a[20:23], a[68:71], v[184:187], a[20:23]
ds_read_b64_tr_b16 a[50:51], v32 offset:19008
v_mfma_f32_16x16x32_bf16 a[8:11], a[72:75], v[56:59], a[8:11]
ds_read_b64_tr_b16 a[52:53], v33 offset:16896
ds_read_b64_tr_b16 a[54:55], v33 offset:19008
v_mfma_f32_16x16x32_bf16 a[24:27], a[72:75], v[184:187], a[24:27]
ds_read_b64_tr_b16 a[56:57], v34 offset:16896
v_mfma_f32_16x16x32_bf16 a[12:15], a[76:79], v[56:59], a[12:15]
ds_read_b64_tr_b16 a[58:59], v34 offset:19008
ds_read_b64_tr_b16 a[60:61], v35 offset:16896
v_mfma_f32_16x16x32_bf16 a[28:31], a[76:79], v[184:187], a[28:31]
ds_read_b64_tr_b16 a[62:63], v35 offset:19008
s_add_u32 m0, s49, 69696
s_waitcnt lgkmcnt(5)
v_mfma_f32_16x16x32_bf16 a[40:43], a[80:83], a[224:227], 0
s_add_u32 s48, s56, 270464
buffer_load_dwordx4 v2, s[12:15], s48 offen nt lds
v_mfma_f32_16x16x32_bf16 a[44:47], a[84:87], a[224:227], 0
ds_read_b64_tr_b16 a[64:65], v32 offset:21120
v_mfma_f32_16x16x32_bf16 a[0:3], a[48:51], v[60:63], a[0:3]
ds_read_b64_tr_b16 a[66:67], v32 offset:23232
ds_read_b64_tr_b16 a[68:69], v33 offset:21120
v_mfma_f32_16x16x32_bf16 a[16:19], a[48:51], v[188:191], a[16:19]
ds_read_b64_tr_b16 a[70:71], v33 offset:23232
s_waitcnt lgkmcnt(4)
v_mfma_f32_16x16x32_bf16 a[4:7], a[52:55], v[60:63], a[4:7]
ds_read_b64_tr_b16 a[72:73], v34 offset:21120
ds_read_b64_tr_b16 a[74:75], v34 offset:23232
v_mfma_f32_16x16x32_bf16 a[20:23], a[52:55], v[188:191], a[20:23]
ds_read_b64_tr_b16 a[76:77], v35 offset:21120
v_mfma_f32_16x16x32_bf16 a[8:11], a[56:59], v[60:63], a[8:11]
ds_read_b64_tr_b16 a[78:79], v35 offset:23232
ds_read_b64_tr_b16 a[80:81], v36 offset:16896
v_mfma_f32_16x16x32_bf16 a[24:27], a[56:59], v[188:191], a[24:27]
ds_read_b64_tr_b16 a[82:83], v36 offset:25344
s_add_u32 m0, s49, 70752
v_mfma_f32_16x16x32_bf16 a[12:15], a[60:63], v[60:63], a[12:15]
s_add_u32 s48, s56, 274560
buffer_load_dwordx4 v2, s[12:15], s48 offen nt lds
v_mfma_f32_16x16x32_bf16 a[28:31], a[60:63], v[188:191], a[28:31]
ds_read_b64_tr_b16 a[84:85], v37 offset:16896
s_waitcnt lgkmcnt(3)
v_mfma_f32_16x16x32_bf16 a[0:3], a[64:67], v[64:67], a[0:3]
ds_read_b64_tr_b16 a[86:87], v37 offset:25344
ds_read_b64_tr_b16 a[48:49], v32 offset:25344
v_mfma_f32_16x16x32_bf16 a[16:19], a[64:67], v[192:195], a[16:19]
ds_read_b64_tr_b16 a[50:51], v32 offset:27456
v_mfma_f32_16x16x32_bf16 a[4:7], a[68:71], v[64:67], a[4:7]
ds_read_b64_tr_b16 a[52:53], v33 offset:25344
ds_read_b64_tr_b16 a[54:55], v33 offset:27456
v_mfma_f32_16x16x32_bf16 a[20:23], a[68:71], v[192:195], a[20:23]
ds_read_b64_tr_b16 a[56:57], v34 offset:25344
v_mfma_f32_16x16x32_bf16 a[8:11], a[72:75], v[64:67], a[8:11]
ds_read_b64_tr_b16 a[58:59], v34 offset:27456
v_mfma_f32_16x16x32_bf16 a[24:27], a[72:75], v[192:195], a[24:27]
ds_read_b64_tr_b16 a[60:61], v35 offset:25344
ds_read_b64_tr_b16 a[62:63], v35 offset:27456
s_add_u32 m0, s49, 71808
v_mfma_f32_16x16x32_bf16 a[12:15], a[76:79], v[64:67], a[12:15]
s_add_u32 s48, s56, 278656
buffer_load_dwordx4 v2, s[12:15], s48 offen nt lds
v_mfma_f32_16x16x32_bf16 a[28:31], a[76:79], v[192:195], a[28:31]
ds_read_b64_tr_b16 a[64:65], v32 offset:29568
s_waitcnt lgkmcnt(3)
v_mfma_f32_16x16x32_bf16 a[32:35], a[80:83], a[228:231], a[32:35]
ds_read_b64_tr_b16 a[66:67], v32 offset:31680
ds_read_b64_tr_b16 a[68:69], v33 offset:29568
v_mfma_f32_16x16x32_bf16 a[36:39], a[84:87], a[228:231], a[36:39]
ds_read_b64_tr_b16 a[70:71], v33 offset:31680
v_mfma_f32_16x16x32_bf16 a[0:3], a[48:51], v[68:71], a[0:3]
ds_read_b64_tr_b16 a[72:73], v34 offset:29568
ds_read_b64_tr_b16 a[74:75], v34 offset:31680
v_mfma_f32_16x16x32_bf16 a[16:19], a[48:51], v[196:199], a[16:19]
ds_read_b64_tr_b16 a[76:77], v35 offset:29568
v_mfma_f32_16x16x32_bf16 a[4:7], a[52:55], v[68:71], a[4:7]
ds_read_b64_tr_b16 a[78:79], v35 offset:31680
v_mfma_f32_16x16x32_bf16 a[20:23], a[52:55], v[196:199], a[20:23]
ds_read_b64_tr_b16 a[80:81], v38 offset:16896
ds_read_b64_tr_b16 a[82:83], v38 offset:25344
s_add_u32 m0, s49, 72864
v_mfma_f32_16x16x32_bf16 a[8:11], a[56:59], v[68:71], a[8:11]
s_add_u32 s48, s56, 282752
buffer_load_dwordx4 v2, s[12:15], s48 offen nt lds
v_mfma_f32_16x16x32_bf16 a[24:27], a[56:59], v[196:199], a[24:27]
ds_read_b64_tr_b16 a[84:85], v39 offset:16896
s_waitcnt lgkmcnt(3)
v_mfma_f32_16x16x32_bf16 a[12:15], a[60:63], v[68:71], a[12:15]
ds_read_b64_tr_b16 a[86:87], v39 offset:25344
v_add_u32 v32, 33792, v32
v_mfma_f32_16x16x32_bf16 a[28:31], a[60:63], v[196:199], a[28:31]
v_add_u32 v33, 33792, v33
v_mfma_f32_16x16x32_bf16 a[0:3], a[64:67], v[72:75], a[0:3]
v_add_u32 v34, 33792, v34
v_add_u32 v35, 33792, v35
v_mfma_f32_16x16x32_bf16 a[16:19], a[64:67], v[200:203], a[16:19]
v_add_u32 v36, 33792, v36
v_mfma_f32_16x16x32_bf16 a[4:7], a[68:71], v[72:75], a[4:7]
v_add_u32 v37, 33792, v37
v_mfma_f32_16x16x32_bf16 a[20:23], a[68:71], v[200:203], a[20:23]
v_add_u32 v38, 33792, v38
v_add_u32 v39, 33792, v39
L_stage28:
s_waitcnt vmcnt(6)
s_waitcnt lgkmcnt(0)
s_barrier
ds_read_b64_tr_b16 a[48:49], v32
ds_read_b64_tr_b16 a[50:51], v32 offset:2112
v_mfma_f32_16x16x32_bf16 a[8:11], a[72:75], v[72:75], a[8:11]
ds_read_b64_tr_b16 a[52:53], v33
ds_read_b64_tr_b16 a[54:55], v33 offset:2112
v_mfma_f32_16x16x32_bf16 a[24:27], a[72:75], v[200:203], a[24:27]
ds_read_b64_tr_b16 a[56:57], v34
ds_read_b64_tr_b16 a[58:59], v34 offset:2112
v_mfma_f32_16x16x32_bf16 a[12:15], a[76:79], v[72:75], a[12:15]
ds_read_b64_tr_b16 a[60:61], v35
ds_read_b64_tr_b16 a[62:63], v35 offset:2112
v_mfma_f32_16x16x32_bf16 a[28:31], a[76:79], v[200:203], a[28:31]
ds_read_b64_tr_b16 a[64:65], v32 offset:4224
ds_read_b64_tr_b16 a[66:67], v32 offset:6336
v_mfma_f32_16x16x32_bf16 a[40:43], a[80:83], a[228:231], a[40:43]
s_add_u32 m0, s49, 73920
s_add_u32 s48, s56, 286848
buffer_load_dwordx4 v2, s[12:15], s48 offen nt lds
v_mfma_f32_16x16x32_bf16 a[44:47], a[84:87], a[228:231], a[44:47]
ds_read_b64_tr_b16 a[68:69], v33 offset:4224
ds_read_b64_tr_b16 a[70:71], v33 offset:6336
s_waitcnt lgkmcnt(4)
v_mfma_f32_16x16x32_bf16 a[0:3], a[48:51], v[76:79], a[0:3]
ds_read_b64_tr_b16 a[72:73], v34 offset:4224
ds_read_b64_tr_b16 a[74:75], v34 offset:6336
v_mfma_f32_16x16x32_bf16 a[16:19], a[48:51], v[204:207], a[16:19]
ds_read_b64_tr_b16 a[76:77], v35 offset:4224
ds_read_b64_tr_b16 a[78:79], v35 offset:6336
v_mfma_f32_16x16x32_bf16 a[4:7], a[52:55], v[76:79], a[4:7]
ds_read_b64_tr_b16 a[80:81], v36
ds_read_b64_tr_b16 a[82:83], v36 offset:8448
v_mfma_f32_16x16x32_bf16 a[20:23], a[52:55], v[204:207], a[20:23]
ds_read_b64_tr_b16 a[84:85], v37
ds_read_b64_tr_b16 a[86:87], v37 offset:8448
v_mfma_f32_16x16x32_bf16 a[8:11], a[56:59], v[76:79], a[8:11]
s_add_u32 m0, s49, 74976
s_add_u32 s48, s56, 290944
buffer_load_dwordx4 v2, s[12:15], s48 offen nt lds
v_mfma_f32_16x16x32_bf16 a[24:27], a[56:59], v[204:207], a[24:27]
ds_read_b64_tr_b16 a[48:49], v32 offset:8448
ds_read_b64_tr_b16 a[50:51], v32 offset:10560
v_mfma_f32_16x16x32_bf16 a[12:15], a[60:63], v[76:79], a[12:15]
ds_read_b64_tr_b16 a[52:53], v33 offset:8448
ds_read_b64_tr_b16 a[54:55], v33 offset:10560
v_mfma_f32_16x16x32_bf16 a[28:31], a[60:63], v[204:207], a[28:31]
ds_read_b64_tr_b16 a[56:57], v34 offset:8448
ds_read_b64_tr_b16 a[58:59], v34 offset:10560
s_waitcnt lgkmcnt(6)
v_mfma_f32_16x16x32_bf16 a[0:3], a[64:67], v[80:83], a[0:3]
ds_read_b64_tr_b16 a[60:61], v35 offset:8448
ds_read_b64_tr_b16 a[62:63], v35 offset:10560
s_lshl_b32 s4, s3, 10
v_mfma_f32_16x16x32_bf16 a[16:19], a[64:67], v[208:211], a[16:19]
s_add_u32 s4, s4, 138240
v_add_u32 v7, s4, v1
v_mfma_f32_16x16x32_bf16 a[4:7], a[68:71], v[80:83], a[4:7]
ds_read_b128 v[12:15], v7
ds_read_b128 v[16:19], v7 offset:4096
v_mfma_f32_16x16x32_bf16 a[20:23], a[68:71], v[208:211], a[20:23]
ds_read_b128 v[20:23], v7 offset:8192
ds_read_b128 v[24:27], v7 offset:12288
v_mfma_f32_16x16x32_bf16 a[8:11], a[72:75], v[80:83], a[8:11]
s_waitcnt lgkmcnt(2)
v_add_f32 v12, v12, v16
s_waitcnt lgkmcnt(0)
v_add_f32 v20, v20, v24
v_mfma_f32_16x16x32_bf16 a[24:27], a[72:75], v[208:211], a[24:27]
v_add_f32 v13, v13, v17
v_add_f32 v21, v21, v25
v_mfma_f32_16x16x32_bf16 a[12:15], a[76:79], v[80:83], a[12:15]
v_add_f32 v14, v14, v18
v_add_f32 v22, v22, v26
v_mfma_f32_16x16x32_bf16 a[28:31], a[76:79], v[208:211], a[28:31]
v_add_f32 v15, v15, v19
v_add_f32 v23, v23, v27
v_mfma_f32_16x16x32_bf16 a[32:35], a[80:83], a[232:235], a[32:35]
v_add_f32 v12, v12, v20
v_add_f32 v13, v13, v21
v_mfma_f32_16x16x32_bf16 a[36:39], a[84:87], a[232:235], a[36:39]
v_add_f32 v14, v14, v22
v_add_f32 v15, v15, v23
v_mfma_f32_16x16x32_bf16 a[0:3], a[48:51], v[84:87], a[0:3]
v_cvt_pk_bf16_f32 v16, v12, v13
v_cvt_pk_bf16_f32 v17, v14, v15
v_mfma_f32_16x16x32_bf16 a[16:19], a[48:51], v[212:215], a[16:19]
v_accvgpr_write_b32 a120, v16
v_accvgpr_write_b32 a121, v17
v_mfma_f32_16x16x32_bf16 a[4:7], a[52:55], v[84:87], a[4:7]
ds_read_b64_tr_b16 a[64:65], v32 offset:12672
ds_read_b64_tr_b16 a[66:67], v32 offset:14784
v_mfma_f32_16x16x32_bf16 a[20:23], a[52:55], v[212:215], a[20:23]
ds_read_b64_tr_b16 a[68:69], v33 offset:12672
v_mfma_f32_16x16x32_bf16 a[8:11], a[56:59], v[84:87], a[8:11]
ds_read_b64_tr_b16 a[70:71], v33 offset:14784
ds_read_b64_tr_b16 a[72:73], v34 offset:12672
v_mfma_f32_16x16x32_bf16 a[24:27], a[56:59], v[212:215], a[24:27]
ds_read_b64_tr_b16 a[74:75], v34 offset:14784
v_mfma_f32_16x16x32_bf16 a[12:15], a[60:63], v[84:87], a[12:15]
ds_read_b64_tr_b16 a[76:77], v35 offset:12672
ds_read_b64_tr_b16 a[78:79], v35 offset:14784
v_mfma_f32_16x16x32_bf16 a[28:31], a[60:63], v[212:215], a[28:31]
ds_read_b64_tr_b16 a[80:81], v38
s_waitcnt lgkmcnt(6)
v_mfma_f32_16x16x32_bf16 a[0:3], a[64:67], v[88:91], a[0:3]
ds_read_b64_tr_b16 a[82:83], v38 offset:8448
s_add_u32 m0, s49, 0
s_add_u32 s48, s56, 393344
v_mfma_f32_16x16x32_bf16 a[16:19], a[64:67], v[216:219], a[16:19]
buffer_load_dwordx4 v2, s[12:15], s48 offen nt lds
ds_read_b64_tr_b16 a[84:85], v39
s_waitcnt lgkmcnt(3)
v_mfma_f32_16x16x32_bf16 a[4:7], a[68:71], v[88:91], a[4:7]
ds_read_b64_tr_b16 a[86:87], v39 offset:8448
v_mfma_f32_16x16x32_bf16 a[20:23], a[68:71], v[216:219], a[20:23]
ds_read_b64_tr_b16 a[48:49], v32 offset:16896
ds_read_b64_tr_b16 a[50:51], v32 offset:19008
v_mfma_f32_16x16x32_bf16 a[8:11], a[72:75], v[88:91], a[8:11]
ds_read_b64_tr_b16 a[52:53], v33 offset:16896
v_mfma_f32_16x16x32_bf16 a[24:27], a[72:75], v[216:219], a[24:27]
ds_read_b64_tr_b16 a[54:55], v33 offset:19008
s_add_u32 m0, s49, 1056
s_add_u32 s48, s56, 397440
v_mfma_f32_16x16x32_bf16 a[12:15], a[76:79], v[88:91], a[12:15]
buffer_load_dwordx4 v2, s[12:15], s48 offen nt lds
ds_read_b64_tr_b16 a[56:57], v34 offset:16896
v_mfma_f32_16x16x32_bf16 a[28:31], a[76:79], v[216:219], a[28:31]
ds_read_b64_tr_b16 a[58:59], v34 offset:19008
s_waitcnt lgkmcnt(3)
v_mfma_f32_16x16x32_bf16 a[40:43], a[80:83], a[232:235], a[40:43]
ds_read_b64_tr_b16 a[60:61], v35 offset:16896
ds_read_b64_tr_b16 a[62:63], v35 offset:19008
v_mfma_f32_16x16x32_bf16 a[44:47], a[84:87], a[232:235], a[44:47]
ds_read_b64_tr_b16 a[64:65], v32 offset:21120
v_mfma_f32_16x16x32_bf16 a[0:3], a[48:51], v[92:95], a[0:3]
ds_read_b64_tr_b16 a[66:67], v32 offset:23232
ds_read_b64_tr_b16 a[68:69], v33 offset:21120
v_mfma_f32_16x16x32_bf16 a[16:19], a[48:51], v[220:223], a[16:19]
ds_read_b64_tr_b16 a[70:71], v33 offset:23232
s_add_u32 m0, s49, 2112
s_add_u32 s48, s56, 401536
s_waitcnt lgkmcnt(4)
v_mfma_f32_16x16x32_bf16 a[4:7], a[52:55], v[92:95], a[4:7]
buffer_load_dwordx4 v2, s[12:15], s48 offen nt lds
v_mfma_f32_16x16x32_bf16 a[20:23], a[52:55], v[220:223], a[20:23]
ds_read_b64_tr_b16 a[72:73], v34 offset:21120
ds_read_b64_tr_b16 a[74:75], v34 offset:23232
v_mfma_f32_16x16x32_bf16 a[8:11], a[56:59], v[92:95], a[8:11]
ds_read_b64_tr_b16 a[76:77], v35 offset:21120
v_mfma_f32_16x16x32_bf16 a[24:27], a[56:59], v[220:223], a[24:27]
ds_read_b64_tr_b16 a[78:79], v35 offset:23232
ds_read_b64_tr_b16 a[80:81], v36 offset:16896
v_mfma_f32_16x16x32_bf16 a[12:15], a[60:63], v[92:95], a[12:15]
ds_read_b64_tr_b16 a[82:83], v36 offset:25344
v_mfma_f32_16x16x32_bf16 a[28:31], a[60:63], v[220:223], a[28:31]
ds_read_b64_tr_b16 a[84:85], v37 offset:16896
ds_read_b64_tr_b16 a[86:87], v37 offset:25344
s_waitcnt lgkmcnt(6)
v_mfma_f32_16x16x32_bf16 a[0:3], a[64:67], v[96:99], a[0:3]
ds_read_b64_tr_b16 a[48:49], v32 offset:25344
v_mfma_f32_16x16x32_bf16 a[16:19], a[64:67], v[224:227], a[16:19]
ds_read_b64_tr_b16 a[50:51], v32 offset:27456
s_add_u32 m0, s49, 3168
s_add_u32 s48, s56, 405632
v_mfma_f32_16x16x32_bf16 a[4:7], a[68:71], v[96:99], a[4:7]
buffer_load_dwordx4 v2, s[12:15], s48 offen nt lds
ds_read_b64_tr_b16 a[52:53], v33 offset:25344
v_mfma_f32_16x16x32_bf16 a[20:23], a[68:71], v[224:227], a[20:23]
ds_read_b64_tr_b16 a[54:55], v33 offset:27456
v_mfma_f32_16x16x32_bf16 a[8:11], a[72:75], v[96:99], a[8:11]
ds_read_b64_tr_b16 a[56:57], v34 offset:25344
v_mfma_f32_16x16x32_bf16 a[24:27], a[72:75], v[224:227], a[24:27]
ds_read_b64_tr_b16 a[58:59], v34 offset:27456
ds_read_b64_tr_b16 a[60:61], v35 offset:25344
s_waitcnt lgkmcnt(5)
v_mfma_f32_16x16x32_bf16 a[12:15], a[76:79], v[96:99], a[12:15]
ds_read_b64_tr_b16 a[62:63], v35 offset:27456
s_add_u32 m0, s49, 4224
s_add_u32 s48, s56, 409728
v_mfma_f32_16x16x32_bf16 a[28:31], a[76:79], v[224:227], a[28:31]
buffer_load_dwordx4 v2, s[12:15], s48 offen nt lds
v_mfma_f32_16x16x32_bf16 a[32:35], a[80:83], a[236:239], a[32:35]
ds_read_b64_tr_b16 a[64:65], v32 offset:29568
ds_read_b64_tr_b16 a[66:67], v32 offset:31680
v_mfma_f32_16x16x32_bf16 a[36:39], a[84:87], a[236:239], a[36:39]
ds_read_b64_tr_b16 a[68:69], v33 offset:29568
v_mfma_f32_16x16x32_bf16 a[0:3], a[48:51], v[100:103], a[0:3]
ds_read_b64_tr_b16 a[70:71], v33 offset:31680
ds_read_b64_tr_b16 a[72:73], v34 offset:29568
v_mfma_f32_16x16x32_bf16 a[16:19], a[48:51], v[228:231], a[16:19]
ds_read_b64_tr_b16 a[74:75], v34 offset:31680
s_waitcnt lgkmcnt(6)
v_mfma_f32_16x16x32_bf16 a[4:7], a[52:55], v[100:103], a[4:7]
ds_read_b64_tr_b16 a[76:77], v35 offset:29568
ds_read_b64_tr_b16 a[78:79], v35 offset:31680
v_mfma_f32_16x16x32_bf16 a[20:23], a[52:55], v[228:231], a[20:23]
ds_read_b64_tr_b16 a[80:81], v38 offset:16896
v_mfma_f32_16x16x32_bf16 a[8:11], a[56:59], v[100:103], a[8:11]
ds_read_b64_tr_b16 a[82:83], v38 offset:25344
s_add_u32 m0, s49, 5280
s_add_u32 s48, s56, 413824
v_mfma_f32_16x16x32_bf16 a[24:27], a[56:59], v[228:231], a[24:27]
buffer_load_dwordx4 v2, s[12:15], s48 offen nt lds
ds_read_b64_tr_b16 a[84:85], v39 offset:16896
v_mfma_f32_16x16x32_bf16 a[12:15], a[60:63], v[100:103], a[12:15]
ds_read_b64_tr_b16 a[86:87], v39 offset:25344
v_mfma_f32_16x16x32_bf16 a[28:31], a[60:63], v[228:231], a[28:31]
v_add_u32 v32, 33792, v32
v_add_u32 v33, 33792, v33
s_waitcnt lgkmcnt(2)
v_mfma_f32_16x16x32_bf16 a[0:3], a[64:67], v[104:107], a[0:3]
v_add_u32 v34, 33792, v34
v_mfma_f32_16x16x32_bf16 a[16:19], a[64:67], v[232:235], a[16:19]
v_add_u32 v35, 33792, v35
v_add_u32 v36, 33792, v36
v_mfma_f32_16x16x32_bf16 a[4:7], a[68:71], v[104:107], a[4:7]
v_add_u32 v37, 33792, v37
v_mfma_f32_16x16x32_bf16 a[20:23], a[68:71], v[232:235], a[20:23]
v_add_u32 v38, 33792, v38
v_add_u32 v39, 33792, v39
L_stage29:
s_waitcnt vmcnt(6)
s_waitcnt lgkmcnt(0)
s_barrier
ds_read_b64_tr_b16 a[48:49], v32
v_mfma_f32_16x16x32_bf16 a[8:11], a[72:75], v[104:107], a[8:11]
ds_read_b64_tr_b16 a[50:51], v32 offset:2112
ds_read_b64_tr_b16 a[52:53], v33
v_mfma_f32_16x16x32_bf16 a[24:27], a[72:75], v[232:235], a[24:27]
ds_read_b64_tr_b16 a[54:55], v33 offset:2112
v_mfma_f32_16x16x32_bf16 a[12:15], a[76:79], v[104:107], a[12:15]
ds_read_b64_tr_b16 a[56:57], v34
v_mfma_f32_16x16x32_bf16 a[28:31], a[76:79], v[232:235], a[28:31]
ds_read_b64_tr_b16 a[58:59], v34 offset:2112
ds_read_b64_tr_b16 a[60:61], v35
v_mfma_f32_16x16x32_bf16 a[40:43], a[80:83], a[236:239], a[40:43]
ds_read_b64_tr_b16 a[62:63], v35 offset:2112
v_mfma_f32_16x16x32_bf16 a[44:47], a[84:87], a[236:239], a[44:47]
ds_read_b64_tr_b16 a[64:65], v32 offset:4224
s_waitcnt lgkmcnt(5)
v_mfma_f32_16x16x32_bf16 a[0:3], a[48:51], v[108:111], a[0:3]
ds_read_b64_tr_b16 a[66:67], v32 offset:6336
s_add_u32 m0, s49, 6336
s_add_u32 s48, s56, 417920
v_mfma_f32_16x16x32_bf16 a[16:19], a[48:51], v[236:239], a[16:19]
buffer_load_dwordx4 v2, s[12:15], s48 offen nt lds
ds_read_b64_tr_b16 a[68:69], v33 offset:4224
v_mfma_f32_16x16x32_bf16 a[4:7], a[52:55], v[108:111], a[4:7]
ds_read_b64_tr_b16 a[70:71], v33 offset:6336
v_mfma_f32_16x16x32_bf16 a[20:23], a[52:55], v[236:239], a[20:23]
ds_read_b64_tr_b16 a[72:73], v34 offset:4224
s_waitcnt lgkmcnt(3)
v_mfma_f32_16x16x32_bf16 a[8:11], a[56:59], v[108:111], a[8:11]
ds_read_b64_tr_b16 a[74:75], v34 offset:6336
ds_read_b64_tr_b16 a[76:77], v35 offset:4224
v_mfma_f32_16x16x32_bf16 a[24:27], a[56:59], v[236:239], a[24:27]
ds_read_b64_tr_b16 a[78:79], v35 offset:6336
v_mfma_f32_16x16x32_bf16 a[12:15], a[60:63], v[108:111], a[12:15]
ds_read_b64_tr_b16 a[80:81], v36
v_mfma_f32_16x16x32_bf16 a[28:31], a[60:63], v[236:239], a[28:31]
ds_read_b64_tr_b16 a[82:83], v36 offset:8448
ds_read_b64_tr_b16 a[84:85], v37
v_mfma_f32_16x16x32_bf16 a[0:3], a[64:67], v[112:115], a[0:3]
ds_read_b64_tr_b16 a[86:87], v37 offset:8448
v_mfma_f32_16x16x32_bf16 a[16:19], a[64:67], v[240:243], a[16:19]
ds_read_b64_tr_b16 a[48:49], v32 offset:8448
ds_read_b64_tr_b16 a[50:51], v32 offset:10560
s_waitcnt lgkmcnt(6)
v_mfma_f32_16x16x32_bf16 a[4:7], a[68:71], v[112:115], a[4:7]
s_add_u32 m0, s49, 7392
s_add_u32 s48, s56, 422016
v_mfma_f32_16x16x32_bf16 a[20:23], a[68:71], v[240:243], a[20:23]
buffer_load_dwordx4 v2, s[12:15], s48 offen nt lds
ds_read_b64_tr_b16 a[52:53], v33 offset:8448
v_mfma_f32_16x16x32_bf16 a[8:11], a[72:75], v[112:115], a[8:11]
ds_read_b64_tr_b16 a[54:55], v33 offset:10560
v_mfma_f32_16x16x32_bf16 a[24:27], a[72:75], v[240:243], a[24:27]
ds_read_b64_tr_b16 a[56:57], v34 offset:8448
ds_read_b64_tr_b16 a[58:59], v34 offset:10560
v_mfma_f32_16x16x32_bf16 a[12:15], a[76:79], v[112:115], a[12:15]
ds_read_b64_tr_b16 a[60:61], v35 offset:8448
v_mfma_f32_16x16x32_bf16 a[28:31], a[76:79], v[240:243], a[28:31]
ds_read_b64_tr_b16 a[62:63], v35 offset:10560
s_waitcnt lgkmcnt(5)
v_mfma_f32_16x16x32_bf16 a[32:35], a[80:83], a[240:243], a[32:35]
ds_read_b64_tr_b16 a[64:65], v32 offset:12672
ds_read_b64_tr_b16 a[66:67], v32 offset:14784
v_mfma_f32_16x16x32_bf16 a[36:39], a[84:87], a[240:243], a[36:39]
s_add_u32 m0, s49, 33792
s_add_u32 s48, s56, 256
buffer_load_dwordx4 v2, s[12:15], s48 offen nt lds
v_mfma_f32_16x16x32_bf16 a[0:3], a[48:51], v[116:119], a[0:3]
ds_read_b64_tr_b16 a[68:69], v33 offset:12672
v_mfma_f32_16x16x32_bf16 a[16:19], a[48:51], v[244:247], a[16:19]
ds_read_b64_tr_b16 a[70:71], v33 offset:14784
s_waitcnt lgkmcnt(3)
v_mfma_f32_16x16x32_bf16 a[4:7], a[52:55], v[116:119], a[4:7]
ds_read_b64_tr_b16 a[72:73], v34 offset:12672
ds_read_b64_tr_b16 a[74:75], v34 offset:14784
v_mfma_f32_16x16x32_bf16 a[20:23], a[52:55], v[244:247], a[20:23]
ds_read_b64_tr_b16 a[76:77], v35 offset:12672
v_mfma_f32_16x16x32_bf16 a[8:11], a[56:59], v[116:119], a[8:11]
ds_read_b64_tr_b16 a[78:79], v35 offset:14784
v_mfma_f32_16x16x32_bf16 a[24:27], a[56:59], v[244:247], a[24:27]
ds_read_b64_tr_b16 a[80:81], v38
ds_read_b64_tr_b16 a[82:83], v38 offset:8448
v_mfma_f32_16x16x32_bf16 a[12:15], a[60:63], v[116:119], a[12:15]
ds_read_b64_tr_b16 a[84:85], v39
v_mfma_f32_16x16x32_bf16 a[28:31], a[60:63], v[244:247], a[28:31]
ds_read_b64_tr_b16 a[86:87], v39 offset:8448
s_add_u32 m0, s49, 34848
s_add_u32 s48, s56, 4352
s_waitcnt lgkmcnt(4)
v_mfma_f32_16x16x32_bf16 a[0:3], a[64:67], v[120:123], a[0:3]
buffer_load_dwordx4 v2, s[12:15], s48 offen nt lds
v_mfma_f32_16x16x32_bf16 a[16:19], a[64:67], v[248:251], a[16:19]
ds_read_b64_tr_b16 a[48:49], v32 offset:16896
ds_read_b64_tr_b16 a[50:51], v32 offset:19008
v_mfma_f32_16x16x32_bf16 a[4:7], a[68:71], v[120:123], a[4:7]
ds_read_b64_tr_b16 a[52:53], v33 offset:16896
v_mfma_f32_16x16x32_bf16 a[20:23], a[68:71], v[248:251], a[20:23]
ds_read_b64_tr_b16 a[54:55], v33 offset:19008
v_mfma_f32_16x16x32_bf16 a[8:11], a[72:75], v[120:123], a[8:11]
ds_read_b64_tr_b16 a[56:57], v34 offset:16896
ds_read_b64_tr_b16 a[58:59], v34 offset:19008
v_mfma_f32_16x16x32_bf16 a[24:27], a[72:75], v[248:251], a[24:27]
ds_read_b64_tr_b16 a[60:61], v35 offset:16896
v_mfma_f32_16x16x32_bf16 a[12:15], a[76:79], v[120:123], a[12:15]
ds_read_b64_tr_b16 a[62:63], v35 offset:19008
s_add_u32 m0, s49, 35904
s_add_u32 s48, s56, 8448
v_mfma_f32_16x16x32_bf16 a[28:31], a[76:79], v[248:251], a[28:31]
buffer_load_dwordx4 v2, s[12:15], s48 offen nt lds
s_waitcnt lgkmcnt(3)
v_mfma_f32_16x16x32_bf16 a[40:43], a[80:83], a[240:243], a[40:43]
ds_read_b64_tr_b16 a[64:65], v32 offset:21120
ds_read_b64_tr_b16 a[66:67], v32 offset:23232
v_mfma_f32_16x16x32_bf16 a[44:47], a[84:87], a[240:243], a[44:47]
ds_read_b64_tr_b16 a[68:69], v33 offset:21120
v_mfma_f32_16x16x32_bf16 a[0:3], a[48:51], v[124:127], a[0:3]
ds_read_b64_tr_b16 a[70:71], v33 offset:23232
ds_read_b64_tr_b16 a[72:73], v34 offset:21120
v_mfma_f32_16x16x32_bf16 a[16:19], a[48:51], v[252:255], a[16:19]
ds_read_b64_tr_b16 a[74:75], v34 offset:23232
v_mfma_f32_16x16x32_bf16 a[4:7], a[52:55], v[124:127], a[4:7]
ds_read_b64_tr_b16 a[76:77], v35 offset:21120
v_mfma_f32_16x16x32_bf16 a[20:23], a[52:55], v[252:255], a[20:23]
ds_read_b64_tr_b16 a[78:79], v35 offset:23232
ds_read_b64_tr_b16 a[80:81], v36 offset:16896
s_waitcnt lgkmcnt(6)
v_mfma_f32_16x16x32_bf16 a[8:11], a[56:59], v[124:127], a[8:11]
ds_read_b64_tr_b16 a[82:83], v36 offset:25344
s_add_u32 m0, s49, 36960
s_add_u32 s48, s56, 12544
v_mfma_f32_16x16x32_bf16 a[24:27], a[56:59], v[252:255], a[24:27]
buffer_load_dwordx4 v2, s[12:15], s48 offen nt lds
v_mfma_f32_16x16x32_bf16 a[12:15], a[60:63], v[124:127], a[12:15]
ds_read_b64_tr_b16 a[84:85], v37 offset:16896
v_mfma_f32_16x16x32_bf16 a[28:31], a[60:63], v[252:255], a[28:31]
ds_read_b64_tr_b16 a[86:87], v37 offset:25344
ds_read_b64_tr_b16 a[48:49], v32 offset:25344
v_mfma_f32_16x16x32_bf16 a[0:3], a[64:67], v[128:131], a[0:3]
ds_read_b64_tr_b16 a[50:51], v32 offset:27456
v_mfma_f32_16x16x32_bf16 a[16:19], a[64:67], a[180:183], a[16:19]
ds_read_b64_tr_b16 a[52:53], v33 offset:25344
s_waitcnt lgkmcnt(5)
v_mfma_f32_16x16x32_bf16 a[4:7], a[68:71], v[128:131], a[4:7]
ds_read_b64_tr_b16 a[54:55], v33 offset:27456
ds_read_b64_tr_b16 a[56:57], v34 offset:25344
v_mfma_f32_16x16x32_bf16 a[20:23], a[68:71], a[180:183], a[20:23]
ds_read_b64_tr_b16 a[58:59], v34 offset:27456
v_mfma_f32_16x16x32_bf16 a[8:11], a[72:75], v[128:131], a[8:11]
ds_read_b64_tr_b16 a[60:61], v35 offset:25344
ds_read_b64_tr_b16 a[62:63], v35 offset:27456
v_mfma_f32_16x16x32_bf16 a[24:27], a[72:75], a[180:183], a[24:27]
s_add_u32 m0, s49, 38016
s_add_u32 s48, s56, 16640
v_mfma_f32_16x16x32_bf16 a[12:15], a[76:79], v[128:131], a[12:15]
buffer_load_dwordx4 v2, s[12:15], s48 offen nt lds
ds_read_b64_tr_b16 a[64:65], v32 offset:29568
v_mfma_f32_16x16x32_bf16 a[28:31], a[76:79], a[180:183], a[28:31]
ds_read_b64_tr_b16 a[66:67], v32 offset:31680
v_mfma_f32_16x16x32_bf16 a[32:35], a[80:83], a[244:247], a[32:35]
ds_read_b64_tr_b16 a[68:69], v33 offset:29568
s_waitcnt lgkmcnt(3)
v_mfma_f32_16x16x32_bf16 a[36:39], a[84:87], a[244:247], a[36:39]
ds_read_b64_tr_b16 a[70:71], v33 offset:31680
ds_read_b64_tr_b16 a[72:73], v34 offset:29568
v_mfma_f32_16x16x32_bf16 a[0:3], a[48:51], v[132:135], a[0:3]
ds_read_b64_tr_b16 a[74:75], v34 offset:31680
v_mfma_f32_16x16x32_bf16 a[16:19], a[48:51], a[184:187], a[16:19]
ds_read_b64_tr_b16 a[76:77], v35 offset:29568
ds_read_b64_tr_b16 a[78:79], v35 offset:31680
v_mfma_f32_16x16x32_bf16 a[4:7], a[52:55], v[132:135], a[4:7]
ds_read_b64_tr_b16 a[80:81], v38 offset:16896
v_mfma_f32_16x16x32_bf16 a[20:23], a[52:55], a[184:187], a[20:23]
ds_read_b64_tr_b16 a[82:83], v38 offset:25344
s_add_u32 m0, s49, 39072
s_add_u32 s48, s56, 20736
v_mfma_f32_16x16x32_bf16 a[8:11], a[56:59], v[132:135], a[8:11]
buffer_load_dwordx4 v2, s[12:15], s48 offen nt lds
v_mfma_f32_16x16x32_bf16 a[24:27], a[56:59], a[184:187], a[24:27]
ds_read_b64_tr_b16 a[84:85], v39 offset:16896
ds_read_b64_tr_b16 a[86:87], v39 offset:25344
v_mfma_f32_16x16x32_bf16 a[12:15], a[60:63], v[132:135], a[12:15]
v_subrev_u32 v32, 67584, v32
v_mfma_f32_16x16x32_bf16 a[28:31], a[60:63], a[184:187], a[28:31]
v_subrev_u32 v33, 67584, v33
s_waitcnt lgkmcnt(2)
v_mfma_f32_16x16x32_bf16 a[0:3], a[64:67], v[136:139], a[0:3]
v_subrev_u32 v34, 67584, v34
v_subrev_u32 v35, 67584, v35
v_mfma_f32_16x16x32_bf16 a[16:19], a[64:67], a[188:191], a[16:19]
v_subrev_u32 v36, 67584, v36
v_mfma_f32_16x16x32_bf16 a[4:7], a[68:71], v[136:139], a[4:7]
v_subrev_u32 v37, 67584, v37
v_mfma_f32_16x16x32_bf16 a[20:23], a[68:71], a[188:191], a[20:23]
v_subrev_u32 v38, 67584, v38
v_subrev_u32 v39, 67584, v39
L_stage30:
s_waitcnt vmcnt(6)
s_waitcnt lgkmcnt(0)
s_barrier
ds_read_b64_tr_b16 a[48:49], v32
v_mfma_f32_16x16x32_bf16 a[8:11], a[72:75], v[136:139], a[8:11]
ds_read_b64_tr_b16 a[50:51], v32 offset:2112
ds_read_b64_tr_b16 a[52:53], v33
v_mfma_f32_16x16x32_bf16 a[24:27], a[72:75], a[188:191], a[24:27]
ds_read_b64_tr_b16 a[54:55], v33 offset:2112
v_mfma_f32_16x16x32_bf16 a[12:15], a[76:79], v[136:139], a[12:15]
ds_read_b64_tr_b16 a[56:57], v34
v_mfma_f32_16x16x32_bf16 a[28:31], a[76:79], a[188:191], a[28:31]
ds_read_b64_tr_b16 a[58:59], v34 offset:2112
ds_read_b64_tr_b16 a[60:61], v35
v_mfma_f32_16x16x32_bf16 a[40:43], a[80:83], a[244:247], a[40:43]
ds_read_b64_tr_b16 a[62:63], v35 offset:2112
v_mfma_f32_16x16x32_bf16 a[44:47], a[84:87], a[244:247], a[44:47]
ds_read_b64_tr_b16 a[64:65], v32 offset:4224
s_waitcnt lgkmcnt(5)
v_mfma_f32_16x16x32_bf16 a[0:3], a[48:51], v[140:143], a[0:3]
ds_read_b64_tr_b16 a[66:67], v32 offset:6336
s_add_u32 m0, s49, 40128
s_add_u32 s48, s56, 24832
v_mfma_f32_16x16x32_bf16 a[16:19], a[48:51], a[192:195], a[16:19]
buffer_load_dwordx4 v2, s[12:15], s48 offen nt lds
ds_read_b64_tr_b16 a[68:69], v33 offset:4224
v_mfma_f32_16x16x32_bf16 a[4:7], a[52:55], v[140:143], a[4:7]
ds_read_b64_tr_b16 a[70:71], v33 offset:6336
v_mfma_f32_16x16x32_bf16 a[20:23], a[52:55], a[192:195], a[20:23]
ds_read_b64_tr_b16 a[72:73], v34 offset:4224
s_waitcnt lgkmcnt(3)
v_mfma_f32_16x16x32_bf16 a[8:11], a[56:59], v[140:143], a[8:11]
ds_read_b64_tr_b16 a[74:75], v34 offset:6336
ds_read_b64_tr_b16 a[76:77], v35 offset:4224
v_mfma_f32_16x16x32_bf16 a[24:27], a[56:59], a[192:195], a[24:27]
ds_read_b64_tr_b16 a[78:79], v35 offset:6336
v_mfma_f32_16x16x32_bf16 a[12:15], a[60:63], v[140:143], a[12:15]
ds_read_b64_tr_b16 a[80:81], v36
v_mfma_f32_16x16x32_bf16 a[28:31], a[60:63], a[192:195], a[28:31]
ds_read_b64_tr_b16 a[82:83], v36 offset:8448
ds_read_b64_tr_b16 a[84:85], v37
v_mfma_f32_16x16x32_bf16 a[0:3], a[64:67], v[144:147], a[0:3]
ds_read_b64_tr_b16 a[86:87], v37 offset:8448
v_mfma_f32_16x16x32_bf16 a[16:19], a[64:67], a[196:199], a[16:19]
ds_read_b64_tr_b16 a[48:49], v32 offset:8448
ds_read_b64_tr_b16 a[50:51], v32 offset:10560
s_waitcnt lgkmcnt(6)
v_mfma_f32_16x16x32_bf16 a[4:7], a[68:71], v[144:147], a[4:7]
s_add_u32 m0, s49, 41184
s_add_u32 s48, s56, 28928
v_mfma_f32_16x16x32_bf16 a[20:23], a[68:71], a[196:199], a[20:23]
buffer_load_dwordx4 v2, s[12:15], s48 offen nt lds
ds_read_b64_tr_b16 a[52:53], v33 offset:8448
v_mfma_f32_16x16x32_bf16 a[8:11], a[72:75], v[144:147], a[8:11]
ds_read_b64_tr_b16 a[54:55], v33 offset:10560
v_mfma_f32_16x16x32_bf16 a[24:27], a[72:75], a[196:199], a[24:27]
ds_read_b64_tr_b16 a[56:57], v34 offset:8448
ds_read_b64_tr_b16 a[58:59], v34 offset:10560
v_mfma_f32_16x16x32_bf16 a[12:15], a[76:79], v[144:147], a[12:15]
ds_read_b64_tr_b16 a[60:61], v35 offset:8448
v_mfma_f32_16x16x32_bf16 a[28:31], a[76:79], a[196:199], a[28:31]
ds_read_b64_tr_b16 a[62:63], v35 offset:10560
s_waitcnt lgkmcnt(5)
v_mfma_f32_16x16x32_bf16 a[32:35], a[80:83], a[248:251], a[32:35]
ds_read_b64_tr_b16 a[64:65], v32 offset:12672
ds_read_b64_tr_b16 a[66:67], v32 offset:14784
v_mfma_f32_16x16x32_bf16 a[36:39], a[84:87], a[248:251], a[36:39]
s_add_u32 m0, s49, 67584
s_add_u32 s48, s56, 131328
buffer_load_dwordx4 v2, s[12:15], s48 offen nt lds
v_mfma_f32_16x16x32_bf16 a[0:3], a[48:51], v[148:151], a[0:3]
ds_read_b64_tr_b16 a[68:69], v33 offset:12672
v_mfma_f32_16x16x32_bf16 a[16:19], a[48:51], a[200:203], a[16:19]
ds_read_b64_tr_b16 a[70:71], v33 offset:14784
s_waitcnt lgkmcnt(3)
v_mfma_f32_16x16x32_bf16 a[4:7], a[52:55], v[148:151], a[4:7]
ds_read_b64_tr_b16 a[72:73], v34 offset:12672
ds_read_b64_tr_b16 a[74:75], v34 offset:14784
v_mfma_f32_16x16x32_bf16 a[20:23], a[52:55], a[200:203], a[20:23]
ds_read_b64_tr_b16 a[76:77], v35 offset:12672
v_mfma_f32_16x16x32_bf16 a[8:11], a[56:59], v[148:151], a[8:11]
ds_read_b64_tr_b16 a[78:79], v35 offset:14784
v_mfma_f32_16x16x32_bf16 a[24:27], a[56:59], a[200:203], a[24:27]
ds_read_b64_tr_b16 a[80:81], v38
ds_read_b64_tr_b16 a[82:83], v38 offset:8448
v_mfma_f32_16x16x32_bf16 a[12:15], a[60:63], v[148:151], a[12:15]
ds_read_b64_tr_b16 a[84:85], v39
v_mfma_f32_16x16x32_bf16 a[28:31], a[60:63], a[200:203], a[28:31]
ds_read_b64_tr_b16 a[86:87], v39 offset:8448
s_add_u32 m0, s49, 68640
s_add_u32 s48, s56, 135424
s_waitcnt lgkmcnt(4)
v_mfma_f32_16x16x32_bf16 a[0:3], a[64:67], v[152:155], a[0:3]
buffer_load_dwordx4 v2, s[12:15], s48 offen nt lds
v_mfma_f32_16x16x32_bf16 a[16:19], a[64:67], a[204:207], a[16:19]
ds_read_b64_tr_b16 a[48:49], v32 offset:16896
ds_read_b64_tr_b16 a[50:51], v32 offset:19008
v_mfma_f32_16x16x32_bf16 a[4:7], a[68:71], v[152:155], a[4:7]
ds_read_b64_tr_b16 a[52:53], v33 offset:16896
v_mfma_f32_16x16x32_bf16 a[20:23], a[68:71], a[204:207], a[20:23]
ds_read_b64_tr_b16 a[54:55], v33 offset:19008
v_mfma_f32_16x16x32_bf16 a[8:11], a[72:75], v[152:155], a[8:11]
ds_read_b64_tr_b16 a[56:57], v34 offset:16896
ds_read_b64_tr_b16 a[58:59], v34 offset:19008
v_mfma_f32_16x16x32_bf16 a[24:27], a[72:75], a[204:207], a[24:27]
ds_read_b64_tr_b16 a[60:61], v35 offset:16896
v_mfma_f32_16x16x32_bf16 a[12:15], a[76:79], v[152:155], a[12:15]
ds_read_b64_tr_b16 a[62:63], v35 offset:19008
s_add_u32 m0, s49, 69696
s_add_u32 s48, s56, 139520
v_mfma_f32_16x16x32_bf16 a[28:31], a[76:79], a[204:207], a[28:31]
buffer_load_dwordx4 v2, s[12:15], s48 offen nt lds
s_waitcnt lgkmcnt(3)
v_mfma_f32_16x16x32_bf16 a[40:43], a[80:83], a[248:251], a[40:43]
ds_read_b64_tr_b16 a[64:65], v32 offset:21120
ds_read_b64_tr_b16 a[66:67], v32 offset:23232
v_mfma_f32_16x16x32_bf16 a[44:47], a[84:87], a[248:251], a[44:47]
ds_read_b64_tr_b16 a[68:69], v33 offset:21120
v_mfma_f32_16x16x32_bf16 a[0:3], a[48:51], v[156:159], a[0:3]
ds_read_b64_tr_b16 a[70:71], v33 offset:23232
ds_read_b64_tr_b16 a[72:73], v34 offset:21120
v_mfma_f32_16x16x32_bf16 a[16:19], a[48:51], a[208:211], a[16:19]
ds_read_b64_tr_b16 a[74:75], v34 offset:23232
v_mfma_f32_16x16x32_bf16 a[4:7], a[52:55], v[156:159], a[4:7]
ds_read_b64_tr_b16 a[76:77], v35 offset:21120
v_mfma_f32_16x16x32_bf16 a[20:23], a[52:55], a[208:211], a[20:23]
ds_read_b64_tr_b16 a[78:79], v35 offset:23232
ds_read_b64_tr_b16 a[80:81], v36 offset:16896
s_waitcnt lgkmcnt(6)
v_mfma_f32_16x16x32_bf16 a[8:11], a[56:59], v[156:159], a[8:11]
ds_read_b64_tr_b16 a[82:83], v36 offset:25344
s_add_u32 m0, s49, 70752
s_add_u32 s48, s56, 143616
v_mfma_f32_16x16x32_bf16 a[24:27], a[56:59], a[208:211], a[24:27]
buffer_load_dwordx4 v2, s[12:15], s48 offen nt lds
v_mfma_f32_16x16x32_bf16 a[12:15], a[60:63], v[156:159], a[12:15]
ds_read_b64_tr_b16 a[84:85], v37 offset:16896
v_mfma_f32_16x16x32_bf16 a[28:31], a[60:63], a[208:211], a[28:31]
ds_read_b64_tr_b16 a[86:87], v37 offset:25344
ds_read_b64_tr_b16 a[48:49], v32 offset:25344
v_mfma_f32_16x16x32_bf16 a[0:3], a[64:67], v[160:163], a[0:3]
ds_read_b64_tr_b16 a[50:51], v32 offset:27456
v_mfma_f32_16x16x32_bf16 a[16:19], a[64:67], a[212:215], a[16:19]
ds_read_b64_tr_b16 a[52:53], v33 offset:25344
s_waitcnt lgkmcnt(5)
v_mfma_f32_16x16x32_bf16 a[4:7], a[68:71], v[160:163], a[4:7]
ds_read_b64_tr_b16 a[54:55], v33 offset:27456
ds_read_b64_tr_b16 a[56:57], v34 offset:25344
v_mfma_f32_16x16x32_bf16 a[20:23], a[68:71], a[212:215], a[20:23]
ds_read_b64_tr_b16 a[58:59], v34 offset:27456
v_mfma_f32_16x16x32_bf16 a[8:11], a[72:75], v[160:163], a[8:11]
ds_read_b64_tr_b16 a[60:61], v35 offset:25344
ds_read_b64_tr_b16 a[62:63], v35 offset:27456
v_mfma_f32_16x16x32_bf16 a[24:27], a[72:75], a[212:215], a[24:27]
s_add_u32 m0, s49, 71808
s_add_u32 s48, s56, 147712
v_mfma_f32_16x16x32_bf16 a[12:15], a[76:79], v[160:163], a[12:15]
buffer_load_dwordx4 v2, s[12:15], s48 offen nt lds
ds_read_b64_tr_b16 a[64:65], v32 offset:29568
v_mfma_f32_16x16x32_bf16 a[28:31], a[76:79], a[212:215], a[28:31]
ds_read_b64_tr_b16 a[66:67], v32 offset:31680
v_mfma_f32_16x16x32_bf16 a[32:35], a[80:83], a[252:255], a[32:35]
ds_read_b64_tr_b16 a[68:69], v33 offset:29568
s_waitcnt lgkmcnt(3)
v_mfma_f32_16x16x32_bf16 a[36:39], a[84:87], a[252:255], a[36:39]
ds_read_b64_tr_b16 a[70:71], v33 offset:31680
ds_read_b64_tr_b16 a[72:73], v34 offset:29568
v_mfma_f32_16x16x32_bf16 a[0:3], a[48:51], v[164:167], a[0:3]
ds_read_b64_tr_b16 a[74:75], v34 offset:31680
v_mfma_f32_16x16x32_bf16 a[16:19], a[48:51], a[216:219], a[16:19]
ds_read_b64_tr_b16 a[76:77], v35 offset:29568
ds_read_b64_tr_b16 a[78:79], v35 offset:31680
v_mfma_f32_16x16x32_bf16 a[4:7], a[52:55], v[164:167], a[4:7]
ds_read_b64_tr_b16 a[80:81], v38 offset:16896
v_mfma_f32_16x16x32_bf16 a[20:23], a[52:55], a[216:219], a[20:23]
ds_read_b64_tr_b16 a[82:83], v38 offset:25344
s_add_u32 m0, s49, 72864
s_add_u32 s48, s56, 151808
v_mfma_f32_16x16x32_bf16 a[8:11], a[56:59], v[164:167], a[8:11]
buffer_load_dwordx4 v2, s[12:15], s48 offen nt lds
v_mfma_f32_16x16x32_bf16 a[24:27], a[56:59], a[216:219], a[24:27]
ds_read_b64_tr_b16 a[84:85], v39 offset:16896
ds_read_b64_tr_b16 a[86:87], v39 offset:25344
v_mfma_f32_16x16x32_bf16 a[12:15], a[60:63], v[164:167], a[12:15]
v_add_u32 v32, 33792, v32
v_mfma_f32_16x16x32_bf16 a[28:31], a[60:63], a[216:219], a[28:31]
v_add_u32 v33, 33792, v33
s_waitcnt lgkmcnt(2)
v_mfma_f32_16x16x32_bf16 a[0:3], a[64:67], v[168:171], a[0:3]
v_add_u32 v34, 33792, v34
v_add_u32 v35, 33792, v35
v_mfma_f32_16x16x32_bf16 a[16:19], a[64:67], a[220:223], a[16:19]
v_add_u32 v36, 33792, v36
v_mfma_f32_16x16x32_bf16 a[4:7], a[68:71], v[168:171], a[4:7]
v_add_u32 v37, 33792, v37
v_mfma_f32_16x16x32_bf16 a[20:23], a[68:71], a[220:223], a[20:23]
v_add_u32 v38, 33792, v38
v_add_u32 v39, 33792, v39
L_stage31:
s_waitcnt vmcnt(6)
s_waitcnt lgkmcnt(0)
s_barrier
ds_read_b64_tr_b16 a[48:49], v32
ds_read_b64_tr_b16 a[50:51], v32 offset:2112
ds_read_b64_tr_b16 a[52:53], v33
ds_read_b64_tr_b16 a[54:55], v33 offset:2112
v_mfma_f32_16x16x32_bf16 a[8:11], a[72:75], v[168:171], a[8:11]
ds_read_b64_tr_b16 a[56:57], v34
ds_read_b64_tr_b16 a[58:59], v34 offset:2112
ds_read_b64_tr_b16 a[60:61], v35
ds_read_b64_tr_b16 a[62:63], v35 offset:2112
v_mfma_f32_16x16x32_bf16 a[24:27], a[72:75], a[220:223], a[24:27]
ds_read_b64_tr_b16 a[64:65], v32 offset:4224
ds_read_b64_tr_b16 a[66:67], v32 offset:6336
s_add_u32 m0, s49, 73920
s_add_u32 s48, s56, 155904
buffer_load_dwordx4 v2, s[12:15], s48 offen nt lds
v_mfma_f32_16x16x32_bf16 a[12:15], a[76:79], v[168:171], a[12:15]
ds_read_b64_tr_b16 a[68:69], v33 offset:4224
ds_read_b64_tr_b16 a[70:71], v33 offset:6336
ds_read_b64_tr_b16 a[72:73], v34 offset:4224
ds_read_b64_tr_b16 a[74:75], v34 offset:6336
v_mfma_f32_16x16x32_bf16 a[28:31], a[76:79], a[220:223], a[28:31]
ds_read_b64_tr_b16 a[76:77], v35 offset:4224
ds_read_b64_tr_b16 a[78:79], v35 offset:6336
v_accvgpr_read_b32 v12, a0
v_accvgpr_read_b32 v13, a1
v_accvgpr_read_b32 v14, a2
v_accvgpr_read_b32 v15, a3
v_mul_f32 v12, v12, v4
v_mul_f32 v13, v13, v4
v_mul_f32 v14, v14, v4
v_mul_f32 v15, v15, v4
v_cvt_pk_bf16_f32 v16, v12, v13
v_cvt_pk_bf16_f32 v17, v14, v15
v_accvgpr_write_b32 a124, v16
v_mfma_f32_16x16x32_bf16 a[40:43], a[80:83], a[252:255], a[40:43]
v_accvgpr_write_b32 a125, v17
v_accvgpr_read_b32 v18, a4
v_accvgpr_read_b32 v19, a5
v_accvgpr_read_b32 v20, a6
v_accvgpr_read_b32 v21, a7
v_mul_f32 v18, v18, v4
v_mul_f32 v19, v19, v4
v_mul_f32 v20, v20, v4
v_mul_f32 v21, v21, v4
v_cvt_pk_bf16_f32 v22, v18, v19
v_cvt_pk_bf16_f32 v23, v20, v21
v_accvgpr_write_b32 a126, v22
v_accvgpr_write_b32 a127, v23
v_accvgpr_read_b32 v12, a8
v_mfma_f32_16x16x32_bf16 a[44:47], a[84:87], a[252:255], a[44:47]
v_accvgpr_read_b32 v13, a9
v_accvgpr_read_b32 v14, a10
v_accvgpr_read_b32 v15, a11
v_mul_f32 v12, v12, v4
v_mul_f32 v13, v13, v4
v_mul_f32 v14, v14, v4
v_mul_f32 v15, v15, v4
v_cvt_pk_bf16_f32 v16, v12, v13
v_cvt_pk_bf16_f32 v17, v14, v15
v_accvgpr_write_b32 a128, v16
v_accvgpr_write_b32 a129, v17
v_accvgpr_read_b32 v18, a12
v_accvgpr_read_b32 v19, a13
s_waitcnt lgkmcnt(0)
v_mfma_f32_16x16x32_bf16 a[0:3], a[48:51], v[44:47], 0
v_accvgpr_read_b32 v20, a14
v_accvgpr_read_b32 v21, a15
v_mul_f32 v18, v18, v4
v_mul_f32 v19, v19, v4
v_mul_f32 v20, v20, v4
v_mul_f32 v21, v21, v4
v_cvt_pk_bf16_f32 v22, v18, v19
v_cvt_pk_bf16_f32 v23, v20, v21
v_accvgpr_write_b32 a130, v22
v_accvgpr_write_b32 a131, v23
v_accvgpr_read_b32 v12, a16
v_accvgpr_read_b32 v13, a17
v_accvgpr_read_b32 v14, a18
v_accvgpr_read_b32 v15, a19
v_mfma_f32_16x16x32_bf16 a[16:19], a[48:51], v[172:175], 0
v_mul_f32 v12, v12, v5
v_mul_f32 v13, v13, v5
v_mul_f32 v14, v14, v5
v_mul_f32 v15, v15, v5
v_cvt_pk_bf16_f32 v16, v12, v13
v_cvt_pk_bf16_f32 v17, v14, v15
v_accvgpr_write_b32 a132, v16
v_accvgpr_write_b32 a133, v17
v_mfma_f32_16x16x32_bf16 a[4:7], a[52:55], v[44:47], 0
v_accvgpr_read_b32 v18, a20
v_accvgpr_read_b32 v19, a21
v_accvgpr_read_b32 v20, a22
v_accvgpr_read_b32 v21, a23
v_mul_f32 v18, v18, v5
v_mul_f32 v19, v19, v5
v_mul_f32 v20, v20, v5
v_mul_f32 v21, v21, v5
v_cvt_pk_bf16_f32 v22, v18, v19
v_mfma_f32_16x16x32_bf16 a[20:23], a[52:55], v[172:175], 0
v_cvt_pk_bf16_f32 v23, v20, v21
v_accvgpr_write_b32 a134, v22
v_accvgpr_write_b32 a135, v23
v_accvgpr_read_b32 v12, a24
v_accvgpr_read_b32 v13, a25
v_accvgpr_read_b32 v14, a26
v_accvgpr_read_b32 v15, a27
v_mul_f32 v12, v12, v5
v_mfma_f32_16x16x32_bf16 a[8:11], a[56:59], v[44:47], 0
v_mul_f32 v13, v13, v5
v_mul_f32 v14, v14, v5
v_mul_f32 v15, v15, v5
v_cvt_pk_bf16_f32 v16, v12, v13
v_cvt_pk_bf16_f32 v17, v14, v15
v_accvgpr_write_b32 a136, v16
v_accvgpr_write_b32 a137, v17
v_accvgpr_read_b32 v18, a28
v_mfma_f32_16x16x32_bf16 a[24:27], a[56:59], v[172:175], 0
v_accvgpr_read_b32 v19, a29
v_accvgpr_read_b32 v20, a30
v_accvgpr_read_b32 v21, a31
v_mul_f32 v18, v18, v5
v_mul_f32 v19, v19, v5
v_mul_f32 v20, v20, v5
v_mul_f32 v21, v21, v5
v_cvt_pk_bf16_f32 v22, v18, v19
v_cvt_pk_bf16_f32 v23, v20, v21
v_mfma_f32_16x16x32_bf16 a[12:15], a[60:63], v[44:47], 0
v_accvgpr_write_b32 a138, v22
v_accvgpr_write_b32 a139, v23
s_lshl_b32 s4, s3, 12
s_add_u32 s4, s4, 138240
v_add_u32 v7, s4, v1
v_accvgpr_read_b32 v24, a32
v_accvgpr_read_b32 v25, a33
v_accvgpr_read_b32 v26, a34
v_accvgpr_read_b32 v27, a35
v_mfma_f32_16x16x32_bf16 a[28:31], a[60:63], v[172:175], 0
v_mul_f32 v24, v24, v6
v_mul_f32 v25, v25, v6
v_mul_f32 v26, v26, v6
v_mul_f32 v27, v27, v6
ds_write_b128 v7, v[24:27]
v_accvgpr_read_b32 v28, a36
v_accvgpr_read_b32 v29, a37
v_accvgpr_read_b32 v30, a38
v_accvgpr_read_b32 v31, a39
v_mfma_f32_16x16x32_bf16 a[0:3], a[64:67], v[48:51], a[0:3]
v_mul_f32 v28, v28, v6
v_mul_f32 v29, v29, v6
v_mul_f32 v30, v30, v6
v_mul_f32 v31, v31, v6
ds_write_b128 v7, v[28:31] offset:1024
v_accvgpr_read_b32 v24, a40
v_accvgpr_read_b32 v25, a41
v_accvgpr_read_b32 v26, a42
v_mfma_f32_16x16x32_bf16 a[16:19], a[64:67], v[176:179], a[16:19]
v_accvgpr_read_b32 v27, a43
v_mul_f32 v24, v24, v6
v_mul_f32 v25, v25, v6
v_mul_f32 v26, v26, v6
v_mul_f32 v27, v27, v6
ds_write_b128 v7, v[24:27] offset:2048
v_accvgpr_read_b32 v28, a44
v_accvgpr_read_b32 v29, a45
v_mfma_f32_16x16x32_bf16 a[4:7], a[68:71], v[48:51], a[4:7]
v_accvgpr_read_b32 v30, a46
v_accvgpr_read_b32 v31, a47
v_mul_f32 v28, v28, v6
v_mul_f32 v29, v29, v6
v_mul_f32 v30, v30, v6
v_mul_f32 v31, v31, v6
ds_write_b128 v7, v[28:31] offset:3072
ds_read_b64_tr_b16 a[80:81], v36
ds_read_b64_tr_b16 a[82:83], v36 offset:8448
v_mfma_f32_16x16x32_bf16 a[20:23], a[68:71], v[176:179], a[20:23]
ds_read_b64_tr_b16 a[84:85], v37
ds_read_b64_tr_b16 a[86:87], v37 offset:8448
v_mfma_f32_16x16x32_bf16 a[8:11], a[72:75], v[48:51], a[8:11]
ds_read_b64_tr_b16 a[48:49], v32 offset:8448
ds_read_b64_tr_b16 a[50:51], v32 offset:10560
s_add_u32 m0, s49, 74976
v_mfma_f32_16x16x32_bf16 a[24:27], a[72:75], v[176:179], a[24:27]
s_add_u32 s48, s56, 160000
buffer_load_dwordx4 v2, s[12:15], s48 offen nt lds
v_mfma_f32_16x16x32_bf16 a[12:15], a[76:79], v[48:51], a[12:15]
ds_read_b64_tr_b16 a[52:53], v33 offset:8448
ds_read_b64_tr_b16 a[54:55], v33 offset:10560
v_mfma_f32_16x16x32_bf16 a[28:31], a[76:79], v[176:179], a[28:31]
ds_read_b64_tr_b16 a[56:57], v34 offset:8448
s_waitcnt lgkmcnt(3)
v_mfma_f32_16x16x32_bf16 a[32:35], a[80:83], a[224:227], 0
ds_read_b64_tr_b16 a[58:59], v34 offset:10560
ds_read_b64_tr_b16 a[60:61], v35 offset:8448
v_mfma_f32_16x16x32_bf16 a[36:39], a[84:87], a[224:227], 0
ds_read_b64_tr_b16 a[62:63], v35 offset:10560
v_mfma_f32_16x16x32_bf16 a[0:3], a[48:51], v[52:55], a[0:3]
ds_read_b64_tr_b16 a[64:65], v32 offset:12672
ds_read_b64_tr_b16 a[66:67], v32 offset:14784
v_mfma_f32_16x16x32_bf16 a[16:19], a[48:51], v[180:183], a[16:19]
s_add_u32 m0, s49, 0
s_add_u32 s48, s56, 262400
s_waitcnt lgkmcnt(4)
v_mfma_f32_16x16x32_bf16 a[4:7], a[52:55], v[52:55], a[4:7]
buffer_load_dwordx4 v2, s[12:15], s48 offen nt lds
ds_read_b64_tr_b16 a[68:69], v33 offset:12672
v_mfma_f32_16x16x32_bf16 a[20:23], a[52:55], v[180:183], a[20:23]
ds_read_b64_tr_b16 a[70:71], v33 offset:14784
v_mfma_f32_16x16x32_bf16 a[8:11], a[56:59], v[52:55], a[8:11]
ds_read_b64_tr_b16 a[72:73], v34 offset:12672
ds_read_b64_tr_b16 a[74:75], v34 offset:14784
v_mfma_f32_16x16x32_bf16 a[24:27], a[56:59], v[180:183], a[24:27]
ds_read_b64_tr_b16 a[76:77], v35 offset:12672
s_waitcnt lgkmcnt(5)
v_mfma_f32_16x16x32_bf16 a[12:15], a[60:63], v[52:55], a[12:15]
ds_read_b64_tr_b16 a[78:79], v35 offset:14784
ds_read_b64_tr_b16 a[80:81], v38
v_mfma_f32_16x16x32_bf16 a[28:31], a[60:63], v[180:183], a[28:31]
ds_read_b64_tr_b16 a[82:83], v38 offset:8448
v_mfma_f32_16x16x32_bf16 a[0:3], a[64:67], v[56:59], a[0:3]
ds_read_b64_tr_b16 a[84:85], v39
v_mfma_f32_16x16x32_bf16 a[16:19], a[64:67], v[184:187], a[16:19]
ds_read_b64_tr_b16 a[86:87], v39 offset:8448
s_add_u32 m0, s49, 1056
s_add_u32 s48, s56, 266496
s_waitcnt lgkmcnt(4)
v_mfma_f32_16x16x32_bf16 a[4:7], a[68:71], v[56:59], a[4:7]
buffer_load_dwordx4 v2, s[12:15], s48 offen nt lds
ds_read_b64_tr_b16 a[48:49], v32 offset:16896
v_mfma_f32_16x16x32_bf16 a[20:23], a[68:71], v[184:187], a[20:23]
ds_read_b64_tr_b16 a[50:51], v32 offset:19008
v_mfma_f32_16x16x32_bf16 a[8:11], a[72:75], v[56:59], a[8:11]
ds_read_b64_tr_b16 a[52:53], v33 offset:16896
ds_read_b64_tr_b16 a[54:55], v33 offset:19008
v_mfma_f32_16x16x32_bf16 a[24:27], a[72:75], v[184:187], a[24:27]
ds_read_b64_tr_b16 a[56:57], v34 offset:16896
v_mfma_f32_16x16x32_bf16 a[12:15], a[76:79], v[56:59], a[12:15]
ds_read_b64_tr_b16 a[58:59], v34 offset:19008
ds_read_b64_tr_b16 a[60:61], v35 offset:16896
v_mfma_f32_16x16x32_bf16 a[28:31], a[76:79], v[184:187], a[28:31]
ds_read_b64_tr_b16 a[62:63], v35 offset:19008
s_add_u32 m0, s49, 2112
s_waitcnt lgkmcnt(5)
v_mfma_f32_16x16x32_bf16 a[40:43], a[80:83], a[224:227], 0
s_add_u32 s48, s56, 270592
buffer_load_dwordx4 v2, s[12:15], s48 offen nt lds
v_mfma_f32_16x16x32_bf16 a[44:47], a[84:87], a[224:227], 0
ds_read_b64_tr_b16 a[64:65], v32 offset:21120
v_mfma_f32_16x16x32_bf16 a[0:3], a[48:51], v[60:63], a[0:3]
ds_read_b64_tr_b16 a[66:67], v32 offset:23232
ds_read_b64_tr_b16 a[68:69], v33 offset:21120
v_mfma_f32_16x16x32_bf16 a[16:19], a[48:51], v[188:191], a[16:19]
ds_read_b64_tr_b16 a[70:71], v33 offset:23232
s_waitcnt lgkmcnt(4)
v_mfma_f32_16x16x32_bf16 a[4:7], a[52:55], v[60:63], a[4:7]
ds_read_b64_tr_b16 a[72:73], v34 offset:21120
ds_read_b64_tr_b16 a[74:75], v34 offset:23232
v_mfma_f32_16x16x32_bf16 a[20:23], a[52:55], v[188:191], a[20:23]
ds_read_b64_tr_b16 a[76:77], v35 offset:21120
v_mfma_f32_16x16x32_bf16 a[8:11], a[56:59], v[60:63], a[8:11]
ds_read_b64_tr_b16 a[78:79], v35 offset:23232
ds_read_b64_tr_b16 a[80:81], v36 offset:16896
v_mfma_f32_16x16x32_bf16 a[24:27], a[56:59], v[188:191], a[24:27]
ds_read_b64_tr_b16 a[82:83], v36 offset:25344
s_add_u32 m0, s49, 3168
v_mfma_f32_16x16x32_bf16 a[12:15], a[60:63], v[60:63], a[12:15]
s_add_u32 s48, s56, 274688
buffer_load_dwordx4 v2, s[12:15], s48 offen nt lds
v_mfma_f32_16x16x32_bf16 a[28:31], a[60:63], v[188:191], a[28:31]
ds_read_b64_tr_b16 a[84:85], v37 offset:16896
s_waitcnt lgkmcnt(3)
v_mfma_f32_16x16x32_bf16 a[0:3], a[64:67], v[64:67], a[0:3]
ds_read_b64_tr_b16 a[86:87], v37 offset:25344
ds_read_b64_tr_b16 a[48:49], v32 offset:25344
v_mfma_f32_16x16x32_bf16 a[16:19], a[64:67], v[192:195], a[16:19]
ds_read_b64_tr_b16 a[50:51], v32 offset:27456
v_mfma_f32_16x16x32_bf16 a[4:7], a[68:71], v[64:67], a[4:7]
ds_read_b64_tr_b16 a[52:53], v33 offset:25344
ds_read_b64_tr_b16 a[54:55], v33 offset:27456
v_mfma_f32_16x16x32_bf16 a[20:23], a[68:71], v[192:195], a[20:23]
ds_read_b64_tr_b16 a[56:57], v34 offset:25344
v_mfma_f32_16x16x32_bf16 a[8:11], a[72:75], v[64:67], a[8:11]
ds_read_b64_tr_b16 a[58:59], v34 offset:27456
v_mfma_f32_16x16x32_bf16 a[24:27], a[72:75], v[192:195], a[24:27]
ds_read_b64_tr_b16 a[60:61], v35 offset:25344
ds_read_b64_tr_b16 a[62:63], v35 offset:27456
s_add_u32 m0, s49, 4224
v_mfma_f32_16x16x32_bf16 a[12:15], a[76:79], v[64:67], a[12:15]
s_add_u32 s48, s56, 278784
buffer_load_dwordx4 v2, s[12:15], s48 offen nt lds
v_mfma_f32_16x16x32_bf16 a[28:31], a[76:79], v[192:195], a[28:31]
ds_read_b64_tr_b16 a[64:65], v32 offset:29568
s_waitcnt lgkmcnt(3)
v_mfma_f32_16x16x32_bf16 a[32:35], a[80:83], a[228:231], a[32:35]
ds_read_b64_tr_b16 a[66:67], v32 offset:31680
ds_read_b64_tr_b16 a[68:69], v33 offset:29568
v_mfma_f32_16x16x32_bf16 a[36:39], a[84:87], a[228:231], a[36:39]
ds_read_b64_tr_b16 a[70:71], v33 offset:31680
v_mfma_f32_16x16x32_bf16 a[0:3], a[48:51], v[68:71], a[0:3]
ds_read_b64_tr_b16 a[72:73], v34 offset:29568
ds_read_b64_tr_b16 a[74:75], v34 offset:31680
v_mfma_f32_16x16x32_bf16 a[16:19], a[48:51], v[196:199], a[16:19]
ds_read_b64_tr_b16 a[76:77], v35 offset:29568
v_mfma_f32_16x16x32_bf16 a[4:7], a[52:55], v[68:71], a[4:7]
ds_read_b64_tr_b16 a[78:79], v35 offset:31680
v_mfma_f32_16x16x32_bf16 a[20:23], a[52:55], v[196:199], a[20:23]
ds_read_b64_tr_b16 a[80:81], v38 offset:16896
ds_read_b64_tr_b16 a[82:83], v38 offset:25344
s_add_u32 m0, s49, 5280
v_mfma_f32_16x16x32_bf16 a[8:11], a[56:59], v[68:71], a[8:11]
s_add_u32 s48, s56, 282880
buffer_load_dwordx4 v2, s[12:15], s48 offen nt lds
v_mfma_f32_16x16x32_bf16 a[24:27], a[56:59], v[196:199], a[24:27]
ds_read_b64_tr_b16 a[84:85], v39 offset:16896
s_waitcnt lgkmcnt(3)
v_mfma_f32_16x16x32_bf16 a[12:15], a[60:63], v[68:71], a[12:15]
ds_read_b64_tr_b16 a[86:87], v39 offset:25344
v_add_u32 v32, 33792, v32
v_mfma_f32_16x16x32_bf16 a[28:31], a[60:63], v[196:199], a[28:31]
v_add_u32 v33, 33792, v33
v_mfma_f32_16x16x32_bf16 a[0:3], a[64:67], v[72:75], a[0:3]
v_add_u32 v34, 33792, v34
v_add_u32 v35, 33792, v35
v_mfma_f32_16x16x32_bf16 a[16:19], a[64:67], v[200:203], a[16:19]
v_add_u32 v36, 33792, v36
v_mfma_f32_16x16x32_bf16 a[4:7], a[68:71], v[72:75], a[4:7]
v_add_u32 v37, 33792, v37
v_mfma_f32_16x16x32_bf16 a[20:23], a[68:71], v[200:203], a[20:23]
v_add_u32 v38, 33792, v38
v_add_u32 v39, 33792, v39
L_stage32:
s_waitcnt vmcnt(6)
s_waitcnt lgkmcnt(0)
s_barrier
ds_read_b64_tr_b16 a[48:49], v32
ds_read_b64_tr_b16 a[50:51], v32 offset:2112
v_mfma_f32_16x16x32_bf16 a[8:11], a[72:75], v[72:75], a[8:11]
ds_read_b64_tr_b16 a[52:53], v33
ds_read_b64_tr_b16 a[54:55], v33 offset:2112
v_mfma_f32_16x16x32_bf16 a[24:27], a[72:75], v[200:203], a[24:27]
ds_read_b64_tr_b16 a[56:57], v34
ds_read_b64_tr_b16 a[58:59], v34 offset:2112
v_mfma_f32_16x16x32_bf16 a[12:15], a[76:79], v[72:75], a[12:15]
ds_read_b64_tr_b16 a[60:61], v35
ds_read_b64_tr_b16 a[62:63], v35 offset:2112
v_mfma_f32_16x16x32_bf16 a[28:31], a[76:79], v[200:203], a[28:31]
ds_read_b64_tr_b16 a[64:65], v32 offset:4224
ds_read_b64_tr_b16 a[66:67], v32 offset:6336
v_mfma_f32_16x16x32_bf16 a[40:43], a[80:83], a[228:231], a[40:43]
s_add_u32 m0, s49, 6336
s_add_u32 s48, s56, 286976
buffer_load_dwordx4 v2, s[12:15], s48 offen nt lds
v_mfma_f32_16x16x32_bf16 a[44:47], a[84:87], a[228:231], a[44:47]
ds_read_b64_tr_b16 a[68:69], v33 offset:4224
ds_read_b64_tr_b16 a[70:71], v33 offset:6336
s_waitcnt lgkmcnt(4)
v_mfma_f32_16x16x32_bf16 a[0:3], a[48:51], v[76:79], a[0:3]
ds_read_b64_tr_b16 a[72:73], v34 offset:4224
ds_read_b64_tr_b16 a[74:75], v34 offset:6336
v_mfma_f32_16x16x32_bf16 a[16:19], a[48:51], v[204:207], a[16:19]
ds_read_b64_tr_b16 a[76:77], v35 offset:4224
ds_read_b64_tr_b16 a[78:79], v35 offset:6336
v_mfma_f32_16x16x32_bf16 a[4:7], a[52:55], v[76:79], a[4:7]
ds_read_b64_tr_b16 a[80:81], v36
ds_read_b64_tr_b16 a[82:83], v36 offset:8448
v_mfma_f32_16x16x32_bf16 a[20:23], a[52:55], v[204:207], a[20:23]
ds_read_b64_tr_b16 a[84:85], v37
ds_read_b64_tr_b16 a[86:87], v37 offset:8448
v_mfma_f32_16x16x32_bf16 a[8:11], a[56:59], v[76:79], a[8:11]
s_add_u32 m0, s49, 7392
s_add_u32 s48, s56, 291072
buffer_load_dwordx4 v2, s[12:15], s48 offen nt lds
v_mfma_f32_16x16x32_bf16 a[24:27], a[56:59], v[204:207], a[24:27]
ds_read_b64_tr_b16 a[48:49], v32 offset:8448
ds_read_b64_tr_b16 a[50:51], v32 offset:10560
v_mfma_f32_16x16x32_bf16 a[12:15], a[60:63], v[76:79], a[12:15]
ds_read_b64_tr_b16 a[52:53], v33 offset:8448
ds_read_b64_tr_b16 a[54:55], v33 offset:10560
v_mfma_f32_16x16x32_bf16 a[28:31], a[60:63], v[204:207], a[28:31]
ds_read_b64_tr_b16 a[56:57], v34 offset:8448
ds_read_b64_tr_b16 a[58:59], v34 offset:10560
s_waitcnt lgkmcnt(6)
v_mfma_f32_16x16x32_bf16 a[0:3], a[64:67], v[80:83], a[0:3]
ds_read_b64_tr_b16 a[60:61], v35 offset:8448
ds_read_b64_tr_b16 a[62:63], v35 offset:10560
s_lshl_b32 s4, s3, 10
v_mfma_f32_16x16x32_bf16 a[16:19], a[64:67], v[208:211], a[16:19]
s_add_u32 s4, s4, 138240
v_add_u32 v7, s4, v1
v_mfma_f32_16x16x32_bf16 a[4:7], a[68:71], v[80:83], a[4:7]
ds_read_b128 v[12:15], v7
ds_read_b128 v[16:19], v7 offset:4096
v_mfma_f32_16x16x32_bf16 a[20:23], a[68:71], v[208:211], a[20:23]
ds_read_b128 v[20:23], v7 offset:8192
ds_read_b128 v[24:27], v7 offset:12288
v_mfma_f32_16x16x32_bf16 a[8:11], a[72:75], v[80:83], a[8:11]
s_waitcnt lgkmcnt(2)
v_add_f32 v12, v12, v16
s_waitcnt lgkmcnt(0)
v_add_f32 v20, v20, v24
v_mfma_f32_16x16x32_bf16 a[24:27], a[72:75], v[208:211], a[24:27]
v_add_f32 v13, v13, v17
v_add_f32 v21, v21, v25
v_mfma_f32_16x16x32_bf16 a[12:15], a[76:79], v[80:83], a[12:15]
v_add_f32 v14, v14, v18
v_add_f32 v22, v22, v26
v_mfma_f32_16x16x32_bf16 a[28:31], a[76:79], v[208:211], a[28:31]
v_add_f32 v15, v15, v19
v_add_f32 v23, v23, v27
v_mfma_f32_16x16x32_bf16 a[32:35], a[80:83], a[232:235], a[32:35]
v_add_f32 v12, v12, v20
v_add_f32 v13, v13, v21
v_mfma_f32_16x16x32_bf16 a[36:39], a[84:87], a[232:235], a[36:39]
v_add_f32 v14, v14, v22
v_add_f32 v15, v15, v23
v_mfma_f32_16x16x32_bf16 a[0:3], a[48:51], v[84:87], a[0:3]
v_cvt_pk_bf16_f32 v16, v12, v13
v_cvt_pk_bf16_f32 v17, v14, v15
v_mfma_f32_16x16x32_bf16 a[16:19], a[48:51], v[212:215], a[16:19]
v_accvgpr_write_b32 a140, v16
v_accvgpr_write_b32 a141, v17
v_mfma_f32_16x16x32_bf16 a[4:7], a[52:55], v[84:87], a[4:7]
ds_read_b64_tr_b16 a[64:65], v32 offset:12672
ds_read_b64_tr_b16 a[66:67], v32 offset:14784
v_mfma_f32_16x16x32_bf16 a[20:23], a[52:55], v[212:215], a[20:23]
ds_read_b64_tr_b16 a[68:69], v33 offset:12672
v_mfma_f32_16x16x32_bf16 a[8:11], a[56:59], v[84:87], a[8:11]
ds_read_b64_tr_b16 a[70:71], v33 offset:14784
ds_read_b64_tr_b16 a[72:73], v34 offset:12672
v_mfma_f32_16x16x32_bf16 a[24:27], a[56:59], v[212:215], a[24:27]
ds_read_b64_tr_b16 a[74:75], v34 offset:14784
v_mfma_f32_16x16x32_bf16 a[12:15], a[60:63], v[84:87], a[12:15]
ds_read_b64_tr_b16 a[76:77], v35 offset:12672
ds_read_b64_tr_b16 a[78:79], v35 offset:14784
v_mfma_f32_16x16x32_bf16 a[28:31], a[60:63], v[212:215], a[28:31]
ds_read_b64_tr_b16 a[80:81], v38
s_waitcnt lgkmcnt(6)
v_mfma_f32_16x16x32_bf16 a[0:3], a[64:67], v[88:91], a[0:3]
ds_read_b64_tr_b16 a[82:83], v38 offset:8448
s_add_u32 m0, s49, 33792
s_add_u32 s48, s56, 393472
v_mfma_f32_16x16x32_bf16 a[16:19], a[64:67], v[216:219], a[16:19]
buffer_load_dwordx4 v2, s[12:15], s48 offen nt lds
ds_read_b64_tr_b16 a[84:85], v39
s_waitcnt lgkmcnt(3)
v_mfma_f32_16x16x32_bf16 a[4:7], a[68:71], v[88:91], a[4:7]
ds_read_b64_tr_b16 a[86:87], v39 offset:8448
v_mfma_f32_16x16x32_bf16 a[20:23], a[68:71], v[216:219], a[20:23]
ds_read_b64_tr_b16 a[48:49], v32 offset:16896
ds_read_b64_tr_b16 a[50:51], v32 offset:19008
v_mfma_f32_16x16x32_bf16 a[8:11], a[72:75], v[88:91], a[8:11]
ds_read_b64_tr_b16 a[52:53], v33 offset:16896
v_mfma_f32_16x16x32_bf16 a[24:27], a[72:75], v[216:219], a[24:27]
ds_read_b64_tr_b16 a[54:55], v33 offset:19008
s_add_u32 m0, s49, 34848
s_add_u32 s48, s56, 397568
v_mfma_f32_16x16x32_bf16 a[12:15], a[76:79], v[88:91], a[12:15]
buffer_load_dwordx4 v2, s[12:15], s48 offen nt lds
ds_read_b64_tr_b16 a[56:57], v34 offset:16896
v_mfma_f32_16x16x32_bf16 a[28:31], a[76:79], v[216:219], a[28:31]
ds_read_b64_tr_b16 a[58:59], v34 offset:19008
s_waitcnt lgkmcnt(3)
v_mfma_f32_16x16x32_bf16 a[40:43], a[80:83], a[232:235], a[40:43]
ds_read_b64_tr_b16 a[60:61], v35 offset:16896
ds_read_b64_tr_b16 a[62:63], v35 offset:19008
v_mfma_f32_16x16x32_bf16 a[44:47], a[84:87], a[232:235], a[44:47]
ds_read_b64_tr_b16 a[64:65], v32 offset:21120
v_mfma_f32_16x16x32_bf16 a[0:3], a[48:51], v[92:95], a[0:3]
ds_read_b64_tr_b16 a[66:67], v32 offset:23232
ds_read_b64_tr_b16 a[68:69], v33 offset:21120
v_mfma_f32_16x16x32_bf16 a[16:19], a[48:51], v[220:223], a[16:19]
ds_read_b64_tr_b16 a[70:71], v33 offset:23232
s_add_u32 m0, s49, 35904
s_add_u32 s48, s56, 401664
s_waitcnt lgkmcnt(4)
v_mfma_f32_16x16x32_bf16 a[4:7], a[52:55], v[92:95], a[4:7]
buffer_load_dwordx4 v2, s[12:15], s48 offen nt lds
v_mfma_f32_16x16x32_bf16 a[20:23], a[52:55], v[220:223], a[20:23]
ds_read_b64_tr_b16 a[72:73], v34 offset:21120
ds_read_b64_tr_b16 a[74:75], v34 offset:23232
v_mfma_f32_16x16x32_bf16 a[8:11], a[56:59], v[92:95], a[8:11]
ds_read_b64_tr_b16 a[76:77], v35 offset:21120
v_mfma_f32_16x16x32_bf16 a[24:27], a[56:59], v[220:223], a[24:27]
ds_read_b64_tr_b16 a[78:79], v35 offset:23232
ds_read_b64_tr_b16 a[80:81], v36 offset:16896
v_mfma_f32_16x16x32_bf16 a[12:15], a[60:63], v[92:95], a[12:15]
ds_read_b64_tr_b16 a[82:83], v36 offset:25344
v_mfma_f32_16x16x32_bf16 a[28:31], a[60:63], v[220:223], a[28:31]
ds_read_b64_tr_b16 a[84:85], v37 offset:16896
ds_read_b64_tr_b16 a[86:87], v37 offset:25344
s_waitcnt lgkmcnt(6)
v_mfma_f32_16x16x32_bf16 a[0:3], a[64:67], v[96:99], a[0:3]
ds_read_b64_tr_b16 a[48:49], v32 offset:25344
v_mfma_f32_16x16x32_bf16 a[16:19], a[64:67], v[224:227], a[16:19]
ds_read_b64_tr_b16 a[50:51], v32 offset:27456
s_add_u32 m0, s49, 36960
s_add_u32 s48, s56, 405760
v_mfma_f32_16x16x32_bf16 a[4:7], a[68:71], v[96:99], a[4:7]
buffer_load_dwordx4 v2, s[12:15], s48 offen nt lds
ds_read_b64_tr_b16 a[52:53], v33 offset:25344
v_mfma_f32_16x16x32_bf16 a[20:23], a[68:71], v[224:227], a[20:23]
ds_read_b64_tr_b16 a[54:55], v33 offset:27456
v_mfma_f32_16x16x32_bf16 a[8:11], a[72:75], v[96:99], a[8:11]
ds_read_b64_tr_b16 a[56:57], v34 offset:25344
v_mfma_f32_16x16x32_bf16 a[24:27], a[72:75], v[224:227], a[24:27]
ds_read_b64_tr_b16 a[58:59], v34 offset:27456
ds_read_b64_tr_b16 a[60:61], v35 offset:25344
s_waitcnt lgkmcnt(5)
v_mfma_f32_16x16x32_bf16 a[12:15], a[76:79], v[96:99], a[12:15]
ds_read_b64_tr_b16 a[62:63], v35 offset:27456
s_add_u32 m0, s49, 38016
s_add_u32 s48, s56, 409856
v_mfma_f32_16x16x32_bf16 a[28:31], a[76:79], v[224:227], a[28:31]
buffer_load_dwordx4 v2, s[12:15], s48 offen nt lds
v_mfma_f32_16x16x32_bf16 a[32:35], a[80:83], a[236:239], a[32:35]
ds_read_b64_tr_b16 a[64:65], v32 offset:29568
ds_read_b64_tr_b16 a[66:67], v32 offset:31680
v_mfma_f32_16x16x32_bf16 a[36:39], a[84:87], a[236:239], a[36:39]
ds_read_b64_tr_b16 a[68:69], v33 offset:29568
v_mfma_f32_16x16x32_bf16 a[0:3], a[48:51], v[100:103], a[0:3]
ds_read_b64_tr_b16 a[70:71], v33 offset:31680
ds_read_b64_tr_b16 a[72:73], v34 offset:29568
v_mfma_f32_16x16x32_bf16 a[16:19], a[48:51], v[228:231], a[16:19]
ds_read_b64_tr_b16 a[74:75], v34 offset:31680
s_waitcnt lgkmcnt(6)
v_mfma_f32_16x16x32_bf16 a[4:7], a[52:55], v[100:103], a[4:7]
ds_read_b64_tr_b16 a[76:77], v35 offset:29568
ds_read_b64_tr_b16 a[78:79], v35 offset:31680
v_mfma_f32_16x16x32_bf16 a[20:23], a[52:55], v[228:231], a[20:23]
ds_read_b64_tr_b16 a[80:81], v38 offset:16896
v_mfma_f32_16x16x32_bf16 a[8:11], a[56:59], v[100:103], a[8:11]
ds_read_b64_tr_b16 a[82:83], v38 offset:25344
s_add_u32 m0, s49, 39072
s_add_u32 s48, s56, 413952
v_mfma_f32_16x16x32_bf16 a[24:27], a[56:59], v[228:231], a[24:27]
buffer_load_dwordx4 v2, s[12:15], s48 offen nt lds
ds_read_b64_tr_b16 a[84:85], v39 offset:16896
v_mfma_f32_16x16x32_bf16 a[12:15], a[60:63], v[100:103], a[12:15]
ds_read_b64_tr_b16 a[86:87], v39 offset:25344
v_mfma_f32_16x16x32_bf16 a[28:31], a[60:63], v[228:231], a[28:31]
v_subrev_u32 v32, 67584, v32
v_subrev_u32 v33, 67584, v33
s_waitcnt lgkmcnt(2)
v_mfma_f32_16x16x32_bf16 a[0:3], a[64:67], v[104:107], a[0:3]
v_subrev_u32 v34, 67584, v34
v_mfma_f32_16x16x32_bf16 a[16:19], a[64:67], v[232:235], a[16:19]
v_subrev_u32 v35, 67584, v35
v_subrev_u32 v36, 67584, v36
v_mfma_f32_16x16x32_bf16 a[4:7], a[68:71], v[104:107], a[4:7]
v_subrev_u32 v37, 67584, v37
v_mfma_f32_16x16x32_bf16 a[20:23], a[68:71], v[232:235], a[20:23]
v_subrev_u32 v38, 67584, v38
v_subrev_u32 v39, 67584, v39
L_stage33:
s_waitcnt vmcnt(6)
s_waitcnt lgkmcnt(0)
s_barrier
ds_read_b64_tr_b16 a[48:49], v32
v_mfma_f32_16x16x32_bf16 a[8:11], a[72:75], v[104:107], a[8:11]
ds_read_b64_tr_b16 a[50:51], v32 offset:2112
ds_read_b64_tr_b16 a[52:53], v33
v_mfma_f32_16x16x32_bf16 a[24:27], a[72:75], v[232:235], a[24:27]
ds_read_b64_tr_b16 a[54:55], v33 offset:2112
v_mfma_f32_16x16x32_bf16 a[12:15], a[76:79], v[104:107], a[12:15]
ds_read_b64_tr_b16 a[56:57], v34
v_mfma_f32_16x16x32_bf16 a[28:31], a[76:79], v[232:235], a[28:31]
ds_read_b64_tr_b16 a[58:59], v34 offset:2112
ds_read_b64_tr_b16 a[60:61], v35
v_mfma_f32_16x16x32_bf16 a[40:43], a[80:83], a[236:239], a[40:43]
ds_read_b64_tr_b16 a[62:63], v35 offset:2112
v_mfma_f32_16x16x32_bf16 a[44:47], a[84:87], a[236:239], a[44:47]
ds_read_b64_tr_b16 a[64:65], v32 offset:4224
s_waitcnt lgkmcnt(5)
v_mfma_f32_16x16x32_bf16 a[0:3], a[48:51], v[108:111], a[0:3]
ds_read_b64_tr_b16 a[66:67], v32 offset:6336
s_add_u32 m0, s49, 40128
s_add_u32 s48, s56, 418048
v_mfma_f32_16x16x32_bf16 a[16:19], a[48:51], v[236:239], a[16:19]
buffer_load_dwordx4 v2, s[12:15], s48 offen nt lds
ds_read_b64_tr_b16 a[68:69], v33 offset:4224
v_mfma_f32_16x16x32_bf16 a[4:7], a[52:55], v[108:111], a[4:7]
ds_read_b64_tr_b16 a[70:71], v33 offset:6336
v_mfma_f32_16x16x32_bf16 a[20:23], a[52:55], v[236:239], a[20:23]
ds_read_b64_tr_b16 a[72:73], v34 offset:4224
s_waitcnt lgkmcnt(3)
v_mfma_f32_16x16x32_bf16 a[8:11], a[56:59], v[108:111], a[8:11]
ds_read_b64_tr_b16 a[74:75], v34 offset:6336
ds_read_b64_tr_b16 a[76:77], v35 offset:4224
v_mfma_f32_16x16x32_bf16 a[24:27], a[56:59], v[236:239], a[24:27]
ds_read_b64_tr_b16 a[78:79], v35 offset:6336
v_mfma_f32_16x16x32_bf16 a[12:15], a[60:63], v[108:111], a[12:15]
ds_read_b64_tr_b16 a[80:81], v36
v_mfma_f32_16x16x32_bf16 a[28:31], a[60:63], v[236:239], a[28:31]
ds_read_b64_tr_b16 a[82:83], v36 offset:8448
ds_read_b64_tr_b16 a[84:85], v37
v_mfma_f32_16x16x32_bf16 a[0:3], a[64:67], v[112:115], a[0:3]
ds_read_b64_tr_b16 a[86:87], v37 offset:8448
v_mfma_f32_16x16x32_bf16 a[16:19], a[64:67], v[240:243], a[16:19]
ds_read_b64_tr_b16 a[48:49], v32 offset:8448
ds_read_b64_tr_b16 a[50:51], v32 offset:10560
s_waitcnt lgkmcnt(6)
v_mfma_f32_16x16x32_bf16 a[4:7], a[68:71], v[112:115], a[4:7]
s_add_u32 m0, s49, 41184
s_add_u32 s48, s56, 422144
v_mfma_f32_16x16x32_bf16 a[20:23], a[68:71], v[240:243], a[20:23]
buffer_load_dwordx4 v2, s[12:15], s48 offen nt lds
ds_read_b64_tr_b16 a[52:53], v33 offset:8448
v_mfma_f32_16x16x32_bf16 a[8:11], a[72:75], v[112:115], a[8:11]
ds_read_b64_tr_b16 a[54:55], v33 offset:10560
v_mfma_f32_16x16x32_bf16 a[24:27], a[72:75], v[240:243], a[24:27]
ds_read_b64_tr_b16 a[56:57], v34 offset:8448
ds_read_b64_tr_b16 a[58:59], v34 offset:10560
v_mfma_f32_16x16x32_bf16 a[12:15], a[76:79], v[112:115], a[12:15]
ds_read_b64_tr_b16 a[60:61], v35 offset:8448
v_mfma_f32_16x16x32_bf16 a[28:31], a[76:79], v[240:243], a[28:31]
ds_read_b64_tr_b16 a[62:63], v35 offset:10560
s_waitcnt lgkmcnt(5)
v_mfma_f32_16x16x32_bf16 a[32:35], a[80:83], a[240:243], a[32:35]
ds_read_b64_tr_b16 a[64:65], v32 offset:12672
ds_read_b64_tr_b16 a[66:67], v32 offset:14784
v_mfma_f32_16x16x32_bf16 a[36:39], a[84:87], a[240:243], a[36:39]
s_add_u32 m0, s49, 67584
s_add_u32 s48, s56, 384
buffer_load_dwordx4 v2, s[12:15], s48 offen nt lds
v_mfma_f32_16x16x32_bf16 a[0:3], a[48:51], v[116:119], a[0:3]
ds_read_b64_tr_b16 a[68:69], v33 offset:12672
v_mfma_f32_16x16x32_bf16 a[16:19], a[48:51], v[244:247], a[16:19]
ds_read_b64_tr_b16 a[70:71], v33 offset:14784
s_waitcnt lgkmcnt(3)
v_mfma_f32_16x16x32_bf16 a[4:7], a[52:55], v[116:119], a[4:7]
ds_read_b64_tr_b16 a[72:73], v34 offset:12672
ds_read_b64_tr_b16 a[74:75], v34 offset:14784
v_mfma_f32_16x16x32_bf16 a[20:23], a[52:55], v[244:247], a[20:23]
ds_read_b64_tr_b16 a[76:77], v35 offset:12672
v_mfma_f32_16x16x32_bf16 a[8:11], a[56:59], v[116:119], a[8:11]
ds_read_b64_tr_b16 a[78:79], v35 offset:14784
v_mfma_f32_16x16x32_bf16 a[24:27], a[56:59], v[244:247], a[24:27]
ds_read_b64_tr_b16 a[80:81], v38
ds_read_b64_tr_b16 a[82:83], v38 offset:8448
v_mfma_f32_16x16x32_bf16 a[12:15], a[60:63], v[116:119], a[12:15]
ds_read_b64_tr_b16 a[84:85], v39
v_mfma_f32_16x16x32_bf16 a[28:31], a[60:63], v[244:247], a[28:31]
ds_read_b64_tr_b16 a[86:87], v39 offset:8448
s_add_u32 m0, s49, 68640
s_add_u32 s48, s56, 4480
s_waitcnt lgkmcnt(4)
v_mfma_f32_16x16x32_bf16 a[0:3], a[64:67], v[120:123], a[0:3]
buffer_load_dwordx4 v2, s[12:15], s48 offen nt lds
v_mfma_f32_16x16x32_bf16 a[16:19], a[64:67], v[248:251], a[16:19]
ds_read_b64_tr_b16 a[48:49], v32 offset:16896
ds_read_b64_tr_b16 a[50:51], v32 offset:19008
v_mfma_f32_16x16x32_bf16 a[4:7], a[68:71], v[120:123], a[4:7]
ds_read_b64_tr_b16 a[52:53], v33 offset:16896
v_mfma_f32_16x16x32_bf16 a[20:23], a[68:71], v[248:251], a[20:23]
ds_read_b64_tr_b16 a[54:55], v33 offset:19008
v_mfma_f32_16x16x32_bf16 a[8:11], a[72:75], v[120:123], a[8:11]
ds_read_b64_tr_b16 a[56:57], v34 offset:16896
ds_read_b64_tr_b16 a[58:59], v34 offset:19008
v_mfma_f32_16x16x32_bf16 a[24:27], a[72:75], v[248:251], a[24:27]
ds_read_b64_tr_b16 a[60:61], v35 offset:16896
v_mfma_f32_16x16x32_bf16 a[12:15], a[76:79], v[120:123], a[12:15]
ds_read_b64_tr_b16 a[62:63], v35 offset:19008
s_add_u32 m0, s49, 69696
s_add_u32 s48, s56, 8576
v_mfma_f32_16x16x32_bf16 a[28:31], a[76:79], v[248:251], a[28:31]
buffer_load_dwordx4 v2, s[12:15], s48 offen nt lds
s_waitcnt lgkmcnt(3)
v_mfma_f32_16x16x32_bf16 a[40:43], a[80:83], a[240:243], a[40:43]
ds_read_b64_tr_b16 a[64:65], v32 offset:21120
ds_read_b64_tr_b16 a[66:67], v32 offset:23232
v_mfma_f32_16x16x32_bf16 a[44:47], a[84:87], a[240:243], a[44:47]
ds_read_b64_tr_b16 a[68:69], v33 offset:21120
v_mfma_f32_16x16x32_bf16 a[0:3], a[48:51], v[124:127], a[0:3]
ds_read_b64_tr_b16 a[70:71], v33 offset:23232
ds_read_b64_tr_b16 a[72:73], v34 offset:21120
v_mfma_f32_16x16x32_bf16 a[16:19], a[48:51], v[252:255], a[16:19]
ds_read_b64_tr_b16 a[74:75], v34 offset:23232
v_mfma_f32_16x16x32_bf16 a[4:7], a[52:55], v[124:127], a[4:7]
ds_read_b64_tr_b16 a[76:77], v35 offset:21120
v_mfma_f32_16x16x32_bf16 a[20:23], a[52:55], v[252:255], a[20:23]
ds_read_b64_tr_b16 a[78:79], v35 offset:23232
ds_read_b64_tr_b16 a[80:81], v36 offset:16896
s_waitcnt lgkmcnt(6)
v_mfma_f32_16x16x32_bf16 a[8:11], a[56:59], v[124:127], a[8:11]
ds_read_b64_tr_b16 a[82:83], v36 offset:25344
s_add_u32 m0, s49, 70752
s_add_u32 s48, s56, 12672
v_mfma_f32_16x16x32_bf16 a[24:27], a[56:59], v[252:255], a[24:27]
buffer_load_dwordx4 v2, s[12:15], s48 offen nt lds
v_mfma_f32_16x16x32_bf16 a[12:15], a[60:63], v[124:127], a[12:15]
ds_read_b64_tr_b16 a[84:85], v37 offset:16896
v_mfma_f32_16x16x32_bf16 a[28:31], a[60:63], v[252:255], a[28:31]
ds_read_b64_tr_b16 a[86:87], v37 offset:25344
ds_read_b64_tr_b16 a[48:49], v32 offset:25344
v_mfma_f32_16x16x32_bf16 a[0:3], a[64:67], v[128:131], a[0:3]
ds_read_b64_tr_b16 a[50:51], v32 offset:27456
v_mfma_f32_16x16x32_bf16 a[16:19], a[64:67], a[180:183], a[16:19]
ds_read_b64_tr_b16 a[52:53], v33 offset:25344
s_waitcnt lgkmcnt(5)
v_mfma_f32_16x16x32_bf16 a[4:7], a[68:71], v[128:131], a[4:7]
ds_read_b64_tr_b16 a[54:55], v33 offset:27456
ds_read_b64_tr_b16 a[56:57], v34 offset:25344
v_mfma_f32_16x16x32_bf16 a[20:23], a[68:71], a[180:183], a[20:23]
ds_read_b64_tr_b16 a[58:59], v34 offset:27456
v_mfma_f32_16x16x32_bf16 a[8:11], a[72:75], v[128:131], a[8:11]
ds_read_b64_tr_b16 a[60:61], v35 offset:25344
ds_read_b64_tr_b16 a[62:63], v35 offset:27456
v_mfma_f32_16x16x32_bf16 a[24:27], a[72:75], a[180:183], a[24:27]
s_add_u32 m0, s49, 71808
s_add_u32 s48, s56, 16768
v_mfma_f32_16x16x32_bf16 a[12:15], a[76:79], v[128:131], a[12:15]
buffer_load_dwordx4 v2, s[12:15], s48 offen nt lds
ds_read_b64_tr_b16 a[64:65], v32 offset:29568
v_mfma_f32_16x16x32_bf16 a[28:31], a[76:79], a[180:183], a[28:31]
ds_read_b64_tr_b16 a[66:67], v32 offset:31680
v_mfma_f32_16x16x32_bf16 a[32:35], a[80:83], a[244:247], a[32:35]
ds_read_b64_tr_b16 a[68:69], v33 offset:29568
s_waitcnt lgkmcnt(3)
v_mfma_f32_16x16x32_bf16 a[36:39], a[84:87], a[244:247], a[36:39]
ds_read_b64_tr_b16 a[70:71], v33 offset:31680
ds_read_b64_tr_b16 a[72:73], v34 offset:29568
v_mfma_f32_16x16x32_bf16 a[0:3], a[48:51], v[132:135], a[0:3]
ds_read_b64_tr_b16 a[74:75], v34 offset:31680
v_mfma_f32_16x16x32_bf16 a[16:19], a[48:51], a[184:187], a[16:19]
ds_read_b64_tr_b16 a[76:77], v35 offset:29568
ds_read_b64_tr_b16 a[78:79], v35 offset:31680
v_mfma_f32_16x16x32_bf16 a[4:7], a[52:55], v[132:135], a[4:7]
ds_read_b64_tr_b16 a[80:81], v38 offset:16896
v_mfma_f32_16x16x32_bf16 a[20:23], a[52:55], a[184:187], a[20:23]
ds_read_b64_tr_b16 a[82:83], v38 offset:25344
s_add_u32 m0, s49, 72864
s_add_u32 s48, s56, 20864
v_mfma_f32_16x16x32_bf16 a[8:11], a[56:59], v[132:135], a[8:11]
buffer_load_dwordx4 v2, s[12:15], s48 offen nt lds
v_mfma_f32_16x16x32_bf16 a[24:27], a[56:59], a[184:187], a[24:27]
ds_read_b64_tr_b16 a[84:85], v39 offset:16896
ds_read_b64_tr_b16 a[86:87], v39 offset:25344
v_mfma_f32_16x16x32_bf16 a[12:15], a[60:63], v[132:135], a[12:15]
v_add_u32 v32, 33792, v32
v_mfma_f32_16x16x32_bf16 a[28:31], a[60:63], a[184:187], a[28:31]
v_add_u32 v33, 33792, v33
s_waitcnt lgkmcnt(2)
v_mfma_f32_16x16x32_bf16 a[0:3], a[64:67], v[136:139], a[0:3]
v_add_u32 v34, 33792, v34
v_add_u32 v35, 33792, v35
v_mfma_f32_16x16x32_bf16 a[16:19], a[64:67], a[188:191], a[16:19]
v_add_u32 v36, 33792, v36
v_mfma_f32_16x16x32_bf16 a[4:7], a[68:71], v[136:139], a[4:7]
v_add_u32 v37, 33792, v37
v_mfma_f32_16x16x32_bf16 a[20:23], a[68:71], a[188:191], a[20:23]
v_add_u32 v38, 33792, v38
v_add_u32 v39, 33792, v39
L_stage34:
s_waitcnt vmcnt(6)
s_waitcnt lgkmcnt(0)
s_barrier
ds_read_b64_tr_b16 a[48:49], v32
v_mfma_f32_16x16x32_bf16 a[8:11], a[72:75], v[136:139], a[8:11]
ds_read_b64_tr_b16 a[50:51], v32 offset:2112
ds_read_b64_tr_b16 a[52:53], v33
v_mfma_f32_16x16x32_bf16 a[24:27], a[72:75], a[188:191], a[24:27]
ds_read_b64_tr_b16 a[54:55], v33 offset:2112
v_mfma_f32_16x16x32_bf16 a[12:15], a[76:79], v[136:139], a[12:15]
ds_read_b64_tr_b16 a[56:57], v34
v_mfma_f32_16x16x32_bf16 a[28:31], a[76:79], a[188:191], a[28:31]
ds_read_b64_tr_b16 a[58:59], v34 offset:2112
ds_read_b64_tr_b16 a[60:61], v35
v_mfma_f32_16x16x32_bf16 a[40:43], a[80:83], a[244:247], a[40:43]
ds_read_b64_tr_b16 a[62:63], v35 offset:2112
v_mfma_f32_16x16x32_bf16 a[44:47], a[84:87], a[244:247], a[44:47]
ds_read_b64_tr_b16 a[64:65], v32 offset:4224
s_waitcnt lgkmcnt(5)
v_mfma_f32_16x16x32_bf16 a[0:3], a[48:51], v[140:143], a[0:3]
ds_read_b64_tr_b16 a[66:67], v32 offset:6336
s_add_u32 m0, s49, 73920
s_add_u32 s48, s56, 24960
v_mfma_f32_16x16x32_bf16 a[16:19], a[48:51], a[192:195], a[16:19]
buffer_load_dwordx4 v2, s[12:15], s48 offen nt lds
ds_read_b64_tr_b16 a[68:69], v33 offset:4224
v_mfma_f32_16x16x32_bf16 a[4:7], a[52:55], v[140:143], a[4:7]
ds_read_b64_tr_b16 a[70:71], v33 offset:6336
v_mfma_f32_16x16x32_bf16 a[20:23], a[52:55], a[192:195], a[20:23]
ds_read_b64_tr_b16 a[72:73], v34 offset:4224
s_waitcnt lgkmcnt(3)
v_mfma_f32_16x16x32_bf16 a[8:11], a[56:59], v[140:143], a[8:11]
ds_read_b64_tr_b16 a[74:75], v34 offset:6336
ds_read_b64_tr_b16 a[76:77], v35 offset:4224
v_mfma_f32_16x16x32_bf16 a[24:27], a[56:59], a[192:195], a[24:27]
ds_read_b64_tr_b16 a[78:79], v35 offset:6336
v_mfma_f32_16x16x32_bf16 a[12:15], a[60:63], v[140:143], a[12:15]
ds_read_b64_tr_b16 a[80:81], v36
v_mfma_f32_16x16x32_bf16 a[28:31], a[60:63], a[192:195], a[28:31]
ds_read_b64_tr_b16 a[82:83], v36 offset:8448
ds_read_b64_tr_b16 a[84:85], v37
v_mfma_f32_16x16x32_bf16 a[0:3], a[64:67], v[144:147], a[0:3]
ds_read_b64_tr_b16 a[86:87], v37 offset:8448
v_mfma_f32_16x16x32_bf16 a[16:19], a[64:67], a[196:199], a[16:19]
ds_read_b64_tr_b16 a[48:49], v32 offset:8448
ds_read_b64_tr_b16 a[50:51], v32 offset:10560
s_waitcnt lgkmcnt(6)
v_mfma_f32_16x16x32_bf16 a[4:7], a[68:71], v[144:147], a[4:7]
s_add_u32 m0, s49, 74976
s_add_u32 s48, s56, 29056
v_mfma_f32_16x16x32_bf16 a[20:23], a[68:71], a[196:199], a[20:23]
buffer_load_dwordx4 v2, s[12:15], s48 offen nt lds
ds_read_b64_tr_b16 a[52:53], v33 offset:8448
v_mfma_f32_16x16x32_bf16 a[8:11], a[72:75], v[144:147], a[8:11]
ds_read_b64_tr_b16 a[54:55], v33 offset:10560
v_mfma_f32_16x16x32_bf16 a[24:27], a[72:75], a[196:199], a[24:27]
ds_read_b64_tr_b16 a[56:57], v34 offset:8448
ds_read_b64_tr_b16 a[58:59], v34 offset:10560
v_mfma_f32_16x16x32_bf16 a[12:15], a[76:79], v[144:147], a[12:15]
ds_read_b64_tr_b16 a[60:61], v35 offset:8448
v_mfma_f32_16x16x32_bf16 a[28:31], a[76:79], a[196:199], a[28:31]
ds_read_b64_tr_b16 a[62:63], v35 offset:10560
s_waitcnt lgkmcnt(5)
v_mfma_f32_16x16x32_bf16 a[32:35], a[80:83], a[248:251], a[32:35]
ds_read_b64_tr_b16 a[64:65], v32 offset:12672
ds_read_b64_tr_b16 a[66:67], v32 offset:14784
v_mfma_f32_16x16x32_bf16 a[36:39], a[84:87], a[248:251], a[36:39]
s_add_u32 m0, s49, 0
s_add_u32 s48, s56, 131456
buffer_load_dwordx4 v2, s[12:15], s48 offen nt lds
v_mfma_f32_16x16x32_bf16 a[0:3], a[48:51], v[148:151], a[0:3]
ds_read_b64_tr_b16 a[68:69], v33 offset:12672
v_mfma_f32_16x16x32_bf16 a[16:19], a[48:51], a[200:203], a[16:19]
ds_read_b64_tr_b16 a[70:71], v33 offset:14784
s_waitcnt lgkmcnt(3)
v_mfma_f32_16x16x32_bf16 a[4:7], a[52:55], v[148:151], a[4:7]
ds_read_b64_tr_b16 a[72:73], v34 offset:12672
ds_read_b64_tr_b16 a[74:75], v34 offset:14784
v_mfma_f32_16x16x32_bf16 a[20:23], a[52:55], a[200:203], a[20:23]
ds_read_b64_tr_b16 a[76:77], v35 offset:12672
v_mfma_f32_16x16x32_bf16 a[8:11], a[56:59], v[148:151], a[8:11]
ds_read_b64_tr_b16 a[78:79], v35 offset:14784
v_mfma_f32_16x16x32_bf16 a[24:27], a[56:59], a[200:203], a[24:27]
ds_read_b64_tr_b16 a[80:81], v38
ds_read_b64_tr_b16 a[82:83], v38 offset:8448
v_mfma_f32_16x16x32_bf16 a[12:15], a[60:63], v[148:151], a[12:15]
ds_read_b64_tr_b16 a[84:85], v39
v_mfma_f32_16x16x32_bf16 a[28:31], a[60:63], a[200:203], a[28:31]
ds_read_b64_tr_b16 a[86:87], v39 offset:8448
s_add_u32 m0, s49, 1056
s_add_u32 s48, s56, 135552
s_waitcnt lgkmcnt(4)
v_mfma_f32_16x16x32_bf16 a[0:3], a[64:67], v[152:155], a[0:3]
buffer_load_dwordx4 v2, s[12:15], s48 offen nt lds
v_mfma_f32_16x16x32_bf16 a[16:19], a[64:67], a[204:207], a[16:19]
ds_read_b64_tr_b16 a[48:49], v32 offset:16896
ds_read_b64_tr_b16 a[50:51], v32 offset:19008
v_mfma_f32_16x16x32_bf16 a[4:7], a[68:71], v[152:155], a[4:7]
ds_read_b64_tr_b16 a[52:53], v33 offset:16896
v_mfma_f32_16x16x32_bf16 a[20:23], a[68:71], a[204:207], a[20:23]
ds_read_b64_tr_b16 a[54:55], v33 offset:19008
v_mfma_f32_16x16x32_bf16 a[8:11], a[72:75], v[152:155], a[8:11]
ds_read_b64_tr_b16 a[56:57], v34 offset:16896
ds_read_b64_tr_b16 a[58:59], v34 offset:19008
v_mfma_f32_16x16x32_bf16 a[24:27], a[72:75], a[204:207], a[24:27]
ds_read_b64_tr_b16 a[60:61], v35 offset:16896
v_mfma_f32_16x16x32_bf16 a[12:15], a[76:79], v[152:155], a[12:15]
ds_read_b64_tr_b16 a[62:63], v35 offset:19008
s_add_u32 m0, s49, 2112
s_add_u32 s48, s56, 139648
v_mfma_f32_16x16x32_bf16 a[28:31], a[76:79], a[204:207], a[28:31]
buffer_load_dwordx4 v2, s[12:15], s48 offen nt lds
s_waitcnt lgkmcnt(3)
v_mfma_f32_16x16x32_bf16 a[40:43], a[80:83], a[248:251], a[40:43]
ds_read_b64_tr_b16 a[64:65], v32 offset:21120
ds_read_b64_tr_b16 a[66:67], v32 offset:23232
v_mfma_f32_16x16x32_bf16 a[44:47], a[84:87], a[248:251], a[44:47]
ds_read_b64_tr_b16 a[68:69], v33 offset:21120
v_mfma_f32_16x16x32_bf16 a[0:3], a[48:51], v[156:159], a[0:3]
ds_read_b64_tr_b16 a[70:71], v33 offset:23232
ds_read_b64_tr_b16 a[72:73], v34 offset:21120
v_mfma_f32_16x16x32_bf16 a[16:19], a[48:51], a[208:211], a[16:19]
ds_read_b64_tr_b16 a[74:75], v34 offset:23232
v_mfma_f32_16x16x32_bf16 a[4:7], a[52:55], v[156:159], a[4:7]
ds_read_b64_tr_b16 a[76:77], v35 offset:21120
v_mfma_f32_16x16x32_bf16 a[20:23], a[52:55], a[208:211], a[20:23]
ds_read_b64_tr_b16 a[78:79], v35 offset:23232
ds_read_b64_tr_b16 a[80:81], v36 offset:16896
s_waitcnt lgkmcnt(6)
v_mfma_f32_16x16x32_bf16 a[8:11], a[56:59], v[156:159], a[8:11]
ds_read_b64_tr_b16 a[82:83], v36 offset:25344
s_add_u32 m0, s49, 3168
s_add_u32 s48, s56, 143744
v_mfma_f32_16x16x32_bf16 a[24:27], a[56:59], a[208:211], a[24:27]
buffer_load_dwordx4 v2, s[12:15], s48 offen nt lds
v_mfma_f32_16x16x32_bf16 a[12:15], a[60:63], v[156:159], a[12:15]
ds_read_b64_tr_b16 a[84:85], v37 offset:16896
v_mfma_f32_16x16x32_bf16 a[28:31], a[60:63], a[208:211], a[28:31]
ds_read_b64_tr_b16 a[86:87], v37 offset:25344
ds_read_b64_tr_b16 a[48:49], v32 offset:25344
v_mfma_f32_16x16x32_bf16 a[0:3], a[64:67], v[160:163], a[0:3]
ds_read_b64_tr_b16 a[50:51], v32 offset:27456
v_mfma_f32_16x16x32_bf16 a[16:19], a[64:67], a[212:215], a[16:19]
ds_read_b64_tr_b16 a[52:53], v33 offset:25344
s_waitcnt lgkmcnt(5)
v_mfma_f32_16x16x32_bf16 a[4:7], a[68:71], v[160:163], a[4:7]
ds_read_b64_tr_b16 a[54:55], v33 offset:27456
ds_read_b64_tr_b16 a[56:57], v34 offset:25344
v_mfma_f32_16x16x32_bf16 a[20:23], a[68:71], a[212:215], a[20:23]
ds_read_b64_tr_b16 a[58:59], v34 offset:27456
v_mfma_f32_16x16x32_bf16 a[8:11], a[72:75], v[160:163], a[8:11]
ds_read_b64_tr_b16 a[60:61], v35 offset:25344
ds_read_b64_tr_b16 a[62:63], v35 offset:27456
v_mfma_f32_16x16x32_bf16 a[24:27], a[72:75], a[212:215], a[24:27]
s_add_u32 m0, s49, 4224
s_add_u32 s48, s56, 147840
v_mfma_f32_16x16x32_bf16 a[12:15], a[76:79], v[160:163], a[12:15]
buffer_load_dwordx4 v2, s[12:15], s48 offen nt lds
ds_read_b64_tr_b16 a[64:65], v32 offset:29568
v_mfma_f32_16x16x32_bf16 a[28:31], a[76:79], a[212:215], a[28:31]
ds_read_b64_tr_b16 a[66:67], v32 offset:31680
v_mfma_f32_16x16x32_bf16 a[32:35], a[80:83], a[252:255], a[32:35]
ds_read_b64_tr_b16 a[68:69], v33 offset:29568
s_waitcnt lgkmcnt(3)
v_mfma_f32_16x16x32_bf16 a[36:39], a[84:87], a[252:255], a[36:39]
ds_read_b64_tr_b16 a[70:71], v33 offset:31680
ds_read_b64_tr_b16 a[72:73], v34 offset:29568
v_mfma_f32_16x16x32_bf16 a[0:3], a[48:51], v[164:167], a[0:3]
ds_read_b64_tr_b16 a[74:75], v34 offset:31680
v_mfma_f32_16x16x32_bf16 a[16:19], a[48:51], a[216:219], a[16:19]
ds_read_b64_tr_b16 a[76:77], v35 offset:29568
ds_read_b64_tr_b16 a[78:79], v35 offset:31680
v_mfma_f32_16x16x32_bf16 a[4:7], a[52:55], v[164:167], a[4:7]
ds_read_b64_tr_b16 a[80:81], v38 offset:16896
v_mfma_f32_16x16x32_bf16 a[20:23], a[52:55], a[216:219], a[20:23]
ds_read_b64_tr_b16 a[82:83], v38 offset:25344
s_add_u32 m0, s49, 5280
s_add_u32 s48, s56, 151936
v_mfma_f32_16x16x32_bf16 a[8:11], a[56:59], v[164:167], a[8:11]
buffer_load_dwordx4 v2, s[12:15], s48 offen nt lds
v_mfma_f32_16x16x32_bf16 a[24:27], a[56:59], a[216:219], a[24:27]
ds_read_b64_tr_b16 a[84:85], v39 offset:16896
ds_read_b64_tr_b16 a[86:87], v39 offset:25344
v_mfma_f32_16x16x32_bf16 a[12:15], a[60:63], v[164:167], a[12:15]
v_add_u32 v32, 33792, v32
v_mfma_f32_16x16x32_bf16 a[28:31], a[60:63], a[216:219], a[28:31]
v_add_u32 v33, 33792, v33
s_waitcnt lgkmcnt(2)
v_mfma_f32_16x16x32_bf16 a[0:3], a[64:67], v[168:171], a[0:3]
v_add_u32 v34, 33792, v34
v_add_u32 v35, 33792, v35
v_mfma_f32_16x16x32_bf16 a[16:19], a[64:67], a[220:223], a[16:19]
v_add_u32 v36, 33792, v36
v_mfma_f32_16x16x32_bf16 a[4:7], a[68:71], v[168:171], a[4:7]
v_add_u32 v37, 33792, v37
v_mfma_f32_16x16x32_bf16 a[20:23], a[68:71], a[220:223], a[20:23]
v_add_u32 v38, 33792, v38
v_add_u32 v39, 33792, v39
L_stage35:
s_waitcnt vmcnt(6)
s_waitcnt lgkmcnt(0)
s_barrier
ds_read_b64_tr_b16 a[48:49], v32
ds_read_b64_tr_b16 a[50:51], v32 offset:2112
ds_read_b64_tr_b16 a[52:53], v33
ds_read_b64_tr_b16 a[54:55], v33 offset:2112
v_mfma_f32_16x16x32_bf16 a[8:11], a[72:75], v[168:171], a[8:11]
ds_read_b64_tr_b16 a[56:57], v34
ds_read_b64_tr_b16 a[58:59], v34 offset:2112
ds_read_b64_tr_b16 a[60:61], v35
ds_read_b64_tr_b16 a[62:63], v35 offset:2112
v_mfma_f32_16x16x32_bf16 a[24:27], a[72:75], a[220:223], a[24:27]
ds_read_b64_tr_b16 a[64:65], v32 offset:4224
ds_read_b64_tr_b16 a[66:67], v32 offset:6336
s_add_u32 m0, s49, 6336
s_add_u32 s48, s56, 156032
buffer_load_dwordx4 v2, s[12:15], s48 offen nt lds
v_mfma_f32_16x16x32_bf16 a[12:15], a[76:79], v[168:171], a[12:15]
ds_read_b64_tr_b16 a[68:69], v33 offset:4224
ds_read_b64_tr_b16 a[70:71], v33 offset:6336
ds_read_b64_tr_b16 a[72:73], v34 offset:4224
ds_read_b64_tr_b16 a[74:75], v34 offset:6336
v_mfma_f32_16x16x32_bf16 a[28:31], a[76:79], a[220:223], a[28:31]
ds_read_b64_tr_b16 a[76:77], v35 offset:4224
ds_read_b64_tr_b16 a[78:79], v35 offset:6336
v_accvgpr_read_b32 v12, a0
v_accvgpr_read_b32 v13, a1
v_accvgpr_read_b32 v14, a2
v_accvgpr_read_b32 v15, a3
v_mul_f32 v12, v12, v4
v_mul_f32 v13, v13, v4
v_mul_f32 v14, v14, v4
v_mul_f32 v15, v15, v4
v_cvt_pk_bf16_f32 v16, v12, v13
v_cvt_pk_bf16_f32 v17, v14, v15
v_accvgpr_write_b32 a144, v16
v_mfma_f32_16x16x32_bf16 a[40:43], a[80:83], a[252:255], a[40:43]
v_accvgpr_write_b32 a145, v17
v_accvgpr_read_b32 v18, a4
v_accvgpr_read_b32 v19, a5
v_accvgpr_read_b32 v20, a6
v_accvgpr_read_b32 v21, a7
v_mul_f32 v18, v18, v4
v_mul_f32 v19, v19, v4
v_mul_f32 v20, v20, v4
v_mul_f32 v21, v21, v4
v_cvt_pk_bf16_f32 v22, v18, v19
v_cvt_pk_bf16_f32 v23, v20, v21
v_accvgpr_write_b32 a146, v22
v_accvgpr_write_b32 a147, v23
v_accvgpr_read_b32 v12, a8
v_mfma_f32_16x16x32_bf16 a[44:47], a[84:87], a[252:255], a[44:47]
v_accvgpr_read_b32 v13, a9
v_accvgpr_read_b32 v14, a10
v_accvgpr_read_b32 v15, a11
v_mul_f32 v12, v12, v4
v_mul_f32 v13, v13, v4
v_mul_f32 v14, v14, v4
v_mul_f32 v15, v15, v4
v_cvt_pk_bf16_f32 v16, v12, v13
v_cvt_pk_bf16_f32 v17, v14, v15
v_accvgpr_write_b32 a148, v16
v_accvgpr_write_b32 a149, v17
v_accvgpr_read_b32 v18, a12
v_accvgpr_read_b32 v19, a13
s_waitcnt lgkmcnt(0)
v_mfma_f32_16x16x32_bf16 a[0:3], a[48:51], v[44:47], 0
v_accvgpr_read_b32 v20, a14
v_accvgpr_read_b32 v21, a15
v_mul_f32 v18, v18, v4
v_mul_f32 v19, v19, v4
v_mul_f32 v20, v20, v4
v_mul_f32 v21, v21, v4
v_cvt_pk_bf16_f32 v22, v18, v19
v_cvt_pk_bf16_f32 v23, v20, v21
v_accvgpr_write_b32 a150, v22
v_accvgpr_write_b32 a151, v23
v_accvgpr_read_b32 v12, a16
v_accvgpr_read_b32 v13, a17
v_accvgpr_read_b32 v14, a18
v_accvgpr_read_b32 v15, a19
v_mfma_f32_16x16x32_bf16 a[16:19], a[48:51], v[172:175], 0
v_mul_f32 v12, v12, v5
v_mul_f32 v13, v13, v5
v_mul_f32 v14, v14, v5
v_mul_f32 v15, v15, v5
v_cvt_pk_bf16_f32 v16, v12, v13
v_cvt_pk_bf16_f32 v17, v14, v15
v_accvgpr_write_b32 a152, v16
v_accvgpr_write_b32 a153, v17
v_mfma_f32_16x16x32_bf16 a[4:7], a[52:55], v[44:47], 0
v_accvgpr_read_b32 v18, a20
v_accvgpr_read_b32 v19, a21
v_accvgpr_read_b32 v20, a22
v_accvgpr_read_b32 v21, a23
v_mul_f32 v18, v18, v5
v_mul_f32 v19, v19, v5
v_mul_f32 v20, v20, v5
v_mul_f32 v21, v21, v5
v_cvt_pk_bf16_f32 v22, v18, v19
v_mfma_f32_16x16x32_bf16 a[20:23], a[52:55], v[172:175], 0
v_cvt_pk_bf16_f32 v23, v20, v21
v_accvgpr_write_b32 a154, v22
v_accvgpr_write_b32 a155, v23
v_accvgpr_read_b32 v12, a24
v_accvgpr_read_b32 v13, a25
v_accvgpr_read_b32 v14, a26
v_accvgpr_read_b32 v15, a27
v_mul_f32 v12, v12, v5
v_mfma_f32_16x16x32_bf16 a[8:11], a[56:59], v[44:47], 0
v_mul_f32 v13, v13, v5
v_mul_f32 v14, v14, v5
v_mul_f32 v15, v15, v5
v_cvt_pk_bf16_f32 v16, v12, v13
v_cvt_pk_bf16_f32 v17, v14, v15
v_accvgpr_write_b32 a156, v16
v_accvgpr_write_b32 a157, v17
v_accvgpr_read_b32 v18, a28
v_mfma_f32_16x16x32_bf16 a[24:27], a[56:59], v[172:175], 0
v_accvgpr_read_b32 v19, a29
v_accvgpr_read_b32 v20, a30
v_accvgpr_read_b32 v21, a31
v_mul_f32 v18, v18, v5
v_mul_f32 v19, v19, v5
v_mul_f32 v20, v20, v5
v_mul_f32 v21, v21, v5
v_cvt_pk_bf16_f32 v22, v18, v19
v_cvt_pk_bf16_f32 v23, v20, v21
v_mfma_f32_16x16x32_bf16 a[12:15], a[60:63], v[44:47], 0
v_accvgpr_write_b32 a158, v22
v_accvgpr_write_b32 a159, v23
s_lshl_b32 s4, s3, 12
s_add_u32 s4, s4, 138240
v_add_u32 v7, s4, v1
v_accvgpr_read_b32 v24, a32
v_accvgpr_read_b32 v25, a33
v_accvgpr_read_b32 v26, a34
v_accvgpr_read_b32 v27, a35
v_mfma_f32_16x16x32_bf16 a[28:31], a[60:63], v[172:175], 0
v_mul_f32 v24, v24, v6
v_mul_f32 v25, v25, v6
v_mul_f32 v26, v26, v6
v_mul_f32 v27, v27, v6
ds_write_b128 v7, v[24:27]
v_accvgpr_read_b32 v28, a36
v_accvgpr_read_b32 v29, a37
v_accvgpr_read_b32 v30, a38
v_accvgpr_read_b32 v31, a39
v_mfma_f32_16x16x32_bf16 a[0:3], a[64:67], v[48:51], a[0:3]
v_mul_f32 v28, v28, v6
v_mul_f32 v29, v29, v6
v_mul_f32 v30, v30, v6
v_mul_f32 v31, v31, v6
ds_write_b128 v7, v[28:31] offset:1024
v_accvgpr_read_b32 v24, a40
v_accvgpr_read_b32 v25, a41
v_accvgpr_read_b32 v26, a42
v_mfma_f32_16x16x32_bf16 a[16:19], a[64:67], v[176:179], a[16:19]
v_accvgpr_read_b32 v27, a43
v_mul_f32 v24, v24, v6
v_mul_f32 v25, v25, v6
v_mul_f32 v26, v26, v6
v_mul_f32 v27, v27, v6
ds_write_b128 v7, v[24:27] offset:2048
v_accvgpr_read_b32 v28, a44
v_accvgpr_read_b32 v29, a45
v_mfma_f32_16x16x32_bf16 a[4:7], a[68:71], v[48:51], a[4:7]
v_accvgpr_read_b32 v30, a46
v_accvgpr_read_b32 v31, a47
v_mul_f32 v28, v28, v6
v_mul_f32 v29, v29, v6
v_mul_f32 v30, v30, v6
v_mul_f32 v31, v31, v6
ds_write_b128 v7, v[28:31] offset:3072
ds_read_b64_tr_b16 a[80:81], v36
ds_read_b64_tr_b16 a[82:83], v36 offset:8448
v_mfma_f32_16x16x32_bf16 a[20:23], a[68:71], v[176:179], a[20:23]
ds_read_b64_tr_b16 a[84:85], v37
ds_read_b64_tr_b16 a[86:87], v37 offset:8448
v_mfma_f32_16x16x32_bf16 a[8:11], a[72:75], v[48:51], a[8:11]
ds_read_b64_tr_b16 a[48:49], v32 offset:8448
ds_read_b64_tr_b16 a[50:51], v32 offset:10560
s_add_u32 m0, s49, 7392
v_mfma_f32_16x16x32_bf16 a[24:27], a[72:75], v[176:179], a[24:27]
s_add_u32 s48, s56, 160128
buffer_load_dwordx4 v2, s[12:15], s48 offen nt lds
v_mfma_f32_16x16x32_bf16 a[12:15], a[76:79], v[48:51], a[12:15]
ds_read_b64_tr_b16 a[52:53], v33 offset:8448
ds_read_b64_tr_b16 a[54:55], v33 offset:10560
v_mfma_f32_16x16x32_bf16 a[28:31], a[76:79], v[176:179], a[28:31]
ds_read_b64_tr_b16 a[56:57], v34 offset:8448
s_waitcnt lgkmcnt(3)
v_mfma_f32_16x16x32_bf16 a[32:35], a[80:83], a[224:227], 0
ds_read_b64_tr_b16 a[58:59], v34 offset:10560
ds_read_b64_tr_b16 a[60:61], v35 offset:8448
v_mfma_f32_16x16x32_bf16 a[36:39], a[84:87], a[224:227], 0
ds_read_b64_tr_b16 a[62:63], v35 offset:10560
v_mfma_f32_16x16x32_bf16 a[0:3], a[48:51], v[52:55], a[0:3]
ds_read_b64_tr_b16 a[64:65], v32 offset:12672
ds_read_b64_tr_b16 a[66:67], v32 offset:14784
v_mfma_f32_16x16x32_bf16 a[16:19], a[48:51], v[180:183], a[16:19]
s_add_u32 m0, s49, 33792
s_add_u32 s48, s56, 262528
s_waitcnt lgkmcnt(4)
v_mfma_f32_16x16x32_bf16 a[4:7], a[52:55], v[52:55], a[4:7]
buffer_load_dwordx4 v2, s[12:15], s48 offen nt lds
ds_read_b64_tr_b16 a[68:69], v33 offset:12672
v_mfma_f32_16x16x32_bf16 a[20:23], a[52:55], v[180:183], a[20:23]
ds_read_b64_tr_b16 a[70:71], v33 offset:14784
v_mfma_f32_16x16x32_bf16 a[8:11], a[56:59], v[52:55], a[8:11]
ds_read_b64_tr_b16 a[72:73], v34 offset:12672
ds_read_b64_tr_b16 a[74:75], v34 offset:14784
v_mfma_f32_16x16x32_bf16 a[24:27], a[56:59], v[180:183], a[24:27]
ds_read_b64_tr_b16 a[76:77], v35 offset:12672
s_waitcnt lgkmcnt(5)
v_mfma_f32_16x16x32_bf16 a[12:15], a[60:63], v[52:55], a[12:15]
ds_read_b64_tr_b16 a[78:79], v35 offset:14784
ds_read_b64_tr_b16 a[80:81], v38
v_mfma_f32_16x16x32_bf16 a[28:31], a[60:63], v[180:183], a[28:31]
ds_read_b64_tr_b16 a[82:83], v38 offset:8448
v_mfma_f32_16x16x32_bf16 a[0:3], a[64:67], v[56:59], a[0:3]
ds_read_b64_tr_b16 a[84:85], v39
v_mfma_f32_16x16x32_bf16 a[16:19], a[64:67], v[184:187], a[16:19]
ds_read_b64_tr_b16 a[86:87], v39 offset:8448
s_add_u32 m0, s49, 34848
s_add_u32 s48, s56, 266624
s_waitcnt lgkmcnt(4)
v_mfma_f32_16x16x32_bf16 a[4:7], a[68:71], v[56:59], a[4:7]
buffer_load_dwordx4 v2, s[12:15], s48 offen nt lds
ds_read_b64_tr_b16 a[48:49], v32 offset:16896
v_mfma_f32_16x16x32_bf16 a[20:23], a[68:71], v[184:187], a[20:23]
ds_read_b64_tr_b16 a[50:51], v32 offset:19008
v_mfma_f32_16x16x32_bf16 a[8:11], a[72:75], v[56:59], a[8:11]
ds_read_b64_tr_b16 a[52:53], v33 offset:16896
ds_read_b64_tr_b16 a[54:55], v33 offset:19008
v_mfma_f32_16x16x32_bf16 a[24:27], a[72:75], v[184:187], a[24:27]
ds_read_b64_tr_b16 a[56:57], v34 offset:16896
v_mfma_f32_16x16x32_bf16 a[12:15], a[76:79], v[56:59], a[12:15]
ds_read_b64_tr_b16 a[58:59], v34 offset:19008
ds_read_b64_tr_b16 a[60:61], v35 offset:16896
v_mfma_f32_16x16x32_bf16 a[28:31], a[76:79], v[184:187], a[28:31]
ds_read_b64_tr_b16 a[62:63], v35 offset:19008
s_add_u32 m0, s49, 35904
s_waitcnt lgkmcnt(5)
v_mfma_f32_16x16x32_bf16 a[40:43], a[80:83], a[224:227], 0
s_add_u32 s48, s56, 270720
buffer_load_dwordx4 v2, s[12:15], s48 offen nt lds
v_mfma_f32_16x16x32_bf16 a[44:47], a[84:87], a[224:227], 0
ds_read_b64_tr_b16 a[64:65], v32 offset:21120
v_mfma_f32_16x16x32_bf16 a[0:3], a[48:51], v[60:63], a[0:3]
ds_read_b64_tr_b16 a[66:67], v32 offset:23232
ds_read_b64_tr_b16 a[68:69], v33 offset:21120
v_mfma_f32_16x16x32_bf16 a[16:19], a[48:51], v[188:191], a[16:19]
ds_read_b64_tr_b16 a[70:71], v33 offset:23232
s_waitcnt lgkmcnt(4)
v_mfma_f32_16x16x32_bf16 a[4:7], a[52:55], v[60:63], a[4:7]
ds_read_b64_tr_b16 a[72:73], v34 offset:21120
ds_read_b64_tr_b16 a[74:75], v34 offset:23232
v_mfma_f32_16x16x32_bf16 a[20:23], a[52:55], v[188:191], a[20:23]
ds_read_b64_tr_b16 a[76:77], v35 offset:21120
v_mfma_f32_16x16x32_bf16 a[8:11], a[56:59], v[60:63], a[8:11]
ds_read_b64_tr_b16 a[78:79], v35 offset:23232
ds_read_b64_tr_b16 a[80:81], v36 offset:16896
v_mfma_f32_16x16x32_bf16 a[24:27], a[56:59], v[188:191], a[24:27]
ds_read_b64_tr_b16 a[82:83], v36 offset:25344
s_add_u32 m0, s49, 36960
v_mfma_f32_16x16x32_bf16 a[12:15], a[60:63], v[60:63], a[12:15]
s_add_u32 s48, s56, 274816
buffer_load_dwordx4 v2, s[12:15], s48 offen nt lds
v_mfma_f32_16x16x32_bf16 a[28:31], a[60:63], v[188:191], a[28:31]
ds_read_b64_tr_b16 a[84:85], v37 offset:16896
s_waitcnt lgkmcnt(3)
v_mfma_f32_16x16x32_bf16 a[0:3], a[64:67], v[64:67], a[0:3]
ds_read_b64_tr_b16 a[86:87], v37 offset:25344
ds_read_b64_tr_b16 a[48:49], v32 offset:25344
v_mfma_f32_16x16x32_bf16 a[16:19], a[64:67], v[192:195], a[16:19]
ds_read_b64_tr_b16 a[50:51], v32 offset:27456
v_mfma_f32_16x16x32_bf16 a[4:7], a[68:71], v[64:67], a[4:7]
ds_read_b64_tr_b16 a[52:53], v33 offset:25344
ds_read_b64_tr_b16 a[54:55], v33 offset:27456
v_mfma_f32_16x16x32_bf16 a[20:23], a[68:71], v[192:195], a[20:23]
ds_read_b64_tr_b16 a[56:57], v34 offset:25344
v_mfma_f32_16x16x32_bf16 a[8:11], a[72:75], v[64:67], a[8:11]
ds_read_b64_tr_b16 a[58:59], v34 offset:27456
v_mfma_f32_16x16x32_bf16 a[24:27], a[72:75], v[192:195], a[24:27]
ds_read_b64_tr_b16 a[60:61], v35 offset:25344
ds_read_b64_tr_b16 a[62:63], v35 offset:27456
s_add_u32 m0, s49, 38016
v_mfma_f32_16x16x32_bf16 a[12:15], a[76:79], v[64:67], a[12:15]
s_add_u32 s48, s56, 278912
buffer_load_dwordx4 v2, s[12:15], s48 offen nt lds
v_mfma_f32_16x16x32_bf16 a[28:31], a[76:79], v[192:195], a[28:31]
ds_read_b64_tr_b16 a[64:65], v32 offset:29568
s_waitcnt lgkmcnt(3)
v_mfma_f32_16x16x32_bf16 a[32:35], a[80:83], a[228:231], a[32:35]
ds_read_b64_tr_b16 a[66:67], v32 offset:31680
ds_read_b64_tr_b16 a[68:69], v33 offset:29568
v_mfma_f32_16x16x32_bf16 a[36:39], a[84:87], a[228:231], a[36:39]
ds_read_b64_tr_b16 a[70:71], v33 offset:31680
v_mfma_f32_16x16x32_bf16 a[0:3], a[48:51], v[68:71], a[0:3]
ds_read_b64_tr_b16 a[72:73], v34 offset:29568
ds_read_b64_tr_b16 a[74:75], v34 offset:31680
v_mfma_f32_16x16x32_bf16 a[16:19], a[48:51], v[196:199], a[16:19]
ds_read_b64_tr_b16 a[76:77], v35 offset:29568
v_mfma_f32_16x16x32_bf16 a[4:7], a[52:55], v[68:71], a[4:7]
ds_read_b64_tr_b16 a[78:79], v35 offset:31680
v_mfma_f32_16x16x32_bf16 a[20:23], a[52:55], v[196:199], a[20:23]
ds_read_b64_tr_b16 a[80:81], v38 offset:16896
ds_read_b64_tr_b16 a[82:83], v38 offset:25344
s_add_u32 m0, s49, 39072
v_mfma_f32_16x16x32_bf16 a[8:11], a[56:59], v[68:71], a[8:11]
s_add_u32 s48, s56, 283008
buffer_load_dwordx4 v2, s[12:15], s48 offen nt lds
v_mfma_f32_16x16x32_bf16 a[24:27], a[56:59], v[196:199], a[24:27]
ds_read_b64_tr_b16 a[84:85], v39 offset:16896
s_waitcnt lgkmcnt(3)
v_mfma_f32_16x16x32_bf16 a[12:15], a[60:63], v[68:71], a[12:15]
ds_read_b64_tr_b16 a[86:87], v39 offset:25344
v_subrev_u32 v32, 67584, v32
v_mfma_f32_16x16x32_bf16 a[28:31], a[60:63], v[196:199], a[28:31]
v_subrev_u32 v33, 67584, v33
v_mfma_f32_16x16x32_bf16 a[0:3], a[64:67], v[72:75], a[0:3]
v_subrev_u32 v34, 67584, v34
v_subrev_u32 v35, 67584, v35
v_mfma_f32_16x16x32_bf16 a[16:19], a[64:67], v[200:203], a[16:19]
v_subrev_u32 v36, 67584, v36
v_mfma_f32_16x16x32_bf16 a[4:7], a[68:71], v[72:75], a[4:7]
v_subrev_u32 v37, 67584, v37
v_mfma_f32_16x16x32_bf16 a[20:23], a[68:71], v[200:203], a[20:23]
v_subrev_u32 v38, 67584, v38
v_subrev_u32 v39, 67584, v39
L_stage36:
s_waitcnt vmcnt(6)
s_waitcnt lgkmcnt(0)
s_barrier
ds_read_b64_tr_b16 a[48:49], v32
ds_read_b64_tr_b16 a[50:51], v32 offset:2112
v_mfma_f32_16x16x32_bf16 a[8:11], a[72:75], v[72:75], a[8:11]
ds_read_b64_tr_b16 a[52:53], v33
ds_read_b64_tr_b16 a[54:55], v33 offset:2112
v_mfma_f32_16x16x32_bf16 a[24:27], a[72:75], v[200:203], a[24:27]
ds_read_b64_tr_b16 a[56:57], v34
ds_read_b64_tr_b16 a[58:59], v34 offset:2112
v_mfma_f32_16x16x32_bf16 a[12:15], a[76:79], v[72:75], a[12:15]
ds_read_b64_tr_b16 a[60:61], v35
ds_read_b64_tr_b16 a[62:63], v35 offset:2112
v_mfma_f32_16x16x32_bf16 a[28:31], a[76:79], v[200:203], a[28:31]
ds_read_b64_tr_b16 a[64:65], v32 offset:4224
ds_read_b64_tr_b16 a[66:67], v32 offset:6336
v_mfma_f32_16x16x32_bf16 a[40:43], a[80:83], a[228:231], a[40:43]
s_add_u32 m0, s49, 40128
s_add_u32 s48, s56, 287104
buffer_load_dwordx4 v2, s[12:15], s48 offen nt lds
v_mfma_f32_16x16x32_bf16 a[44:47], a[84:87], a[228:231], a[44:47]
ds_read_b64_tr_b16 a[68:69], v33 offset:4224
ds_read_b64_tr_b16 a[70:71], v33 offset:6336
s_waitcnt lgkmcnt(4)
v_mfma_f32_16x16x32_bf16 a[0:3], a[48:51], v[76:79], a[0:3]
ds_read_b64_tr_b16 a[72:73], v34 offset:4224
ds_read_b64_tr_b16 a[74:75], v34 offset:6336
v_mfma_f32_16x16x32_bf16 a[16:19], a[48:51], v[204:207], a[16:19]
ds_read_b64_tr_b16 a[76:77], v35 offset:4224
ds_read_b64_tr_b16 a[78:79], v35 offset:6336
v_mfma_f32_16x16x32_bf16 a[4:7], a[52:55], v[76:79], a[4:7]
ds_read_b64_tr_b16 a[80:81], v36
ds_read_b64_tr_b16 a[82:83], v36 offset:8448
v_mfma_f32_16x16x32_bf16 a[20:23], a[52:55], v[204:207], a[20:23]
ds_read_b64_tr_b16 a[84:85], v37
ds_read_b64_tr_b16 a[86:87], v37 offset:8448
v_mfma_f32_16x16x32_bf16 a[8:11], a[56:59], v[76:79], a[8:11]
s_add_u32 m0, s49, 41184
s_add_u32 s48, s56, 291200
buffer_load_dwordx4 v2, s[12:15], s48 offen nt lds
v_mfma_f32_16x16x32_bf16 a[24:27], a[56:59], v[204:207], a[24:27]
ds_read_b64_tr_b16 a[48:49], v32 offset:8448
ds_read_b64_tr_b16 a[50:51], v32 offset:10560
v_mfma_f32_16x16x32_bf16 a[12:15], a[60:63], v[76:79], a[12:15]
ds_read_b64_tr_b16 a[52:53], v33 offset:8448
ds_read_b64_tr_b16 a[54:55], v33 offset:10560
v_mfma_f32_16x16x32_bf16 a[28:31], a[60:63], v[204:207], a[28:31]
ds_read_b64_tr_b16 a[56:57], v34 offset:8448
ds_read_b64_tr_b16 a[58:59], v34 offset:10560
s_waitcnt lgkmcnt(6)
v_mfma_f32_16x16x32_bf16 a[0:3], a[64:67], v[80:83], a[0:3]
ds_read_b64_tr_b16 a[60:61], v35 offset:8448
ds_read_b64_tr_b16 a[62:63], v35 offset:10560
s_lshl_b32 s4, s3, 10
v_mfma_f32_16x16x32_bf16 a[16:19], a[64:67], v[208:211], a[16:19]
s_add_u32 s4, s4, 138240
v_add_u32 v7, s4, v1
v_mfma_f32_16x16x32_bf16 a[4:7], a[68:71], v[80:83], a[4:7]
ds_read_b128 v[12:15], v7
ds_read_b128 v[16:19], v7 offset:4096
v_mfma_f32_16x16x32_bf16 a[20:23], a[68:71], v[208:211], a[20:23]
ds_read_b128 v[20:23], v7 offset:8192
ds_read_b128 v[24:27], v7 offset:12288
v_mfma_f32_16x16x32_bf16 a[8:11], a[72:75], v[80:83], a[8:11]
s_waitcnt lgkmcnt(2)
v_add_f32 v12, v12, v16
s_waitcnt lgkmcnt(0)
v_add_f32 v20, v20, v24
v_mfma_f32_16x16x32_bf16 a[24:27], a[72:75], v[208:211], a[24:27]
v_add_f32 v13, v13, v17
v_add_f32 v21, v21, v25
v_mfma_f32_16x16x32_bf16 a[12:15], a[76:79], v[80:83], a[12:15]
v_add_f32 v14, v14, v18
v_add_f32 v22, v22, v26
v_mfma_f32_16x16x32_bf16 a[28:31], a[76:79], v[208:211], a[28:31]
v_add_f32 v15, v15, v19
v_add_f32 v23, v23, v27
v_mfma_f32_16x16x32_bf16 a[32:35], a[80:83], a[232:235], a[32:35]
v_add_f32 v12, v12, v20
v_add_f32 v13, v13, v21
v_mfma_f32_16x16x32_bf16 a[36:39], a[84:87], a[232:235], a[36:39]
v_add_f32 v14, v14, v22
v_add_f32 v15, v15, v23
v_mfma_f32_16x16x32_bf16 a[0:3], a[48:51], v[84:87], a[0:3]
v_cvt_pk_bf16_f32 v16, v12, v13
v_cvt_pk_bf16_f32 v17, v14, v15
v_mfma_f32_16x16x32_bf16 a[16:19], a[48:51], v[212:215], a[16:19]
v_accvgpr_write_b32 a160, v16
v_accvgpr_write_b32 a161, v17
v_mfma_f32_16x16x32_bf16 a[4:7], a[52:55], v[84:87], a[4:7]
ds_read_b64_tr_b16 a[64:65], v32 offset:12672
ds_read_b64_tr_b16 a[66:67], v32 offset:14784
v_mfma_f32_16x16x32_bf16 a[20:23], a[52:55], v[212:215], a[20:23]
ds_read_b64_tr_b16 a[68:69], v33 offset:12672
v_mfma_f32_16x16x32_bf16 a[8:11], a[56:59], v[84:87], a[8:11]
ds_read_b64_tr_b16 a[70:71], v33 offset:14784
ds_read_b64_tr_b16 a[72:73], v34 offset:12672
v_mfma_f32_16x16x32_bf16 a[24:27], a[56:59], v[212:215], a[24:27]
ds_read_b64_tr_b16 a[74:75], v34 offset:14784
v_mfma_f32_16x16x32_bf16 a[12:15], a[60:63], v[84:87], a[12:15]
ds_read_b64_tr_b16 a[76:77], v35 offset:12672
ds_read_b64_tr_b16 a[78:79], v35 offset:14784
v_mfma_f32_16x16x32_bf16 a[28:31], a[60:63], v[212:215], a[28:31]
ds_read_b64_tr_b16 a[80:81], v38
s_waitcnt lgkmcnt(6)
v_mfma_f32_16x16x32_bf16 a[0:3], a[64:67], v[88:91], a[0:3]
ds_read_b64_tr_b16 a[82:83], v38 offset:8448
s_add_u32 m0, s49, 67584
s_add_u32 s48, s56, 393600
v_mfma_f32_16x16x32_bf16 a[16:19], a[64:67], v[216:219], a[16:19]
buffer_load_dwordx4 v2, s[12:15], s48 offen nt lds
ds_read_b64_tr_b16 a[84:85], v39
s_waitcnt lgkmcnt(3)
v_mfma_f32_16x16x32_bf16 a[4:7], a[68:71], v[88:91], a[4:7]
ds_read_b64_tr_b16 a[86:87], v39 offset:8448
v_mfma_f32_16x16x32_bf16 a[20:23], a[68:71], v[216:219], a[20:23]
ds_read_b64_tr_b16 a[48:49], v32 offset:16896
ds_read_b64_tr_b16 a[50:51], v32 offset:19008
v_mfma_f32_16x16x32_bf16 a[8:11], a[72:75], v[88:91], a[8:11]
ds_read_b64_tr_b16 a[52:53], v33 offset:16896
v_mfma_f32_16x16x32_bf16 a[24:27], a[72:75], v[216:219], a[24:27]
ds_read_b64_tr_b16 a[54:55], v33 offset:19008
s_add_u32 m0, s49, 68640
s_add_u32 s48, s56, 397696
v_mfma_f32_16x16x32_bf16 a[12:15], a[76:79], v[88:91], a[12:15]
buffer_load_dwordx4 v2, s[12:15], s48 offen nt lds
ds_read_b64_tr_b16 a[56:57], v34 offset:16896
v_mfma_f32_16x16x32_bf16 a[28:31], a[76:79], v[216:219], a[28:31]
ds_read_b64_tr_b16 a[58:59], v34 offset:19008
s_waitcnt lgkmcnt(3)
v_mfma_f32_16x16x32_bf16 a[40:43], a[80:83], a[232:235], a[40:43]
ds_read_b64_tr_b16 a[60:61], v35 offset:16896
ds_read_b64_tr_b16 a[62:63], v35 offset:19008
v_mfma_f32_16x16x32_bf16 a[44:47], a[84:87], a[232:235], a[44:47]
ds_read_b64_tr_b16 a[64:65], v32 offset:21120
v_mfma_f32_16x16x32_bf16 a[0:3], a[48:51], v[92:95], a[0:3]
ds_read_b64_tr_b16 a[66:67], v32 offset:23232
ds_read_b64_tr_b16 a[68:69], v33 offset:21120
v_mfma_f32_16x16x32_bf16 a[16:19], a[48:51], v[220:223], a[16:19]
ds_read_b64_tr_b16 a[70:71], v33 offset:23232
s_add_u32 m0, s49, 69696
s_add_u32 s48, s56, 401792
s_waitcnt lgkmcnt(4)
v_mfma_f32_16x16x32_bf16 a[4:7], a[52:55], v[92:95], a[4:7]
buffer_load_dwordx4 v2, s[12:15], s48 offen nt lds
v_mfma_f32_16x16x32_bf16 a[20:23], a[52:55], v[220:223], a[20:23]
ds_read_b64_tr_b16 a[72:73], v34 offset:21120
ds_read_b64_tr_b16 a[74:75], v34 offset:23232
v_mfma_f32_16x16x32_bf16 a[8:11], a[56:59], v[92:95], a[8:11]
ds_read_b64_tr_b16 a[76:77], v35 offset:21120
v_mfma_f32_16x16x32_bf16 a[24:27], a[56:59], v[220:223], a[24:27]
ds_read_b64_tr_b16 a[78:79], v35 offset:23232
ds_read_b64_tr_b16 a[80:81], v36 offset:16896
v_mfma_f32_16x16x32_bf16 a[12:15], a[60:63], v[92:95], a[12:15]
ds_read_b64_tr_b16 a[82:83], v36 offset:25344
v_mfma_f32_16x16x32_bf16 a[28:31], a[60:63], v[220:223], a[28:31]
ds_read_b64_tr_b16 a[84:85], v37 offset:16896
ds_read_b64_tr_b16 a[86:87], v37 offset:25344
s_waitcnt lgkmcnt(6)
v_mfma_f32_16x16x32_bf16 a[0:3], a[64:67], v[96:99], a[0:3]
ds_read_b64_tr_b16 a[48:49], v32 offset:25344
v_mfma_f32_16x16x32_bf16 a[16:19], a[64:67], v[224:227], a[16:19]
ds_read_b64_tr_b16 a[50:51], v32 offset:27456
s_add_u32 m0, s49, 70752
s_add_u32 s48, s56, 405888
v_mfma_f32_16x16x32_bf16 a[4:7], a[68:71], v[96:99], a[4:7]
buffer_load_dwordx4 v2, s[12:15], s48 offen nt lds
ds_read_b64_tr_b16 a[52:53], v33 offset:25344
v_mfma_f32_16x16x32_bf16 a[20:23], a[68:71], v[224:227], a[20:23]
ds_read_b64_tr_b16 a[54:55], v33 offset:27456
v_mfma_f32_16x16x32_bf16 a[8:11], a[72:75], v[96:99], a[8:11]
ds_read_b64_tr_b16 a[56:57], v34 offset:25344
v_mfma_f32_16x16x32_bf16 a[24:27], a[72:75], v[224:227], a[24:27]
ds_read_b64_tr_b16 a[58:59], v34 offset:27456
ds_read_b64_tr_b16 a[60:61], v35 offset:25344
s_waitcnt lgkmcnt(5)
v_mfma_f32_16x16x32_bf16 a[12:15], a[76:79], v[96:99], a[12:15]
ds_read_b64_tr_b16 a[62:63], v35 offset:27456
s_add_u32 m0, s49, 71808
s_add_u32 s48, s56, 409984
v_mfma_f32_16x16x32_bf16 a[28:31], a[76:79], v[224:227], a[28:31]
buffer_load_dwordx4 v2, s[12:15], s48 offen nt lds
v_mfma_f32_16x16x32_bf16 a[32:35], a[80:83], a[236:239], a[32:35]
ds_read_b64_tr_b16 a[64:65], v32 offset:29568
ds_read_b64_tr_b16 a[66:67], v32 offset:31680
v_mfma_f32_16x16x32_bf16 a[36:39], a[84:87], a[236:239], a[36:39]
ds_read_b64_tr_b16 a[68:69], v33 offset:29568
v_mfma_f32_16x16x32_bf16 a[0:3], a[48:51], v[100:103], a[0:3]
ds_read_b64_tr_b16 a[70:71], v33 offset:31680
ds_read_b64_tr_b16 a[72:73], v34 offset:29568
v_mfma_f32_16x16x32_bf16 a[16:19], a[48:51], v[228:231], a[16:19]
ds_read_b64_tr_b16 a[74:75], v34 offset:31680
s_waitcnt lgkmcnt(6)
v_mfma_f32_16x16x32_bf16 a[4:7], a[52:55], v[100:103], a[4:7]
ds_read_b64_tr_b16 a[76:77], v35 offset:29568
ds_read_b64_tr_b16 a[78:79], v35 offset:31680
v_mfma_f32_16x16x32_bf16 a[20:23], a[52:55], v[228:231], a[20:23]
ds_read_b64_tr_b16 a[80:81], v38 offset:16896
v_mfma_f32_16x16x32_bf16 a[8:11], a[56:59], v[100:103], a[8:11]
ds_read_b64_tr_b16 a[82:83], v38 offset:25344
s_add_u32 m0, s49, 72864
s_add_u32 s48, s56, 414080
v_mfma_f32_16x16x32_bf16 a[24:27], a[56:59], v[228:231], a[24:27]
buffer_load_dwordx4 v2, s[12:15], s48 offen nt lds
ds_read_b64_tr_b16 a[84:85], v39 offset:16896
v_mfma_f32_16x16x32_bf16 a[12:15], a[60:63], v[100:103], a[12:15]
ds_read_b64_tr_b16 a[86:87], v39 offset:25344
v_mfma_f32_16x16x32_bf16 a[28:31], a[60:63], v[228:231], a[28:31]
v_add_u32 v32, 33792, v32
v_add_u32 v33, 33792, v33
s_waitcnt lgkmcnt(2)
v_mfma_f32_16x16x32_bf16 a[0:3], a[64:67], v[104:107], a[0:3]
v_add_u32 v34, 33792, v34
v_mfma_f32_16x16x32_bf16 a[16:19], a[64:67], v[232:235], a[16:19]
v_add_u32 v35, 33792, v35
v_add_u32 v36, 33792, v36
v_mfma_f32_16x16x32_bf16 a[4:7], a[68:71], v[104:107], a[4:7]
v_add_u32 v37, 33792, v37
v_mfma_f32_16x16x32_bf16 a[20:23], a[68:71], v[232:235], a[20:23]
v_add_u32 v38, 33792, v38
v_add_u32 v39, 33792, v39
L_stage37:
s_waitcnt vmcnt(6)
s_waitcnt lgkmcnt(0)
s_barrier
ds_read_b64_tr_b16 a[48:49], v32
v_mfma_f32_16x16x32_bf16 a[8:11], a[72:75], v[104:107], a[8:11]
ds_read_b64_tr_b16 a[50:51], v32 offset:2112
ds_read_b64_tr_b16 a[52:53], v33
v_mfma_f32_16x16x32_bf16 a[24:27], a[72:75], v[232:235], a[24:27]
ds_read_b64_tr_b16 a[54:55], v33 offset:2112
v_mfma_f32_16x16x32_bf16 a[12:15], a[76:79], v[104:107], a[12:15]
ds_read_b64_tr_b16 a[56:57], v34
ds_read_b64_tr_b16 a[58:59], v34 offset:2112
v_mfma_f32_16x16x32_bf16 a[28:31], a[76:79], v[232:235], a[28:31]
ds_read_b64_tr_b16 a[60:61], v35
v_mfma_f32_16x16x32_bf16 a[40:43], a[80:83], a[236:239], a[40:43]
ds_read_b64_tr_b16 a[62:63], v35 offset:2112
v_mfma_f32_16x16x32_bf16 a[44:47], a[84:87], a[236:239], a[44:47]
ds_read_b64_tr_b16 a[64:65], v32 offset:4224
ds_read_b64_tr_b16 a[66:67], v32 offset:6336
s_add_u32 m0, s49, 73920
s_waitcnt lgkmcnt(5)
v_mfma_f32_16x16x32_bf16 a[0:3], a[48:51], v[108:111], a[0:3]
s_add_u32 s48, s56, 418176
buffer_load_dwordx4 v2, s[12:15], s48 offen nt lds
v_mfma_f32_16x16x32_bf16 a[16:19], a[48:51], v[236:239], a[16:19]
ds_read_b64_tr_b16 a[68:69], v33 offset:4224
v_mfma_f32_16x16x32_bf16 a[4:7], a[52:55], v[108:111], a[4:7]
ds_read_b64_tr_b16 a[70:71], v33 offset:6336
ds_read_b64_tr_b16 a[72:73], v34 offset:4224
v_mfma_f32_16x16x32_bf16 a[20:23], a[52:55], v[236:239], a[20:23]
ds_read_b64_tr_b16 a[74:75], v34 offset:6336
s_waitcnt lgkmcnt(4)
v_mfma_f32_16x16x32_bf16 a[8:11], a[56:59], v[108:111], a[8:11]
ds_read_b64_tr_b16 a[76:77], v35 offset:4224
v_mfma_f32_16x16x32_bf16 a[24:27], a[56:59], v[236:239], a[24:27]
ds_read_b64_tr_b16 a[78:79], v35 offset:6336
ds_read_b64_tr_b16 a[80:81], v36
v_mfma_f32_16x16x32_bf16 a[12:15], a[60:63], v[108:111], a[12:15]
ds_read_b64_tr_b16 a[82:83], v36 offset:8448
v_mfma_f32_16x16x32_bf16 a[28:31], a[60:63], v[236:239], a[28:31]
ds_read_b64_tr_b16 a[84:85], v37
ds_read_b64_tr_b16 a[86:87], v37 offset:8448
v_mfma_f32_16x16x32_bf16 a[0:3], a[64:67], v[112:115], a[0:3]
s_add_u32 m0, s49, 74976
s_add_u32 s48, s56, 422272
buffer_load_dwordx4 v2, s[12:15], s48 offen nt lds
v_mfma_f32_16x16x32_bf16 a[16:19], a[64:67], v[240:243], a[16:19]
ds_read_b64_tr_b16 a[48:49], v32 offset:8448
s_waitcnt lgkmcnt(3)
v_mfma_f32_16x16x32_bf16 a[4:7], a[68:71], v[112:115], a[4:7]
ds_read_b64_tr_b16 a[50:51], v32 offset:10560
ds_read_b64_tr_b16 a[52:53], v33 offset:8448
v_mfma_f32_16x16x32_bf16 a[20:23], a[68:71], v[240:243], a[20:23]
ds_read_b64_tr_b16 a[54:55], v33 offset:10560
v_mfma_f32_16x16x32_bf16 a[8:11], a[72:75], v[112:115], a[8:11]
ds_read_b64_tr_b16 a[56:57], v34 offset:8448
v_mfma_f32_16x16x32_bf16 a[24:27], a[72:75], v[240:243], a[24:27]
ds_read_b64_tr_b16 a[58:59], v34 offset:10560
ds_read_b64_tr_b16 a[60:61], v35 offset:8448
v_mfma_f32_16x16x32_bf16 a[12:15], a[76:79], v[112:115], a[12:15]
ds_read_b64_tr_b16 a[62:63], v35 offset:10560
s_lshl_b32 s51, s3, 11
s_add_u32 s51, s51, s57
v_mfma_f32_16x16x32_bf16 a[28:31], a[76:79], v[240:243], a[28:31]
s_add_u32 s48, s51, 0
buffer_store_dwordx4 a[104:107], v1, s[28:31], s48 offen sc1
v_mfma_f32_16x16x32_bf16 a[32:35], a[80:83], a[240:243], a[32:35]
ds_read_b64_tr_b16 a[64:65], v32 offset:12672
s_waitcnt lgkmcnt(2)
v_mfma_f32_16x16x32_bf16 a[36:39], a[84:87], a[240:243], a[36:39]
ds_read_b64_tr_b16 a[66:67], v32 offset:14784
ds_read_b64_tr_b16 a[68:69], v33 offset:12672
v_mfma_f32_16x16x32_bf16 a[0:3], a[48:51], v[116:119], a[0:3]
ds_read_b64_tr_b16 a[70:71], v33 offset:14784
v_mfma_f32_16x16x32_bf16 a[16:19], a[48:51], v[244:247], a[16:19]
ds_read_b64_tr_b16 a[72:73], v34 offset:12672
ds_read_b64_tr_b16 a[74:75], v34 offset:14784
v_mfma_f32_16x16x32_bf16 a[4:7], a[52:55], v[116:119], a[4:7]
ds_read_b64_tr_b16 a[76:77], v35 offset:12672
v_mfma_f32_16x16x32_bf16 a[20:23], a[52:55], v[244:247], a[20:23]
ds_read_b64_tr_b16 a[78:79], v35 offset:14784
v_mfma_f32_16x16x32_bf16 a[8:11], a[56:59], v[116:119], a[8:11]
ds_read_b64_tr_b16 a[80:81], v38
ds_read_b64_tr_b16 a[82:83], v38 offset:8448
s_lshl_b32 s51, s3, 11
v_mfma_f32_16x16x32_bf16 a[24:27], a[56:59], v[244:247], a[24:27]
s_add_u32 s51, s51, s57
s_add_u32 s48, s51, 73728
buffer_store_dwordx4 a[108:111], v1, s[28:31], s48 offen sc1
s_waitcnt lgkmcnt(3)
v_mfma_f32_16x16x32_bf16 a[12:15], a[60:63], v[116:119], a[12:15]
ds_read_b64_tr_b16 a[84:85], v39
v_mfma_f32_16x16x32_bf16 a[28:31], a[60:63], v[244:247], a[28:31]
ds_read_b64_tr_b16 a[86:87], v39 offset:8448
v_mfma_f32_16x16x32_bf16 a[0:3], a[64:67], v[120:123], a[0:3]
ds_read_b64_tr_b16 a[48:49], v32 offset:16896
ds_read_b64_tr_b16 a[50:51], v32 offset:19008
v_mfma_f32_16x16x32_bf16 a[16:19], a[64:67], v[248:251], a[16:19]
ds_read_b64_tr_b16 a[52:53], v33 offset:16896
v_mfma_f32_16x16x32_bf16 a[4:7], a[68:71], v[120:123], a[4:7]
ds_read_b64_tr_b16 a[54:55], v33 offset:19008
s_lshl_b32 s51, s3, 11
s_add_u32 s51, s51, s57
s_add_u32 s48, s51, 1024
v_mfma_f32_16x16x32_bf16 a[20:23], a[68:71], v[248:251], a[20:23]
buffer_store_dwordx4 a[112:115], v1, s[28:31], s48 offen sc1
v_mfma_f32_16x16x32_bf16 a[8:11], a[72:75], v[120:123], a[8:11]
ds_read_b64_tr_b16 a[56:57], v34 offset:16896
ds_read_b64_tr_b16 a[58:59], v34 offset:19008
v_mfma_f32_16x16x32_bf16 a[24:27], a[72:75], v[248:251], a[24:27]
ds_read_b64_tr_b16 a[60:61], v35 offset:16896
s_waitcnt lgkmcnt(3)
v_mfma_f32_16x16x32_bf16 a[12:15], a[76:79], v[120:123], a[12:15]
ds_read_b64_tr_b16 a[62:63], v35 offset:19008
ds_read_b64_tr_b16 a[64:65], v32 offset:21120
v_mfma_f32_16x16x32_bf16 a[28:31], a[76:79], v[248:251], a[28:31]
ds_read_b64_tr_b16 a[66:67], v32 offset:23232
v_mfma_f32_16x16x32_bf16 a[40:43], a[80:83], a[240:243], a[40:43]
ds_read_b64_tr_b16 a[68:69], v33 offset:21120
ds_read_b64_tr_b16 a[70:71], v33 offset:23232
v_mfma_f32_16x16x32_bf16 a[44:47], a[84:87], a[240:243], a[44:47]
s_lshl_b32 s51, s3, 11
s_add_u32 s51, s51, s57
s_add_u32 s48, s51, 74752
v_mfma_f32_16x16x32_bf16 a[0:3], a[48:51], v[124:127], a[0:3]
buffer_store_dwordx4 a[116:119], v1, s[28:31], s48 offen sc1
ds_read_b64_tr_b16 a[72:73], v34 offset:21120
v_mfma_f32_16x16x32_bf16 a[16:19], a[48:51], v[252:255], a[16:19]
ds_read_b64_tr_b16 a[74:75], v34 offset:23232
v_mfma_f32_16x16x32_bf16 a[4:7], a[52:55], v[124:127], a[4:7]
ds_read_b64_tr_b16 a[76:77], v35 offset:21120
v_mfma_f32_16x16x32_bf16 a[20:23], a[52:55], v[252:255], a[20:23]
ds_read_b64_tr_b16 a[78:79], v35 offset:23232
ds_read_b64_tr_b16 a[80:81], v36 offset:16896
s_waitcnt lgkmcnt(5)
v_mfma_f32_16x16x32_bf16 a[8:11], a[56:59], v[124:127], a[8:11]
ds_read_b64_tr_b16 a[82:83], v36 offset:25344
v_mfma_f32_16x16x32_bf16 a[24:27], a[56:59], v[252:255], a[24:27]
ds_read_b64_tr_b16 a[84:85], v37 offset:16896
ds_read_b64_tr_b16 a[86:87], v37 offset:25344
v_mfma_f32_16x16x32_bf16 a[12:15], a[60:63], v[124:127], a[12:15]
ds_read_b64_tr_b16 a[48:49], v32 offset:25344
v_mfma_f32_16x16x32_bf16 a[28:31], a[60:63], v[252:255], a[28:31]
ds_read_b64_tr_b16 a[50:51], v32 offset:27456
s_lshr_b32 s51, s3, 1
s_mul_i32 s51, s51, 73728
s_and_b32 s48, s3, 1
s_lshl_b32 s48, s48, 3
v_mfma_f32_16x16x32_bf16 a[0:3], a[64:67], v[128:131], a[0:3]
s_add_u32 s51, s51, s48
s_add_u32 s51, s51, s57
s_add_u32 s48, s51, 8192
v_mfma_f32_16x16x32_bf16 a[16:19], a[64:67], a[180:183], a[16:19]
buffer_store_dwordx2 a[120:121], v1, s[28:31], s48 offen sc1
ds_read_b64_tr_b16 a[52:53], v33 offset:25344
v_mfma_f32_16x16x32_bf16 a[4:7], a[68:71], v[128:131], a[4:7]
ds_read_b64_tr_b16 a[54:55], v33 offset:27456
v_mfma_f32_16x16x32_bf16 a[20:23], a[68:71], a[180:183], a[20:23]
ds_read_b64_tr_b16 a[56:57], v34 offset:25344
ds_read_b64_tr_b16 a[58:59], v34 offset:27456
s_waitcnt lgkmcnt(4)
v_mfma_f32_16x16x32_bf16 a[8:11], a[72:75], v[128:131], a[8:11]
ds_read_b64_tr_b16 a[60:61], v35 offset:25344
v_mfma_f32_16x16x32_bf16 a[24:27], a[72:75], a[180:183], a[24:27]
ds_read_b64_tr_b16 a[62:63], v35 offset:27456
s_lshl_b32 s51, s3, 11
s_add_u32 s51, s51, s57
s_add_u32 s48, s51, 2359296
v_mfma_f32_16x16x32_bf16 a[12:15], a[76:79], v[128:131], a[12:15]
buffer_store_dwordx4 a[124:127], v1, s[28:31], s48 offen sc1
v_mfma_f32_16x16x32_bf16 a[28:31], a[76:79], a[180:183], a[28:31]
ds_read_b64_tr_b16 a[64:65], v32 offset:29568
ds_read_b64_tr_b16 a[66:67], v32 offset:31680
v_mfma_f32_16x16x32_bf16 a[32:35], a[80:83], a[244:247], a[32:35]
ds_read_b64_tr_b16 a[68:69], v33 offset:29568
v_mfma_f32_16x16x32_bf16 a[36:39], a[84:87], a[244:247], a[36:39]
ds_read_b64_tr_b16 a[70:71], v33 offset:31680
v_mfma_f32_16x16x32_bf16 a[0:3], a[48:51], v[132:135], a[0:3]
ds_read_b64_tr_b16 a[72:73], v34 offset:29568
ds_read_b64_tr_b16 a[74:75], v34 offset:31680
v_mfma_f32_16x16x32_bf16 a[16:19], a[48:51], a[184:187], a[16:19]
ds_read_b64_tr_b16 a[76:77], v35 offset:29568
s_waitcnt lgkmcnt(5)
v_mfma_f32_16x16x32_bf16 a[4:7], a[52:55], v[132:135], a[4:7]
ds_read_b64_tr_b16 a[78:79], v35 offset:31680
ds_read_b64_tr_b16 a[80:81], v38 offset:16896
v_mfma_f32_16x16x32_bf16 a[20:23], a[52:55], a[184:187], a[20:23]
ds_read_b64_tr_b16 a[82:83], v38 offset:25344
s_lshl_b32 s51, s3, 11
s_add_u32 s51, s51, s57
v_mfma_f32_16x16x32_bf16 a[8:11], a[56:59], v[132:135], a[8:11]
s_add_u32 s48, s51, 2433024
buffer_store_dwordx4 a[128:131], v1, s[28:31], s48 offen sc1
v_mfma_f32_16x16x32_bf16 a[24:27], a[56:59], a[184:187], a[24:27]
ds_read_b64_tr_b16 a[84:85], v39 offset:16896
v_mfma_f32_16x16x32_bf16 a[12:15], a[60:63], v[132:135], a[12:15]
ds_read_b64_tr_b16 a[86:87], v39 offset:25344
v_add_u32 v32, 33792, v32
v_mfma_f32_16x16x32_bf16 a[28:31], a[60:63], a[184:187], a[28:31]
v_add_u32 v33, 33792, v33
v_mfma_f32_16x16x32_bf16 a[0:3], a[64:67], v[136:139], a[0:3]
v_add_u32 v34, 33792, v34
v_add_u32 v35, 33792, v35
v_mfma_f32_16x16x32_bf16 a[16:19], a[64:67], a[188:191], a[16:19]
v_add_u32 v36, 33792, v36
s_waitcnt lgkmcnt(1)
v_mfma_f32_16x16x32_bf16 a[4:7], a[68:71], v[136:139], a[4:7]
v_add_u32 v37, 33792, v37
v_mfma_f32_16x16x32_bf16 a[20:23], a[68:71], a[188:191], a[20:23]
v_add_u32 v38, 33792, v38
v_add_u32 v39, 33792, v39
L_stage38:
s_waitcnt vmcnt(7)
s_waitcnt lgkmcnt(0)
s_barrier
ds_read_b64_tr_b16 a[48:49], v32
ds_read_b64_tr_b16 a[50:51], v32 offset:2112
v_mfma_f32_16x16x32_bf16 a[8:11], a[72:75], v[136:139], a[8:11]
ds_read_b64_tr_b16 a[52:53], v33
v_mfma_f32_16x16x32_bf16 a[24:27], a[72:75], a[188:191], a[24:27]
ds_read_b64_tr_b16 a[54:55], v33 offset:2112
ds_read_b64_tr_b16 a[56:57], v34
v_mfma_f32_16x16x32_bf16 a[12:15], a[76:79], v[136:139], a[12:15]
ds_read_b64_tr_b16 a[58:59], v34 offset:2112
ds_read_b64_tr_b16 a[60:61], v35
v_mfma_f32_16x16x32_bf16 a[28:31], a[76:79], a[188:191], a[28:31]
ds_read_b64_tr_b16 a[62:63], v35 offset:2112
ds_read_b64_tr_b16 a[64:65], v32 offset:4224
v_mfma_f32_16x16x32_bf16 a[40:43], a[80:83], a[244:247], a[40:43]
ds_read_b64_tr_b16 a[66:67], v32 offset:6336
s_mul_i32 s4, s42, 9216
s_mul_i32 s5, s3, 576
s_add_u32 s4, s4, s5
v_mfma_f32_16x16x32_bf16 a[44:47], a[84:87], a[244:247], a[44:47]
s_lshl_b32 s5, s46, 2
s_add_u32 s4, s4, s5
s_lshl_b32 s93, s4, 10
s_mul_i32 s4, s3, 917504
s_lshl_b32 s5, s47, 7
s_add_u32 s94, s4, s5
s_lshl_b32 s4, s3, 13
s_waitcnt lgkmcnt(0)
v_mfma_f32_16x16x32_bf16 a[0:3], a[48:51], v[140:143], a[0:3]
s_add_u32 s66, s4, 102400
s_add_u32 s58, s4, 69632
v_lshrrev_b32 v7, 3, v0
v_mfma_f32_16x16x32_bf16 a[16:19], a[48:51], a[192:195], a[16:19]
v_and_b32 v8, 6, v7
v_and_b32 v10, 7, v0
v_mfma_f32_16x16x32_bf16 a[4:7], a[52:55], v[140:143], a[4:7]
v_xor_b32 v8, v8, v10
v_mfma_f32_16x16x32_bf16 a[20:23], a[52:55], a[192:195], a[20:23]
v_mul_u32_u24 v7, 896, v7
v_lshl_add_u32 v3, v8, 4, v7
v_mfma_f32_16x16x32_bf16 a[8:11], a[56:59], v[140:143], a[8:11]
ds_read_b64_tr_b16 a[68:69], v33 offset:4224
ds_read_b64_tr_b16 a[70:71], v33 offset:6336
v_mfma_f32_16x16x32_bf16 a[24:27], a[56:59], a[192:195], a[24:27]
ds_read_b64_tr_b16 a[72:73], v34 offset:4224
v_mfma_f32_16x16x32_bf16 a[12:15], a[60:63], v[140:143], a[12:15]
ds_read_b64_tr_b16 a[74:75], v34 offset:6336
ds_read_b64_tr_b16 a[76:77], v35 offset:4224
v_mfma_f32_16x16x32_bf16 a[28:31], a[60:63], a[192:195], a[28:31]
ds_read_b64_tr_b16 a[78:79], v35 offset:6336
ds_read_b64_tr_b16 a[80:81], v36
v_mfma_f32_16x16x32_bf16 a[0:3], a[64:67], v[144:147], a[0:3]
ds_read_b64_tr_b16 a[82:83], v36 offset:8448
ds_read_b64_tr_b16 a[84:85], v37
v_mfma_f32_16x16x32_bf16 a[16:19], a[64:67], a[196:199], a[16:19]
ds_read_b64_tr_b16 a[86:87], v37 offset:8448
s_lshl_b32 s51, s3, 11
s_add_u32 s51, s51, s57
s_add_u32 s48, s51, 2360320
s_waitcnt lgkmcnt(4)
v_mfma_f32_16x16x32_bf16 a[4:7], a[68:71], v[144:147], a[4:7]
buffer_store_dwordx4 a[132:135], v1, s[28:31], s48 offen sc1
v_mfma_f32_16x16x32_bf16 a[20:23], a[68:71], a[196:199], a[20:23]
ds_read_b64_tr_b16 a[48:49], v32 offset:8448
ds_read_b64_tr_b16 a[50:51], v32 offset:10560
v_mfma_f32_16x16x32_bf16 a[8:11], a[72:75], v[144:147], a[8:11]
ds_read_b64_tr_b16 a[52:53], v33 offset:8448
ds_read_b64_tr_b16 a[54:55], v33 offset:10560
v_mfma_f32_16x16x32_bf16 a[24:27], a[72:75], a[196:199], a[24:27]
ds_read_b64_tr_b16 a[56:57], v34 offset:8448
v_mfma_f32_16x16x32_bf16 a[12:15], a[76:79], v[144:147], a[12:15]
ds_read_b64_tr_b16 a[58:59], v34 offset:10560
s_add_u32 m0, s66, 0
s_add_u32 s48, s94, 0
buffer_load_dwordx4 v3, s[24:27], s48 offen lds
v_mfma_f32_16x16x32_bf16 a[28:31], a[76:79], a[196:199], a[28:31]
s_add_u32 m0, s66, 1024
s_add_u32 s48, s94, 7168
buffer_load_dwordx4 v3, s[24:27], s48 offen lds
s_waitcnt lgkmcnt(1)
v_mfma_f32_16x16x32_bf16 a[32:35], a[80:83], a[248:251], a[32:35]
s_add_u32 m0, s66, 2048
s_add_u32 s48, s94, 14336
buffer_load_dwordx4 v3, s[24:27], s48 offen lds
s_add_u32 m0, s66, 3072
v_mfma_f32_16x16x32_bf16 a[36:39], a[84:87], a[248:251], a[36:39]
s_add_u32 s48, s94, 21504
buffer_load_dwordx4 v3, s[24:27], s48 offen lds
v_mfma_f32_16x16x32_bf16 a[0:3], a[48:51], v[148:151], a[0:3]
ds_read_b64_tr_b16 a[60:61], v35 offset:8448
ds_read_b64_tr_b16 a[62:63], v35 offset:10560
v_mfma_f32_16x16x32_bf16 a[16:19], a[48:51], a[200:203], a[16:19]
ds_read_b64_tr_b16 a[64:65], v32 offset:12672
v_mfma_f32_16x16x32_bf16 a[4:7], a[52:55], v[148:151], a[4:7]
ds_read_b64_tr_b16 a[66:67], v32 offset:14784
ds_read_b64_tr_b16 a[68:69], v33 offset:12672
v_mfma_f32_16x16x32_bf16 a[20:23], a[52:55], a[200:203], a[20:23]
ds_read_b64_tr_b16 a[70:71], v33 offset:14784
s_lshl_b32 s51, s3, 11
s_add_u32 s51, s51, s57
s_add_u32 s48, s51, 2434048
s_waitcnt lgkmcnt(4)
v_mfma_f32_16x16x32_bf16 a[8:11], a[56:59], v[148:151], a[8:11]
buffer_store_dwordx4 a[136:139], v1, s[28:31], s48 offen sc1
v_mfma_f32_16x16x32_bf16 a[24:27], a[56:59], a[200:203], a[24:27]
ds_read_b64_tr_b16 a[72:73], v34 offset:12672
ds_read_b64_tr_b16 a[74:75], v34 offset:14784
v_mfma_f32_16x16x32_bf16 a[12:15], a[60:63], v[148:151], a[12:15]
ds_read_b64_tr_b16 a[76:77], v35 offset:12672
ds_read_b64_tr_b16 a[78:79], v35 offset:14784
v_mfma_f32_16x16x32_bf16 a[28:31], a[60:63], a[200:203], a[28:31]
ds_read_b64_tr_b16 a[80:81], v38
s_waitcnt lgkmcnt(5)
v_mfma_f32_16x16x32_bf16 a[0:3], a[64:67], v[152:155], a[0:3]
ds_read_b64_tr_b16 a[82:83], v38 offset:8448
ds_read_b64_tr_b16 a[84:85], v39
v_mfma_f32_16x16x32_bf16 a[16:19], a[64:67], a[204:207], a[16:19]
ds_read_b64_tr_b16 a[86:87], v39 offset:8448
s_lshr_b32 s51, s3, 1
s_mul_i32 s51, s51, 73728
s_and_b32 s48, s3, 1
v_mfma_f32_16x16x32_bf16 a[4:7], a[68:71], v[152:155], a[4:7]
s_lshl_b32 s48, s48, 3
s_add_u32 s51, s51, s48
s_add_u32 s51, s51, s57
s_add_u32 s48, s51, 2367488
v_mfma_f32_16x16x32_bf16 a[20:23], a[68:71], a[204:207], a[20:23]
buffer_store_dwordx2 a[140:141], v1, s[28:31], s48 offen sc1
ds_read_b64_tr_b16 a[48:49], v32 offset:16896
s_waitcnt lgkmcnt(1)
v_mfma_f32_16x16x32_bf16 a[8:11], a[72:75], v[152:155], a[8:11]
ds_read_b64_tr_b16 a[50:51], v32 offset:19008
ds_read_b64_tr_b16 a[52:53], v33 offset:16896
v_mfma_f32_16x16x32_bf16 a[24:27], a[72:75], a[204:207], a[24:27]
ds_read_b64_tr_b16 a[54:55], v33 offset:19008
v_mfma_f32_16x16x32_bf16 a[12:15], a[76:79], v[152:155], a[12:15]
ds_read_b64_tr_b16 a[56:57], v34 offset:16896
ds_read_b64_tr_b16 a[58:59], v34 offset:19008
v_mfma_f32_16x16x32_bf16 a[28:31], a[76:79], a[204:207], a[28:31]
s_lshl_b32 s51, s3, 11
s_add_u32 s51, s51, s57
s_add_u32 s48, s51, 4718592
buffer_store_dwordx4 a[144:147], v1, s[28:31], s48 offen sc1
v_mfma_f32_16x16x32_bf16 a[40:43], a[80:83], a[248:251], a[40:43]
ds_read_b64_tr_b16 a[60:61], v35 offset:16896
v_mfma_f32_16x16x32_bf16 a[44:47], a[84:87], a[248:251], a[44:47]
ds_read_b64_tr_b16 a[62:63], v35 offset:19008
ds_read_b64_tr_b16 a[64:65], v32 offset:21120
s_waitcnt lgkmcnt(3)
v_mfma_f32_16x16x32_bf16 a[0:3], a[48:51], v[156:159], a[0:3]
ds_read_b64_tr_b16 a[66:67], v32 offset:23232
v_mfma_f32_16x16x32_bf16 a[16:19], a[48:51], a[208:211], a[16:19]
ds_read_b64_tr_b16 a[68:69], v33 offset:21120
ds_read_b64_tr_b16 a[70:71], v33 offset:23232
s_lshl_b32 s51, s3, 11
v_mfma_f32_16x16x32_bf16 a[4:7], a[52:55], v[156:159], a[4:7]
s_add_u32 s51, s51, s57
s_add_u32 s48, s51, 4792320
buffer_store_dwordx4 a[148:151], v1, s[28:31], s48 offen sc1
v_mfma_f32_16x16x32_bf16 a[20:23], a[52:55], a[208:211], a[20:23]
ds_read_b64_tr_b16 a[72:73], v34 offset:21120
v_mfma_f32_16x16x32_bf16 a[8:11], a[56:59], v[156:159], a[8:11]
ds_read_b64_tr_b16 a[74:75], v34 offset:23232
ds_read_b64_tr_b16 a[76:77], v35 offset:21120
v_mfma_f32_16x16x32_bf16 a[24:27], a[56:59], a[208:211], a[24:27]
ds_read_b64_tr_b16 a[78:79], v35 offset:23232
ds_read_b64_tr_b16 a[80:81], v36 offset:16896
s_waitcnt lgkmcnt(5)
v_mfma_f32_16x16x32_bf16 a[12:15], a[60:63], v[156:159], a[12:15]
ds_read_b64_tr_b16 a[82:83], v36 offset:25344
v_mfma_f32_16x16x32_bf16 a[28:31], a[60:63], a[208:211], a[28:31]
ds_read_b64_tr_b16 a[84:85], v37 offset:16896
ds_read_b64_tr_b16 a[86:87], v37 offset:25344
s_add_u32 m0, s66, 4096
v_mfma_f32_16x16x32_bf16 a[0:3], a[64:67], v[160:163], a[0:3]
s_add_u32 s48, s94, 28672
buffer_load_dwordx4 v3, s[24:27], s48 offen lds
s_add_u32 m0, s66, 5120
v_mfma_f32_16x16x32_bf16 a[16:19], a[64:67], a[212:215], a[16:19]
s_add_u32 s48, s94, 35840
buffer_load_dwordx4 v3, s[24:27], s48 offen lds
s_add_u32 m0, s66, 6144
s_add_u32 s48, s94, 43008
v_mfma_f32_16x16x32_bf16 a[4:7], a[68:71], v[160:163], a[4:7]
buffer_load_dwordx4 v3, s[24:27], s48 offen lds
s_add_u32 m0, s66, 7168
s_add_u32 s48, s94, 50176
v_mfma_f32_16x16x32_bf16 a[20:23], a[68:71], a[212:215], a[20:23]
buffer_load_dwordx4 v3, s[24:27], s48 offen lds
s_waitcnt lgkmcnt(0)
v_mfma_f32_16x16x32_bf16 a[8:11], a[72:75], v[160:163], a[8:11]
ds_read_b64_tr_b16 a[48:49], v32 offset:25344
ds_read_b64_tr_b16 a[50:51], v32 offset:27456
v_mfma_f32_16x16x32_bf16 a[24:27], a[72:75], a[212:215], a[24:27]
ds_read_b64_tr_b16 a[52:53], v33 offset:25344
v_mfma_f32_16x16x32_bf16 a[12:15], a[76:79], v[160:163], a[12:15]
ds_read_b64_tr_b16 a[54:55], v33 offset:27456
ds_read_b64_tr_b16 a[56:57], v34 offset:25344
v_mfma_f32_16x16x32_bf16 a[28:31], a[76:79], a[212:215], a[28:31]
ds_read_b64_tr_b16 a[58:59], v34 offset:27456
s_lshl_b32 s51, s3, 11
s_add_u32 s51, s51, s57
s_add_u32 s48, s51, 4719616
v_mfma_f32_16x16x32_bf16 a[32:35], a[80:83], a[252:255], a[32:35]
buffer_store_dwordx4 a[152:155], v1, s[28:31], s48 offen sc1
v_mfma_f32_16x16x32_bf16 a[36:39], a[84:87], a[252:255], a[36:39]
ds_read_b64_tr_b16 a[60:61], v35 offset:25344
ds_read_b64_tr_b16 a[62:63], v35 offset:27456
s_waitcnt lgkmcnt(3)
v_mfma_f32_16x16x32_bf16 a[0:3], a[48:51], v[164:167], a[0:3]
ds_read_b64_tr_b16 a[64:65], v32 offset:29568
v_mfma_f32_16x16x32_bf16 a[16:19], a[48:51], a[216:219], a[16:19]
ds_read_b64_tr_b16 a[66:67], v32 offset:31680
ds_read_b64_tr_b16 a[68:69], v33 offset:29568
v_mfma_f32_16x16x32_bf16 a[4:7], a[52:55], v[164:167], a[4:7]
ds_read_b64_tr_b16 a[70:71], v33 offset:31680
s_lshl_b32 s51, s3, 11
s_add_u32 s51, s51, s57
v_mfma_f32_16x16x32_bf16 a[20:23], a[52:55], a[216:219], a[20:23]
s_add_u32 s48, s51, 4793344
buffer_store_dwordx4 a[156:159], v1, s[28:31], s48 offen sc1
s_waitcnt lgkmcnt(3)
v_mfma_f32_16x16x32_bf16 a[8:11], a[56:59], v[164:167], a[8:11]
ds_read_b64_tr_b16 a[72:73], v34 offset:29568
v_mfma_f32_16x16x32_bf16 a[24:27], a[56:59], a[216:219], a[24:27]
ds_read_b64_tr_b16 a[74:75], v34 offset:31680
ds_read_b64_tr_b16 a[76:77], v35 offset:29568
v_mfma_f32_16x16x32_bf16 a[12:15], a[60:63], v[164:167], a[12:15]
ds_read_b64_tr_b16 a[78:79], v35 offset:31680
v_mfma_f32_16x16x32_bf16 a[28:31], a[60:63], a[216:219], a[28:31]
ds_read_b64_tr_b16 a[80:81], v38 offset:16896
ds_read_b64_tr_b16 a[82:83], v38 offset:25344
s_waitcnt lgkmcnt(6)
v_mfma_f32_16x16x32_bf16 a[0:3], a[64:67], v[168:171], a[0:3]
ds_read_b64_tr_b16 a[84:85], v39 offset:16896
ds_read_b64_tr_b16 a[86:87], v39 offset:25344
v_mfma_f32_16x16x32_bf16 a[16:19], a[64:67], a[220:223], a[16:19]
s_lshr_b32 s51, s3, 1
s_mul_i32 s51, s51, 73728
s_and_b32 s48, s3, 1
s_lshl_b32 s48, s48, 3
s_add_u32 s51, s51, s48
s_add_u32 s51, s51, s57
v_mfma_f32_16x16x32_bf16 a[4:7], a[68:71], v[168:171], a[4:7]
s_add_u32 s48, s51, 4726784
buffer_store_dwordx2 a[160:161], v1, s[28:31], s48 offen sc1
v_mfma_f32_16x16x32_bf16 a[20:23], a[68:71], a[220:223], a[20:23]
v_accvgpr_read_b32 v12, a0
v_accvgpr_read_b32 v13, a1
v_accvgpr_read_b32 v14, a2
v_accvgpr_read_b32 v15, a3
v_mul_f32 v12, v12, v4
v_mul_f32 v13, v13, v4
s_waitcnt lgkmcnt(0)
v_mfma_f32_16x16x32_bf16 a[8:11], a[72:75], v[168:171], a[8:11]
v_mul_f32 v14, v14, v4
v_mul_f32 v15, v15, v4
v_cvt_pk_bf16_f32 v16, v12, v13
v_cvt_pk_bf16_f32 v17, v14, v15
v_accvgpr_write_b32 a164, v16
v_accvgpr_write_b32 a165, v17
v_mfma_f32_16x16x32_bf16 a[24:27], a[72:75], a[220:223], a[24:27]
v_accvgpr_read_b32 v18, a4
v_accvgpr_read_b32 v19, a5
v_accvgpr_read_b32 v20, a6
v_accvgpr_read_b32 v21, a7
v_mul_f32 v18, v18, v4
v_mul_f32 v19, v19, v4
v_mfma_f32_16x16x32_bf16 a[12:15], a[76:79], v[168:171], a[12:15]
v_mul_f32 v20, v20, v4
v_mul_f32 v21, v21, v4
v_cvt_pk_bf16_f32 v22, v18, v19
v_cvt_pk_bf16_f32 v23, v20, v21
v_accvgpr_write_b32 a166, v22
v_accvgpr_write_b32 a167, v23
v_mfma_f32_16x16x32_bf16 a[28:31], a[76:79], a[220:223], a[28:31]
v_accvgpr_read_b32 v12, a8
v_accvgpr_read_b32 v13, a9
v_accvgpr_read_b32 v14, a10
v_accvgpr_read_b32 v15, a11
v_mul_f32 v12, v12, v4
v_mul_f32 v13, v13, v4
v_mfma_f32_16x16x32_bf16 a[40:43], a[80:83], a[252:255], a[40:43]
v_mul_f32 v14, v14, v4
v_mul_f32 v15, v15, v4
v_cvt_pk_bf16_f32 v16, v12, v13
v_cvt_pk_bf16_f32 v17, v14, v15
v_accvgpr_write_b32 a168, v16
v_accvgpr_write_b32 a169, v17
v_mfma_f32_16x16x32_bf16 a[44:47], a[84:87], a[252:255], a[44:47]
v_accvgpr_read_b32 v18, a12
v_accvgpr_read_b32 v19, a13
v_accvgpr_read_b32 v20, a14
v_accvgpr_read_b32 v21, a15
v_mul_f32 v18, v18, v4
v_mul_f32 v19, v19, v4
v_mul_f32 v20, v20, v4
v_mul_f32 v21, v21, v4
v_cvt_pk_bf16_f32 v22, v18, v19
v_cvt_pk_bf16_f32 v23, v20, v21
v_accvgpr_write_b32 a170, v22
v_accvgpr_write_b32 a171, v23
v_accvgpr_read_b32 v12, a16
v_accvgpr_read_b32 v13, a17
v_accvgpr_read_b32 v14, a18
v_accvgpr_read_b32 v15, a19
v_mul_f32 v12, v12, v5
v_mul_f32 v13, v13, v5
v_mul_f32 v14, v14, v5
v_mul_f32 v15, v15, v5
v_cvt_pk_bf16_f32 v16, v12, v13
v_cvt_pk_bf16_f32 v17, v14, v15
v_accvgpr_write_b32 a172, v16
v_accvgpr_write_b32 a173, v17
v_accvgpr_read_b32 v18, a20
v_accvgpr_read_b32 v19, a21
v_accvgpr_read_b32 v20, a22
v_accvgpr_read_b32 v21, a23
v_mul_f32 v18, v18, v5
v_mul_f32 v19, v19, v5
v_mul_f32 v20, v20, v5
v_mul_f32 v21, v21, v5
v_cvt_pk_bf16_f32 v22, v18, v19
v_cvt_pk_bf16_f32 v23, v20, v21
v_accvgpr_write_b32 a174, v22
v_accvgpr_write_b32 a175, v23
v_accvgpr_read_b32 v12, a24
v_accvgpr_read_b32 v13, a25
v_accvgpr_read_b32 v14, a26
v_accvgpr_read_b32 v15, a27
v_mul_f32 v12, v12, v5
v_mul_f32 v13, v13, v5
v_mul_f32 v14, v14, v5
v_mul_f32 v15, v15, v5
v_cvt_pk_bf16_f32 v16, v12, v13
v_cvt_pk_bf16_f32 v17, v14, v15
v_accvgpr_write_b32 a176, v16
v_accvgpr_write_b32 a177, v17
v_accvgpr_read_b32 v18, a28
v_accvgpr_read_b32 v19, a29
v_accvgpr_read_b32 v20, a30
v_accvgpr_read_b32 v21, a31
v_mul_f32 v18, v18, v5
v_mul_f32 v19, v19, v5
v_mul_f32 v20, v20, v5
v_mul_f32 v21, v21, v5
v_cvt_pk_bf16_f32 v22, v18, v19
v_cvt_pk_bf16_f32 v23, v20, v21
v_accvgpr_write_b32 a178, v22
v_accvgpr_write_b32 a179, v23
s_lshl_b32 s4, s3, 12
s_add_u32 s4, s4, 138240
v_add_u32 v7, s4, v1
v_accvgpr_read_b32 v24, a32
v_accvgpr_read_b32 v25, a33
v_accvgpr_read_b32 v26, a34
v_accvgpr_read_b32 v27, a35
v_mul_f32 v24, v24, v6
v_mul_f32 v25, v25, v6
v_mul_f32 v26, v26, v6
v_mul_f32 v27, v27, v6
ds_write_b128 v7, v[24:27]
v_accvgpr_read_b32 v28, a36
v_accvgpr_read_b32 v29, a37
v_accvgpr_read_b32 v30, a38
v_accvgpr_read_b32 v31, a39
v_mul_f32 v28, v28, v6
v_mul_f32 v29, v29, v6
v_mul_f32 v30, v30, v6
v_mul_f32 v31, v31, v6
ds_write_b128 v7, v[28:31] offset:1024
v_accvgpr_read_b32 v24, a40
v_accvgpr_read_b32 v25, a41
v_accvgpr_read_b32 v26, a42
v_accvgpr_read_b32 v27, a43
v_mul_f32 v24, v24, v6
v_mul_f32 v25, v25, v6
v_mul_f32 v26, v26, v6
v_mul_f32 v27, v27, v6
ds_write_b128 v7, v[24:27] offset:2048
v_accvgpr_read_b32 v28, a44
v_accvgpr_read_b32 v29, a45
v_accvgpr_read_b32 v30, a46
v_accvgpr_read_b32 v31, a47
v_mul_f32 v28, v28, v6
v_mul_f32 v29, v29, v6
v_mul_f32 v30, v30, v6
v_mul_f32 v31, v31, v6
ds_write_b128 v7, v[28:31] offset:3072
s_waitcnt vmcnt(0)
s_waitcnt lgkmcnt(0)
s_barrier
s_add_u32 s51, s59, 0
s_cmp_lg_u32 s3, 0
s_cbranch_scc1 L_fl_o0
v_mov_b32 v10, s67
s_mov_b64 exec, 1
buffer_store_dword v10, off, s[28:31], s51 sc1
s_mov_b64 exec, -1
L_fl_o0:
s_lshl_b32 s4, s3, 10
s_add_u32 s4, s4, 138240
v_add_u32 v7, s4, v1
ds_read_b128 v[12:15], v7
ds_read_b128 v[16:19], v7 offset:4096
ds_read_b128 v[20:23], v7 offset:8192
ds_read_b128 v[24:27], v7 offset:12288
s_waitcnt lgkmcnt(2)
v_add_f32 v12, v12, v16
s_waitcnt lgkmcnt(0)
v_add_f32 v20, v20, v24
v_add_f32 v13, v13, v17
v_add_f32 v21, v21, v25
v_add_f32 v14, v14, v18
v_add_f32 v22, v22, v26
v_add_f32 v15, v15, v19
v_add_f32 v23, v23, v27
v_add_f32 v12, v12, v20
v_add_f32 v13, v13, v21
v_add_f32 v14, v14, v22
v_add_f32 v15, v15, v23
v_cvt_pk_bf16_f32 v16, v12, v13
v_cvt_pk_bf16_f32 v17, v14, v15
v_accvgpr_write_b32 a180, v16
v_accvgpr_write_b32 a181, v17
s_lshl_b32 s51, s3, 11
s_add_u32 s51, s51, s57
s_add_u32 s48, s51, 7077888
buffer_store_dwordx4 a[164:167], v1, s[28:31], s48 offen sc1
s_lshl_b32 s51, s3, 11
s_add_u32 s51, s51, s57
s_add_u32 s48, s51, 7151616
buffer_store_dwordx4 a[168:171], v1, s[28:31], s48 offen sc1
s_lshl_b32 s51, s3, 11
s_add_u32 s51, s51, s57
s_add_u32 s48, s51, 7078912
buffer_store_dwordx4 a[172:175], v1, s[28:31], s48 offen sc1
s_lshl_b32 s51, s3, 11
s_add_u32 s51, s51, s57
s_add_u32 s48, s51, 7152640
buffer_store_dwordx4 a[176:179], v1, s[28:31], s48 offen sc1
s_lshr_b32 s51, s3, 1
s_mul_i32 s51, s51, 73728
s_and_b32 s48, s3, 1
s_lshl_b32 s48, s48, 3
s_add_u32 s51, s51, s48
s_add_u32 s51, s51, s57
s_add_u32 s48, s51, 7086080
buffer_store_dwordx2 a[180:181], v1, s[28:31], s48 offen sc1
L_tail:
s_cmp_ge_u32 s45, 126
s_cbranch_scc0 L_havetile
s_waitcnt vmcnt(0)
s_barrier
s_add_u32 s51, s59, 128
s_cmp_lg_u32 s3, 0
s_cbranch_scc1 L_fl_o1x
v_mov_b32 v10, s67
s_mov_b64 exec, 1
buffer_store_dword v10, off, s[28:31], s51 sc1
s_mov_b64 exec, -1
L_fl_o1x:
s_branch L_fin
L_havetile:
s_lshl_b32 s4, s46, 2
s_mul_i32 s5, s4, 57
s_lshr_b32 s5, s5, 9
s_add_u32 s4, s4, 3
s_mul_i32 s6, s4, 57
s_lshr_b32 s6, s6, 9
s_lshl_b32 s7, s42, 3
s_add_u32 s5, s5, s7
s_add_u32 s6, s6, s7
s_lshl_b32 s5, s5, 9
s_lshl_b32 s6, s6, 9
v_mov_b32 v8, s5
v_mov_b32 v10, s6
v_cmp_gt_u32 vcc, 16, v0
s_nop 1
v_cndmask_b32 v8, v10, v8, vcc
v_and_b32 v7, 15, v0
v_lshl_add_u32 v7, v7, 2, v8
v_add_u32 v9, 26214400, v7
v_lshrrev_b32 v16, 4, v0
v_bfe_u32 v17, v0, 2, 2
v_and_b32 v18, 3, v0
v_and_b32 v19, 1, v16
v_lshl_add_u32 v19, v19, 2, v17
v_lshrrev_b32 v7, 1, v16
v_lshlrev_b32 v7, 10, v7
v_lshl_add_u32 v7, v19, 7, v7
v_lshl_add_u32 v7, v18, 3, v7
v_lshrrev_b32 v19, 1, v19
v_xor_b32 v8, 0, v19
v_lshl_add_u32 v8, v8, 5, v7
v_add_u32 v40, s66, v8
v_add_u32 v28, s58, v8
v_xor_b32 v8, 1, v19
v_lshl_add_u32 v8, v8, 5, v7
v_add_u32 v41, s66, v8
v_add_u32 v29, s58, v8
v_xor_b32 v8, 2, v19
v_lshl_add_u32 v8, v8, 5, v7
v_add_u32 v42, s66, v8
v_add_u32 v30, s58, v8
v_xor_b32 v8, 3, v19
v_lshl_add_u32 v8, v8, 5, v7
v_add_u32 v43, s66, v8
v_add_u32 v31, s58, v8
s_mov_b32 s95, 0
s_mov_b64 exec, -1
L_poll3:
buffer_load_dword v10, v9, s[28:31], 0 offen sc1
s_waitcnt vmcnt(0)
v_cmp_ne_u32 vcc, s67, v10
s_add_u32 s95, s95, 1
s_cmp_gt_u32 s95, 100000
s_cbranch_scc1 L_pollend3
s_cbranch_vccz L_pollend3
s_sleep 2
s_branch L_poll3
L_pollend3:
s_mov_b64 exec, -1
s_add_u32 s48, s93, 0
buffer_load_dwordx4 a[0:3], v1, s[28:31], s48 offen sc1
buffer_load_dwordx4 a[4:7], v1, s[28:31], s48 offen offset:1024 sc1
buffer_load_dwordx4 a[8:11], v1, s[28:31], s48 offen offset:2048 sc1
buffer_load_dwordx4 a[12:15], v1, s[28:31], s48 offen offset:3072 sc1
s_add_u32 s48, s93, 73728
buffer_load_dwordx4 a[16:19], v1, s[28:31], s48 offen sc1
buffer_load_dwordx4 a[20:23], v1, s[28:31], s48 offen offset:1024 sc1
buffer_load_dwordx4 a[24:27], v1, s[28:31], s48 offen offset:2048 sc1
buffer_load_dwordx4 a[28:31], v1, s[28:31], s48 offen offset:3072 sc1
s_add_u32 s48, s93, 147456
buffer_load_dwordx4 a[32:35], v1, s[28:31], s48 offen sc1
buffer_load_dwordx4 a[36:39], v1, s[28:31], s48 offen offset:1024 sc1
buffer_load_dwordx4 a[40:43], v1, s[28:31], s48 offen offset:2048 sc1
buffer_load_dwordx4 a[44:47], v1, s[28:31], s48 offen offset:3072 sc1
s_barrier
s_add_u32 s51, s59, 128
s_cmp_lg_u32 s3, 0
s_cbranch_scc1 L_fl_o1
v_mov_b32 v10, s67
s_mov_b64 exec, 1
buffer_store_dword v10, off, s[28:31], s51 sc1
s_mov_b64 exec, -1
L_fl_o1:
s_add_u32 m0, s58, 0
s_add_u32 s48, s94, 229376
buffer_load_dwordx4 v3, s[24:27], s48 offen lds
s_add_u32 m0, s58, 1024
s_add_u32 s48, s94, 236544
buffer_load_dwordx4 v3, s[24:27], s48 offen lds
s_add_u32 m0, s58, 2048
s_add_u32 s48, s94, 243712
buffer_load_dwordx4 v3, s[24:27], s48 offen lds
s_add_u32 m0, s58, 3072
s_add_u32 s48, s94, 250880
buffer_load_dwordx4 v3, s[24:27], s48 offen lds
ds_read_b64_tr_b16 a[224:225], v40
ds_read_b64_tr_b16 a[226:227], v40 offset:2048
ds_read_b64_tr_b16 a[228:229], v41
ds_read_b64_tr_b16 a[230:231], v41 offset:2048
ds_read_b64_tr_b16 a[232:233], v42
ds_read_b64_tr_b16 a[234:235], v42 offset:2048
ds_read_b64_tr_b16 a[236:237], v43
ds_read_b64_tr_b16 a[238:239], v43 offset:2048
s_add_u32 m0, s58, 4096
s_add_u32 s48, s94, 258048
buffer_load_dwordx4 v3, s[24:27], s48 offen lds
s_add_u32 m0, s58, 5120
s_add_u32 s48, s94, 265216
buffer_load_dwordx4 v3, s[24:27], s48 offen lds
s_add_u32 m0, s58, 6144
s_add_u32 s48, s94, 272384
buffer_load_dwordx4 v3, s[24:27], s48 offen lds
s_add_u32 m0, s58, 7168
s_add_u32 s48, s94, 279552
buffer_load_dwordx4 v3, s[24:27], s48 offen lds
s_add_u32 s48, s93, 221184
buffer_load_dwordx4 a[48:51], v1, s[28:31], s48 offen sc1
buffer_load_dwordx4 a[52:55], v1, s[28:31], s48 offen offset:1024 sc1
buffer_load_dwordx4 a[56:59], v1, s[28:31], s48 offen offset:2048 sc1
buffer_load_dwordx4 a[60:63], v1, s[28:31], s48 offen offset:3072 sc1
ds_read_b64_tr_b16 a[240:241], v40 offset:4096
s_waitcnt vmcnt(23) lgkmcnt(1)
v_mfma_f32_16x16x32_bf16 v[44:47], a[224:227], a[0:3], 0
ds_read_b64_tr_b16 a[242:243], v40 offset:6144
s_waitcnt vmcnt(22)
v_mfma_f32_16x16x32_bf16 v[48:51], a[224:227], a[4:7], 0
ds_read_b64_tr_b16 a[244:245], v41 offset:4096
s_waitcnt vmcnt(21)
v_mfma_f32_16x16x32_bf16 v[52:55], a[224:227], a[8:11], 0
ds_read_b64_tr_b16 a[246:247], v41 offset:6144
s_waitcnt vmcnt(20)
v_mfma_f32_16x16x32_bf16 v[56:59], a[224:227], a[12:15], 0
ds_read_b64_tr_b16 a[248:249], v42 offset:4096
v_mfma_f32_16x16x32_bf16 v[60:63], a[228:231], a[0:3], 0
ds_read_b64_tr_b16 a[250:251], v42 offset:6144
v_mfma_f32_16x16x32_bf16 v[64:67], a[228:231], a[4:7], 0
ds_read_b64_tr_b16 a[252:253], v43 offset:4096
v_mfma_f32_16x16x32_bf16 v[68:71], a[228:231], a[8:11], 0
ds_read_b64_tr_b16 a[254:255], v43 offset:6144
s_add_u32 m0, s66, 0
s_add_u32 s48, s94, 458752
v_mfma_f32_16x16x32_bf16 v[72:75], a[228:231], a[12:15], 0
buffer_load_dwordx4 v3, s[24:27], s48 offen lds
s_add_u32 m0, s66, 1024
v_mfma_f32_16x16x32_bf16 v[76:79], a[232:235], a[0:3], 0
s_add_u32 s48, s94, 465920
buffer_load_dwordx4 v3, s[24:27], s48 offen lds
v_mfma_f32_16x16x32_bf16 v[80:83], a[232:235], a[4:7], 0
s_add_u32 m0, s66, 2048
s_add_u32 s48, s94, 473088
v_mfma_f32_16x16x32_bf16 v[84:87], a[232:235], a[8:11], 0
buffer_load_dwordx4 v3, s[24:27], s48 offen lds
s_add_u32 m0, s66, 3072
s_add_u32 s48, s94, 480256
v_mfma_f32_16x16x32_bf16 v[88:91], a[232:235], a[12:15], 0
buffer_load_dwordx4 v3, s[24:27], s48 offen lds
s_add_u32 s48, s93, 294912
v_mfma_f32_16x16x32_bf16 v[92:95], a[236:239], a[0:3], 0
buffer_load_dwordx4 a[64:67], v1, s[28:31], s48 offen sc1
v_mfma_f32_16x16x32_bf16 v[96:99], a[236:239], a[4:7], 0
buffer_load_dwordx4 a[68:71], v1, s[28:31], s48 offen offset:1024 sc1
v_mfma_f32_16x16x32_bf16 v[100:103], a[236:239], a[8:11], 0
buffer_load_dwordx4 a[72:75], v1, s[28:31], s48 offen offset:2048 sc1
v_mfma_f32_16x16x32_bf16 v[104:107], a[236:239], a[12:15], 0
buffer_load_dwordx4 a[76:79], v1, s[28:31], s48 offen offset:3072 sc1
s_waitcnt vmcnt(16)
ds_read_b64_tr_b16 a[224:225], v28
s_waitcnt lgkmcnt(1)
v_mfma_f32_16x16x32_bf16 v[44:47], a[240:243], a[16:19], v[44:47]
ds_read_b64_tr_b16 a[226:227], v28 offset:2048
v_mfma_f32_16x16x32_bf16 v[48:51], a[240:243], a[20:23], v[48:51]
ds_read_b64_tr_b16 a[228:229], v29
v_mfma_f32_16x16x32_bf16 v[52:55], a[240:243], a[24:27], v[52:55]
ds_read_b64_tr_b16 a[230:231], v29 offset:2048
v_mfma_f32_16x16x32_bf16 v[56:59], a[240:243], a[28:31], v[56:59]
ds_read_b64_tr_b16 a[232:233], v30
v_mfma_f32_16x16x32_bf16 v[60:63], a[244:247], a[16:19], v[60:63]
ds_read_b64_tr_b16 a[234:235], v30 offset:2048
v_mfma_f32_16x16x32_bf16 v[64:67], a[244:247], a[20:23], v[64:67]
ds_read_b64_tr_b16 a[236:237], v31
v_mfma_f32_16x16x32_bf16 v[68:71], a[244:247], a[24:27], v[68:71]
ds_read_b64_tr_b16 a[238:239], v31 offset:2048
s_add_u32 m0, s66, 4096
s_add_u32 s48, s94, 487424
v_mfma_f32_16x16x32_bf16 v[72:75], a[244:247], a[28:31], v[72:75]
buffer_load_dwordx4 v3, s[24:27], s48 offen lds
s_add_u32 m0, s66, 5120
v_mfma_f32_16x16x32_bf16 v[76:79], a[248:251], a[16:19], v[76:79]
s_add_u32 s48, s94, 494592
buffer_load_dwordx4 v3, s[24:27], s48 offen lds
v_mfma_f32_16x16x32_bf16 v[80:83], a[248:251], a[20:23], v[80:83]
s_add_u32 m0, s66, 6144
s_add_u32 s48, s94, 501760
v_mfma_f32_16x16x32_bf16 v[84:87], a[248:251], a[24:27], v[84:87]
buffer_load_dwordx4 v3, s[24:27], s48 offen lds
s_add_u32 m0, s66, 7168
s_add_u32 s48, s94, 508928
v_mfma_f32_16x16x32_bf16 v[88:91], a[248:251], a[28:31], v[88:91]
buffer_load_dwordx4 v3, s[24:27], s48 offen lds
s_add_u32 s48, s93, 368640
v_mfma_f32_16x16x32_bf16 v[92:95], a[252:255], a[16:19], v[92:95]
buffer_load_dwordx4 a[80:83], v1, s[28:31], s48 offen sc1
v_mfma_f32_16x16x32_bf16 v[96:99], a[252:255], a[20:23], v[96:99]
buffer_load_dwordx4 a[84:87], v1, s[28:31], s48 offen offset:1024 sc1
v_mfma_f32_16x16x32_bf16 v[100:103], a[252:255], a[24:27], v[100:103]
buffer_load_dwordx4 a[88:91], v1, s[28:31], s48 offen offset:2048 sc1
v_mfma_f32_16x16x32_bf16 v[104:107], a[252:255], a[28:31], v[104:107]
buffer_load_dwordx4 a[92:95], v1, s[28:31], s48 offen offset:3072 sc1
s_waitcnt vmcnt(20)
ds_read_b64_tr_b16 a[240:241], v28 offset:4096
s_waitcnt lgkmcnt(1)
v_mfma_f32_16x16x32_bf16 v[44:47], a[224:227], a[32:35], v[44:47]
ds_read_b64_tr_b16 a[242:243], v28 offset:6144
v_mfma_f32_16x16x32_bf16 v[48:51], a[224:227], a[36:39], v[48:51]
ds_read_b64_tr_b16 a[244:245], v29 offset:4096
v_mfma_f32_16x16x32_bf16 v[52:55], a[224:227], a[40:43], v[52:55]
ds_read_b64_tr_b16 a[246:247], v29 offset:6144
v_mfma_f32_16x16x32_bf16 v[56:59], a[224:227], a[44:47], v[56:59]
ds_read_b64_tr_b16 a[248:249], v30 offset:4096
v_mfma_f32_16x16x32_bf16 v[60:63], a[228:231], a[32:35], v[60:63]
ds_read_b64_tr_b16 a[250:251], v30 offset:6144
v_mfma_f32_16x16x32_bf16 v[64:67], a[228:231], a[36:39], v[64:67]
ds_read_b64_tr_b16 a[252:253], v31 offset:4096
v_mfma_f32_16x16x32_bf16 v[68:71], a[228:231], a[40:43], v[68:71]
ds_read_b64_tr_b16 a[254:255], v31 offset:6144
s_add_u32 m0, s58, 0
s_add_u32 s48, s94, 688128
v_mfma_f32_16x16x32_bf16 v[72:75], a[228:231], a[44:47], v[72:75]
buffer_load_dwordx4 v3, s[24:27], s48 offen lds
s_add_u32 m0, s58, 1024
v_mfma_f32_16x16x32_bf16 v[76:79], a[232:235], a[32:35], v[76:79]
s_add_u32 s48, s94, 695296
buffer_load_dwordx4 v3, s[24:27], s48 offen lds
v_mfma_f32_16x16x32_bf16 v[80:83], a[232:235], a[36:39], v[80:83]
s_add_u32 m0, s58, 2048
s_add_u32 s48, s94, 702464
v_mfma_f32_16x16x32_bf16 v[84:87], a[232:235], a[40:43], v[84:87]
buffer_load_dwordx4 v3, s[24:27], s48 offen lds
s_add_u32 m0, s58, 3072
s_add_u32 s48, s94, 709632
v_mfma_f32_16x16x32_bf16 v[88:91], a[232:235], a[44:47], v[88:91]
buffer_load_dwordx4 v3, s[24:27], s48 offen lds
s_add_u32 s48, s93, 442368
v_mfma_f32_16x16x32_bf16 v[92:95], a[236:239], a[32:35], v[92:95]
buffer_load_dwordx4 a[0:3], v1, s[28:31], s48 offen sc1
v_mfma_f32_16x16x32_bf16 v[96:99], a[236:239], a[36:39], v[96:99]
buffer_load_dwordx4 a[4:7], v1, s[28:31], s48 offen offset:1024 sc1
v_mfma_f32_16x16x32_bf16 v[100:103], a[236:239], a[40:43], v[100:103]
buffer_load_dwordx4 a[8:11], v1, s[28:31], s48 offen offset:2048 sc1
v_mfma_f32_16x16x32_bf16 v[104:107], a[236:239], a[44:47], v[104:107]
buffer_load_dwordx4 a[12:15], v1, s[28:31], s48 offen offset:3072 sc1
s_waitcnt vmcnt(20)
ds_read_b64_tr_b16 a[224:225], v40
s_waitcnt lgkmcnt(1)
v_mfma_f32_16x16x32_bf16 v[44:47], a[240:243], a[48:51], v[44:47]
ds_read_b64_tr_b16 a[226:227], v40 offset:2048
v_mfma_f32_16x16x32_bf16 v[48:51], a[240:243], a[52:55], v[48:51]
ds_read_b64_tr_b16 a[228:229], v41
v_mfma_f32_16x16x32_bf16 v[52:55], a[240:243], a[56:59], v[52:55]
ds_read_b64_tr_b16 a[230:231], v41 offset:2048
v_mfma_f32_16x16x32_bf16 v[56:59], a[240:243], a[60:63], v[56:59]
ds_read_b64_tr_b16 a[232:233], v42
v_mfma_f32_16x16x32_bf16 v[60:63], a[244:247], a[48:51], v[60:63]
ds_read_b64_tr_b16 a[234:235], v42 offset:2048
v_mfma_f32_16x16x32_bf16 v[64:67], a[244:247], a[52:55], v[64:67]
ds_read_b64_tr_b16 a[236:237], v43
v_mfma_f32_16x16x32_bf16 v[68:71], a[244:247], a[56:59], v[68:71]
ds_read_b64_tr_b16 a[238:239], v43 offset:2048
s_add_u32 m0, s58, 4096
s_add_u32 s48, s94, 716800
v_mfma_f32_16x16x32_bf16 v[72:75], a[244:247], a[60:63], v[72:75]
buffer_load_dwordx4 v3, s[24:27], s48 offen lds
s_add_u32 m0, s58, 5120
v_mfma_f32_16x16x32_bf16 v[76:79], a[248:251], a[48:51], v[76:79]
s_add_u32 s48, s94, 723968
buffer_load_dwordx4 v3, s[24:27], s48 offen lds
v_mfma_f32_16x16x32_bf16 v[80:83], a[248:251], a[52:55], v[80:83]
s_add_u32 m0, s58, 6144
s_add_u32 s48, s94, 731136
v_mfma_f32_16x16x32_bf16 v[84:87], a[248:251], a[56:59], v[84:87]
buffer_load_dwordx4 v3, s[24:27], s48 offen lds
s_add_u32 m0, s58, 7168
s_add_u32 s48, s94, 738304
v_mfma_f32_16x16x32_bf16 v[88:91], a[248:251], a[60:63], v[88:91]
buffer_load_dwordx4 v3, s[24:27], s48 offen lds
s_add_u32 s48, s93, 516096
v_mfma_f32_16x16x32_bf16 v[92:95], a[252:255], a[48:51], v[92:95]
buffer_load_dwordx4 a[16:19], v1, s[28:31], s48 offen sc1
v_mfma_f32_16x16x32_bf16 v[96:99], a[252:255], a[52:55], v[96:99]
buffer_load_dwordx4 a[20:23], v1, s[28:31], s48 offen offset:1024 sc1
v_mfma_f32_16x16x32_bf16 v[100:103], a[252:255], a[56:59], v[100:103]
buffer_load_dwordx4 a[24:27], v1, s[28:31], s48 offen offset:2048 sc1
v_mfma_f32_16x16x32_bf16 v[104:107], a[252:255], a[60:63], v[104:107]
buffer_load_dwordx4 a[28:31], v1, s[28:31], s48 offen offset:3072 sc1
s_waitcnt vmcnt(20)
ds_read_b64_tr_b16 a[240:241], v40 offset:4096
s_waitcnt lgkmcnt(1)
v_mfma_f32_16x16x32_bf16 v[44:47], a[224:227], a[64:67], v[44:47]
ds_read_b64_tr_b16 a[242:243], v40 offset:6144
v_mfma_f32_16x16x32_bf16 v[48:51], a[224:227], a[68:71], v[48:51]
ds_read_b64_tr_b16 a[244:245], v41 offset:4096
v_mfma_f32_16x16x32_bf16 v[52:55], a[224:227], a[72:75], v[52:55]
ds_read_b64_tr_b16 a[246:247], v41 offset:6144
v_mfma_f32_16x16x32_bf16 v[56:59], a[224:227], a[76:79], v[56:59]
ds_read_b64_tr_b16 a[248:249], v42 offset:4096
v_mfma_f32_16x16x32_bf16 v[60:63], a[228:231], a[64:67], v[60:63]
ds_read_b64_tr_b16 a[250:251], v42 offset:6144
v_mfma_f32_16x16x32_bf16 v[64:67], a[228:231], a[68:71], v[64:67]
ds_read_b64_tr_b16 a[252:253], v43 offset:4096
v_mfma_f32_16x16x32_bf16 v[68:71], a[228:231], a[72:75], v[68:71]
ds_read_b64_tr_b16 a[254:255], v43 offset:6144
s_add_u32 m0, s66, 0
s_add_u32 s48, s94, 57344
v_mfma_f32_16x16x32_bf16 v[72:75], a[228:231], a[76:79], v[72:75]
buffer_load_dwordx4 v3, s[24:27], s48 offen lds
s_add_u32 m0, s66, 1024
v_mfma_f32_16x16x32_bf16 v[76:79], a[232:235], a[64:67], v[76:79]
s_add_u32 s48, s94, 64512
buffer_load_dwordx4 v3, s[24:27], s48 offen lds
v_mfma_f32_16x16x32_bf16 v[80:83], a[232:235], a[68:71], v[80:83]
s_add_u32 m0, s66, 2048
s_add_u32 s48, s94, 71680
v_mfma_f32_16x16x32_bf16 v[84:87], a[232:235], a[72:75], v[84:87]
buffer_load_dwordx4 v3, s[24:27], s48 offen lds
s_add_u32 m0, s66, 3072
s_add_u32 s48, s94, 78848
v_mfma_f32_16x16x32_bf16 v[88:91], a[232:235], a[76:79], v[88:91]
buffer_load_dwordx4 v3, s[24:27], s48 offen lds
s_add_u32 s48, s93, 2359296
v_mfma_f32_16x16x32_bf16 v[92:95], a[236:239], a[64:67], v[92:95]
buffer_load_dwordx4 a[32:35], v1, s[28:31], s48 offen sc1
v_mfma_f32_16x16x32_bf16 v[96:99], a[236:239], a[68:71], v[96:99]
buffer_load_dwordx4 a[36:39], v1, s[28:31], s48 offen offset:1024 sc1
v_mfma_f32_16x16x32_bf16 v[100:103], a[236:239], a[72:75], v[100:103]
buffer_load_dwordx4 a[40:43], v1, s[28:31], s48 offen offset:2048 sc1
v_mfma_f32_16x16x32_bf16 v[104:107], a[236:239], a[76:79], v[104:107]
buffer_load_dwordx4 a[44:47], v1, s[28:31], s48 offen offset:3072 sc1
s_waitcnt vmcnt(20)
ds_read_b64_tr_b16 a[224:225], v28
s_waitcnt lgkmcnt(1)
v_mfma_f32_16x16x32_bf16 v[44:47], a[240:243], a[80:83], v[44:47]
ds_read_b64_tr_b16 a[226:227], v28 offset:2048
v_mfma_f32_16x16x32_bf16 v[48:51], a[240:243], a[84:87], v[48:51]
ds_read_b64_tr_b16 a[228:229], v29
v_mfma_f32_16x16x32_bf16 v[52:55], a[240:243], a[88:91], v[52:55]
ds_read_b64_tr_b16 a[230:231], v29 offset:2048
v_mfma_f32_16x16x32_bf16 v[56:59], a[240:243], a[92:95], v[56:59]
ds_read_b64_tr_b16 a[232:233], v30
v_mfma_f32_16x16x32_bf16 v[60:63], a[244:247], a[80:83], v[60:63]
ds_read_b64_tr_b16 a[234:235], v30 offset:2048
v_mfma_f32_16x16x32_bf16 v[64:67], a[244:247], a[84:87], v[64:67]
ds_read_b64_tr_b16 a[236:237], v31
v_mfma_f32_16x16x32_bf16 v[68:71], a[244:247], a[88:91], v[68:71]
ds_read_b64_tr_b16 a[238:239], v31 offset:2048
s_add_u32 m0, s66, 4096
s_add_u32 s48, s94, 86016
v_mfma_f32_16x16x32_bf16 v[72:75], a[244:247], a[92:95], v[72:75]
buffer_load_dwordx4 v3, s[24:27], s48 offen lds
s_add_u32 m0, s66, 5120
v_mfma_f32_16x16x32_bf16 v[76:79], a[248:251], a[80:83], v[76:79]
s_add_u32 s48, s94, 93184
buffer_load_dwordx4 v3, s[24:27], s48 offen lds
v_mfma_f32_16x16x32_bf16 v[80:83], a[248:251], a[84:87], v[80:83]
s_add_u32 m0, s66, 6144
s_add_u32 s48, s94, 100352
v_mfma_f32_16x16x32_bf16 v[84:87], a[248:251], a[88:91], v[84:87]
buffer_load_dwordx4 v3, s[24:27], s48 offen lds
s_add_u32 m0, s66, 7168
s_add_u32 s48, s94, 107520
v_mfma_f32_16x16x32_bf16 v[88:91], a[248:251], a[92:95], v[88:91]
buffer_load_dwordx4 v3, s[24:27], s48 offen lds
s_add_u32 s48, s93, 2433024
v_mfma_f32_16x16x32_bf16 v[92:95], a[252:255], a[80:83], v[92:95]
buffer_load_dwordx4 a[48:51], v1, s[28:31], s48 offen sc1
v_mfma_f32_16x16x32_bf16 v[96:99], a[252:255], a[84:87], v[96:99]
buffer_load_dwordx4 a[52:55], v1, s[28:31], s48 offen offset:1024 sc1
v_mfma_f32_16x16x32_bf16 v[100:103], a[252:255], a[88:91], v[100:103]
buffer_load_dwordx4 a[56:59], v1, s[28:31], s48 offen offset:2048 sc1
v_mfma_f32_16x16x32_bf16 v[104:107], a[252:255], a[92:95], v[104:107]
buffer_load_dwordx4 a[60:63], v1, s[28:31], s48 offen offset:3072 sc1
s_waitcnt vmcnt(20)
ds_read_b64_tr_b16 a[240:241], v28 offset:4096
s_waitcnt lgkmcnt(1)
v_mfma_f32_16x16x32_bf16 v[44:47], a[224:227], a[0:3], v[44:47]
ds_read_b64_tr_b16 a[242:243], v28 offset:6144
v_mfma_f32_16x16x32_bf16 v[48:51], a[224:227], a[4:7], v[48:51]
ds_read_b64_tr_b16 a[244:245], v29 offset:4096
v_mfma_f32_16x16x32_bf16 v[52:55], a[224:227], a[8:11], v[52:55]
ds_read_b64_tr_b16 a[246:247], v29 offset:6144
v_mfma_f32_16x16x32_bf16 v[56:59], a[224:227], a[12:15], v[56:59]
ds_read_b64_tr_b16 a[248:249], v30 offset:4096
v_mfma_f32_16x16x32_bf16 v[60:63], a[228:231], a[0:3], v[60:63]
ds_read_b64_tr_b16 a[250:251], v30 offset:6144
v_mfma_f32_16x16x32_bf16 v[64:67], a[228:231], a[4:7], v[64:67]
ds_read_b64_tr_b16 a[252:253], v31 offset:4096
v_mfma_f32_16x16x32_bf16 v[68:71], a[228:231], a[8:11], v[68:71]
ds_read_b64_tr_b16 a[254:255], v31 offset:6144
s_add_u32 m0, s58, 0
s_add_u32 s48, s94, 286720
v_mfma_f32_16x16x32_bf16 v[72:75], a[228:231], a[12:15], v[72:75]
buffer_load_dwordx4 v3, s[24:27], s48 offen lds
s_add_u32 m0, s58, 1024
v_mfma_f32_16x16x32_bf16 v[76:79], a[232:235], a[0:3], v[76:79]
s_add_u32 s48, s94, 293888
buffer_load_dwordx4 v3, s[24:27], s48 offen lds
v_mfma_f32_16x16x32_bf16 v[80:83], a[232:235], a[4:7], v[80:83]
s_add_u32 m0, s58, 2048
s_add_u32 s48, s94, 301056
v_mfma_f32_16x16x32_bf16 v[84:87], a[232:235], a[8:11], v[84:87]
buffer_load_dwordx4 v3, s[24:27], s48 offen lds
s_add_u32 m0, s58, 3072
s_add_u32 s48, s94, 308224
v_mfma_f32_16x16x32_bf16 v[88:91], a[232:235], a[12:15], v[88:91]
buffer_load_dwordx4 v3, s[24:27], s48 offen lds
s_add_u32 s48, s93, 2506752
v_mfma_f32_16x16x32_bf16 v[92:95], a[236:239], a[0:3], v[92:95]
buffer_load_dwordx4 a[64:67], v1, s[28:31], s48 offen sc1
v_mfma_f32_16x16x32_bf16 v[96:99], a[236:239], a[4:7], v[96:99]
buffer_load_dwordx4 a[68:71], v1, s[28:31], s48 offen offset:1024 sc1
v_mfma_f32_16x16x32_bf16 v[100:103], a[236:239], a[8:11], v[100:103]
buffer_load_dwordx4 a[72:75], v1, s[28:31], s48 offen offset:2048 sc1
v_mfma_f32_16x16x32_bf16 v[104:107], a[236:239], a[12:15], v[104:107]
buffer_load_dwordx4 a[76:79], v1, s[28:31], s48 offen offset:3072 sc1
s_waitcnt vmcnt(20)
ds_read_b64_tr_b16 a[224:225], v40
s_waitcnt lgkmcnt(1)
v_mfma_f32_16x16x32_bf16 v[44:47], a[240:243], a[16:19], v[44:47]
ds_read_b64_tr_b16 a[226:227], v40 offset:2048
v_mfma_f32_16x16x32_bf16 v[48:51], a[240:243], a[20:23], v[48:51]
ds_read_b64_tr_b16 a[228:229], v41
v_mfma_f32_16x16x32_bf16 v[52:55], a[240:243], a[24:27], v[52:55]
ds_read_b64_tr_b16 a[230:231], v41 offset:2048
v_mfma_f32_16x16x32_bf16 v[56:59], a[240:243], a[28:31], v[56:59]
ds_read_b64_tr_b16 a[232:233], v42
v_mfma_f32_16x16x32_bf16 v[60:63], a[244:247], a[16:19], v[60:63]
ds_read_b64_tr_b16 a[234:235], v42 offset:2048
v_mfma_f32_16x16x32_bf16 v[64:67], a[244:247], a[20:23], v[64:67]
ds_read_b64_tr_b16 a[236:237], v43
v_mfma_f32_16x16x32_bf16 v[68:71], a[244:247], a[24:27], v[68:71]
ds_read_b64_tr_b16 a[238:239], v43 offset:2048
s_add_u32 m0, s58, 4096
s_add_u32 s48, s94, 315392
v_mfma_f32_16x16x32_bf16 v[72:75], a[244:247], a[28:31], v[72:75]
buffer_load_dwordx4 v3, s[24:27], s48 offen lds
s_add_u32 m0, s58, 5120
v_mfma_f32_16x16x32_bf16 v[76:79], a[248:251], a[16:19], v[76:79]
s_add_u32 s48, s94, 322560
buffer_load_dwordx4 v3, s[24:27], s48 offen lds
v_mfma_f32_16x16x32_bf16 v[80:83], a[248:251], a[20:23], v[80:83]
s_add_u32 m0, s58, 6144
s_add_u32 s48, s94, 329728
v_mfma_f32_16x16x32_bf16 v[84:87], a[248:251], a[24:27], v[84:87]
buffer_load_dwordx4 v3, s[24:27], s48 offen lds
s_add_u32 m0, s58, 7168
s_add_u32 s48, s94, 336896
v_mfma_f32_16x16x32_bf16 v[88:91], a[248:251], a[28:31], v[88:91]
buffer_load_dwordx4 v3, s[24:27], s48 offen lds
s_add_u32 s48, s93, 2580480
v_mfma_f32_16x16x32_bf16 v[92:95], a[252:255], a[16:19], v[92:95]
buffer_load_dwordx4 a[80:83], v1, s[28:31], s48 offen sc1
v_mfma_f32_16x16x32_bf16 v[96:99], a[252:255], a[20:23], v[96:99]
buffer_load_dwordx4 a[84:87], v1, s[28:31], s48 offen offset:1024 sc1
v_mfma_f32_16x16x32_bf16 v[100:103], a[252:255], a[24:27], v[100:103]
buffer_load_dwordx4 a[88:91], v1, s[28:31], s48 offen offset:2048 sc1
v_mfma_f32_16x16x32_bf16 v[104:107], a[252:255], a[28:31], v[104:107]
buffer_load_dwordx4 a[92:95], v1, s[28:31], s48 offen offset:3072 sc1
s_waitcnt vmcnt(20)
ds_read_b64_tr_b16 a[240:241], v40 offset:4096
s_waitcnt lgkmcnt(1)
v_mfma_f32_16x16x32_bf16 v[44:47], a[224:227], a[32:35], v[44:47]
ds_read_b64_tr_b16 a[242:243], v40 offset:6144
v_mfma_f32_16x16x32_bf16 v[48:51], a[224:227], a[36:39], v[48:51]
ds_read_b64_tr_b16 a[244:245], v41 offset:4096
v_mfma_f32_16x16x32_bf16 v[52:55], a[224:227], a[40:43], v[52:55]
ds_read_b64_tr_b16 a[246:247], v41 offset:6144
v_mfma_f32_16x16x32_bf16 v[56:59], a[224:227], a[44:47], v[56:59]
ds_read_b64_tr_b16 a[248:249], v42 offset:4096
v_mfma_f32_16x16x32_bf16 v[60:63], a[228:231], a[32:35], v[60:63]
ds_read_b64_tr_b16 a[250:251], v42 offset:6144
v_mfma_f32_16x16x32_bf16 v[64:67], a[228:231], a[36:39], v[64:67]
ds_read_b64_tr_b16 a[252:253], v43 offset:4096
v_mfma_f32_16x16x32_bf16 v[68:71], a[228:231], a[40:43], v[68:71]
ds_read_b64_tr_b16 a[254:255], v43 offset:6144
s_add_u32 m0, s66, 0
s_add_u32 s48, s94, 516096
v_mfma_f32_16x16x32_bf16 v[72:75], a[228:231], a[44:47], v[72:75]
buffer_load_dwordx4 v3, s[24:27], s48 offen lds
s_add_u32 m0, s66, 1024
v_mfma_f32_16x16x32_bf16 v[76:79], a[232:235], a[32:35], v[76:79]
s_add_u32 s48, s94, 523264
buffer_load_dwordx4 v3, s[24:27], s48 offen lds
v_mfma_f32_16x16x32_bf16 v[80:83], a[232:235], a[36:39], v[80:83]
s_add_u32 m0, s66, 2048
s_add_u32 s48, s94, 530432
v_mfma_f32_16x16x32_bf16 v[84:87], a[232:235], a[40:43], v[84:87]
buffer_load_dwordx4 v3, s[24:27], s48 offen lds
s_add_u32 m0, s66, 3072
s_add_u32 s48, s94, 537600
v_mfma_f32_16x16x32_bf16 v[88:91], a[232:235], a[44:47], v[88:91]
buffer_load_dwordx4 v3, s[24:27], s48 offen lds
s_add_u32 s48, s93, 2654208
v_mfma_f32_16x16x32_bf16 v[92:95], a[236:239], a[32:35], v[92:95]
buffer_load_dwordx4 a[0:3], v1, s[28:31], s48 offen sc1
v_mfma_f32_16x16x32_bf16 v[96:99], a[236:239], a[36:39], v[96:99]
buffer_load_dwordx4 a[4:7], v1, s[28:31], s48 offen offset:1024 sc1
v_mfma_f32_16x16x32_bf16 v[100:103], a[236:239], a[40:43], v[100:103]
buffer_load_dwordx4 a[8:11], v1, s[28:31], s48 offen offset:2048 sc1
v_mfma_f32_16x16x32_bf16 v[104:107], a[236:239], a[44:47], v[104:107]
buffer_load_dwordx4 a[12:15], v1, s[28:31], s48 offen offset:3072 sc1
s_waitcnt vmcnt(20)
ds_read_b64_tr_b16 a[224:225], v28
s_waitcnt lgkmcnt(1)
v_mfma_f32_16x16x32_bf16 v[44:47], a[240:243], a[48:51], v[44:47]
ds_read_b64_tr_b16 a[226:227], v28 offset:2048
v_mfma_f32_16x16x32_bf16 v[48:51], a[240:243], a[52:55], v[48:51]
ds_read_b64_tr_b16 a[228:229], v29
v_mfma_f32_16x16x32_bf16 v[52:55], a[240:243], a[56:59], v[52:55]
ds_read_b64_tr_b16 a[230:231], v29 offset:2048
v_mfma_f32_16x16x32_bf16 v[56:59], a[240:243], a[60:63], v[56:59]
ds_read_b64_tr_b16 a[232:233], v30
v_mfma_f32_16x16x32_bf16 v[60:63], a[244:247], a[48:51], v[60:63]
ds_read_b64_tr_b16 a[234:235], v30 offset:2048
v_mfma_f32_16x16x32_bf16 v[64:67], a[244:247], a[52:55], v[64:67]
ds_read_b64_tr_b16 a[236:237], v31
v_mfma_f32_16x16x32_bf16 v[68:71], a[244:247], a[56:59], v[68:71]
ds_read_b64_tr_b16 a[238:239], v31 offset:2048
s_add_u32 m0, s66, 4096
s_add_u32 s48, s94, 544768
v_mfma_f32_16x16x32_bf16 v[72:75], a[244:247], a[60:63], v[72:75]
buffer_load_dwordx4 v3, s[24:27], s48 offen lds
s_add_u32 m0, s66, 5120
v_mfma_f32_16x16x32_bf16 v[76:79], a[248:251], a[48:51], v[76:79]
s_add_u32 s48, s94, 551936
buffer_load_dwordx4 v3, s[24:27], s48 offen lds
v_mfma_f32_16x16x32_bf16 v[80:83], a[248:251], a[52:55], v[80:83]
s_add_u32 m0, s66, 6144
s_add_u32 s48, s94, 559104
v_mfma_f32_16x16x32_bf16 v[84:87], a[248:251], a[56:59], v[84:87]
buffer_load_dwordx4 v3, s[24:27], s48 offen lds
s_add_u32 m0, s66, 7168
s_add_u32 s48, s94, 566272
v_mfma_f32_16x16x32_bf16 v[88:91], a[248:251], a[60:63], v[88:91]
buffer_load_dwordx4 v3, s[24:27], s48 offen lds
s_add_u32 s48, s93, 2727936
v_mfma_f32_16x16x32_bf16 v[92:95], a[252:255], a[48:51], v[92:95]
buffer_load_dwordx4 a[16:19], v1, s[28:31], s48 offen sc1
v_mfma_f32_16x16x32_bf16 v[96:99], a[252:255], a[52:55], v[96:99]
buffer_load_dwordx4 a[20:23], v1, s[28:31], s48 offen offset:1024 sc1
v_mfma_f32_16x16x32_bf16 v[100:103], a[252:255], a[56:59], v[100:103]
buffer_load_dwordx4 a[24:27], v1, s[28:31], s48 offen offset:2048 sc1
v_mfma_f32_16x16x32_bf16 v[104:107], a[252:255], a[60:63], v[104:107]
buffer_load_dwordx4 a[28:31], v1, s[28:31], s48 offen offset:3072 sc1
s_waitcnt vmcnt(20)
ds_read_b64_tr_b16 a[240:241], v28 offset:4096
s_waitcnt lgkmcnt(1)
v_mfma_f32_16x16x32_bf16 v[44:47], a[224:227], a[64:67], v[44:47]
ds_read_b64_tr_b16 a[242:243], v28 offset:6144
v_mfma_f32_16x16x32_bf16 v[48:51], a[224:227], a[68:71], v[48:51]
ds_read_b64_tr_b16 a[244:245], v29 offset:4096
v_mfma_f32_16x16x32_bf16 v[52:55], a[224:227], a[72:75], v[52:55]
ds_read_b64_tr_b16 a[246:247], v29 offset:6144
v_mfma_f32_16x16x32_bf16 v[56:59], a[224:227], a[76:79], v[56:59]
ds_read_b64_tr_b16 a[248:249], v30 offset:4096
v_mfma_f32_16x16x32_bf16 v[60:63], a[228:231], a[64:67], v[60:63]
ds_read_b64_tr_b16 a[250:251], v30 offset:6144
v_mfma_f32_16x16x32_bf16 v[64:67], a[228:231], a[68:71], v[64:67]
ds_read_b64_tr_b16 a[252:253], v31 offset:4096
v_mfma_f32_16x16x32_bf16 v[68:71], a[228:231], a[72:75], v[68:71]
ds_read_b64_tr_b16 a[254:255], v31 offset:6144
s_add_u32 m0, s58, 0
s_add_u32 s48, s94, 745472
v_mfma_f32_16x16x32_bf16 v[72:75], a[228:231], a[76:79], v[72:75]
buffer_load_dwordx4 v3, s[24:27], s48 offen lds
s_add_u32 m0, s58, 1024
v_mfma_f32_16x16x32_bf16 v[76:79], a[232:235], a[64:67], v[76:79]
s_add_u32 s48, s94, 752640
buffer_load_dwordx4 v3, s[24:27], s48 offen lds
v_mfma_f32_16x16x32_bf16 v[80:83], a[232:235], a[68:71], v[80:83]
s_add_u32 m0, s58, 2048
s_add_u32 s48, s94, 759808
v_mfma_f32_16x16x32_bf16 v[84:87], a[232:235], a[72:75], v[84:87]
buffer_load_dwordx4 v3, s[24:27], s48 offen lds
s_add_u32 m0, s58, 3072
s_add_u32 s48, s94, 766976
v_mfma_f32_16x16x32_bf16 v[88:91], a[232:235], a[76:79], v[88:91]
buffer_load_dwordx4 v3, s[24:27], s48 offen lds
s_add_u32 s48, s93, 2801664
v_mfma_f32_16x16x32_bf16 v[92:95], a[236:239], a[64:67], v[92:95]
buffer_load_dwordx4 a[32:35], v1, s[28:31], s48 offen sc1
v_mfma_f32_16x16x32_bf16 v[96:99], a[236:239], a[68:71], v[96:99]
buffer_load_dwordx4 a[36:39], v1, s[28:31], s48 offen offset:1024 sc1
v_mfma_f32_16x16x32_bf16 v[100:103], a[236:239], a[72:75], v[100:103]
buffer_load_dwordx4 a[40:43], v1, s[28:31], s48 offen offset:2048 sc1
v_mfma_f32_16x16x32_bf16 v[104:107], a[236:239], a[76:79], v[104:107]
buffer_load_dwordx4 a[44:47], v1, s[28:31], s48 offen offset:3072 sc1
s_waitcnt vmcnt(20)
ds_read_b64_tr_b16 a[224:225], v40
s_waitcnt lgkmcnt(1)
v_mfma_f32_16x16x32_bf16 v[44:47], a[240:243], a[80:83], v[44:47]
ds_read_b64_tr_b16 a[226:227], v40 offset:2048
v_mfma_f32_16x16x32_bf16 v[48:51], a[240:243], a[84:87], v[48:51]
ds_read_b64_tr_b16 a[228:229], v41
v_mfma_f32_16x16x32_bf16 v[52:55], a[240:243], a[88:91], v[52:55]
ds_read_b64_tr_b16 a[230:231], v41 offset:2048
v_mfma_f32_16x16x32_bf16 v[56:59], a[240:243], a[92:95], v[56:59]
ds_read_b64_tr_b16 a[232:233], v42
v_mfma_f32_16x16x32_bf16 v[60:63], a[244:247], a[80:83], v[60:63]
ds_read_b64_tr_b16 a[234:235], v42 offset:2048
v_mfma_f32_16x16x32_bf16 v[64:67], a[244:247], a[84:87], v[64:67]
ds_read_b64_tr_b16 a[236:237], v43
v_mfma_f32_16x16x32_bf16 v[68:71], a[244:247], a[88:91], v[68:71]
ds_read_b64_tr_b16 a[238:239], v43 offset:2048
s_add_u32 m0, s58, 4096
s_add_u32 s48, s94, 774144
v_mfma_f32_16x16x32_bf16 v[72:75], a[244:247], a[92:95], v[72:75]
buffer_load_dwordx4 v3, s[24:27], s48 offen lds
s_add_u32 m0, s58, 5120
v_mfma_f32_16x16x32_bf16 v[76:79], a[248:251], a[80:83], v[76:79]
s_add_u32 s48, s94, 781312
buffer_load_dwordx4 v3, s[24:27], s48 offen lds
v_mfma_f32_16x16x32_bf16 v[80:83], a[248:251], a[84:87], v[80:83]
s_add_u32 m0, s58, 6144
s_add_u32 s48, s94, 788480
v_mfma_f32_16x16x32_bf16 v[84:87], a[248:251], a[88:91], v[84:87]
buffer_load_dwordx4 v3, s[24:27], s48 offen lds
s_add_u32 m0, s58, 7168
s_add_u32 s48, s94, 795648
v_mfma_f32_16x16x32_bf16 v[88:91], a[248:251], a[92:95], v[88:91]
buffer_load_dwordx4 v3, s[24:27], s48 offen lds
s_add_u32 s48, s93, 2875392
v_mfma_f32_16x16x32_bf16 v[92:95], a[252:255], a[80:83], v[92:95]
buffer_load_dwordx4 a[48:51], v1, s[28:31], s48 offen sc1
v_mfma_f32_16x16x32_bf16 v[96:99], a[252:255], a[84:87], v[96:99]
buffer_load_dwordx4 a[52:55], v1, s[28:31], s48 offen offset:1024 sc1
v_mfma_f32_16x16x32_bf16 v[100:103], a[252:255], a[88:91], v[100:103]
buffer_load_dwordx4 a[56:59], v1, s[28:31], s48 offen offset:2048 sc1
v_mfma_f32_16x16x32_bf16 v[104:107], a[252:255], a[92:95], v[104:107]
buffer_load_dwordx4 a[60:63], v1, s[28:31], s48 offen offset:3072 sc1
s_waitcnt vmcnt(20)
ds_read_b64_tr_b16 a[240:241], v40 offset:4096
s_waitcnt lgkmcnt(1)
v_mfma_f32_16x16x32_bf16 v[44:47], a[224:227], a[0:3], v[44:47]
ds_read_b64_tr_b16 a[242:243], v40 offset:6144
v_mfma_f32_16x16x32_bf16 v[48:51], a[224:227], a[4:7], v[48:51]
ds_read_b64_tr_b16 a[244:245], v41 offset:4096
v_mfma_f32_16x16x32_bf16 v[52:55], a[224:227], a[8:11], v[52:55]
ds_read_b64_tr_b16 a[246:247], v41 offset:6144
v_mfma_f32_16x16x32_bf16 v[56:59], a[224:227], a[12:15], v[56:59]
ds_read_b64_tr_b16 a[248:249], v42 offset:4096
v_mfma_f32_16x16x32_bf16 v[60:63], a[228:231], a[0:3], v[60:63]
ds_read_b64_tr_b16 a[250:251], v42 offset:6144
v_mfma_f32_16x16x32_bf16 v[64:67], a[228:231], a[4:7], v[64:67]
ds_read_b64_tr_b16 a[252:253], v43 offset:4096
v_mfma_f32_16x16x32_bf16 v[68:71], a[228:231], a[8:11], v[68:71]
ds_read_b64_tr_b16 a[254:255], v43 offset:6144
s_add_u32 m0, s66, 0
s_add_u32 s48, s94, 114688
v_mfma_f32_16x16x32_bf16 v[72:75], a[228:231], a[12:15], v[72:75]
buffer_load_dwordx4 v3, s[24:27], s48 offen lds
s_add_u32 m0, s66, 1024
v_mfma_f32_16x16x32_bf16 v[76:79], a[232:235], a[0:3], v[76:79]
s_add_u32 s48, s94, 121856
buffer_load_dwordx4 v3, s[24:27], s48 offen lds
v_mfma_f32_16x16x32_bf16 v[80:83], a[232:235], a[4:7], v[80:83]
s_add_u32 m0, s66, 2048
s_add_u32 s48, s94, 129024
v_mfma_f32_16x16x32_bf16 v[84:87], a[232:235], a[8:11], v[84:87]
buffer_load_dwordx4 v3, s[24:27], s48 offen lds
s_add_u32 m0, s66, 3072
s_add_u32 s48, s94, 136192
v_mfma_f32_16x16x32_bf16 v[88:91], a[232:235], a[12:15], v[88:91]
buffer_load_dwordx4 v3, s[24:27], s48 offen lds
s_add_u32 s48, s93, 4718592
v_mfma_f32_16x16x32_bf16 v[92:95], a[236:239], a[0:3], v[92:95]
buffer_load_dwordx4 a[64:67], v1, s[28:31], s48 offen sc1
v_mfma_f32_16x16x32_bf16 v[96:99], a[236:239], a[4:7], v[96:99]
buffer_load_dwordx4 a[68:71], v1, s[28:31], s48 offen offset:1024 sc1
v_mfma_f32_16x16x32_bf16 v[100:103], a[236:239], a[8:11], v[100:103]
buffer_load_dwordx4 a[72:75], v1, s[28:31], s48 offen offset:2048 sc1
v_mfma_f32_16x16x32_bf16 v[104:107], a[236:239], a[12:15], v[104:107]
buffer_load_dwordx4 a[76:79], v1, s[28:31], s48 offen offset:3072 sc1
s_waitcnt vmcnt(20)
ds_read_b64_tr_b16 a[224:225], v28
s_waitcnt lgkmcnt(1)
v_mfma_f32_16x16x32_bf16 v[44:47], a[240:243], a[16:19], v[44:47]
ds_read_b64_tr_b16 a[226:227], v28 offset:2048
v_mfma_f32_16x16x32_bf16 v[48:51], a[240:243], a[20:23], v[48:51]
ds_read_b64_tr_b16 a[228:229], v29
v_mfma_f32_16x16x32_bf16 v[52:55], a[240:243], a[24:27], v[52:55]
ds_read_b64_tr_b16 a[230:231], v29 offset:2048
v_mfma_f32_16x16x32_bf16 v[56:59], a[240:243], a[28:31], v[56:59]
ds_read_b64_tr_b16 a[232:233], v30
v_mfma_f32_16x16x32_bf16 v[60:63], a[244:247], a[16:19], v[60:63]
ds_read_b64_tr_b16 a[234:235], v30 offset:2048
v_mfma_f32_16x16x32_bf16 v[64:67], a[244:247], a[20:23], v[64:67]
ds_read_b64_tr_b16 a[236:237], v31
v_mfma_f32_16x16x32_bf16 v[68:71], a[244:247], a[24:27], v[68:71]
ds_read_b64_tr_b16 a[238:239], v31 offset:2048
s_add_u32 m0, s66, 4096
s_add_u32 s48, s94, 143360
v_mfma_f32_16x16x32_bf16 v[72:75], a[244:247], a[28:31], v[72:75]
buffer_load_dwordx4 v3, s[24:27], s48 offen lds
s_add_u32 m0, s66, 5120
v_mfma_f32_16x16x32_bf16 v[76:79], a[248:251], a[16:19], v[76:79]
s_add_u32 s48, s94, 150528
buffer_load_dwordx4 v3, s[24:27], s48 offen lds
v_mfma_f32_16x16x32_bf16 v[80:83], a[248:251], a[20:23], v[80:83]
s_add_u32 m0, s66, 6144
s_add_u32 s48, s94, 157696
v_mfma_f32_16x16x32_bf16 v[84:87], a[248:251], a[24:27], v[84:87]
buffer_load_dwordx4 v3, s[24:27], s48 offen lds
s_add_u32 m0, s66, 7168
s_add_u32 s48, s94, 164864
v_mfma_f32_16x16x32_bf16 v[88:91], a[248:251], a[28:31], v[88:91]
buffer_load_dwordx4 v3, s[24:27], s48 offen lds
s_add_u32 s48, s93, 4792320
v_mfma_f32_16x16x32_bf16 v[92:95], a[252:255], a[16:19], v[92:95]
buffer_load_dwordx4 a[80:83], v1, s[28:31], s48 offen sc1
v_mfma_f32_16x16x32_bf16 v[96:99], a[252:255], a[20:23], v[96:99]
buffer_load_dwordx4 a[84:87], v1, s[28:31], s48 offen offset:1024 sc1
v_mfma_f32_16x16x32_bf16 v[100:103], a[252:255], a[24:27], v[100:103]
buffer_load_dwordx4 a[88:91], v1, s[28:31], s48 offen offset:2048 sc1
v_mfma_f32_16x16x32_bf16 v[104:107], a[252:255], a[28:31], v[104:107]
buffer_load_dwordx4 a[92:95], v1, s[28:31], s48 offen offset:3072 sc1
s_waitcnt vmcnt(20)
ds_read_b64_tr_b16 a[240:241], v28 offset:4096
s_waitcnt lgkmcnt(1)
v_mfma_f32_16x16x32_bf16 v[44:47], a[224:227], a[32:35], v[44:47]
ds_read_b64_tr_b16 a[242:243], v28 offset:6144
v_mfma_f32_16x16x32_bf16 v[48:51], a[224:227], a[36:39], v[48:51]
ds_read_b64_tr_b16 a[244:245], v29 offset:4096
v_mfma_f32_16x16x32_bf16 v[52:55], a[224:227], a[40:43], v[52:55]
ds_read_b64_tr_b16 a[246:247], v29 offset:6144
v_mfma_f32_16x16x32_bf16 v[56:59], a[224:227], a[44:47], v[56:59]
ds_read_b64_tr_b16 a[248:249], v30 offset:4096
v_mfma_f32_16x16x32_bf16 v[60:63], a[228:231], a[32:35], v[60:63]
ds_read_b64_tr_b16 a[250:251], v30 offset:6144
v_mfma_f32_16x16x32_bf16 v[64:67], a[228:231], a[36:39], v[64:67]
ds_read_b64_tr_b16 a[252:253], v31 offset:4096
v_mfma_f32_16x16x32_bf16 v[68:71], a[228:231], a[40:43], v[68:71]
ds_read_b64_tr_b16 a[254:255], v31 offset:6144
s_add_u32 m0, s58, 0
s_add_u32 s48, s94, 344064
v_mfma_f32_16x16x32_bf16 v[72:75], a[228:231], a[44:47], v[72:75]
buffer_load_dwordx4 v3, s[24:27], s48 offen lds
s_add_u32 m0, s58, 1024
v_mfma_f32_16x16x32_bf16 v[76:79], a[232:235], a[32:35], v[76:79]
s_add_u32 s48, s94, 351232
buffer_load_dwordx4 v3, s[24:27], s48 offen lds
v_mfma_f32_16x16x32_bf16 v[80:83], a[232:235], a[36:39], v[80:83]
s_add_u32 m0, s58, 2048
s_add_u32 s48, s94, 358400
v_mfma_f32_16x16x32_bf16 v[84:87], a[232:235], a[40:43], v[84:87]
buffer_load_dwordx4 v3, s[24:27], s48 offen lds
s_add_u32 m0, s58, 3072
s_add_u32 s48, s94, 365568
v_mfma_f32_16x16x32_bf16 v[88:91], a[232:235], a[44:47], v[88:91]
buffer_load_dwordx4 v3, s[24:27], s48 offen lds
s_add_u32 s48, s93, 4866048
v_mfma_f32_16x16x32_bf16 v[92:95], a[236:239], a[32:35], v[92:95]
buffer_load_dwordx4 a[0:3], v1, s[28:31], s48 offen sc1
v_mfma_f32_16x16x32_bf16 v[96:99], a[236:239], a[36:39], v[96:99]
buffer_load_dwordx4 a[4:7], v1, s[28:31], s48 offen offset:1024 sc1
v_mfma_f32_16x16x32_bf16 v[100:103], a[236:239], a[40:43], v[100:103]
buffer_load_dwordx4 a[8:11], v1, s[28:31], s48 offen offset:2048 sc1
v_mfma_f32_16x16x32_bf16 v[104:107], a[236:239], a[44:47], v[104:107]
buffer_load_dwordx4 a[12:15], v1, s[28:31], s48 offen offset:3072 sc1
s_waitcnt vmcnt(20)
ds_read_b64_tr_b16 a[224:225], v40
s_waitcnt lgkmcnt(1)
v_mfma_f32_16x16x32_bf16 v[44:47], a[240:243], a[48:51], v[44:47]
ds_read_b64_tr_b16 a[226:227], v40 offset:2048
v_mfma_f32_16x16x32_bf16 v[48:51], a[240:243], a[52:55], v[48:51]
ds_read_b64_tr_b16 a[228:229], v41
v_mfma_f32_16x16x32_bf16 v[52:55], a[240:243], a[56:59], v[52:55]
ds_read_b64_tr_b16 a[230:231], v41 offset:2048
v_mfma_f32_16x16x32_bf16 v[56:59], a[240:243], a[60:63], v[56:59]
ds_read_b64_tr_b16 a[232:233], v42
v_mfma_f32_16x16x32_bf16 v[60:63], a[244:247], a[48:51], v[60:63]
ds_read_b64_tr_b16 a[234:235], v42 offset:2048
v_mfma_f32_16x16x32_bf16 v[64:67], a[244:247], a[52:55], v[64:67]
ds_read_b64_tr_b16 a[236:237], v43
v_mfma_f32_16x16x32_bf16 v[68:71], a[244:247], a[56:59], v[68:71]
ds_read_b64_tr_b16 a[238:239], v43 offset:2048
s_add_u32 m0, s58, 4096
s_add_u32 s48, s94, 372736
v_mfma_f32_16x16x32_bf16 v[72:75], a[244:247], a[60:63], v[72:75]
buffer_load_dwordx4 v3, s[24:27], s48 offen lds
s_add_u32 m0, s58, 5120
v_mfma_f32_16x16x32_bf16 v[76:79], a[248:251], a[48:51], v[76:79]
s_add_u32 s48, s94, 379904
buffer_load_dwordx4 v3, s[24:27], s48 offen lds
v_mfma_f32_16x16x32_bf16 v[80:83], a[248:251], a[52:55], v[80:83]
s_add_u32 m0, s58, 6144
s_add_u32 s48, s94, 387072
v_mfma_f32_16x16x32_bf16 v[84:87], a[248:251], a[56:59], v[84:87]
buffer_load_dwordx4 v3, s[24:27], s48 offen lds
s_add_u32 m0, s58, 7168
s_add_u32 s48, s94, 394240
v_mfma_f32_16x16x32_bf16 v[88:91], a[248:251], a[60:63], v[88:91]
buffer_load_dwordx4 v3, s[24:27], s48 offen lds
s_add_u32 s48, s93, 4939776
v_mfma_f32_16x16x32_bf16 v[92:95], a[252:255], a[48:51], v[92:95]
buffer_load_dwordx4 a[16:19], v1, s[28:31], s48 offen sc1
v_mfma_f32_16x16x32_bf16 v[96:99], a[252:255], a[52:55], v[96:99]
buffer_load_dwordx4 a[20:23], v1, s[28:31], s48 offen offset:1024 sc1
v_mfma_f32_16x16x32_bf16 v[100:103], a[252:255], a[56:59], v[100:103]
buffer_load_dwordx4 a[24:27], v1, s[28:31], s48 offen offset:2048 sc1
v_mfma_f32_16x16x32_bf16 v[104:107], a[252:255], a[60:63], v[104:107]
buffer_load_dwordx4 a[28:31], v1, s[28:31], s48 offen offset:3072 sc1
s_waitcnt vmcnt(20)
ds_read_b64_tr_b16 a[240:241], v40 offset:4096
s_waitcnt lgkmcnt(1)
v_mfma_f32_16x16x32_bf16 v[44:47], a[224:227], a[64:67], v[44:47]
ds_read_b64_tr_b16 a[242:243], v40 offset:6144
v_mfma_f32_16x16x32_bf16 v[48:51], a[224:227], a[68:71], v[48:51]
ds_read_b64_tr_b16 a[244:245], v41 offset:4096
v_mfma_f32_16x16x32_bf16 v[52:55], a[224:227], a[72:75], v[52:55]
ds_read_b64_tr_b16 a[246:247], v41 offset:6144
v_mfma_f32_16x16x32_bf16 v[56:59], a[224:227], a[76:79], v[56:59]
ds_read_b64_tr_b16 a[248:249], v42 offset:4096
v_mfma_f32_16x16x32_bf16 v[60:63], a[228:231], a[64:67], v[60:63]
ds_read_b64_tr_b16 a[250:251], v42 offset:6144
v_mfma_f32_16x16x32_bf16 v[64:67], a[228:231], a[68:71], v[64:67]
ds_read_b64_tr_b16 a[252:253], v43 offset:4096
v_mfma_f32_16x16x32_bf16 v[68:71], a[228:231], a[72:75], v[68:71]
ds_read_b64_tr_b16 a[254:255], v43 offset:6144
s_add_u32 m0, s66, 0
s_add_u32 s48, s94, 573440
v_mfma_f32_16x16x32_bf16 v[72:75], a[228:231], a[76:79], v[72:75]
buffer_load_dwordx4 v3, s[24:27], s48 offen lds
s_add_u32 m0, s66, 1024
v_mfma_f32_16x16x32_bf16 v[76:79], a[232:235], a[64:67], v[76:79]
s_add_u32 s48, s94, 580608
buffer_load_dwordx4 v3, s[24:27], s48 offen lds
v_mfma_f32_16x16x32_bf16 v[80:83], a[232:235], a[68:71], v[80:83]
s_add_u32 m0, s66, 2048
s_add_u32 s48, s94, 587776
v_mfma_f32_16x16x32_bf16 v[84:87], a[232:235], a[72:75], v[84:87]
buffer_load_dwordx4 v3, s[24:27], s48 offen lds
s_add_u32 m0, s66, 3072
s_add_u32 s48, s94, 594944
v_mfma_f32_16x16x32_bf16 v[88:91], a[232:235], a[76:79], v[88:91]
buffer_load_dwordx4 v3, s[24:27], s48 offen lds
s_add_u32 s48, s93, 5013504
v_mfma_f32_16x16x32_bf16 v[92:95], a[236:239], a[64:67], v[92:95]
buffer_load_dwordx4 a[32:35], v1, s[28:31], s48 offen sc1
v_mfma_f32_16x16x32_bf16 v[96:99], a[236:239], a[68:71], v[96:99]
buffer_load_dwordx4 a[36:39], v1, s[28:31], s48 offen offset:1024 sc1
v_mfma_f32_16x16x32_bf16 v[100:103], a[236:239], a[72:75], v[100:103]
buffer_load_dwordx4 a[40:43], v1, s[28:31], s48 offen offset:2048 sc1
v_mfma_f32_16x16x32_bf16 v[104:107], a[236:239], a[76:79], v[104:107]
buffer_load_dwordx4 a[44:47], v1, s[28:31], s48 offen offset:3072 sc1
s_waitcnt vmcnt(20)
ds_read_b64_tr_b16 a[224:225], v28
s_waitcnt lgkmcnt(1)
v_mfma_f32_16x16x32_bf16 v[44:47], a[240:243], a[80:83], v[44:47]
ds_read_b64_tr_b16 a[226:227], v28 offset:2048
v_mfma_f32_16x16x32_bf16 v[48:51], a[240:243], a[84:87], v[48:51]
ds_read_b64_tr_b16 a[228:229], v29
v_mfma_f32_16x16x32_bf16 v[52:55], a[240:243], a[88:91], v[52:55]
ds_read_b64_tr_b16 a[230:231], v29 offset:2048
v_mfma_f32_16x16x32_bf16 v[56:59], a[240:243], a[92:95], v[56:59]
ds_read_b64_tr_b16 a[232:233], v30
v_mfma_f32_16x16x32_bf16 v[60:63], a[244:247], a[80:83], v[60:63]
ds_read_b64_tr_b16 a[234:235], v30 offset:2048
v_mfma_f32_16x16x32_bf16 v[64:67], a[244:247], a[84:87], v[64:67]
ds_read_b64_tr_b16 a[236:237], v31
v_mfma_f32_16x16x32_bf16 v[68:71], a[244:247], a[88:91], v[68:71]
ds_read_b64_tr_b16 a[238:239], v31 offset:2048
s_add_u32 m0, s66, 4096
s_add_u32 s48, s94, 602112
v_mfma_f32_16x16x32_bf16 v[72:75], a[244:247], a[92:95], v[72:75]
buffer_load_dwordx4 v3, s[24:27], s48 offen lds
s_add_u32 m0, s66, 5120
v_mfma_f32_16x16x32_bf16 v[76:79], a[248:251], a[80:83], v[76:79]
s_add_u32 s48, s94, 609280
buffer_load_dwordx4 v3, s[24:27], s48 offen lds
v_mfma_f32_16x16x32_bf16 v[80:83], a[248:251], a[84:87], v[80:83]
s_add_u32 m0, s66, 6144
s_add_u32 s48, s94, 616448
v_mfma_f32_16x16x32_bf16 v[84:87], a[248:251], a[88:91], v[84:87]
buffer_load_dwordx4 v3, s[24:27], s48 offen lds
s_add_u32 m0, s66, 7168
s_add_u32 s48, s94, 623616
v_mfma_f32_16x16x32_bf16 v[88:91], a[248:251], a[92:95], v[88:91]
buffer_load_dwordx4 v3, s[24:27], s48 offen lds
s_add_u32 s48, s93, 5087232
v_mfma_f32_16x16x32_bf16 v[92:95], a[252:255], a[80:83], v[92:95]
buffer_load_dwordx4 a[48:51], v1, s[28:31], s48 offen sc1
v_mfma_f32_16x16x32_bf16 v[96:99], a[252:255], a[84:87], v[96:99]
buffer_load_dwordx4 a[52:55], v1, s[28:31], s48 offen offset:1024 sc1
v_mfma_f32_16x16x32_bf16 v[100:103], a[252:255], a[88:91], v[100:103]
buffer_load_dwordx4 a[56:59], v1, s[28:31], s48 offen offset:2048 sc1
v_mfma_f32_16x16x32_bf16 v[104:107], a[252:255], a[92:95], v[104:107]
buffer_load_dwordx4 a[60:63], v1, s[28:31], s48 offen offset:3072 sc1
s_waitcnt vmcnt(20)
ds_read_b64_tr_b16 a[240:241], v28 offset:4096
s_waitcnt lgkmcnt(1)
v_mfma_f32_16x16x32_bf16 v[44:47], a[224:227], a[0:3], v[44:47]
ds_read_b64_tr_b16 a[242:243], v28 offset:6144
v_mfma_f32_16x16x32_bf16 v[48:51], a[224:227], a[4:7], v[48:51]
ds_read_b64_tr_b16 a[244:245], v29 offset:4096
v_mfma_f32_16x16x32_bf16 v[52:55], a[224:227], a[8:11], v[52:55]
ds_read_b64_tr_b16 a[246:247], v29 offset:6144
v_mfma_f32_16x16x32_bf16 v[56:59], a[224:227], a[12:15], v[56:59]
ds_read_b64_tr_b16 a[248:249], v30 offset:4096
v_mfma_f32_16x16x32_bf16 v[60:63], a[228:231], a[0:3], v[60:63]
ds_read_b64_tr_b16 a[250:251], v30 offset:6144
v_mfma_f32_16x16x32_bf16 v[64:67], a[228:231], a[4:7], v[64:67]
ds_read_b64_tr_b16 a[252:253], v31 offset:4096
v_mfma_f32_16x16x32_bf16 v[68:71], a[228:231], a[8:11], v[68:71]
ds_read_b64_tr_b16 a[254:255], v31 offset:6144
s_add_u32 m0, s58, 0
s_add_u32 s48, s94, 802816
v_mfma_f32_16x16x32_bf16 v[72:75], a[228:231], a[12:15], v[72:75]
buffer_load_dwordx4 v3, s[24:27], s48 offen lds
s_add_u32 m0, s58, 1024
v_mfma_f32_16x16x32_bf16 v[76:79], a[232:235], a[0:3], v[76:79]
s_add_u32 s48, s94, 809984
buffer_load_dwordx4 v3, s[24:27], s48 offen lds
v_mfma_f32_16x16x32_bf16 v[80:83], a[232:235], a[4:7], v[80:83]
s_add_u32 m0, s58, 2048
s_add_u32 s48, s94, 817152
v_mfma_f32_16x16x32_bf16 v[84:87], a[232:235], a[8:11], v[84:87]
buffer_load_dwordx4 v3, s[24:27], s48 offen lds
s_add_u32 m0, s58, 3072
s_add_u32 s48, s94, 824320
v_mfma_f32_16x16x32_bf16 v[88:91], a[232:235], a[12:15], v[88:91]
buffer_load_dwordx4 v3, s[24:27], s48 offen lds
s_add_u32 s48, s93, 5160960
v_mfma_f32_16x16x32_bf16 v[92:95], a[236:239], a[0:3], v[92:95]
buffer_load_dwordx4 a[64:67], v1, s[28:31], s48 offen sc1
v_mfma_f32_16x16x32_bf16 v[96:99], a[236:239], a[4:7], v[96:99]
buffer_load_dwordx4 a[68:71], v1, s[28:31], s48 offen offset:1024 sc1
v_mfma_f32_16x16x32_bf16 v[100:103], a[236:239], a[8:11], v[100:103]
buffer_load_dwordx4 a[72:75], v1, s[28:31], s48 offen offset:2048 sc1
v_mfma_f32_16x16x32_bf16 v[104:107], a[236:239], a[12:15], v[104:107]
buffer_load_dwordx4 a[76:79], v1, s[28:31], s48 offen offset:3072 sc1
s_waitcnt vmcnt(20)
ds_read_b64_tr_b16 a[224:225], v40
s_waitcnt lgkmcnt(1)
v_mfma_f32_16x16x32_bf16 v[44:47], a[240:243], a[16:19], v[44:47]
ds_read_b64_tr_b16 a[226:227], v40 offset:2048
v_mfma_f32_16x16x32_bf16 v[48:51], a[240:243], a[20:23], v[48:51]
ds_read_b64_tr_b16 a[228:229], v41
v_mfma_f32_16x16x32_bf16 v[52:55], a[240:243], a[24:27], v[52:55]
ds_read_b64_tr_b16 a[230:231], v41 offset:2048
v_mfma_f32_16x16x32_bf16 v[56:59], a[240:243], a[28:31], v[56:59]
ds_read_b64_tr_b16 a[232:233], v42
v_mfma_f32_16x16x32_bf16 v[60:63], a[244:247], a[16:19], v[60:63]
ds_read_b64_tr_b16 a[234:235], v42 offset:2048
v_mfma_f32_16x16x32_bf16 v[64:67], a[244:247], a[20:23], v[64:67]
ds_read_b64_tr_b16 a[236:237], v43
v_mfma_f32_16x16x32_bf16 v[68:71], a[244:247], a[24:27], v[68:71]
ds_read_b64_tr_b16 a[238:239], v43 offset:2048
s_add_u32 m0, s58, 4096
s_add_u32 s48, s94, 831488
v_mfma_f32_16x16x32_bf16 v[72:75], a[244:247], a[28:31], v[72:75]
buffer_load_dwordx4 v3, s[24:27], s48 offen lds
s_add_u32 m0, s58, 5120
v_mfma_f32_16x16x32_bf16 v[76:79], a[248:251], a[16:19], v[76:79]
s_add_u32 s48, s94, 838656
buffer_load_dwordx4 v3, s[24:27], s48 offen lds
v_mfma_f32_16x16x32_bf16 v[80:83], a[248:251], a[20:23], v[80:83]
s_add_u32 m0, s58, 6144
s_add_u32 s48, s94, 845824
v_mfma_f32_16x16x32_bf16 v[84:87], a[248:251], a[24:27], v[84:87]
buffer_load_dwordx4 v3, s[24:27], s48 offen lds
s_add_u32 m0, s58, 7168
s_add_u32 s48, s94, 852992
v_mfma_f32_16x16x32_bf16 v[88:91], a[248:251], a[28:31], v[88:91]
buffer_load_dwordx4 v3, s[24:27], s48 offen lds
s_add_u32 s48, s93, 5234688
v_mfma_f32_16x16x32_bf16 v[92:95], a[252:255], a[16:19], v[92:95]
buffer_load_dwordx4 a[80:83], v1, s[28:31], s48 offen sc1
v_mfma_f32_16x16x32_bf16 v[96:99], a[252:255], a[20:23], v[96:99]
buffer_load_dwordx4 a[84:87], v1, s[28:31], s48 offen offset:1024 sc1
v_mfma_f32_16x16x32_bf16 v[100:103], a[252:255], a[24:27], v[100:103]
buffer_load_dwordx4 a[88:91], v1, s[28:31], s48 offen offset:2048 sc1
v_mfma_f32_16x16x32_bf16 v[104:107], a[252:255], a[28:31], v[104:107]
buffer_load_dwordx4 a[92:95], v1, s[28:31], s48 offen offset:3072 sc1
s_waitcnt vmcnt(20)
ds_read_b64_tr_b16 a[240:241], v40 offset:4096
s_waitcnt lgkmcnt(1)
v_mfma_f32_16x16x32_bf16 v[44:47], a[224:227], a[32:35], v[44:47]
ds_read_b64_tr_b16 a[242:243], v40 offset:6144
v_mfma_f32_16x16x32_bf16 v[48:51], a[224:227], a[36:39], v[48:51]
v_mfma_f32_16x16x32_bf16 v[52:55], a[224:227], a[40:43], v[52:55]
ds_read_b64_tr_b16 a[244:245], v41 offset:4096
v_mfma_f32_16x16x32_bf16 v[56:59], a[224:227], a[44:47], v[56:59]
ds_read_b64_tr_b16 a[246:247], v41 offset:6144
v_mfma_f32_16x16x32_bf16 v[60:63], a[228:231], a[32:35], v[60:63]
ds_read_b64_tr_b16 a[248:249], v42 offset:4096
v_mfma_f32_16x16x32_bf16 v[64:67], a[228:231], a[36:39], v[64:67]
ds_read_b64_tr_b16 a[250:251], v42 offset:6144
v_mfma_f32_16x16x32_bf16 v[68:71], a[228:231], a[40:43], v[68:71]
ds_read_b64_tr_b16 a[252:253], v43 offset:4096
v_mfma_f32_16x16x32_bf16 v[72:75], a[228:231], a[44:47], v[72:75]
ds_read_b64_tr_b16 a[254:255], v43 offset:6144
v_mfma_f32_16x16x32_bf16 v[76:79], a[232:235], a[32:35], v[76:79]
s_add_u32 m0, s66, 0
s_add_u32 s48, s94, 172032
v_mfma_f32_16x16x32_bf16 v[80:83], a[232:235], a[36:39], v[80:83]
buffer_load_dwordx4 v3, s[24:27], s48 offen lds
s_add_u32 m0, s66, 1024
s_add_u32 s48, s94, 179200
v_mfma_f32_16x16x32_bf16 v[84:87], a[232:235], a[40:43], v[84:87]
v_mfma_f32_16x16x32_bf16 v[88:91], a[232:235], a[44:47], v[88:91]
buffer_load_dwordx4 v3, s[24:27], s48 offen lds
s_add_u32 m0, s66, 2048
s_add_u32 s48, s94, 186368
v_mfma_f32_16x16x32_bf16 v[92:95], a[236:239], a[32:35], v[92:95]
buffer_load_dwordx4 v3, s[24:27], s48 offen lds
v_mfma_f32_16x16x32_bf16 v[96:99], a[236:239], a[36:39], v[96:99]
s_add_u32 m0, s66, 3072
s_add_u32 s48, s94, 193536
v_mfma_f32_16x16x32_bf16 v[100:103], a[236:239], a[40:43], v[100:103]
buffer_load_dwordx4 v3, s[24:27], s48 offen lds
v_mfma_f32_16x16x32_bf16 v[104:107], a[236:239], a[44:47], v[104:107]
v_add_u32 v9, 128, v9
s_mov_b32 s95, 0
s_mov_b64 exec, -1
L_pollb:
buffer_load_dword v10, v9, s[28:31], 0 offen sc1
s_waitcnt vmcnt(0)
v_cmp_ne_u32 vcc, s67, v10
s_add_u32 s95, s95, 1
s_cmp_gt_u32 s95, 100000
s_cbranch_scc1 L_pollendb
s_cbranch_vccz L_pollendb
s_sleep 2
s_branch L_pollb
L_pollendb:
s_mov_b64 exec, -1
s_add_u32 s48, s93, 7077888
buffer_load_dwordx4 a[0:3], v1, s[28:31], s48 offen sc1
buffer_load_dwordx4 a[4:7], v1, s[28:31], s48 offen offset:1024 sc1
buffer_load_dwordx4 a[8:11], v1, s[28:31], s48 offen offset:2048 sc1
buffer_load_dwordx4 a[12:15], v1, s[28:31], s48 offen offset:3072 sc1
s_waitcnt vmcnt(20)
ds_read_b64_tr_b16 a[224:225], v28
s_waitcnt lgkmcnt(1)
v_mfma_f32_16x16x32_bf16 v[44:47], a[240:243], a[48:51], v[44:47]
ds_read_b64_tr_b16 a[226:227], v28 offset:2048
v_mfma_f32_16x16x32_bf16 v[48:51], a[240:243], a[52:55], v[48:51]
ds_read_b64_tr_b16 a[228:229], v29
v_mfma_f32_16x16x32_bf16 v[52:55], a[240:243], a[56:59], v[52:55]
ds_read_b64_tr_b16 a[230:231], v29 offset:2048
v_mfma_f32_16x16x32_bf16 v[56:59], a[240:243], a[60:63], v[56:59]
ds_read_b64_tr_b16 a[232:233], v30
v_mfma_f32_16x16x32_bf16 v[60:63], a[244:247], a[48:51], v[60:63]
ds_read_b64_tr_b16 a[234:235], v30 offset:2048
v_mfma_f32_16x16x32_bf16 v[64:67], a[244:247], a[52:55], v[64:67]
ds_read_b64_tr_b16 a[236:237], v31
v_mfma_f32_16x16x32_bf16 v[68:71], a[244:247], a[56:59], v[68:71]
ds_read_b64_tr_b16 a[238:239], v31 offset:2048
s_add_u32 m0, s66, 4096
s_add_u32 s48, s94, 200704
v_mfma_f32_16x16x32_bf16 v[72:75], a[244:247], a[60:63], v[72:75]
buffer_load_dwordx4 v3, s[24:27], s48 offen lds
s_add_u32 m0, s66, 5120
v_mfma_f32_16x16x32_bf16 v[76:79], a[248:251], a[48:51], v[76:79]
s_add_u32 s48, s94, 207872
buffer_load_dwordx4 v3, s[24:27], s48 offen lds
v_mfma_f32_16x16x32_bf16 v[80:83], a[248:251], a[52:55], v[80:83]
s_add_u32 m0, s66, 6144
s_add_u32 s48, s94, 215040
v_mfma_f32_16x16x32_bf16 v[84:87], a[248:251], a[56:59], v[84:87]
buffer_load_dwordx4 v3, s[24:27], s48 offen lds
s_add_u32 m0, s66, 7168
s_add_u32 s48, s94, 222208
v_mfma_f32_16x16x32_bf16 v[88:91], a[248:251], a[60:63], v[88:91]
buffer_load_dwordx4 v3, s[24:27], s48 offen lds
s_add_u32 s48, s93, 7151616
v_mfma_f32_16x16x32_bf16 v[92:95], a[252:255], a[48:51], v[92:95]
buffer_load_dwordx4 a[16:19], v1, s[28:31], s48 offen sc1
v_mfma_f32_16x16x32_bf16 v[96:99], a[252:255], a[52:55], v[96:99]
buffer_load_dwordx4 a[20:23], v1, s[28:31], s48 offen offset:1024 sc1
v_mfma_f32_16x16x32_bf16 v[100:103], a[252:255], a[56:59], v[100:103]
buffer_load_dwordx4 a[24:27], v1, s[28:31], s48 offen offset:2048 sc1
v_mfma_f32_16x16x32_bf16 v[104:107], a[252:255], a[60:63], v[104:107]
buffer_load_dwordx4 a[28:31], v1, s[28:31], s48 offen offset:3072 sc1
s_waitcnt vmcnt(20)
ds_read_b64_tr_b16 a[240:241], v28 offset:4096
s_waitcnt lgkmcnt(1)
v_mfma_f32_16x16x32_bf16 v[44:47], a[224:227], a[64:67], v[44:47]
ds_read_b64_tr_b16 a[242:243], v28 offset:6144
v_mfma_f32_16x16x32_bf16 v[48:51], a[224:227], a[68:71], v[48:51]
ds_read_b64_tr_b16 a[244:245], v29 offset:4096
v_mfma_f32_16x16x32_bf16 v[52:55], a[224:227], a[72:75], v[52:55]
ds_read_b64_tr_b16 a[246:247], v29 offset:6144
v_mfma_f32_16x16x32_bf16 v[56:59], a[224:227], a[76:79], v[56:59]
ds_read_b64_tr_b16 a[248:249], v30 offset:4096
v_mfma_f32_16x16x32_bf16 v[60:63], a[228:231], a[64:67], v[60:63]
ds_read_b64_tr_b16 a[250:251], v30 offset:6144
v_mfma_f32_16x16x32_bf16 v[64:67], a[228:231], a[68:71], v[64:67]
ds_read_b64_tr_b16 a[252:253], v31 offset:4096
v_mfma_f32_16x16x32_bf16 v[68:71], a[228:231], a[72:75], v[68:71]
ds_read_b64_tr_b16 a[254:255], v31 offset:6144
s_add_u32 m0, s58, 0
s_add_u32 s48, s94, 401408
v_mfma_f32_16x16x32_bf16 v[72:75], a[228:231], a[76:79], v[72:75]
buffer_load_dwordx4 v3, s[24:27], s48 offen lds
s_add_u32 m0, s58, 1024
v_mfma_f32_16x16x32_bf16 v[76:79], a[232:235], a[64:67], v[76:79]
s_add_u32 s48, s94, 408576
buffer_load_dwordx4 v3, s[24:27], s48 offen lds
v_mfma_f32_16x16x32_bf16 v[80:83], a[232:235], a[68:71], v[80:83]
s_add_u32 m0, s58, 2048
s_add_u32 s48, s94, 415744
v_mfma_f32_16x16x32_bf16 v[84:87], a[232:235], a[72:75], v[84:87]
buffer_load_dwordx4 v3, s[24:27], s48 offen lds
s_add_u32 m0, s58, 3072
s_add_u32 s48, s94, 422912
v_mfma_f32_16x16x32_bf16 v[88:91], a[232:235], a[76:79], v[88:91]
buffer_load_dwordx4 v3, s[24:27], s48 offen lds
s_add_u32 s48, s93, 7225344
v_mfma_f32_16x16x32_bf16 v[92:95], a[236:239], a[64:67], v[92:95]
buffer_load_dwordx4 a[32:35], v1, s[28:31], s48 offen sc1
v_mfma_f32_16x16x32_bf16 v[96:99], a[236:239], a[68:71], v[96:99]
buffer_load_dwordx4 a[36:39], v1, s[28:31], s48 offen offset:1024 sc1
v_mfma_f32_16x16x32_bf16 v[100:103], a[236:239], a[72:75], v[100:103]
buffer_load_dwordx4 a[40:43], v1, s[28:31], s48 offen offset:2048 sc1
v_mfma_f32_16x16x32_bf16 v[104:107], a[236:239], a[76:79], v[104:107]
buffer_load_dwordx4 a[44:47], v1, s[28:31], s48 offen offset:3072 sc1
s_waitcnt vmcnt(20)
ds_read_b64_tr_b16 a[224:225], v40
s_waitcnt lgkmcnt(1)
v_mfma_f32_16x16x32_bf16 v[44:47], a[240:243], a[80:83], v[44:47]
ds_read_b64_tr_b16 a[226:227], v40 offset:2048
v_mfma_f32_16x16x32_bf16 v[48:51], a[240:243], a[84:87], v[48:51]
ds_read_b64_tr_b16 a[228:229], v41
v_mfma_f32_16x16x32_bf16 v[52:55], a[240:243], a[88:91], v[52:55]
ds_read_b64_tr_b16 a[230:231], v41 offset:2048
v_mfma_f32_16x16x32_bf16 v[56:59], a[240:243], a[92:95], v[56:59]
ds_read_b64_tr_b16 a[232:233], v42
v_mfma_f32_16x16x32_bf16 v[60:63], a[244:247], a[80:83], v[60:63]
ds_read_b64_tr_b16 a[234:235], v42 offset:2048
v_mfma_f32_16x16x32_bf16 v[64:67], a[244:247], a[84:87], v[64:67]
ds_read_b64_tr_b16 a[236:237], v43
v_mfma_f32_16x16x32_bf16 v[68:71], a[244:247], a[88:91], v[68:71]
ds_read_b64_tr_b16 a[238:239], v43 offset:2048
s_add_u32 m0, s58, 4096
s_add_u32 s48, s94, 430080
v_mfma_f32_16x16x32_bf16 v[72:75], a[244:247], a[92:95], v[72:75]
buffer_load_dwordx4 v3, s[24:27], s48 offen lds
s_add_u32 m0, s58, 5120
v_mfma_f32_16x16x32_bf16 v[76:79], a[248:251], a[80:83], v[76:79]
s_add_u32 s48, s94, 437248
buffer_load_dwordx4 v3, s[24:27], s48 offen lds
v_mfma_f32_16x16x32_bf16 v[80:83], a[248:251], a[84:87], v[80:83]
s_add_u32 m0, s58, 6144
s_add_u32 s48, s94, 444416
v_mfma_f32_16x16x32_bf16 v[84:87], a[248:251], a[88:91], v[84:87]
buffer_load_dwordx4 v3, s[24:27], s48 offen lds
s_add_u32 m0, s58, 7168
s_add_u32 s48, s94, 451584
v_mfma_f32_16x16x32_bf16 v[88:91], a[248:251], a[92:95], v[88:91]
buffer_load_dwordx4 v3, s[24:27], s48 offen lds
s_add_u32 s48, s93, 7299072
v_mfma_f32_16x16x32_bf16 v[92:95], a[252:255], a[80:83], v[92:95]
buffer_load_dwordx4 a[48:51], v1, s[28:31], s48 offen sc1
v_mfma_f32_16x16x32_bf16 v[96:99], a[252:255], a[84:87], v[96:99]
buffer_load_dwordx4 a[52:55], v1, s[28:31], s48 offen offset:1024 sc1
v_mfma_f32_16x16x32_bf16 v[100:103], a[252:255], a[88:91], v[100:103]
buffer_load_dwordx4 a[56:59], v1, s[28:31], s48 offen offset:2048 sc1
v_mfma_f32_16x16x32_bf16 v[104:107], a[252:255], a[92:95], v[104:107]
buffer_load_dwordx4 a[60:63], v1, s[28:31], s48 offen offset:3072 sc1
s_waitcnt vmcnt(20)
ds_read_b64_tr_b16 a[240:241], v40 offset:4096
s_waitcnt lgkmcnt(1)
v_mfma_f32_16x16x32_bf16 v[44:47], a[224:227], a[0:3], v[44:47]
ds_read_b64_tr_b16 a[242:243], v40 offset:6144
v_mfma_f32_16x16x32_bf16 v[48:51], a[224:227], a[4:7], v[48:51]
ds_read_b64_tr_b16 a[244:245], v41 offset:4096
v_mfma_f32_16x16x32_bf16 v[52:55], a[224:227], a[8:11], v[52:55]
ds_read_b64_tr_b16 a[246:247], v41 offset:6144
v_mfma_f32_16x16x32_bf16 v[56:59], a[224:227], a[12:15], v[56:59]
ds_read_b64_tr_b16 a[248:249], v42 offset:4096
v_mfma_f32_16x16x32_bf16 v[60:63], a[228:231], a[0:3], v[60:63]
ds_read_b64_tr_b16 a[250:251], v42 offset:6144
v_mfma_f32_16x16x32_bf16 v[64:67], a[228:231], a[4:7], v[64:67]
ds_read_b64_tr_b16 a[252:253], v43 offset:4096
v_mfma_f32_16x16x32_bf16 v[68:71], a[228:231], a[8:11], v[68:71]
ds_read_b64_tr_b16 a[254:255], v43 offset:6144
s_add_u32 m0, s66, 0
s_add_u32 s48, s94, 630784
v_mfma_f32_16x16x32_bf16 v[72:75], a[228:231], a[12:15], v[72:75]
buffer_load_dwordx4 v3, s[24:27], s48 offen lds
s_add_u32 m0, s66, 1024
v_mfma_f32_16x16x32_bf16 v[76:79], a[232:235], a[0:3], v[76:79]
s_add_u32 s48, s94, 637952
buffer_load_dwordx4 v3, s[24:27], s48 offen lds
v_mfma_f32_16x16x32_bf16 v[80:83], a[232:235], a[4:7], v[80:83]
s_add_u32 m0, s66, 2048
s_add_u32 s48, s94, 645120
v_mfma_f32_16x16x32_bf16 v[84:87], a[232:235], a[8:11], v[84:87]
buffer_load_dwordx4 v3, s[24:27], s48 offen lds
s_add_u32 m0, s66, 3072
s_add_u32 s48, s94, 652288
v_mfma_f32_16x16x32_bf16 v[88:91], a[232:235], a[12:15], v[88:91]
buffer_load_dwordx4 v3, s[24:27], s48 offen lds
s_add_u32 s48, s93, 7372800
v_mfma_f32_16x16x32_bf16 v[92:95], a[236:239], a[0:3], v[92:95]
buffer_load_dwordx4 a[64:67], v1, s[28:31], s48 offen sc1
v_mfma_f32_16x16x32_bf16 v[96:99], a[236:239], a[4:7], v[96:99]
buffer_load_dwordx4 a[68:71], v1, s[28:31], s48 offen offset:1024 sc1
v_mfma_f32_16x16x32_bf16 v[100:103], a[236:239], a[8:11], v[100:103]
buffer_load_dwordx4 a[72:75], v1, s[28:31], s48 offen offset:2048 sc1
v_mfma_f32_16x16x32_bf16 v[104:107], a[236:239], a[12:15], v[104:107]
buffer_load_dwordx4 a[76:79], v1, s[28:31], s48 offen offset:3072 sc1
s_waitcnt vmcnt(20)
ds_read_b64_tr_b16 a[224:225], v28
s_waitcnt lgkmcnt(1)
v_mfma_f32_16x16x32_bf16 v[44:47], a[240:243], a[16:19], v[44:47]
ds_read_b64_tr_b16 a[226:227], v28 offset:2048
v_mfma_f32_16x16x32_bf16 v[48:51], a[240:243], a[20:23], v[48:51]
ds_read_b64_tr_b16 a[228:229], v29
v_mfma_f32_16x16x32_bf16 v[52:55], a[240:243], a[24:27], v[52:55]
ds_read_b64_tr_b16 a[230:231], v29 offset:2048
v_mfma_f32_16x16x32_bf16 v[56:59], a[240:243], a[28:31], v[56:59]
ds_read_b64_tr_b16 a[232:233], v30
v_mfma_f32_16x16x32_bf16 v[60:63], a[244:247], a[16:19], v[60:63]
ds_read_b64_tr_b16 a[234:235], v30 offset:2048
v_mfma_f32_16x16x32_bf16 v[64:67], a[244:247], a[20:23], v[64:67]
ds_read_b64_tr_b16 a[236:237], v31
v_mfma_f32_16x16x32_bf16 v[68:71], a[244:247], a[24:27], v[68:71]
ds_read_b64_tr_b16 a[238:239], v31 offset:2048
s_add_u32 m0, s66, 4096
s_add_u32 s48, s94, 659456
v_mfma_f32_16x16x32_bf16 v[72:75], a[244:247], a[28:31], v[72:75]
buffer_load_dwordx4 v3, s[24:27], s48 offen lds
s_add_u32 m0, s66, 5120
v_mfma_f32_16x16x32_bf16 v[76:79], a[248:251], a[16:19], v[76:79]
s_add_u32 s48, s94, 666624
buffer_load_dwordx4 v3, s[24:27], s48 offen lds
v_mfma_f32_16x16x32_bf16 v[80:83], a[248:251], a[20:23], v[80:83]
s_add_u32 m0, s66, 6144
s_add_u32 s48, s94, 673792
v_mfma_f32_16x16x32_bf16 v[84:87], a[248:251], a[24:27], v[84:87]
buffer_load_dwordx4 v3, s[24:27], s48 offen lds
s_add_u32 m0, s66, 7168
s_add_u32 s48, s94, 680960
v_mfma_f32_16x16x32_bf16 v[88:91], a[248:251], a[28:31], v[88:91]
buffer_load_dwordx4 v3, s[24:27], s48 offen lds
s_add_u32 s48, s93, 7446528
v_mfma_f32_16x16x32_bf16 v[92:95], a[252:255], a[16:19], v[92:95]
buffer_load_dwordx4 a[80:83], v1, s[28:31], s48 offen sc1
v_mfma_f32_16x16x32_bf16 v[96:99], a[252:255], a[20:23], v[96:99]
buffer_load_dwordx4 a[84:87], v1, s[28:31], s48 offen offset:1024 sc1
v_mfma_f32_16x16x32_bf16 v[100:103], a[252:255], a[24:27], v[100:103]
buffer_load_dwordx4 a[88:91], v1, s[28:31], s48 offen offset:2048 sc1
v_mfma_f32_16x16x32_bf16 v[104:107], a[252:255], a[28:31], v[104:107]
buffer_load_dwordx4 a[92:95], v1, s[28:31], s48 offen offset:3072 sc1
s_waitcnt vmcnt(20)
ds_read_b64_tr_b16 a[240:241], v28 offset:4096
s_waitcnt lgkmcnt(1)
v_mfma_f32_16x16x32_bf16 v[44:47], a[224:227], a[32:35], v[44:47]
ds_read_b64_tr_b16 a[242:243], v28 offset:6144
v_mfma_f32_16x16x32_bf16 v[48:51], a[224:227], a[36:39], v[48:51]
ds_read_b64_tr_b16 a[244:245], v29 offset:4096
v_mfma_f32_16x16x32_bf16 v[52:55], a[224:227], a[40:43], v[52:55]
ds_read_b64_tr_b16 a[246:247], v29 offset:6144
v_mfma_f32_16x16x32_bf16 v[56:59], a[224:227], a[44:47], v[56:59]
ds_read_b64_tr_b16 a[248:249], v30 offset:4096
v_mfma_f32_16x16x32_bf16 v[60:63], a[228:231], a[32:35], v[60:63]
ds_read_b64_tr_b16 a[250:251], v30 offset:6144
v_mfma_f32_16x16x32_bf16 v[64:67], a[228:231], a[36:39], v[64:67]
ds_read_b64_tr_b16 a[252:253], v31 offset:4096
v_mfma_f32_16x16x32_bf16 v[68:71], a[228:231], a[40:43], v[68:71]
ds_read_b64_tr_b16 a[254:255], v31 offset:6144
s_add_u32 m0, s58, 0
s_add_u32 s48, s94, 860160
v_mfma_f32_16x16x32_bf16 v[72:75], a[228:231], a[44:47], v[72:75]
buffer_load_dwordx4 v3, s[24:27], s48 offen lds
s_add_u32 m0, s58, 1024
v_mfma_f32_16x16x32_bf16 v[76:79], a[232:235], a[32:35], v[76:79]
s_add_u32 s48, s94, 867328
buffer_load_dwordx4 v3, s[24:27], s48 offen lds
v_mfma_f32_16x16x32_bf16 v[80:83], a[232:235], a[36:39], v[80:83]
s_add_u32 m0, s58, 2048
s_add_u32 s48, s94, 874496
v_mfma_f32_16x16x32_bf16 v[84:87], a[232:235], a[40:43], v[84:87]
buffer_load_dwordx4 v3, s[24:27], s48 offen lds
s_add_u32 m0, s58, 3072
s_add_u32 s48, s94, 881664
v_mfma_f32_16x16x32_bf16 v[88:91], a[232:235], a[44:47], v[88:91]
buffer_load_dwordx4 v3, s[24:27], s48 offen lds
s_add_u32 s48, s93, 7520256
v_mfma_f32_16x16x32_bf16 v[92:95], a[236:239], a[32:35], v[92:95]
buffer_load_dwordx4 a[0:3], v1, s[28:31], s48 offen sc1
v_mfma_f32_16x16x32_bf16 v[96:99], a[236:239], a[36:39], v[96:99]
buffer_load_dwordx4 a[4:7], v1, s[28:31], s48 offen offset:1024 sc1
v_mfma_f32_16x16x32_bf16 v[100:103], a[236:239], a[40:43], v[100:103]
buffer_load_dwordx4 a[8:11], v1, s[28:31], s48 offen offset:2048 sc1
v_mfma_f32_16x16x32_bf16 v[104:107], a[236:239], a[44:47], v[104:107]
buffer_load_dwordx4 a[12:15], v1, s[28:31], s48 offen offset:3072 sc1
s_waitcnt vmcnt(20)
ds_read_b64_tr_b16 a[224:225], v40
s_waitcnt lgkmcnt(1)
v_mfma_f32_16x16x32_bf16 v[44:47], a[240:243], a[48:51], v[44:47]
ds_read_b64_tr_b16 a[226:227], v40 offset:2048
v_mfma_f32_16x16x32_bf16 v[48:51], a[240:243], a[52:55], v[48:51]
ds_read_b64_tr_b16 a[228:229], v41
v_mfma_f32_16x16x32_bf16 v[52:55], a[240:243], a[56:59], v[52:55]
ds_read_b64_tr_b16 a[230:231], v41 offset:2048
v_mfma_f32_16x16x32_bf16 v[56:59], a[240:243], a[60:63], v[56:59]
ds_read_b64_tr_b16 a[232:233], v42
v_mfma_f32_16x16x32_bf16 v[60:63], a[244:247], a[48:51], v[60:63]
ds_read_b64_tr_b16 a[234:235], v42 offset:2048
v_mfma_f32_16x16x32_bf16 v[64:67], a[244:247], a[52:55], v[64:67]
ds_read_b64_tr_b16 a[236:237], v43
v_mfma_f32_16x16x32_bf16 v[68:71], a[244:247], a[56:59], v[68:71]
ds_read_b64_tr_b16 a[238:239], v43 offset:2048
s_add_u32 m0, s58, 4096
s_add_u32 s48, s94, 888832
v_mfma_f32_16x16x32_bf16 v[72:75], a[244:247], a[60:63], v[72:75]
buffer_load_dwordx4 v3, s[24:27], s48 offen lds
s_add_u32 m0, s58, 5120
v_mfma_f32_16x16x32_bf16 v[76:79], a[248:251], a[48:51], v[76:79]
s_add_u32 s48, s94, 896000
buffer_load_dwordx4 v3, s[24:27], s48 offen lds
v_mfma_f32_16x16x32_bf16 v[80:83], a[248:251], a[52:55], v[80:83]
s_add_u32 m0, s58, 6144
s_add_u32 s48, s94, 903168
v_mfma_f32_16x16x32_bf16 v[84:87], a[248:251], a[56:59], v[84:87]
buffer_load_dwordx4 v3, s[24:27], s48 offen lds
s_add_u32 m0, s58, 7168
s_add_u32 s48, s94, 910336
v_mfma_f32_16x16x32_bf16 v[88:91], a[248:251], a[60:63], v[88:91]
buffer_load_dwordx4 v3, s[24:27], s48 offen lds
s_add_u32 s48, s93, 7593984
v_mfma_f32_16x16x32_bf16 v[92:95], a[252:255], a[48:51], v[92:95]
buffer_load_dwordx4 a[16:19], v1, s[28:31], s48 offen sc1
v_mfma_f32_16x16x32_bf16 v[96:99], a[252:255], a[52:55], v[96:99]
buffer_load_dwordx4 a[20:23], v1, s[28:31], s48 offen offset:1024 sc1
v_mfma_f32_16x16x32_bf16 v[100:103], a[252:255], a[56:59], v[100:103]
buffer_load_dwordx4 a[24:27], v1, s[28:31], s48 offen offset:2048 sc1
v_mfma_f32_16x16x32_bf16 v[104:107], a[252:255], a[60:63], v[104:107]
buffer_load_dwordx4 a[28:31], v1, s[28:31], s48 offen offset:3072 sc1
s_waitcnt vmcnt(20)
s_waitcnt lgkmcnt(0)
v_mfma_f32_16x16x32_bf16 v[44:47], a[224:227], a[64:67], v[44:47]
ds_read_b64_tr_b16 a[240:241], v40 offset:4096
v_mfma_f32_16x16x32_bf16 v[48:51], a[224:227], a[68:71], v[48:51]
v_mfma_f32_16x16x32_bf16 v[52:55], a[224:227], a[72:75], v[52:55]
ds_read_b64_tr_b16 a[242:243], v40 offset:6144
v_mfma_f32_16x16x32_bf16 v[56:59], a[224:227], a[76:79], v[56:59]
v_mfma_f32_16x16x32_bf16 v[60:63], a[228:231], a[64:67], v[60:63]
ds_read_b64_tr_b16 a[244:245], v41 offset:4096
v_mfma_f32_16x16x32_bf16 v[64:67], a[228:231], a[68:71], v[64:67]
v_mfma_f32_16x16x32_bf16 v[68:71], a[228:231], a[72:75], v[68:71]
ds_read_b64_tr_b16 a[246:247], v41 offset:6144
v_mfma_f32_16x16x32_bf16 v[72:75], a[228:231], a[76:79], v[72:75]
v_mfma_f32_16x16x32_bf16 v[76:79], a[232:235], a[64:67], v[76:79]
ds_read_b64_tr_b16 a[248:249], v42 offset:4096
v_mfma_f32_16x16x32_bf16 v[80:83], a[232:235], a[68:71], v[80:83]
v_mfma_f32_16x16x32_bf16 v[84:87], a[232:235], a[72:75], v[84:87]
v_mfma_f32_16x16x32_bf16 v[88:91], a[232:235], a[76:79], v[88:91]
ds_read_b64_tr_b16 a[250:251], v42 offset:6144
v_mfma_f32_16x16x32_bf16 v[92:95], a[236:239], a[64:67], v[92:95]
v_mfma_f32_16x16x32_bf16 v[96:99], a[236:239], a[68:71], v[96:99]
ds_read_b64_tr_b16 a[252:253], v43 offset:4096
v_mfma_f32_16x16x32_bf16 v[100:103], a[236:239], a[72:75], v[100:103]
v_mfma_f32_16x16x32_bf16 v[104:107], a[236:239], a[76:79], v[104:107]
ds_read_b64_tr_b16 a[254:255], v43 offset:6144
s_waitcnt vmcnt(12)
s_waitcnt lgkmcnt(3)
v_mfma_f32_16x16x32_bf16 v[44:47], a[240:243], a[80:83], v[44:47]
ds_read_b64_tr_b16 a[224:225], v28
v_mfma_f32_16x16x32_bf16 v[48:51], a[240:243], a[84:87], v[48:51]
v_mfma_f32_16x16x32_bf16 v[52:55], a[240:243], a[88:91], v[52:55]
ds_read_b64_tr_b16 a[226:227], v28 offset:2048
v_mfma_f32_16x16x32_bf16 v[56:59], a[240:243], a[92:95], v[56:59]
v_mfma_f32_16x16x32_bf16 v[60:63], a[244:247], a[80:83], v[60:63]
ds_read_b64_tr_b16 a[228:229], v29
v_mfma_f32_16x16x32_bf16 v[64:67], a[244:247], a[84:87], v[64:67]
v_mfma_f32_16x16x32_bf16 v[68:71], a[244:247], a[88:91], v[68:71]
ds_read_b64_tr_b16 a[230:231], v29 offset:2048
v_mfma_f32_16x16x32_bf16 v[72:75], a[244:247], a[92:95], v[72:75]
s_waitcnt lgkmcnt(3)
v_mfma_f32_16x16x32_bf16 v[76:79], a[248:251], a[80:83], v[76:79]
ds_read_b64_tr_b16 a[232:233], v30
v_mfma_f32_16x16x32_bf16 v[80:83], a[248:251], a[84:87], v[80:83]
v_mfma_f32_16x16x32_bf16 v[84:87], a[248:251], a[88:91], v[84:87]
v_mfma_f32_16x16x32_bf16 v[88:91], a[248:251], a[92:95], v[88:91]
ds_read_b64_tr_b16 a[234:235], v30 offset:2048
v_mfma_f32_16x16x32_bf16 v[92:95], a[252:255], a[80:83], v[92:95]
v_mfma_f32_16x16x32_bf16 v[96:99], a[252:255], a[84:87], v[96:99]
ds_read_b64_tr_b16 a[236:237], v31
v_mfma_f32_16x16x32_bf16 v[100:103], a[252:255], a[88:91], v[100:103]
v_mfma_f32_16x16x32_bf16 v[104:107], a[252:255], a[92:95], v[104:107]
ds_read_b64_tr_b16 a[238:239], v31 offset:2048
s_waitcnt vmcnt(4)
s_waitcnt lgkmcnt(3)
v_mfma_f32_16x16x32_bf16 v[44:47], a[224:227], a[0:3], v[44:47]
ds_read_b64_tr_b16 a[240:241], v28 offset:4096
v_mfma_f32_16x16x32_bf16 v[48:51], a[224:227], a[4:7], v[48:51]
ds_read_b64_tr_b16 a[242:243], v28 offset:6144
v_mfma_f32_16x16x32_bf16 v[52:55], a[224:227], a[8:11], v[52:55]
v_mfma_f32_16x16x32_bf16 v[56:59], a[224:227], a[12:15], v[56:59]
ds_read_b64_tr_b16 a[244:245], v29 offset:4096
v_mfma_f32_16x16x32_bf16 v[60:63], a[228:231], a[0:3], v[60:63]
ds_read_b64_tr_b16 a[246:247], v29 offset:6144
v_mfma_f32_16x16x32_bf16 v[64:67], a[228:231], a[4:7], v[64:67]
v_mfma_f32_16x16x32_bf16 v[68:71], a[228:231], a[8:11], v[68:71]
ds_read_b64_tr_b16 a[248:249], v30 offset:4096
v_mfma_f32_16x16x32_bf16 v[72:75], a[228:231], a[12:15], v[72:75]
ds_read_b64_tr_b16 a[250:251], v30 offset:6144
s_waitcnt lgkmcnt(4)
v_mfma_f32_16x16x32_bf16 v[76:79], a[232:235], a[0:3], v[76:79]
v_mfma_f32_16x16x32_bf16 v[80:83], a[232:235], a[4:7], v[80:83]
ds_read_b64_tr_b16 a[252:253], v31 offset:4096
v_mfma_f32_16x16x32_bf16 v[84:87], a[232:235], a[8:11], v[84:87]
ds_read_b64_tr_b16 a[254:255], v31 offset:6144
v_mfma_f32_16x16x32_bf16 v[88:91], a[232:235], a[12:15], v[88:91]
v_mfma_f32_16x16x32_bf16 v[92:95], a[236:239], a[0:3], v[92:95]
v_and_b32 v7, 15, v0
v_mfma_f32_16x16x32_bf16 v[96:99], a[236:239], a[4:7], v[96:99]
v_mul_u32_u24 v7, 272, v7
v_mfma_f32_16x16x32_bf16 v[100:103], a[236:239], a[8:11], v[100:103]
v_mfma_f32_16x16x32_bf16 v[104:107], a[236:239], a[12:15], v[104:107]
v_lshrrev_b32 v8, 4, v0
s_waitcnt vmcnt(3)
v_mfma_f32_16x16x32_bf16 v[44:47], a[240:243], a[16:19], v[44:47]
v_lshl_add_u32 v7, v8, 4, v7
s_waitcnt vmcnt(2)
v_mfma_f32_16x16x32_bf16 v[48:51], a[240:243], a[20:23], v[48:51]
s_mul_i32 s4, s3, 17408
s_waitcnt vmcnt(1)
v_mfma_f32_16x16x32_bf16 v[52:55], a[240:243], a[24:27], v[52:55]
v_add_u32 v7, s4, v7
s_waitcnt vmcnt(0)
v_mfma_f32_16x16x32_bf16 v[56:59], a[240:243], a[28:31], v[56:59]
ds_write_b128 v7, v[44:47]
s_waitcnt lgkmcnt(1)
v_mfma_f32_16x16x32_bf16 v[60:63], a[244:247], a[16:19], v[60:63]
ds_write_b128 v7, v[48:51] offset:4352
v_mfma_f32_16x16x32_bf16 v[64:67], a[244:247], a[20:23], v[64:67]
ds_write_b128 v7, v[52:55] offset:8704
v_mfma_f32_16x16x32_bf16 v[68:71], a[244:247], a[24:27], v[68:71]
ds_write_b128 v7, v[56:59] offset:13056
v_mfma_f32_16x16x32_bf16 v[72:75], a[244:247], a[28:31], v[72:75]
ds_write_b128 v7, v[60:63] offset:64
v_mfma_f32_16x16x32_bf16 v[76:79], a[248:251], a[16:19], v[76:79]
ds_write_b128 v7, v[64:67] offset:4416
v_mfma_f32_16x16x32_bf16 v[80:83], a[248:251], a[20:23], v[80:83]
ds_write_b128 v7, v[68:71] offset:8768
v_mfma_f32_16x16x32_bf16 v[84:87], a[248:251], a[24:27], v[84:87]
ds_write_b128 v7, v[72:75] offset:13120
v_mfma_f32_16x16x32_bf16 v[88:91], a[248:251], a[28:31], v[88:91]
ds_write_b128 v7, v[76:79] offset:128
v_mfma_f32_16x16x32_bf16 v[92:95], a[252:255], a[16:19], v[92:95]
ds_write_b128 v7, v[80:83] offset:4480
v_mfma_f32_16x16x32_bf16 v[96:99], a[252:255], a[20:23], v[96:99]
ds_write_b128 v7, v[84:87] offset:8832
v_mfma_f32_16x16x32_bf16 v[100:103], a[252:255], a[24:27], v[100:103]
ds_write_b128 v7, v[88:91] offset:13184
v_mfma_f32_16x16x32_bf16 v[104:107], a[252:255], a[28:31], v[104:107]
ds_write_b128 v7, v[92:95] offset:192
s_nop 0
ds_write_b128 v7, v[96:99] offset:4544
s_nop 1
ds_write_b128 v7, v[100:103] offset:8896
s_nop 1
ds_write_b128 v7, v[104:107] offset:13248
s_waitcnt lgkmcnt(0)
s_barrier
s_lshl_b32 s4, s3, 4
v_lshrrev_b32 v7, 2, v0
v_add_u32 v7, s4, v7
v_and_b32 v8, 3, v0
v_mul_u32_u24 v10, 272, v7
v_lshl_add_u32 v10, v8, 6, v10
ds_read_b128 v[108:111], v10
ds_read_b128 v[112:115], v10 offset:16
ds_read_b128 v[116:119], v10 offset:32
ds_read_b128 v[120:123], v10 offset:48
ds_read_b128 v[124:127], v10 offset:17408
ds_read_b128 v[128:131], v10 offset:17424
ds_read_b128 v[132:135], v10 offset:17440
ds_read_b128 v[136:139], v10 offset:17456
ds_read_b128 v[140:143], v10 offset:34816
ds_read_b128 v[144:147], v10 offset:34832
ds_read_b128 v[148:151], v10 offset:34848
ds_read_b128 v[152:155], v10 offset:34864
ds_read_b128 v[156:159], v10 offset:52224
ds_read_b128 v[160:163], v10 offset:52240
ds_read_b128 v[164:167], v10 offset:52256
ds_read_b128 v[168:171], v10 offset:52272
s_lshl_b32 s4, s46, 6
v_add_u32 v11, s4, v7
s_movk_i32 s5, 1792
v_mul_lo_u32 v11, v11, s5
v_lshl_add_u32 v11, v8, 5, v11
s_waitcnt lgkmcnt(4)
v_add_f32 v108, v108, v124
s_waitcnt lgkmcnt(3)
v_add_f32 v140, v140, v156
v_add_f32 v109, v109, v125
v_add_f32 v141, v141, v157
v_add_f32 v110, v110, v126
v_add_f32 v142, v142, v158
v_add_f32 v111, v111, v127
v_add_f32 v143, v143, v159
v_add_f32 v112, v112, v128
s_waitcnt lgkmcnt(0)
v_add_f32 v144, v144, v160
v_add_f32 v113, v113, v129
v_add_f32 v145, v145, v161
v_add_f32 v114, v114, v130
v_add_f32 v146, v146, v162
v_add_f32 v115, v115, v131
v_add_f32 v147, v147, v163
v_add_f32 v116, v116, v132
v_add_f32 v148, v148, v164
v_add_f32 v117, v117, v133
v_add_f32 v149, v149, v165
v_add_f32 v118, v118, v134
v_add_f32 v150, v150, v166
v_add_f32 v119, v119, v135
v_add_f32 v151, v151, v167
v_add_f32 v120, v120, v136
v_add_f32 v152, v152, v168
v_add_f32 v121, v121, v137
v_add_f32 v153, v153, v169
v_add_f32 v122, v122, v138
v_add_f32 v154, v154, v170
v_add_f32 v123, v123, v139
v_add_f32 v155, v155, v171
v_add_f32 v108, v108, v140
v_add_f32 v109, v109, v141
v_add_f32 v110, v110, v142
v_add_f32 v111, v111, v143
v_add_f32 v112, v112, v144
v_add_f32 v113, v113, v145
v_add_f32 v114, v114, v146
v_add_f32 v115, v115, v147
v_add_f32 v116, v116, v148
v_add_f32 v117, v117, v149
v_add_f32 v118, v118, v150
v_add_f32 v119, v119, v151
v_add_f32 v120, v120, v152
v_add_f32 v121, v121, v153
v_add_f32 v122, v122, v154
v_add_f32 v123, v123, v155
v_cvt_pk_bf16_f32 v172, v108, v109
v_cvt_pk_bf16_f32 v173, v110, v111
v_cvt_pk_bf16_f32 v174, v112, v113
v_cvt_pk_bf16_f32 v175, v114, v115
v_cvt_pk_bf16_f32 v176, v116, v117
v_cvt_pk_bf16_f32 v177, v118, v119
v_cvt_pk_bf16_f32 v178, v120, v121
v_cvt_pk_bf16_f32 v179, v122, v123
s_mul_i32 s4, s42, 896
s_lshl_b32 s5, s47, 7
s_add_u32 s4, s4, s5
buffer_store_dwordx4 v[172:175], v11, s[32:35], s4 offen
buffer_store_dwordx4 v[176:179], v11, s[32:35], s4 offen offset:16
L_fin:
L_done:
s_endpgm
L_rs0:
s_call_b64 s[40:41], L_rareA1
s_branch L_rr0
L_rs1:
s_call_b64 s[40:41], L_rareB1
s_branch L_rr1
L_rs2:
s_call_b64 s[40:41], L_rareA0
s_branch L_rr2
L_rs3:
s_call_b64 s[40:41], L_rareB0
s_branch L_rr3
L_rs4:
s_call_b64 s[40:41], L_rareA1
s_branch L_rr4
L_rs5:
s_call_b64 s[40:41], L_rareB1
s_branch L_rr5
L_rs6:
s_call_b64 s[40:41], L_rareA0
s_branch L_rr6
L_rs7:
s_call_b64 s[40:41], L_rareB0
s_branch L_rr7
L_rs8:
s_call_b64 s[40:41], L_rareA1
s_branch L_rr8
L_rs9:
s_call_b64 s[40:41], L_rareB1
s_branch L_rr9
L_rs10:
s_call_b64 s[40:41], L_rareN0
s_branch L_rr10
L_rs11:
s_call_b64 s[40:41], L_rareA0
s_branch L_rr11
L_rs12:
s_call_b64 s[40:41], L_rareB0
s_branch L_rr12
L_rs13:
s_call_b64 s[40:41], L_rareA1
s_branch L_rr13
L_rs14:
s_call_b64 s[40:41], L_rareB1
s_branch L_rr14
L_rs15:
s_call_b64 s[40:41], L_rareA0
s_branch L_rr15
L_rs16:
s_call_b64 s[40:41], L_rareB0
s_branch L_rr16
L_rs17:
s_call_b64 s[40:41], L_rareA1
s_branch L_rr17
L_rs18:
s_call_b64 s[40:41], L_rareB1
s_branch L_rr18
L_rs19:
s_call_b64 s[40:41], L_rareN0
s_branch L_rr19
L_rs20:
s_call_b64 s[40:41], L_rareA0
s_branch L_rr20
L_rs21:
s_call_b64 s[40:41], L_rareB0
s_branch L_rr21
L_rs22:
s_call_b64 s[40:41], L_rareA1
s_branch L_rr22
L_rs23:
s_call_b64 s[40:41], L_rareB1
s_branch L_rr23
L_rs24:
s_call_b64 s[40:41], L_rareA0
s_branch L_rr24
L_rs25:
s_call_b64 s[40:41], L_rareB0
s_branch L_rr25
L_rs26:
s_call_b64 s[40:41], L_rareA1
s_branch L_rr26
L_rs27:
s_call_b64 s[40:41], L_rareB1
s_branch L_rr27
L_rs28:
s_call_b64 s[40:41], L_rareN0
s_branch L_rr28
L_rs29:
s_call_b64 s[40:41], L_rareA0
s_branch L_rr29
L_rs30:
s_call_b64 s[40:41], L_rareB0
s_branch L_rr30
L_rs31:
s_call_b64 s[40:41], L_rareA1
s_branch L_rr31
L_rs32:
s_call_b64 s[40:41], L_rareB1
s_branch L_rr32
L_rs33:
s_call_b64 s[40:41], L_rareA0
s_branch L_rr33
L_rs34:
s_call_b64 s[40:41], L_rareB0
s_branch L_rr34
L_rs35:
s_call_b64 s[40:41], L_rareA1
s_branch L_rr35
L_rs36:
s_call_b64 s[40:41], L_rareB1
s_branch L_rr36
L_rs37:
s_call_b64 s[40:41], L_rareN0
s_branch L_rr37
L_rs38:
s_call_b64 s[40:41], L_rareA0
s_branch L_rr38
L_rs39:
s_call_b64 s[40:41], L_rareB0
s_branch L_rr39
L_rs40:
s_call_b64 s[40:41], L_rareA1
s_branch L_rr40
L_rs41:
s_call_b64 s[40:41], L_rareB1
s_branch L_rr41
L_rs42:
s_call_b64 s[40:41], L_rareA0
s_branch L_rr42
L_rs43:
s_call_b64 s[40:41], L_rareB0
s_branch L_rr43
L_rs44:
s_call_b64 s[40:41], L_rareA1
s_branch L_rr44
L_rs45:
s_call_b64 s[40:41], L_rareB1
s_branch L_rr45
L_rs46:
s_call_b64 s[40:41], L_rareN0
s_branch L_rr46
L_rs47:
s_call_b64 s[40:41], L_rareA0
s_branch L_rr47
L_rs48:
s_call_b64 s[40:41], L_rareB0
s_branch L_rr48
L_rs49:
s_call_b64 s[40:41], L_rareA1
s_branch L_rr49
L_rs50:
s_call_b64 s[40:41], L_rareB1
s_branch L_rr50
L_rs51:
s_call_b64 s[40:41], L_rareA0
s_branch L_rr51
L_rs52:
s_call_b64 s[40:41], L_rareB0
s_branch L_rr52
L_rs53:
s_call_b64 s[40:41], L_rareA1
s_branch L_rr53
L_rs54:
s_call_b64 s[40:41], L_rareB1
s_branch L_rr54
L_rs55:
s_call_b64 s[40:41], L_rareN0
s_branch L_rr55
L_rs56:
s_call_b64 s[40:41], L_rareA0
s_branch L_rr56
L_rs57:
s_call_b64 s[40:41], L_rareB0
s_branch L_rr57
L_rs58:
s_call_b64 s[40:41], L_rareA1
s_branch L_rr58
L_rs59:
s_call_b64 s[40:41], L_rareB1
s_branch L_rr59
L_rs60:
s_call_b64 s[40:41], L_rareA0
s_branch L_rr60
L_rs61:
s_call_b64 s[40:41], L_rareB0
s_branch L_rr61
L_rs62:
s_call_b64 s[40:41], L_rareA1
s_branch L_rr62
L_rs63:
s_call_b64 s[40:41], L_rareB1
s_branch L_rr63
L_rs64:
s_call_b64 s[40:41], L_rareN0
s_branch L_rr64
L_rs65:
s_call_b64 s[40:41], L_rareA0
s_branch L_rr65
L_rs66:
s_call_b64 s[40:41], L_rareB0
s_branch L_rr66
L_rs67:
s_call_b64 s[40:41], L_rareA1
s_branch L_rr67
L_rs68:
s_call_b64 s[40:41], L_rareB1
s_branch L_rr68
L_rs69:
s_call_b64 s[40:41], L_rareA0
s_branch L_rr69
L_rs70:
s_call_b64 s[40:41], L_rareB0
s_branch L_rr70
L_rs71:
s_call_b64 s[40:41], L_rareA1
s_branch L_rr71
L_rs72:
s_call_b64 s[40:41], L_rareB1
s_branch L_rr72
L_rs73:
s_call_b64 s[40:41], L_rareN0
s_branch L_rr73
L_rs74:
s_call_b64 s[40:41], L_rareA0
s_branch L_rr74
L_rs75:
s_call_b64 s[40:41], L_rareB0
s_branch L_rr75
L_rs76:
s_call_b64 s[40:41], L_rareA1
s_branch L_rr76
L_rs77:
s_call_b64 s[40:41], L_rareB1
s_branch L_rr77
L_rs78:
s_call_b64 s[40:41], L_rareA0
s_branch L_rr78
L_rs79:
s_call_b64 s[40:41], L_rareB0
s_branch L_rr79
L_rs80:
s_call_b64 s[40:41], L_rareA1
s_branch L_rr80
L_rs81:
s_call_b64 s[40:41], L_rareB1
s_branch L_rr81
L_rs82:
s_call_b64 s[40:41], L_rareN0
s_branch L_rr82
L_rs83:
s_call_b64 s[40:41], L_rareA0
s_branch L_rr83
L_rs84:
s_call_b64 s[40:41], L_rareB0
s_branch L_rr84
L_rs85:
s_call_b64 s[40:41], L_rareA1
s_branch L_rr85
L_rs86:
s_call_b64 s[40:41], L_rareB1
s_branch L_rr86
L_rs87:
s_call_b64 s[40:41], L_rareA0
s_branch L_rr87
L_rs88:
s_call_b64 s[40:41], L_rareB0
s_branch L_rr88
L_rs89:
s_call_b64 s[40:41], L_rareA1
s_branch L_rr89
L_rs90:
s_call_b64 s[40:41], L_rareB1
s_branch L_rr90
L_rs91:
s_call_b64 s[40:41], L_rareN0
s_branch L_rr91
L_rs92:
s_call_b64 s[40:41], L_rareA0
s_branch L_rr92
L_rs93:
s_call_b64 s[40:41], L_rareB0
s_branch L_rr93
L_rs94:
s_call_b64 s[40:41], L_rareA1
s_branch L_rr94
L_rs95:
s_call_b64 s[40:41], L_rareB1
s_branch L_rr95
L_rs96:
s_call_b64 s[40:41], L_rareA0
s_branch L_rr96
L_rs97:
s_call_b64 s[40:41], L_rareB0
s_branch L_rr97
L_rs98:
s_call_b64 s[40:41], L_rareA1
s_branch L_rr98
L_rs99:
s_call_b64 s[40:41], L_rareB1
s_branch L_rr99
L_rs100:
s_call_b64 s[40:41], L_rareN0
s_branch L_rr100
L_rs101:
s_call_b64 s[40:41], L_rareA0
s_branch L_rr101
L_rs102:
s_call_b64 s[40:41], L_rareB0
s_branch L_rr102
L_rs103:
s_call_b64 s[40:41], L_rareA1
s_branch L_rr103
L_rs104:
s_call_b64 s[40:41], L_rareB1
s_branch L_rr104
L_rs105:
s_call_b64 s[40:41], L_rareA0
s_branch L_rr105
L_rs106:
s_call_b64 s[40:41], L_rareB0
s_branch L_rr106
L_rs107:
s_call_b64 s[40:41], L_rareA1
s_branch L_rr107
L_rs108:
s_call_b64 s[40:41], L_rareB1
s_branch L_rr108
L_rs109:
s_call_b64 s[40:41], L_rareN0
s_branch L_rr109
L_rs110:
s_call_b64 s[40:41], L_rareA0
s_branch L_rr110
L_rs111:
s_call_b64 s[40:41], L_rareB0
s_branch L_rr111
L_rs112:
s_call_b64 s[40:41], L_rareA1
s_branch L_rr112
L_rs113:
s_call_b64 s[40:41], L_rareB1
s_branch L_rr113
L_rs114:
s_call_b64 s[40:41], L_rareA0
s_branch L_rr114
L_rs115:
s_call_b64 s[40:41], L_rareB0
s_branch L_rr115
L_rs116:
s_call_b64 s[40:41], L_rareA1
s_branch L_rr116
L_rs117:
s_call_b64 s[40:41], L_rareB1
s_branch L_rr117
L_rs118:
s_call_b64 s[40:41], L_rareN0
s_branch L_rr118
L_rs119:
s_call_b64 s[40:41], L_rareA0
s_branch L_rr119
L_rs120:
s_call_b64 s[40:41], L_rareB0
s_branch L_rr120
L_rs121:
s_call_b64 s[40:41], L_rareA1
s_branch L_rr121
L_rs122:
s_call_b64 s[40:41], L_rareB1
s_branch L_rr122
L_rs123:
s_call_b64 s[40:41], L_rareA0
s_branch L_rr123
L_rs124:
s_call_b64 s[40:41], L_rareB0
s_branch L_rr124
L_rs125:
s_call_b64 s[40:41], L_rareA1
s_branch L_rr125
L_rs126:
s_call_b64 s[40:41], L_rareB1
s_branch L_rr126
L_rs127:
s_call_b64 s[40:41], L_rareN0
s_branch L_rr127
L_rs128:
s_call_b64 s[40:41], L_rareA0
s_branch L_rr128
L_rs129:
s_call_b64 s[40:41], L_rareB0
s_branch L_rr129
L_rs130:
s_call_b64 s[40:41], L_rareA1
s_branch L_rr130
L_rs131:
s_call_b64 s[40:41], L_rareB1
s_branch L_rr131
L_rs132:
s_call_b64 s[40:41], L_rareA0
s_branch L_rr132
L_rs133:
s_call_b64 s[40:41], L_rareB0
s_branch L_rr133
L_rs134:
s_call_b64 s[40:41], L_rareA1
s_branch L_rr134
L_rs135:
s_call_b64 s[40:41], L_rareB1
s_branch L_rr135
L_rs136:
s_call_b64 s[40:41], L_rareN0
s_branch L_rr136
L_rs137:
s_call_b64 s[40:41], L_rareA0
s_branch L_rr137
L_rs138:
s_call_b64 s[40:41], L_rareB0
s_branch L_rr138
L_rs139:
s_call_b64 s[40:41], L_rareA1
s_branch L_rr139
L_rs140:
s_call_b64 s[40:41], L_rareB1
s_branch L_rr140
L_rareA0:
s_nop 15
v_max3_f32 v6, v12, v13, v14
v_max_f32 v6, v6, v15
v_mov_b32 v7, v6
s_nop 1
v_permlane32_swap_b32 v6, v7
v_max_f32 v6, v6, v7
v_mov_b32 v7, v6
s_nop 1
v_permlane16_swap_b32 v6, v7
v_max_f32 v6, v6, v7
v_max_f32 v6, 0, v6
v_ceil_f32 v6, v6
v_sub_f32 v12, v12, v6
v_sub_f32 v16, v16, v6
v_sub_f32 v32, v32, v6
v_sub_f32 v13, v13, v6
v_sub_f32 v17, v17, v6
v_sub_f32 v33, v33, v6
v_sub_f32 v14, v14, v6
v_sub_f32 v18, v18, v6
v_sub_f32 v34, v34, v6
v_sub_f32 v15, v15, v6
v_sub_f32 v19, v19, v6
v_sub_f32 v35, v35, v6
v_sub_f32 v6, 0, v6
v_cvt_i32_f32 v6, v6
s_branch L_rescA
L_rareA1:
s_nop 15
v_max3_f32 v6, v16, v17, v18
v_max_f32 v6, v6, v19
v_mov_b32 v7, v6
s_nop 1
v_permlane32_swap_b32 v6, v7
v_max_f32 v6, v6, v7
v_mov_b32 v7, v6
s_nop 1
v_permlane16_swap_b32 v6, v7
v_max_f32 v6, v6, v7
v_max_f32 v6, 0, v6
v_ceil_f32 v6, v6
v_sub_f32 v12, v12, v6
v_sub_f32 v16, v16, v6
v_sub_f32 v32, v32, v6
v_sub_f32 v13, v13, v6
v_sub_f32 v17, v17, v6
v_sub_f32 v33, v33, v6
v_sub_f32 v14, v14, v6
v_sub_f32 v18, v18, v6
v_sub_f32 v34, v34, v6
v_sub_f32 v15, v15, v6
v_sub_f32 v19, v19, v6
v_sub_f32 v35, v35, v6
v_sub_f32 v6, 0, v6
v_cvt_i32_f32 v6, v6
L_rescA:
v_accvgpr_read_b32 v7, a164
v_ldexp_f32 v7, v7, v6
v_accvgpr_write_b32 a164, v7
v_accvgpr_read_b32 v7, a165
v_ldexp_f32 v7, v7, v6
v_accvgpr_write_b32 a165, v7
v_accvgpr_read_b32 v7, a166
v_ldexp_f32 v7, v7, v6
v_accvgpr_write_b32 a166, v7
v_accvgpr_read_b32 v7, a167
v_ldexp_f32 v7, v7, v6
v_accvgpr_write_b32 a167, v7
v_and_b32 v8, 0xffff0000, v44
v_lshlrev_b32 v7, 16, v44
v_ldexp_f32 v8, v8, v6
v_ldexp_f32 v7, v7, v6
v_cvt_pk_bf16_f32 v44, v7, v8
v_and_b32 v8, 0xffff0000, v45
v_lshlrev_b32 v7, 16, v45
v_ldexp_f32 v8, v8, v6
v_ldexp_f32 v7, v7, v6
v_cvt_pk_bf16_f32 v45, v7, v8
v_and_b32 v8, 0xffff0000, v46
v_lshlrev_b32 v7, 16, v46
v_ldexp_f32 v8, v8, v6
v_ldexp_f32 v7, v7, v6
v_cvt_pk_bf16_f32 v46, v7, v8
v_and_b32 v8, 0xffff0000, v47
v_lshlrev_b32 v7, 16, v47
v_ldexp_f32 v8, v8, v6
v_ldexp_f32 v7, v7, v6
v_cvt_pk_bf16_f32 v47, v7, v8
v_and_b32 v8, 0xffff0000, v48
v_lshlrev_b32 v7, 16, v48
v_ldexp_f32 v8, v8, v6
v_ldexp_f32 v7, v7, v6
v_cvt_pk_bf16_f32 v48, v7, v8
v_and_b32 v8, 0xffff0000, v49
v_lshlrev_b32 v7, 16, v49
v_ldexp_f32 v8, v8, v6
v_ldexp_f32 v7, v7, v6
v_cvt_pk_bf16_f32 v49, v7, v8
v_and_b32 v8, 0xffff0000, v50
v_lshlrev_b32 v7, 16, v50
v_ldexp_f32 v8, v8, v6
v_ldexp_f32 v7, v7, v6
v_cvt_pk_bf16_f32 v50, v7, v8
v_and_b32 v8, 0xffff0000, v51
v_lshlrev_b32 v7, 16, v51
v_ldexp_f32 v8, v8, v6
v_ldexp_f32 v7, v7, v6
v_cvt_pk_bf16_f32 v51, v7, v8
v_and_b32 v8, 0xffff0000, v52
v_lshlrev_b32 v7, 16, v52
v_ldexp_f32 v8, v8, v6
v_ldexp_f32 v7, v7, v6
v_cvt_pk_bf16_f32 v52, v7, v8
v_and_b32 v8, 0xffff0000, v53
v_lshlrev_b32 v7, 16, v53
v_ldexp_f32 v8, v8, v6
v_ldexp_f32 v7, v7, v6
v_cvt_pk_bf16_f32 v53, v7, v8
v_and_b32 v8, 0xffff0000, v54
v_lshlrev_b32 v7, 16, v54
v_ldexp_f32 v8, v8, v6
v_ldexp_f32 v7, v7, v6
v_cvt_pk_bf16_f32 v54, v7, v8
v_and_b32 v8, 0xffff0000, v55
v_lshlrev_b32 v7, 16, v55
v_ldexp_f32 v8, v8, v6
v_ldexp_f32 v7, v7, v6
v_cvt_pk_bf16_f32 v55, v7, v8
v_and_b32 v8, 0xffff0000, v56
v_lshlrev_b32 v7, 16, v56
v_ldexp_f32 v8, v8, v6
v_ldexp_f32 v7, v7, v6
v_cvt_pk_bf16_f32 v56, v7, v8
v_and_b32 v8, 0xffff0000, v57
v_lshlrev_b32 v7, 16, v57
v_ldexp_f32 v8, v8, v6
v_ldexp_f32 v7, v7, v6
v_cvt_pk_bf16_f32 v57, v7, v8
v_and_b32 v8, 0xffff0000, v58
v_lshlrev_b32 v7, 16, v58
v_ldexp_f32 v8, v8, v6
v_ldexp_f32 v7, v7, v6
v_cvt_pk_bf16_f32 v58, v7, v8
v_and_b32 v8, 0xffff0000, v59
v_lshlrev_b32 v7, 16, v59
v_ldexp_f32 v8, v8, v6
v_ldexp_f32 v7, v7, v6
v_cvt_pk_bf16_f32 v59, v7, v8
v_and_b32 v8, 0xffff0000, v60
v_lshlrev_b32 v7, 16, v60
v_ldexp_f32 v8, v8, v6
v_ldexp_f32 v7, v7, v6
v_cvt_pk_bf16_f32 v60, v7, v8
v_and_b32 v8, 0xffff0000, v61
v_lshlrev_b32 v7, 16, v61
v_ldexp_f32 v8, v8, v6
v_ldexp_f32 v7, v7, v6
v_cvt_pk_bf16_f32 v61, v7, v8
v_and_b32 v8, 0xffff0000, v62
v_lshlrev_b32 v7, 16, v62
v_ldexp_f32 v8, v8, v6
v_ldexp_f32 v7, v7, v6
v_cvt_pk_bf16_f32 v62, v7, v8
v_and_b32 v8, 0xffff0000, v63
v_lshlrev_b32 v7, 16, v63
v_ldexp_f32 v8, v8, v6
v_ldexp_f32 v7, v7, v6
v_cvt_pk_bf16_f32 v63, v7, v8
v_and_b32 v8, 0xffff0000, v64
v_lshlrev_b32 v7, 16, v64
v_ldexp_f32 v8, v8, v6
v_ldexp_f32 v7, v7, v6
v_cvt_pk_bf16_f32 v64, v7, v8
v_and_b32 v8, 0xffff0000, v65
v_lshlrev_b32 v7, 16, v65
v_ldexp_f32 v8, v8, v6
v_ldexp_f32 v7, v7, v6
v_cvt_pk_bf16_f32 v65, v7, v8
v_and_b32 v8, 0xffff0000, v66
v_lshlrev_b32 v7, 16, v66
v_ldexp_f32 v8, v8, v6
v_ldexp_f32 v7, v7, v6
v_cvt_pk_bf16_f32 v66, v7, v8
v_and_b32 v8, 0xffff0000, v67
v_lshlrev_b32 v7, 16, v67
v_ldexp_f32 v8, v8, v6
v_ldexp_f32 v7, v7, v6
v_cvt_pk_bf16_f32 v67, v7, v8
v_and_b32 v8, 0xffff0000, v68
v_lshlrev_b32 v7, 16, v68
v_ldexp_f32 v8, v8, v6
v_ldexp_f32 v7, v7, v6
v_cvt_pk_bf16_f32 v68, v7, v8
v_and_b32 v8, 0xffff0000, v69
v_lshlrev_b32 v7, 16, v69
v_ldexp_f32 v8, v8, v6
v_ldexp_f32 v7, v7, v6
v_cvt_pk_bf16_f32 v69, v7, v8
v_and_b32 v8, 0xffff0000, v70
v_lshlrev_b32 v7, 16, v70
v_ldexp_f32 v8, v8, v6
v_ldexp_f32 v7, v7, v6
v_cvt_pk_bf16_f32 v70, v7, v8
v_and_b32 v8, 0xffff0000, v71
v_lshlrev_b32 v7, 16, v71
v_ldexp_f32 v8, v8, v6
v_ldexp_f32 v7, v7, v6
v_cvt_pk_bf16_f32 v71, v7, v8
v_and_b32 v8, 0xffff0000, v72
v_lshlrev_b32 v7, 16, v72
v_ldexp_f32 v8, v8, v6
v_ldexp_f32 v7, v7, v6
v_cvt_pk_bf16_f32 v72, v7, v8
v_and_b32 v8, 0xffff0000, v73
v_lshlrev_b32 v7, 16, v73
v_ldexp_f32 v8, v8, v6
v_ldexp_f32 v7, v7, v6
v_cvt_pk_bf16_f32 v73, v7, v8
v_and_b32 v8, 0xffff0000, v74
v_lshlrev_b32 v7, 16, v74
v_ldexp_f32 v8, v8, v6
v_ldexp_f32 v7, v7, v6
v_cvt_pk_bf16_f32 v74, v7, v8
v_and_b32 v8, 0xffff0000, v75
v_lshlrev_b32 v7, 16, v75
v_ldexp_f32 v8, v8, v6
v_ldexp_f32 v7, v7, v6
v_cvt_pk_bf16_f32 v75, v7, v8
v_and_b32 v8, 0xffff0000, v76
v_lshlrev_b32 v7, 16, v76
v_ldexp_f32 v8, v8, v6
v_ldexp_f32 v7, v7, v6
v_cvt_pk_bf16_f32 v76, v7, v8
v_and_b32 v8, 0xffff0000, v77
v_lshlrev_b32 v7, 16, v77
v_ldexp_f32 v8, v8, v6
v_ldexp_f32 v7, v7, v6
v_cvt_pk_bf16_f32 v77, v7, v8
v_and_b32 v8, 0xffff0000, v78
v_lshlrev_b32 v7, 16, v78
v_ldexp_f32 v8, v8, v6
v_ldexp_f32 v7, v7, v6
v_cvt_pk_bf16_f32 v78, v7, v8
v_and_b32 v8, 0xffff0000, v79
v_lshlrev_b32 v7, 16, v79
v_ldexp_f32 v8, v8, v6
v_ldexp_f32 v7, v7, v6
v_cvt_pk_bf16_f32 v79, v7, v8
v_and_b32 v8, 0xffff0000, v80
v_lshlrev_b32 v7, 16, v80
v_ldexp_f32 v8, v8, v6
v_ldexp_f32 v7, v7, v6
v_cvt_pk_bf16_f32 v80, v7, v8
v_and_b32 v8, 0xffff0000, v81
v_lshlrev_b32 v7, 16, v81
v_ldexp_f32 v8, v8, v6
v_ldexp_f32 v7, v7, v6
v_cvt_pk_bf16_f32 v81, v7, v8
v_and_b32 v8, 0xffff0000, v82
v_lshlrev_b32 v7, 16, v82
v_ldexp_f32 v8, v8, v6
v_ldexp_f32 v7, v7, v6
v_cvt_pk_bf16_f32 v82, v7, v8
v_and_b32 v8, 0xffff0000, v83
v_lshlrev_b32 v7, 16, v83
v_ldexp_f32 v8, v8, v6
v_ldexp_f32 v7, v7, v6
v_cvt_pk_bf16_f32 v83, v7, v8
v_and_b32 v8, 0xffff0000, v84
v_lshlrev_b32 v7, 16, v84
v_ldexp_f32 v8, v8, v6
v_ldexp_f32 v7, v7, v6
v_cvt_pk_bf16_f32 v84, v7, v8
v_and_b32 v8, 0xffff0000, v85
v_lshlrev_b32 v7, 16, v85
v_ldexp_f32 v8, v8, v6
v_ldexp_f32 v7, v7, v6
v_cvt_pk_bf16_f32 v85, v7, v8
v_and_b32 v8, 0xffff0000, v86
v_lshlrev_b32 v7, 16, v86
v_ldexp_f32 v8, v8, v6
v_ldexp_f32 v7, v7, v6
v_cvt_pk_bf16_f32 v86, v7, v8
v_and_b32 v8, 0xffff0000, v87
v_lshlrev_b32 v7, 16, v87
v_ldexp_f32 v8, v8, v6
v_ldexp_f32 v7, v7, v6
v_cvt_pk_bf16_f32 v87, v7, v8
v_and_b32 v8, 0xffff0000, v88
v_lshlrev_b32 v7, 16, v88
v_ldexp_f32 v8, v8, v6
v_ldexp_f32 v7, v7, v6
v_cvt_pk_bf16_f32 v88, v7, v8
v_and_b32 v8, 0xffff0000, v89
v_lshlrev_b32 v7, 16, v89
v_ldexp_f32 v8, v8, v6
v_ldexp_f32 v7, v7, v6
v_cvt_pk_bf16_f32 v89, v7, v8
v_and_b32 v8, 0xffff0000, v90
v_lshlrev_b32 v7, 16, v90
v_ldexp_f32 v8, v8, v6
v_ldexp_f32 v7, v7, v6
v_cvt_pk_bf16_f32 v90, v7, v8
v_and_b32 v8, 0xffff0000, v91
v_lshlrev_b32 v7, 16, v91
v_ldexp_f32 v8, v8, v6
v_ldexp_f32 v7, v7, v6
v_cvt_pk_bf16_f32 v91, v7, v8
v_and_b32 v8, 0xffff0000, v92
v_lshlrev_b32 v7, 16, v92
v_ldexp_f32 v8, v8, v6
v_ldexp_f32 v7, v7, v6
v_cvt_pk_bf16_f32 v92, v7, v8
v_and_b32 v8, 0xffff0000, v93
v_lshlrev_b32 v7, 16, v93
v_ldexp_f32 v8, v8, v6
v_ldexp_f32 v7, v7, v6
v_cvt_pk_bf16_f32 v93, v7, v8
v_and_b32 v8, 0xffff0000, v94
v_lshlrev_b32 v7, 16, v94
v_ldexp_f32 v8, v8, v6
v_ldexp_f32 v7, v7, v6
v_cvt_pk_bf16_f32 v94, v7, v8
v_and_b32 v8, 0xffff0000, v95
v_lshlrev_b32 v7, 16, v95
v_ldexp_f32 v8, v8, v6
v_ldexp_f32 v7, v7, v6
v_cvt_pk_bf16_f32 v95, v7, v8
v_and_b32 v8, 0xffff0000, v96
v_lshlrev_b32 v7, 16, v96
v_ldexp_f32 v8, v8, v6
v_ldexp_f32 v7, v7, v6
v_cvt_pk_bf16_f32 v96, v7, v8
v_and_b32 v8, 0xffff0000, v97
v_lshlrev_b32 v7, 16, v97
v_ldexp_f32 v8, v8, v6
v_ldexp_f32 v7, v7, v6
v_cvt_pk_bf16_f32 v97, v7, v8
v_and_b32 v8, 0xffff0000, v98
v_lshlrev_b32 v7, 16, v98
v_ldexp_f32 v8, v8, v6
v_ldexp_f32 v7, v7, v6
v_cvt_pk_bf16_f32 v98, v7, v8
v_and_b32 v8, 0xffff0000, v99
v_lshlrev_b32 v7, 16, v99
v_ldexp_f32 v8, v8, v6
v_ldexp_f32 v7, v7, v6
v_cvt_pk_bf16_f32 v99, v7, v8
v_and_b32 v8, 0xffff0000, v100
v_lshlrev_b32 v7, 16, v100
v_ldexp_f32 v8, v8, v6
v_ldexp_f32 v7, v7, v6
v_cvt_pk_bf16_f32 v100, v7, v8
v_and_b32 v8, 0xffff0000, v101
v_lshlrev_b32 v7, 16, v101
v_ldexp_f32 v8, v8, v6
v_ldexp_f32 v7, v7, v6
v_cvt_pk_bf16_f32 v101, v7, v8
v_and_b32 v8, 0xffff0000, v102
v_lshlrev_b32 v7, 16, v102
v_ldexp_f32 v8, v8, v6
v_ldexp_f32 v7, v7, v6
v_cvt_pk_bf16_f32 v102, v7, v8
v_and_b32 v8, 0xffff0000, v103
v_lshlrev_b32 v7, 16, v103
v_ldexp_f32 v8, v8, v6
v_ldexp_f32 v7, v7, v6
v_cvt_pk_bf16_f32 v103, v7, v8
v_and_b32 v8, 0xffff0000, v104
v_lshlrev_b32 v7, 16, v104
v_ldexp_f32 v8, v8, v6
v_ldexp_f32 v7, v7, v6
v_cvt_pk_bf16_f32 v104, v7, v8
v_and_b32 v8, 0xffff0000, v105
v_lshlrev_b32 v7, 16, v105
v_ldexp_f32 v8, v8, v6
v_ldexp_f32 v7, v7, v6
v_cvt_pk_bf16_f32 v105, v7, v8
v_and_b32 v8, 0xffff0000, v106
v_lshlrev_b32 v7, 16, v106
v_ldexp_f32 v8, v8, v6
v_ldexp_f32 v7, v7, v6
v_cvt_pk_bf16_f32 v106, v7, v8
v_and_b32 v8, 0xffff0000, v107
v_lshlrev_b32 v7, 16, v107
v_ldexp_f32 v8, v8, v6
v_ldexp_f32 v7, v7, v6
v_cvt_pk_bf16_f32 v107, v7, v8
v_and_b32 v8, 0xffff0000, v108
v_lshlrev_b32 v7, 16, v108
v_ldexp_f32 v8, v8, v6
v_ldexp_f32 v7, v7, v6
v_cvt_pk_bf16_f32 v108, v7, v8
v_and_b32 v8, 0xffff0000, v109
v_lshlrev_b32 v7, 16, v109
v_ldexp_f32 v8, v8, v6
v_ldexp_f32 v7, v7, v6
v_cvt_pk_bf16_f32 v109, v7, v8
v_and_b32 v8, 0xffff0000, v110
v_lshlrev_b32 v7, 16, v110
v_ldexp_f32 v8, v8, v6
v_ldexp_f32 v7, v7, v6
v_cvt_pk_bf16_f32 v110, v7, v8
v_and_b32 v8, 0xffff0000, v111
v_lshlrev_b32 v7, 16, v111
v_ldexp_f32 v8, v8, v6
v_ldexp_f32 v7, v7, v6
v_cvt_pk_bf16_f32 v111, v7, v8
v_and_b32 v8, 0xffff0000, v112
v_lshlrev_b32 v7, 16, v112
v_ldexp_f32 v8, v8, v6
v_ldexp_f32 v7, v7, v6
v_cvt_pk_bf16_f32 v112, v7, v8
v_and_b32 v8, 0xffff0000, v113
v_lshlrev_b32 v7, 16, v113
v_ldexp_f32 v8, v8, v6
v_ldexp_f32 v7, v7, v6
v_cvt_pk_bf16_f32 v113, v7, v8
v_and_b32 v8, 0xffff0000, v114
v_lshlrev_b32 v7, 16, v114
v_ldexp_f32 v8, v8, v6
v_ldexp_f32 v7, v7, v6
v_cvt_pk_bf16_f32 v114, v7, v8
v_and_b32 v8, 0xffff0000, v115
v_lshlrev_b32 v7, 16, v115
v_ldexp_f32 v8, v8, v6
v_ldexp_f32 v7, v7, v6
v_cvt_pk_bf16_f32 v115, v7, v8
v_and_b32 v8, 0xffff0000, v116
v_lshlrev_b32 v7, 16, v116
v_ldexp_f32 v8, v8, v6
v_ldexp_f32 v7, v7, v6
v_cvt_pk_bf16_f32 v116, v7, v8
v_and_b32 v8, 0xffff0000, v117
v_lshlrev_b32 v7, 16, v117
v_ldexp_f32 v8, v8, v6
v_ldexp_f32 v7, v7, v6
v_cvt_pk_bf16_f32 v117, v7, v8
v_and_b32 v8, 0xffff0000, v118
v_lshlrev_b32 v7, 16, v118
v_ldexp_f32 v8, v8, v6
v_ldexp_f32 v7, v7, v6
v_cvt_pk_bf16_f32 v118, v7, v8
v_and_b32 v8, 0xffff0000, v119
v_lshlrev_b32 v7, 16, v119
v_ldexp_f32 v8, v8, v6
v_ldexp_f32 v7, v7, v6
v_cvt_pk_bf16_f32 v119, v7, v8
v_and_b32 v8, 0xffff0000, v120
v_lshlrev_b32 v7, 16, v120
v_ldexp_f32 v8, v8, v6
v_ldexp_f32 v7, v7, v6
v_cvt_pk_bf16_f32 v120, v7, v8
v_and_b32 v8, 0xffff0000, v121
v_lshlrev_b32 v7, 16, v121
v_ldexp_f32 v8, v8, v6
v_ldexp_f32 v7, v7, v6
v_cvt_pk_bf16_f32 v121, v7, v8
v_and_b32 v8, 0xffff0000, v122
v_lshlrev_b32 v7, 16, v122
v_ldexp_f32 v8, v8, v6
v_ldexp_f32 v7, v7, v6
v_cvt_pk_bf16_f32 v122, v7, v8
v_and_b32 v8, 0xffff0000, v123
v_lshlrev_b32 v7, 16, v123
v_ldexp_f32 v8, v8, v6
v_ldexp_f32 v7, v7, v6
v_cvt_pk_bf16_f32 v123, v7, v8
v_and_b32 v8, 0xffff0000, v124
v_lshlrev_b32 v7, 16, v124
v_ldexp_f32 v8, v8, v6
v_ldexp_f32 v7, v7, v6
v_cvt_pk_bf16_f32 v124, v7, v8
v_and_b32 v8, 0xffff0000, v125
v_lshlrev_b32 v7, 16, v125
v_ldexp_f32 v8, v8, v6
v_ldexp_f32 v7, v7, v6
v_cvt_pk_bf16_f32 v125, v7, v8
v_and_b32 v8, 0xffff0000, v126
v_lshlrev_b32 v7, 16, v126
v_ldexp_f32 v8, v8, v6
v_ldexp_f32 v7, v7, v6
v_cvt_pk_bf16_f32 v126, v7, v8
v_and_b32 v8, 0xffff0000, v127
v_lshlrev_b32 v7, 16, v127
v_ldexp_f32 v8, v8, v6
v_ldexp_f32 v7, v7, v6
v_cvt_pk_bf16_f32 v127, v7, v8
v_and_b32 v8, 0xffff0000, v128
v_lshlrev_b32 v7, 16, v128
v_ldexp_f32 v8, v8, v6
v_ldexp_f32 v7, v7, v6
v_cvt_pk_bf16_f32 v128, v7, v8
v_and_b32 v8, 0xffff0000, v129
v_lshlrev_b32 v7, 16, v129
v_ldexp_f32 v8, v8, v6
v_ldexp_f32 v7, v7, v6
v_cvt_pk_bf16_f32 v129, v7, v8
v_and_b32 v8, 0xffff0000, v130
v_lshlrev_b32 v7, 16, v130
v_ldexp_f32 v8, v8, v6
v_ldexp_f32 v7, v7, v6
v_cvt_pk_bf16_f32 v130, v7, v8
v_and_b32 v8, 0xffff0000, v131
v_lshlrev_b32 v7, 16, v131
v_ldexp_f32 v8, v8, v6
v_ldexp_f32 v7, v7, v6
v_cvt_pk_bf16_f32 v131, v7, v8
v_and_b32 v8, 0xffff0000, v132
v_lshlrev_b32 v7, 16, v132
v_ldexp_f32 v8, v8, v6
v_ldexp_f32 v7, v7, v6
v_cvt_pk_bf16_f32 v132, v7, v8
v_and_b32 v8, 0xffff0000, v133
v_lshlrev_b32 v7, 16, v133
v_ldexp_f32 v8, v8, v6
v_ldexp_f32 v7, v7, v6
v_cvt_pk_bf16_f32 v133, v7, v8
v_and_b32 v8, 0xffff0000, v134
v_lshlrev_b32 v7, 16, v134
v_ldexp_f32 v8, v8, v6
v_ldexp_f32 v7, v7, v6
v_cvt_pk_bf16_f32 v134, v7, v8
v_and_b32 v8, 0xffff0000, v135
v_lshlrev_b32 v7, 16, v135
v_ldexp_f32 v8, v8, v6
v_ldexp_f32 v7, v7, v6
v_cvt_pk_bf16_f32 v135, v7, v8
v_and_b32 v8, 0xffff0000, v136
v_lshlrev_b32 v7, 16, v136
v_ldexp_f32 v8, v8, v6
v_ldexp_f32 v7, v7, v6
v_cvt_pk_bf16_f32 v136, v7, v8
v_and_b32 v8, 0xffff0000, v137
v_lshlrev_b32 v7, 16, v137
v_ldexp_f32 v8, v8, v6
v_ldexp_f32 v7, v7, v6
v_cvt_pk_bf16_f32 v137, v7, v8
v_and_b32 v8, 0xffff0000, v138
v_lshlrev_b32 v7, 16, v138
v_ldexp_f32 v8, v8, v6
v_ldexp_f32 v7, v7, v6
v_cvt_pk_bf16_f32 v138, v7, v8
v_and_b32 v8, 0xffff0000, v139
v_lshlrev_b32 v7, 16, v139
v_ldexp_f32 v8, v8, v6
v_ldexp_f32 v7, v7, v6
v_cvt_pk_bf16_f32 v139, v7, v8
v_and_b32 v8, 0xffff0000, v140
v_lshlrev_b32 v7, 16, v140
v_ldexp_f32 v8, v8, v6
v_ldexp_f32 v7, v7, v6
v_cvt_pk_bf16_f32 v140, v7, v8
v_and_b32 v8, 0xffff0000, v141
v_lshlrev_b32 v7, 16, v141
v_ldexp_f32 v8, v8, v6
v_ldexp_f32 v7, v7, v6
v_cvt_pk_bf16_f32 v141, v7, v8
v_and_b32 v8, 0xffff0000, v142
v_lshlrev_b32 v7, 16, v142
v_ldexp_f32 v8, v8, v6
v_ldexp_f32 v7, v7, v6
v_cvt_pk_bf16_f32 v142, v7, v8
v_and_b32 v8, 0xffff0000, v143
v_lshlrev_b32 v7, 16, v143
v_ldexp_f32 v8, v8, v6
v_ldexp_f32 v7, v7, v6
v_cvt_pk_bf16_f32 v143, v7, v8
v_and_b32 v8, 0xffff0000, v144
v_lshlrev_b32 v7, 16, v144
v_ldexp_f32 v8, v8, v6
v_ldexp_f32 v7, v7, v6
v_cvt_pk_bf16_f32 v144, v7, v8
v_and_b32 v8, 0xffff0000, v145
v_lshlrev_b32 v7, 16, v145
v_ldexp_f32 v8, v8, v6
v_ldexp_f32 v7, v7, v6
v_cvt_pk_bf16_f32 v145, v7, v8
v_and_b32 v8, 0xffff0000, v146
v_lshlrev_b32 v7, 16, v146
v_ldexp_f32 v8, v8, v6
v_ldexp_f32 v7, v7, v6
v_cvt_pk_bf16_f32 v146, v7, v8
v_and_b32 v8, 0xffff0000, v147
v_lshlrev_b32 v7, 16, v147
v_ldexp_f32 v8, v8, v6
v_ldexp_f32 v7, v7, v6
v_cvt_pk_bf16_f32 v147, v7, v8
v_and_b32 v8, 0xffff0000, v148
v_lshlrev_b32 v7, 16, v148
v_ldexp_f32 v8, v8, v6
v_ldexp_f32 v7, v7, v6
v_cvt_pk_bf16_f32 v148, v7, v8
v_and_b32 v8, 0xffff0000, v149
v_lshlrev_b32 v7, 16, v149
v_ldexp_f32 v8, v8, v6
v_ldexp_f32 v7, v7, v6
v_cvt_pk_bf16_f32 v149, v7, v8
v_and_b32 v8, 0xffff0000, v150
v_lshlrev_b32 v7, 16, v150
v_ldexp_f32 v8, v8, v6
v_ldexp_f32 v7, v7, v6
v_cvt_pk_bf16_f32 v150, v7, v8
v_and_b32 v8, 0xffff0000, v151
v_lshlrev_b32 v7, 16, v151
v_ldexp_f32 v8, v8, v6
v_ldexp_f32 v7, v7, v6
v_cvt_pk_bf16_f32 v151, v7, v8
v_and_b32 v8, 0xffff0000, v152
v_lshlrev_b32 v7, 16, v152
v_ldexp_f32 v8, v8, v6
v_ldexp_f32 v7, v7, v6
v_cvt_pk_bf16_f32 v152, v7, v8
v_and_b32 v8, 0xffff0000, v153
v_lshlrev_b32 v7, 16, v153
v_ldexp_f32 v8, v8, v6
v_ldexp_f32 v7, v7, v6
v_cvt_pk_bf16_f32 v153, v7, v8
v_and_b32 v8, 0xffff0000, v154
v_lshlrev_b32 v7, 16, v154
v_ldexp_f32 v8, v8, v6
v_ldexp_f32 v7, v7, v6
v_cvt_pk_bf16_f32 v154, v7, v8
v_and_b32 v8, 0xffff0000, v155
v_lshlrev_b32 v7, 16, v155
v_ldexp_f32 v8, v8, v6
v_ldexp_f32 v7, v7, v6
v_cvt_pk_bf16_f32 v155, v7, v8
v_and_b32 v8, 0xffff0000, v156
v_lshlrev_b32 v7, 16, v156
v_ldexp_f32 v8, v8, v6
v_ldexp_f32 v7, v7, v6
v_cvt_pk_bf16_f32 v156, v7, v8
v_and_b32 v8, 0xffff0000, v157
v_lshlrev_b32 v7, 16, v157
v_ldexp_f32 v8, v8, v6
v_ldexp_f32 v7, v7, v6
v_cvt_pk_bf16_f32 v157, v7, v8
v_and_b32 v8, 0xffff0000, v158
v_lshlrev_b32 v7, 16, v158
v_ldexp_f32 v8, v8, v6
v_ldexp_f32 v7, v7, v6
v_cvt_pk_bf16_f32 v158, v7, v8
v_and_b32 v8, 0xffff0000, v159
v_lshlrev_b32 v7, 16, v159
v_ldexp_f32 v8, v8, v6
v_ldexp_f32 v7, v7, v6
v_cvt_pk_bf16_f32 v159, v7, v8
v_and_b32 v8, 0xffff0000, v160
v_lshlrev_b32 v7, 16, v160
v_ldexp_f32 v8, v8, v6
v_ldexp_f32 v7, v7, v6
v_cvt_pk_bf16_f32 v160, v7, v8
v_and_b32 v8, 0xffff0000, v161
v_lshlrev_b32 v7, 16, v161
v_ldexp_f32 v8, v8, v6
v_ldexp_f32 v7, v7, v6
v_cvt_pk_bf16_f32 v161, v7, v8
v_and_b32 v8, 0xffff0000, v162
v_lshlrev_b32 v7, 16, v162
v_ldexp_f32 v8, v8, v6
v_ldexp_f32 v7, v7, v6
v_cvt_pk_bf16_f32 v162, v7, v8
v_and_b32 v8, 0xffff0000, v163
v_lshlrev_b32 v7, 16, v163
v_ldexp_f32 v8, v8, v6
v_ldexp_f32 v7, v7, v6
v_cvt_pk_bf16_f32 v163, v7, v8
v_and_b32 v8, 0xffff0000, v164
v_lshlrev_b32 v7, 16, v164
v_ldexp_f32 v8, v8, v6
v_ldexp_f32 v7, v7, v6
v_cvt_pk_bf16_f32 v164, v7, v8
v_and_b32 v8, 0xffff0000, v165
v_lshlrev_b32 v7, 16, v165
v_ldexp_f32 v8, v8, v6
v_ldexp_f32 v7, v7, v6
v_cvt_pk_bf16_f32 v165, v7, v8
v_and_b32 v8, 0xffff0000, v166
v_lshlrev_b32 v7, 16, v166
v_ldexp_f32 v8, v8, v6
v_ldexp_f32 v7, v7, v6
v_cvt_pk_bf16_f32 v166, v7, v8
v_and_b32 v8, 0xffff0000, v167
v_lshlrev_b32 v7, 16, v167
v_ldexp_f32 v8, v8, v6
v_ldexp_f32 v7, v7, v6
v_cvt_pk_bf16_f32 v167, v7, v8
v_and_b32 v8, 0xffff0000, v168
v_lshlrev_b32 v7, 16, v168
v_ldexp_f32 v8, v8, v6
v_ldexp_f32 v7, v7, v6
v_cvt_pk_bf16_f32 v168, v7, v8
v_and_b32 v8, 0xffff0000, v169
v_lshlrev_b32 v7, 16, v169
v_ldexp_f32 v8, v8, v6
v_ldexp_f32 v7, v7, v6
v_cvt_pk_bf16_f32 v169, v7, v8
v_and_b32 v8, 0xffff0000, v170
v_lshlrev_b32 v7, 16, v170
v_ldexp_f32 v8, v8, v6
v_ldexp_f32 v7, v7, v6
v_cvt_pk_bf16_f32 v170, v7, v8
v_and_b32 v8, 0xffff0000, v171
v_lshlrev_b32 v7, 16, v171
v_ldexp_f32 v8, v8, v6
v_ldexp_f32 v7, v7, v6
v_cvt_pk_bf16_f32 v171, v7, v8
s_nop 3
s_setpc_b64 s[40:41]
L_rareB0:
s_nop 15
v_max3_f32 v6, v20, v21, v22
v_max_f32 v6, v6, v23
v_mov_b32 v7, v6
s_nop 1
v_permlane32_swap_b32 v6, v7
v_max_f32 v6, v6, v7
v_mov_b32 v7, v6
s_nop 1
v_permlane16_swap_b32 v6, v7
v_max_f32 v6, v6, v7
v_max_f32 v6, 0, v6
v_ceil_f32 v6, v6
v_sub_f32 v20, v20, v6
v_sub_f32 v24, v24, v6
v_sub_f32 v36, v36, v6
v_sub_f32 v21, v21, v6
v_sub_f32 v25, v25, v6
v_sub_f32 v37, v37, v6
v_sub_f32 v22, v22, v6
v_sub_f32 v26, v26, v6
v_sub_f32 v38, v38, v6
v_sub_f32 v23, v23, v6
v_sub_f32 v27, v27, v6
v_sub_f32 v39, v39, v6
v_sub_f32 v6, 0, v6
v_cvt_i32_f32 v6, v6
s_branch L_rescB
L_rareB1:
s_nop 15
v_max3_f32 v6, v24, v25, v26
v_max_f32 v6, v6, v27
v_mov_b32 v7, v6
s_nop 1
v_permlane32_swap_b32 v6, v7
v_max_f32 v6, v6, v7
v_mov_b32 v7, v6
s_nop 1
v_permlane16_swap_b32 v6, v7
v_max_f32 v6, v6, v7
v_max_f32 v6, 0, v6
v_ceil_f32 v6, v6
v_sub_f32 v20, v20, v6
v_sub_f32 v24, v24, v6
v_sub_f32 v36, v36, v6
v_sub_f32 v21, v21, v6
v_sub_f32 v25, v25, v6
v_sub_f32 v37, v37, v6
v_sub_f32 v22, v22, v6
v_sub_f32 v26, v26, v6
v_sub_f32 v38, v38, v6
v_sub_f32 v23, v23, v6
v_sub_f32 v27, v27, v6
v_sub_f32 v39, v39, v6
v_sub_f32 v6, 0, v6
v_cvt_i32_f32 v6, v6
L_rescB:
v_accvgpr_read_b32 v7, a168
v_ldexp_f32 v7, v7, v6
v_accvgpr_write_b32 a168, v7
v_accvgpr_read_b32 v7, a169
v_ldexp_f32 v7, v7, v6
v_accvgpr_write_b32 a169, v7
v_accvgpr_read_b32 v7, a170
v_ldexp_f32 v7, v7, v6
v_accvgpr_write_b32 a170, v7
v_accvgpr_read_b32 v7, a171
v_ldexp_f32 v7, v7, v6
v_accvgpr_write_b32 a171, v7
v_and_b32 v8, 0xffff0000, v172
v_lshlrev_b32 v7, 16, v172
v_ldexp_f32 v8, v8, v6
v_ldexp_f32 v7, v7, v6
v_cvt_pk_bf16_f32 v172, v7, v8
v_and_b32 v8, 0xffff0000, v173
v_lshlrev_b32 v7, 16, v173
v_ldexp_f32 v8, v8, v6
v_ldexp_f32 v7, v7, v6
v_cvt_pk_bf16_f32 v173, v7, v8
v_and_b32 v8, 0xffff0000, v174
v_lshlrev_b32 v7, 16, v174
v_ldexp_f32 v8, v8, v6
v_ldexp_f32 v7, v7, v6
v_cvt_pk_bf16_f32 v174, v7, v8
v_and_b32 v8, 0xffff0000, v175
v_lshlrev_b32 v7, 16, v175
v_ldexp_f32 v8, v8, v6
v_ldexp_f32 v7, v7, v6
v_cvt_pk_bf16_f32 v175, v7, v8
v_and_b32 v8, 0xffff0000, v176
v_lshlrev_b32 v7, 16, v176
v_ldexp_f32 v8, v8, v6
v_ldexp_f32 v7, v7, v6
v_cvt_pk_bf16_f32 v176, v7, v8
v_and_b32 v8, 0xffff0000, v177
v_lshlrev_b32 v7, 16, v177
v_ldexp_f32 v8, v8, v6
v_ldexp_f32 v7, v7, v6
v_cvt_pk_bf16_f32 v177, v7, v8
v_and_b32 v8, 0xffff0000, v178
v_lshlrev_b32 v7, 16, v178
v_ldexp_f32 v8, v8, v6
v_ldexp_f32 v7, v7, v6
v_cvt_pk_bf16_f32 v178, v7, v8
v_and_b32 v8, 0xffff0000, v179
v_lshlrev_b32 v7, 16, v179
v_ldexp_f32 v8, v8, v6
v_ldexp_f32 v7, v7, v6
v_cvt_pk_bf16_f32 v179, v7, v8
v_and_b32 v8, 0xffff0000, v180
v_lshlrev_b32 v7, 16, v180
v_ldexp_f32 v8, v8, v6
v_ldexp_f32 v7, v7, v6
v_cvt_pk_bf16_f32 v180, v7, v8
v_and_b32 v8, 0xffff0000, v181
v_lshlrev_b32 v7, 16, v181
v_ldexp_f32 v8, v8, v6
v_ldexp_f32 v7, v7, v6
v_cvt_pk_bf16_f32 v181, v7, v8
v_and_b32 v8, 0xffff0000, v182
v_lshlrev_b32 v7, 16, v182
v_ldexp_f32 v8, v8, v6
v_ldexp_f32 v7, v7, v6
v_cvt_pk_bf16_f32 v182, v7, v8
v_and_b32 v8, 0xffff0000, v183
v_lshlrev_b32 v7, 16, v183
v_ldexp_f32 v8, v8, v6
v_ldexp_f32 v7, v7, v6
v_cvt_pk_bf16_f32 v183, v7, v8
v_and_b32 v8, 0xffff0000, v184
v_lshlrev_b32 v7, 16, v184
v_ldexp_f32 v8, v8, v6
v_ldexp_f32 v7, v7, v6
v_cvt_pk_bf16_f32 v184, v7, v8
v_and_b32 v8, 0xffff0000, v185
v_lshlrev_b32 v7, 16, v185
v_ldexp_f32 v8, v8, v6
v_ldexp_f32 v7, v7, v6
v_cvt_pk_bf16_f32 v185, v7, v8
v_and_b32 v8, 0xffff0000, v186
v_lshlrev_b32 v7, 16, v186
v_ldexp_f32 v8, v8, v6
v_ldexp_f32 v7, v7, v6
v_cvt_pk_bf16_f32 v186, v7, v8
v_and_b32 v8, 0xffff0000, v187
v_lshlrev_b32 v7, 16, v187
v_ldexp_f32 v8, v8, v6
v_ldexp_f32 v7, v7, v6
v_cvt_pk_bf16_f32 v187, v7, v8
v_and_b32 v8, 0xffff0000, v188
v_lshlrev_b32 v7, 16, v188
v_ldexp_f32 v8, v8, v6
v_ldexp_f32 v7, v7, v6
v_cvt_pk_bf16_f32 v188, v7, v8
v_and_b32 v8, 0xffff0000, v189
v_lshlrev_b32 v7, 16, v189
v_ldexp_f32 v8, v8, v6
v_ldexp_f32 v7, v7, v6
v_cvt_pk_bf16_f32 v189, v7, v8
v_and_b32 v8, 0xffff0000, v190
v_lshlrev_b32 v7, 16, v190
v_ldexp_f32 v8, v8, v6
v_ldexp_f32 v7, v7, v6
v_cvt_pk_bf16_f32 v190, v7, v8
v_and_b32 v8, 0xffff0000, v191
v_lshlrev_b32 v7, 16, v191
v_ldexp_f32 v8, v8, v6
v_ldexp_f32 v7, v7, v6
v_cvt_pk_bf16_f32 v191, v7, v8
v_and_b32 v8, 0xffff0000, v192
v_lshlrev_b32 v7, 16, v192
v_ldexp_f32 v8, v8, v6
v_ldexp_f32 v7, v7, v6
v_cvt_pk_bf16_f32 v192, v7, v8
v_and_b32 v8, 0xffff0000, v193
v_lshlrev_b32 v7, 16, v193
v_ldexp_f32 v8, v8, v6
v_ldexp_f32 v7, v7, v6
v_cvt_pk_bf16_f32 v193, v7, v8
v_and_b32 v8, 0xffff0000, v194
v_lshlrev_b32 v7, 16, v194
v_ldexp_f32 v8, v8, v6
v_ldexp_f32 v7, v7, v6
v_cvt_pk_bf16_f32 v194, v7, v8
v_and_b32 v8, 0xffff0000, v195
v_lshlrev_b32 v7, 16, v195
v_ldexp_f32 v8, v8, v6
v_ldexp_f32 v7, v7, v6
v_cvt_pk_bf16_f32 v195, v7, v8
v_and_b32 v8, 0xffff0000, v196
v_lshlrev_b32 v7, 16, v196
v_ldexp_f32 v8, v8, v6
v_ldexp_f32 v7, v7, v6
v_cvt_pk_bf16_f32 v196, v7, v8
v_and_b32 v8, 0xffff0000, v197
v_lshlrev_b32 v7, 16, v197
v_ldexp_f32 v8, v8, v6
v_ldexp_f32 v7, v7, v6
v_cvt_pk_bf16_f32 v197, v7, v8
v_and_b32 v8, 0xffff0000, v198
v_lshlrev_b32 v7, 16, v198
v_ldexp_f32 v8, v8, v6
v_ldexp_f32 v7, v7, v6
v_cvt_pk_bf16_f32 v198, v7, v8
v_and_b32 v8, 0xffff0000, v199
v_lshlrev_b32 v7, 16, v199
v_ldexp_f32 v8, v8, v6
v_ldexp_f32 v7, v7, v6
v_cvt_pk_bf16_f32 v199, v7, v8
v_and_b32 v8, 0xffff0000, v200
v_lshlrev_b32 v7, 16, v200
v_ldexp_f32 v8, v8, v6
v_ldexp_f32 v7, v7, v6
v_cvt_pk_bf16_f32 v200, v7, v8
v_and_b32 v8, 0xffff0000, v201
v_lshlrev_b32 v7, 16, v201
v_ldexp_f32 v8, v8, v6
v_ldexp_f32 v7, v7, v6
v_cvt_pk_bf16_f32 v201, v7, v8
v_and_b32 v8, 0xffff0000, v202
v_lshlrev_b32 v7, 16, v202
v_ldexp_f32 v8, v8, v6
v_ldexp_f32 v7, v7, v6
v_cvt_pk_bf16_f32 v202, v7, v8
v_and_b32 v8, 0xffff0000, v203
v_lshlrev_b32 v7, 16, v203
v_ldexp_f32 v8, v8, v6
v_ldexp_f32 v7, v7, v6
v_cvt_pk_bf16_f32 v203, v7, v8
v_and_b32 v8, 0xffff0000, v204
v_lshlrev_b32 v7, 16, v204
v_ldexp_f32 v8, v8, v6
v_ldexp_f32 v7, v7, v6
v_cvt_pk_bf16_f32 v204, v7, v8
v_and_b32 v8, 0xffff0000, v205
v_lshlrev_b32 v7, 16, v205
v_ldexp_f32 v8, v8, v6
v_ldexp_f32 v7, v7, v6
v_cvt_pk_bf16_f32 v205, v7, v8
v_and_b32 v8, 0xffff0000, v206
v_lshlrev_b32 v7, 16, v206
v_ldexp_f32 v8, v8, v6
v_ldexp_f32 v7, v7, v6
v_cvt_pk_bf16_f32 v206, v7, v8
v_and_b32 v8, 0xffff0000, v207
v_lshlrev_b32 v7, 16, v207
v_ldexp_f32 v8, v8, v6
v_ldexp_f32 v7, v7, v6
v_cvt_pk_bf16_f32 v207, v7, v8
v_and_b32 v8, 0xffff0000, v208
v_lshlrev_b32 v7, 16, v208
v_ldexp_f32 v8, v8, v6
v_ldexp_f32 v7, v7, v6
v_cvt_pk_bf16_f32 v208, v7, v8
v_and_b32 v8, 0xffff0000, v209
v_lshlrev_b32 v7, 16, v209
v_ldexp_f32 v8, v8, v6
v_ldexp_f32 v7, v7, v6
v_cvt_pk_bf16_f32 v209, v7, v8
v_and_b32 v8, 0xffff0000, v210
v_lshlrev_b32 v7, 16, v210
v_ldexp_f32 v8, v8, v6
v_ldexp_f32 v7, v7, v6
v_cvt_pk_bf16_f32 v210, v7, v8
v_and_b32 v8, 0xffff0000, v211
v_lshlrev_b32 v7, 16, v211
v_ldexp_f32 v8, v8, v6
v_ldexp_f32 v7, v7, v6
v_cvt_pk_bf16_f32 v211, v7, v8
v_and_b32 v8, 0xffff0000, v212
v_lshlrev_b32 v7, 16, v212
v_ldexp_f32 v8, v8, v6
v_ldexp_f32 v7, v7, v6
v_cvt_pk_bf16_f32 v212, v7, v8
v_and_b32 v8, 0xffff0000, v213
v_lshlrev_b32 v7, 16, v213
v_ldexp_f32 v8, v8, v6
v_ldexp_f32 v7, v7, v6
v_cvt_pk_bf16_f32 v213, v7, v8
v_and_b32 v8, 0xffff0000, v214
v_lshlrev_b32 v7, 16, v214
v_ldexp_f32 v8, v8, v6
v_ldexp_f32 v7, v7, v6
v_cvt_pk_bf16_f32 v214, v7, v8
v_and_b32 v8, 0xffff0000, v215
v_lshlrev_b32 v7, 16, v215
v_ldexp_f32 v8, v8, v6
v_ldexp_f32 v7, v7, v6
v_cvt_pk_bf16_f32 v215, v7, v8
v_and_b32 v8, 0xffff0000, v216
v_lshlrev_b32 v7, 16, v216
v_ldexp_f32 v8, v8, v6
v_ldexp_f32 v7, v7, v6
v_cvt_pk_bf16_f32 v216, v7, v8
v_and_b32 v8, 0xffff0000, v217
v_lshlrev_b32 v7, 16, v217
v_ldexp_f32 v8, v8, v6
v_ldexp_f32 v7, v7, v6
v_cvt_pk_bf16_f32 v217, v7, v8
v_and_b32 v8, 0xffff0000, v218
v_lshlrev_b32 v7, 16, v218
v_ldexp_f32 v8, v8, v6
v_ldexp_f32 v7, v7, v6
v_cvt_pk_bf16_f32 v218, v7, v8
v_and_b32 v8, 0xffff0000, v219
v_lshlrev_b32 v7, 16, v219
v_ldexp_f32 v8, v8, v6
v_ldexp_f32 v7, v7, v6
v_cvt_pk_bf16_f32 v219, v7, v8
v_and_b32 v8, 0xffff0000, v220
v_lshlrev_b32 v7, 16, v220
v_ldexp_f32 v8, v8, v6
v_ldexp_f32 v7, v7, v6
v_cvt_pk_bf16_f32 v220, v7, v8
v_and_b32 v8, 0xffff0000, v221
v_lshlrev_b32 v7, 16, v221
v_ldexp_f32 v8, v8, v6
v_ldexp_f32 v7, v7, v6
v_cvt_pk_bf16_f32 v221, v7, v8
v_and_b32 v8, 0xffff0000, v222
v_lshlrev_b32 v7, 16, v222
v_ldexp_f32 v8, v8, v6
v_ldexp_f32 v7, v7, v6
v_cvt_pk_bf16_f32 v222, v7, v8
v_and_b32 v8, 0xffff0000, v223
v_lshlrev_b32 v7, 16, v223
v_ldexp_f32 v8, v8, v6
v_ldexp_f32 v7, v7, v6
v_cvt_pk_bf16_f32 v223, v7, v8
v_and_b32 v8, 0xffff0000, v224
v_lshlrev_b32 v7, 16, v224
v_ldexp_f32 v8, v8, v6
v_ldexp_f32 v7, v7, v6
v_cvt_pk_bf16_f32 v224, v7, v8
v_and_b32 v8, 0xffff0000, v225
v_lshlrev_b32 v7, 16, v225
v_ldexp_f32 v8, v8, v6
v_ldexp_f32 v7, v7, v6
v_cvt_pk_bf16_f32 v225, v7, v8
v_and_b32 v8, 0xffff0000, v226
v_lshlrev_b32 v7, 16, v226
v_ldexp_f32 v8, v8, v6
v_ldexp_f32 v7, v7, v6
v_cvt_pk_bf16_f32 v226, v7, v8
v_and_b32 v8, 0xffff0000, v227
v_lshlrev_b32 v7, 16, v227
v_ldexp_f32 v8, v8, v6
v_ldexp_f32 v7, v7, v6
v_cvt_pk_bf16_f32 v227, v7, v8
v_and_b32 v8, 0xffff0000, v228
v_lshlrev_b32 v7, 16, v228
v_ldexp_f32 v8, v8, v6
v_ldexp_f32 v7, v7, v6
v_cvt_pk_bf16_f32 v228, v7, v8
v_and_b32 v8, 0xffff0000, v229
v_lshlrev_b32 v7, 16, v229
v_ldexp_f32 v8, v8, v6
v_ldexp_f32 v7, v7, v6
v_cvt_pk_bf16_f32 v229, v7, v8
v_and_b32 v8, 0xffff0000, v230
v_lshlrev_b32 v7, 16, v230
v_ldexp_f32 v8, v8, v6
v_ldexp_f32 v7, v7, v6
v_cvt_pk_bf16_f32 v230, v7, v8
v_and_b32 v8, 0xffff0000, v231
v_lshlrev_b32 v7, 16, v231
v_ldexp_f32 v8, v8, v6
v_ldexp_f32 v7, v7, v6
v_cvt_pk_bf16_f32 v231, v7, v8
v_and_b32 v8, 0xffff0000, v232
v_lshlrev_b32 v7, 16, v232
v_ldexp_f32 v8, v8, v6
v_ldexp_f32 v7, v7, v6
v_cvt_pk_bf16_f32 v232, v7, v8
v_and_b32 v8, 0xffff0000, v233
v_lshlrev_b32 v7, 16, v233
v_ldexp_f32 v8, v8, v6
v_ldexp_f32 v7, v7, v6
v_cvt_pk_bf16_f32 v233, v7, v8
v_and_b32 v8, 0xffff0000, v234
v_lshlrev_b32 v7, 16, v234
v_ldexp_f32 v8, v8, v6
v_ldexp_f32 v7, v7, v6
v_cvt_pk_bf16_f32 v234, v7, v8
v_and_b32 v8, 0xffff0000, v235
v_lshlrev_b32 v7, 16, v235
v_ldexp_f32 v8, v8, v6
v_ldexp_f32 v7, v7, v6
v_cvt_pk_bf16_f32 v235, v7, v8
v_and_b32 v8, 0xffff0000, v236
v_lshlrev_b32 v7, 16, v236
v_ldexp_f32 v8, v8, v6
v_ldexp_f32 v7, v7, v6
v_cvt_pk_bf16_f32 v236, v7, v8
v_and_b32 v8, 0xffff0000, v237
v_lshlrev_b32 v7, 16, v237
v_ldexp_f32 v8, v8, v6
v_ldexp_f32 v7, v7, v6
v_cvt_pk_bf16_f32 v237, v7, v8
v_and_b32 v8, 0xffff0000, v238
v_lshlrev_b32 v7, 16, v238
v_ldexp_f32 v8, v8, v6
v_ldexp_f32 v7, v7, v6
v_cvt_pk_bf16_f32 v238, v7, v8
v_and_b32 v8, 0xffff0000, v239
v_lshlrev_b32 v7, 16, v239
v_ldexp_f32 v8, v8, v6
v_ldexp_f32 v7, v7, v6
v_cvt_pk_bf16_f32 v239, v7, v8
v_and_b32 v8, 0xffff0000, v240
v_lshlrev_b32 v7, 16, v240
v_ldexp_f32 v8, v8, v6
v_ldexp_f32 v7, v7, v6
v_cvt_pk_bf16_f32 v240, v7, v8
v_and_b32 v8, 0xffff0000, v241
v_lshlrev_b32 v7, 16, v241
v_ldexp_f32 v8, v8, v6
v_ldexp_f32 v7, v7, v6
v_cvt_pk_bf16_f32 v241, v7, v8
v_and_b32 v8, 0xffff0000, v242
v_lshlrev_b32 v7, 16, v242
v_ldexp_f32 v8, v8, v6
v_ldexp_f32 v7, v7, v6
v_cvt_pk_bf16_f32 v242, v7, v8
v_and_b32 v8, 0xffff0000, v243
v_lshlrev_b32 v7, 16, v243
v_ldexp_f32 v8, v8, v6
v_ldexp_f32 v7, v7, v6
v_cvt_pk_bf16_f32 v243, v7, v8
v_and_b32 v8, 0xffff0000, v244
v_lshlrev_b32 v7, 16, v244
v_ldexp_f32 v8, v8, v6
v_ldexp_f32 v7, v7, v6
v_cvt_pk_bf16_f32 v244, v7, v8
v_and_b32 v8, 0xffff0000, v245
v_lshlrev_b32 v7, 16, v245
v_ldexp_f32 v8, v8, v6
v_ldexp_f32 v7, v7, v6
v_cvt_pk_bf16_f32 v245, v7, v8
v_and_b32 v8, 0xffff0000, v246
v_lshlrev_b32 v7, 16, v246
v_ldexp_f32 v8, v8, v6
v_ldexp_f32 v7, v7, v6
v_cvt_pk_bf16_f32 v246, v7, v8
v_and_b32 v8, 0xffff0000, v247
v_lshlrev_b32 v7, 16, v247
v_ldexp_f32 v8, v8, v6
v_ldexp_f32 v7, v7, v6
v_cvt_pk_bf16_f32 v247, v7, v8
v_and_b32 v8, 0xffff0000, v248
v_lshlrev_b32 v7, 16, v248
v_ldexp_f32 v8, v8, v6
v_ldexp_f32 v7, v7, v6
v_cvt_pk_bf16_f32 v248, v7, v8
v_and_b32 v8, 0xffff0000, v249
v_lshlrev_b32 v7, 16, v249
v_ldexp_f32 v8, v8, v6
v_ldexp_f32 v7, v7, v6
v_cvt_pk_bf16_f32 v249, v7, v8
v_and_b32 v8, 0xffff0000, v250
v_lshlrev_b32 v7, 16, v250
v_ldexp_f32 v8, v8, v6
v_ldexp_f32 v7, v7, v6
v_cvt_pk_bf16_f32 v250, v7, v8
v_and_b32 v8, 0xffff0000, v251
v_lshlrev_b32 v7, 16, v251
v_ldexp_f32 v8, v8, v6
v_ldexp_f32 v7, v7, v6
v_cvt_pk_bf16_f32 v251, v7, v8
v_and_b32 v8, 0xffff0000, v252
v_lshlrev_b32 v7, 16, v252
v_ldexp_f32 v8, v8, v6
v_ldexp_f32 v7, v7, v6
v_cvt_pk_bf16_f32 v252, v7, v8
v_and_b32 v8, 0xffff0000, v253
v_lshlrev_b32 v7, 16, v253
v_ldexp_f32 v8, v8, v6
v_ldexp_f32 v7, v7, v6
v_cvt_pk_bf16_f32 v253, v7, v8
v_and_b32 v8, 0xffff0000, v254
v_lshlrev_b32 v7, 16, v254
v_ldexp_f32 v8, v8, v6
v_ldexp_f32 v7, v7, v6
v_cvt_pk_bf16_f32 v254, v7, v8
v_and_b32 v8, 0xffff0000, v255
v_lshlrev_b32 v7, 16, v255
v_ldexp_f32 v8, v8, v6
v_ldexp_f32 v7, v7, v6
v_cvt_pk_bf16_f32 v255, v7, v8
v_accvgpr_read_b32 v10, a180
v_and_b32 v8, 0xffff0000, v10
v_lshlrev_b32 v7, 16, v10
v_ldexp_f32 v8, v8, v6
v_ldexp_f32 v7, v7, v6
v_cvt_pk_bf16_f32 v10, v7, v8
v_accvgpr_write_b32 a180, v10
v_accvgpr_read_b32 v10, a181
v_and_b32 v8, 0xffff0000, v10
v_lshlrev_b32 v7, 16, v10
v_ldexp_f32 v8, v8, v6
v_ldexp_f32 v7, v7, v6
v_cvt_pk_bf16_f32 v10, v7, v8
v_accvgpr_write_b32 a181, v10
v_accvgpr_read_b32 v10, a182
v_and_b32 v8, 0xffff0000, v10
v_lshlrev_b32 v7, 16, v10
v_ldexp_f32 v8, v8, v6
v_ldexp_f32 v7, v7, v6
v_cvt_pk_bf16_f32 v10, v7, v8
v_accvgpr_write_b32 a182, v10
v_accvgpr_read_b32 v10, a183
v_and_b32 v8, 0xffff0000, v10
v_lshlrev_b32 v7, 16, v10
v_ldexp_f32 v8, v8, v6
v_ldexp_f32 v7, v7, v6
v_cvt_pk_bf16_f32 v10, v7, v8
v_accvgpr_write_b32 a183, v10
v_accvgpr_read_b32 v10, a184
v_and_b32 v8, 0xffff0000, v10
v_lshlrev_b32 v7, 16, v10
v_ldexp_f32 v8, v8, v6
v_ldexp_f32 v7, v7, v6
v_cvt_pk_bf16_f32 v10, v7, v8
v_accvgpr_write_b32 a184, v10
v_accvgpr_read_b32 v10, a185
v_and_b32 v8, 0xffff0000, v10
v_lshlrev_b32 v7, 16, v10
v_ldexp_f32 v8, v8, v6
v_ldexp_f32 v7, v7, v6
v_cvt_pk_bf16_f32 v10, v7, v8
v_accvgpr_write_b32 a185, v10
v_accvgpr_read_b32 v10, a186
v_and_b32 v8, 0xffff0000, v10
v_lshlrev_b32 v7, 16, v10
v_ldexp_f32 v8, v8, v6
v_ldexp_f32 v7, v7, v6
v_cvt_pk_bf16_f32 v10, v7, v8
v_accvgpr_write_b32 a186, v10
v_accvgpr_read_b32 v10, a187
v_and_b32 v8, 0xffff0000, v10
v_lshlrev_b32 v7, 16, v10
v_ldexp_f32 v8, v8, v6
v_ldexp_f32 v7, v7, v6
v_cvt_pk_bf16_f32 v10, v7, v8
v_accvgpr_write_b32 a187, v10
v_accvgpr_read_b32 v10, a188
v_and_b32 v8, 0xffff0000, v10
v_lshlrev_b32 v7, 16, v10
v_ldexp_f32 v8, v8, v6
v_ldexp_f32 v7, v7, v6
v_cvt_pk_bf16_f32 v10, v7, v8
v_accvgpr_write_b32 a188, v10
v_accvgpr_read_b32 v10, a189
v_and_b32 v8, 0xffff0000, v10
v_lshlrev_b32 v7, 16, v10
v_ldexp_f32 v8, v8, v6
v_ldexp_f32 v7, v7, v6
v_cvt_pk_bf16_f32 v10, v7, v8
v_accvgpr_write_b32 a189, v10
v_accvgpr_read_b32 v10, a190
v_and_b32 v8, 0xffff0000, v10
v_lshlrev_b32 v7, 16, v10
v_ldexp_f32 v8, v8, v6
v_ldexp_f32 v7, v7, v6
v_cvt_pk_bf16_f32 v10, v7, v8
v_accvgpr_write_b32 a190, v10
v_accvgpr_read_b32 v10, a191
v_and_b32 v8, 0xffff0000, v10
v_lshlrev_b32 v7, 16, v10
v_ldexp_f32 v8, v8, v6
v_ldexp_f32 v7, v7, v6
v_cvt_pk_bf16_f32 v10, v7, v8
v_accvgpr_write_b32 a191, v10
v_accvgpr_read_b32 v10, a192
v_and_b32 v8, 0xffff0000, v10
v_lshlrev_b32 v7, 16, v10
v_ldexp_f32 v8, v8, v6
v_ldexp_f32 v7, v7, v6
v_cvt_pk_bf16_f32 v10, v7, v8
v_accvgpr_write_b32 a192, v10
v_accvgpr_read_b32 v10, a193
v_and_b32 v8, 0xffff0000, v10
v_lshlrev_b32 v7, 16, v10
v_ldexp_f32 v8, v8, v6
v_ldexp_f32 v7, v7, v6
v_cvt_pk_bf16_f32 v10, v7, v8
v_accvgpr_write_b32 a193, v10
v_accvgpr_read_b32 v10, a194
v_and_b32 v8, 0xffff0000, v10
v_lshlrev_b32 v7, 16, v10
v_ldexp_f32 v8, v8, v6
v_ldexp_f32 v7, v7, v6
v_cvt_pk_bf16_f32 v10, v7, v8
v_accvgpr_write_b32 a194, v10
v_accvgpr_read_b32 v10, a195
v_and_b32 v8, 0xffff0000, v10
v_lshlrev_b32 v7, 16, v10
v_ldexp_f32 v8, v8, v6
v_ldexp_f32 v7, v7, v6
v_cvt_pk_bf16_f32 v10, v7, v8
v_accvgpr_write_b32 a195, v10
v_accvgpr_read_b32 v10, a196
v_and_b32 v8, 0xffff0000, v10
v_lshlrev_b32 v7, 16, v10
v_ldexp_f32 v8, v8, v6
v_ldexp_f32 v7, v7, v6
v_cvt_pk_bf16_f32 v10, v7, v8
v_accvgpr_write_b32 a196, v10
v_accvgpr_read_b32 v10, a197
v_and_b32 v8, 0xffff0000, v10
v_lshlrev_b32 v7, 16, v10
v_ldexp_f32 v8, v8, v6
v_ldexp_f32 v7, v7, v6
v_cvt_pk_bf16_f32 v10, v7, v8
v_accvgpr_write_b32 a197, v10
v_accvgpr_read_b32 v10, a198
v_and_b32 v8, 0xffff0000, v10
v_lshlrev_b32 v7, 16, v10
v_ldexp_f32 v8, v8, v6
v_ldexp_f32 v7, v7, v6
v_cvt_pk_bf16_f32 v10, v7, v8
v_accvgpr_write_b32 a198, v10
v_accvgpr_read_b32 v10, a199
v_and_b32 v8, 0xffff0000, v10
v_lshlrev_b32 v7, 16, v10
v_ldexp_f32 v8, v8, v6
v_ldexp_f32 v7, v7, v6
v_cvt_pk_bf16_f32 v10, v7, v8
v_accvgpr_write_b32 a199, v10
v_accvgpr_read_b32 v10, a200
v_and_b32 v8, 0xffff0000, v10
v_lshlrev_b32 v7, 16, v10
v_ldexp_f32 v8, v8, v6
v_ldexp_f32 v7, v7, v6
v_cvt_pk_bf16_f32 v10, v7, v8
v_accvgpr_write_b32 a200, v10
v_accvgpr_read_b32 v10, a201
v_and_b32 v8, 0xffff0000, v10
v_lshlrev_b32 v7, 16, v10
v_ldexp_f32 v8, v8, v6
v_ldexp_f32 v7, v7, v6
v_cvt_pk_bf16_f32 v10, v7, v8
v_accvgpr_write_b32 a201, v10
v_accvgpr_read_b32 v10, a202
v_and_b32 v8, 0xffff0000, v10
v_lshlrev_b32 v7, 16, v10
v_ldexp_f32 v8, v8, v6
v_ldexp_f32 v7, v7, v6
v_cvt_pk_bf16_f32 v10, v7, v8
v_accvgpr_write_b32 a202, v10
v_accvgpr_read_b32 v10, a203
v_and_b32 v8, 0xffff0000, v10
v_lshlrev_b32 v7, 16, v10
v_ldexp_f32 v8, v8, v6
v_ldexp_f32 v7, v7, v6
v_cvt_pk_bf16_f32 v10, v7, v8
v_accvgpr_write_b32 a203, v10
v_accvgpr_read_b32 v10, a204
v_and_b32 v8, 0xffff0000, v10
v_lshlrev_b32 v7, 16, v10
v_ldexp_f32 v8, v8, v6
v_ldexp_f32 v7, v7, v6
v_cvt_pk_bf16_f32 v10, v7, v8
v_accvgpr_write_b32 a204, v10
v_accvgpr_read_b32 v10, a205
v_and_b32 v8, 0xffff0000, v10
v_lshlrev_b32 v7, 16, v10
v_ldexp_f32 v8, v8, v6
v_ldexp_f32 v7, v7, v6
v_cvt_pk_bf16_f32 v10, v7, v8
v_accvgpr_write_b32 a205, v10
v_accvgpr_read_b32 v10, a206
v_and_b32 v8, 0xffff0000, v10
v_lshlrev_b32 v7, 16, v10
v_ldexp_f32 v8, v8, v6
v_ldexp_f32 v7, v7, v6
v_cvt_pk_bf16_f32 v10, v7, v8
v_accvgpr_write_b32 a206, v10
v_accvgpr_read_b32 v10, a207
v_and_b32 v8, 0xffff0000, v10
v_lshlrev_b32 v7, 16, v10
v_ldexp_f32 v8, v8, v6
v_ldexp_f32 v7, v7, v6
v_cvt_pk_bf16_f32 v10, v7, v8
v_accvgpr_write_b32 a207, v10
v_accvgpr_read_b32 v10, a208
v_and_b32 v8, 0xffff0000, v10
v_lshlrev_b32 v7, 16, v10
v_ldexp_f32 v8, v8, v6
v_ldexp_f32 v7, v7, v6
v_cvt_pk_bf16_f32 v10, v7, v8
v_accvgpr_write_b32 a208, v10
v_accvgpr_read_b32 v10, a209
v_and_b32 v8, 0xffff0000, v10
v_lshlrev_b32 v7, 16, v10
v_ldexp_f32 v8, v8, v6
v_ldexp_f32 v7, v7, v6
v_cvt_pk_bf16_f32 v10, v7, v8
v_accvgpr_write_b32 a209, v10
v_accvgpr_read_b32 v10, a210
v_and_b32 v8, 0xffff0000, v10
v_lshlrev_b32 v7, 16, v10
v_ldexp_f32 v8, v8, v6
v_ldexp_f32 v7, v7, v6
v_cvt_pk_bf16_f32 v10, v7, v8
v_accvgpr_write_b32 a210, v10
v_accvgpr_read_b32 v10, a211
v_and_b32 v8, 0xffff0000, v10
v_lshlrev_b32 v7, 16, v10
v_ldexp_f32 v8, v8, v6
v_ldexp_f32 v7, v7, v6
v_cvt_pk_bf16_f32 v10, v7, v8
v_accvgpr_write_b32 a211, v10
v_accvgpr_read_b32 v10, a212
v_and_b32 v8, 0xffff0000, v10
v_lshlrev_b32 v7, 16, v10
v_ldexp_f32 v8, v8, v6
v_ldexp_f32 v7, v7, v6
v_cvt_pk_bf16_f32 v10, v7, v8
v_accvgpr_write_b32 a212, v10
v_accvgpr_read_b32 v10, a213
v_and_b32 v8, 0xffff0000, v10
v_lshlrev_b32 v7, 16, v10
v_ldexp_f32 v8, v8, v6
v_ldexp_f32 v7, v7, v6
v_cvt_pk_bf16_f32 v10, v7, v8
v_accvgpr_write_b32 a213, v10
v_accvgpr_read_b32 v10, a214
v_and_b32 v8, 0xffff0000, v10
v_lshlrev_b32 v7, 16, v10
v_ldexp_f32 v8, v8, v6
v_ldexp_f32 v7, v7, v6
v_cvt_pk_bf16_f32 v10, v7, v8
v_accvgpr_write_b32 a214, v10
v_accvgpr_read_b32 v10, a215
v_and_b32 v8, 0xffff0000, v10
v_lshlrev_b32 v7, 16, v10
v_ldexp_f32 v8, v8, v6
v_ldexp_f32 v7, v7, v6
v_cvt_pk_bf16_f32 v10, v7, v8
v_accvgpr_write_b32 a215, v10
v_accvgpr_read_b32 v10, a216
v_and_b32 v8, 0xffff0000, v10
v_lshlrev_b32 v7, 16, v10
v_ldexp_f32 v8, v8, v6
v_ldexp_f32 v7, v7, v6
v_cvt_pk_bf16_f32 v10, v7, v8
v_accvgpr_write_b32 a216, v10
v_accvgpr_read_b32 v10, a217
v_and_b32 v8, 0xffff0000, v10
v_lshlrev_b32 v7, 16, v10
v_ldexp_f32 v8, v8, v6
v_ldexp_f32 v7, v7, v6
v_cvt_pk_bf16_f32 v10, v7, v8
v_accvgpr_write_b32 a217, v10
v_accvgpr_read_b32 v10, a218
v_and_b32 v8, 0xffff0000, v10
v_lshlrev_b32 v7, 16, v10
v_ldexp_f32 v8, v8, v6
v_ldexp_f32 v7, v7, v6
v_cvt_pk_bf16_f32 v10, v7, v8
v_accvgpr_write_b32 a218, v10
v_accvgpr_read_b32 v10, a219
v_and_b32 v8, 0xffff0000, v10
v_lshlrev_b32 v7, 16, v10
v_ldexp_f32 v8, v8, v6
v_ldexp_f32 v7, v7, v6
v_cvt_pk_bf16_f32 v10, v7, v8
v_accvgpr_write_b32 a219, v10
v_accvgpr_read_b32 v10, a220
v_and_b32 v8, 0xffff0000, v10
v_lshlrev_b32 v7, 16, v10
v_ldexp_f32 v8, v8, v6
v_ldexp_f32 v7, v7, v6
v_cvt_pk_bf16_f32 v10, v7, v8
v_accvgpr_write_b32 a220, v10
v_accvgpr_read_b32 v10, a221
v_and_b32 v8, 0xffff0000, v10
v_lshlrev_b32 v7, 16, v10
v_ldexp_f32 v8, v8, v6
v_ldexp_f32 v7, v7, v6
v_cvt_pk_bf16_f32 v10, v7, v8
v_accvgpr_write_b32 a221, v10
v_accvgpr_read_b32 v10, a222
v_and_b32 v8, 0xffff0000, v10
v_lshlrev_b32 v7, 16, v10
v_ldexp_f32 v8, v8, v6
v_ldexp_f32 v7, v7, v6
v_cvt_pk_bf16_f32 v10, v7, v8
v_accvgpr_write_b32 a222, v10
v_accvgpr_read_b32 v10, a223
v_and_b32 v8, 0xffff0000, v10
v_lshlrev_b32 v7, 16, v10
v_ldexp_f32 v8, v8, v6
v_ldexp_f32 v7, v7, v6
v_cvt_pk_bf16_f32 v10, v7, v8
v_accvgpr_write_b32 a223, v10
s_nop 3
s_setpc_b64 s[40:41]
L_rareN0:
s_nop 15
v_max3_f32 v6, v28, v29, v30
v_max_f32 v6, v6, v31
v_mov_b32 v7, v6
s_nop 1
v_permlane32_swap_b32 v6, v7
v_max_f32 v6, v6, v7
v_mov_b32 v7, v6
s_nop 1
v_permlane16_swap_b32 v6, v7
v_max_f32 v6, v6, v7
v_max_f32 v6, 0, v6
v_ceil_f32 v6, v6
v_sub_f32 v28, v28, v6
v_sub_f32 v40, v40, v6
v_sub_f32 v29, v29, v6
v_sub_f32 v41, v41, v6
v_sub_f32 v30, v30, v6
v_sub_f32 v42, v42, v6
v_sub_f32 v31, v31, v6
v_sub_f32 v43, v43, v6
v_sub_f32 v6, 0, v6
v_cvt_i32_f32 v6, v6
L_rescN:
v_accvgpr_read_b32 v7, a172
v_ldexp_f32 v7, v7, v6
v_accvgpr_write_b32 a172, v7
v_accvgpr_read_b32 v7, a173
v_ldexp_f32 v7, v7, v6
v_accvgpr_write_b32 a173, v7
v_accvgpr_read_b32 v7, a174
v_ldexp_f32 v7, v7, v6
v_accvgpr_write_b32 a174, v7
v_accvgpr_read_b32 v7, a175
v_ldexp_f32 v7, v7, v6
v_accvgpr_write_b32 a175, v7
v_accvgpr_read_b32 v10, a224
v_and_b32 v8, 0xffff0000, v10
v_lshlrev_b32 v7, 16, v10
v_ldexp_f32 v8, v8, v6
v_ldexp_f32 v7, v7, v6
v_cvt_pk_bf16_f32 v10, v7, v8
v_accvgpr_write_b32 a224, v10
v_accvgpr_read_b32 v10, a225
v_and_b32 v8, 0xffff0000, v10
v_lshlrev_b32 v7, 16, v10
v_ldexp_f32 v8, v8, v6
v_ldexp_f32 v7, v7, v6
v_cvt_pk_bf16_f32 v10, v7, v8
v_accvgpr_write_b32 a225, v10
v_accvgpr_read_b32 v10, a226
v_and_b32 v8, 0xffff0000, v10
v_lshlrev_b32 v7, 16, v10
v_ldexp_f32 v8, v8, v6
v_ldexp_f32 v7, v7, v6
v_cvt_pk_bf16_f32 v10, v7, v8
v_accvgpr_write_b32 a226, v10
v_accvgpr_read_b32 v10, a227
v_and_b32 v8, 0xffff0000, v10
v_lshlrev_b32 v7, 16, v10
v_ldexp_f32 v8, v8, v6
v_ldexp_f32 v7, v7, v6
v_cvt_pk_bf16_f32 v10, v7, v8
v_accvgpr_write_b32 a227, v10
v_accvgpr_read_b32 v10, a228
v_and_b32 v8, 0xffff0000, v10
v_lshlrev_b32 v7, 16, v10
v_ldexp_f32 v8, v8, v6
v_ldexp_f32 v7, v7, v6
v_cvt_pk_bf16_f32 v10, v7, v8
v_accvgpr_write_b32 a228, v10
v_accvgpr_read_b32 v10, a229
v_and_b32 v8, 0xffff0000, v10
v_lshlrev_b32 v7, 16, v10
v_ldexp_f32 v8, v8, v6
v_ldexp_f32 v7, v7, v6
v_cvt_pk_bf16_f32 v10, v7, v8
v_accvgpr_write_b32 a229, v10
v_accvgpr_read_b32 v10, a230
v_and_b32 v8, 0xffff0000, v10
v_lshlrev_b32 v7, 16, v10
v_ldexp_f32 v8, v8, v6
v_ldexp_f32 v7, v7, v6
v_cvt_pk_bf16_f32 v10, v7, v8
v_accvgpr_write_b32 a230, v10
v_accvgpr_read_b32 v10, a231
v_and_b32 v8, 0xffff0000, v10
v_lshlrev_b32 v7, 16, v10
v_ldexp_f32 v8, v8, v6
v_ldexp_f32 v7, v7, v6
v_cvt_pk_bf16_f32 v10, v7, v8
v_accvgpr_write_b32 a231, v10
v_accvgpr_read_b32 v10, a232
v_and_b32 v8, 0xffff0000, v10
v_lshlrev_b32 v7, 16, v10
v_ldexp_f32 v8, v8, v6
v_ldexp_f32 v7, v7, v6
v_cvt_pk_bf16_f32 v10, v7, v8
v_accvgpr_write_b32 a232, v10
v_accvgpr_read_b32 v10, a233
v_and_b32 v8, 0xffff0000, v10
v_lshlrev_b32 v7, 16, v10
v_ldexp_f32 v8, v8, v6
v_ldexp_f32 v7, v7, v6
v_cvt_pk_bf16_f32 v10, v7, v8
v_accvgpr_write_b32 a233, v10
v_accvgpr_read_b32 v10, a234
v_and_b32 v8, 0xffff0000, v10
v_lshlrev_b32 v7, 16, v10
v_ldexp_f32 v8, v8, v6
v_ldexp_f32 v7, v7, v6
v_cvt_pk_bf16_f32 v10, v7, v8
v_accvgpr_write_b32 a234, v10
v_accvgpr_read_b32 v10, a235
v_and_b32 v8, 0xffff0000, v10
v_lshlrev_b32 v7, 16, v10
v_ldexp_f32 v8, v8, v6
v_ldexp_f32 v7, v7, v6
v_cvt_pk_bf16_f32 v10, v7, v8
v_accvgpr_write_b32 a235, v10
v_accvgpr_read_b32 v10, a236
v_and_b32 v8, 0xffff0000, v10
v_lshlrev_b32 v7, 16, v10
v_ldexp_f32 v8, v8, v6
v_ldexp_f32 v7, v7, v6
v_cvt_pk_bf16_f32 v10, v7, v8
v_accvgpr_write_b32 a236, v10
v_accvgpr_read_b32 v10, a237
v_and_b32 v8, 0xffff0000, v10
v_lshlrev_b32 v7, 16, v10
v_ldexp_f32 v8, v8, v6
v_ldexp_f32 v7, v7, v6
v_cvt_pk_bf16_f32 v10, v7, v8
v_accvgpr_write_b32 a237, v10
v_accvgpr_read_b32 v10, a238
v_and_b32 v8, 0xffff0000, v10
v_lshlrev_b32 v7, 16, v10
v_ldexp_f32 v8, v8, v6
v_ldexp_f32 v7, v7, v6
v_cvt_pk_bf16_f32 v10, v7, v8
v_accvgpr_write_b32 a238, v10
v_accvgpr_read_b32 v10, a239
v_and_b32 v8, 0xffff0000, v10
v_lshlrev_b32 v7, 16, v10
v_ldexp_f32 v8, v8, v6
v_ldexp_f32 v7, v7, v6
v_cvt_pk_bf16_f32 v10, v7, v8
v_accvgpr_write_b32 a239, v10
v_accvgpr_read_b32 v10, a240
v_and_b32 v8, 0xffff0000, v10
v_lshlrev_b32 v7, 16, v10
v_ldexp_f32 v8, v8, v6
v_ldexp_f32 v7, v7, v6
v_cvt_pk_bf16_f32 v10, v7, v8
v_accvgpr_write_b32 a240, v10
v_accvgpr_read_b32 v10, a241
v_and_b32 v8, 0xffff0000, v10
v_lshlrev_b32 v7, 16, v10
v_ldexp_f32 v8, v8, v6
v_ldexp_f32 v7, v7, v6
v_cvt_pk_bf16_f32 v10, v7, v8
v_accvgpr_write_b32 a241, v10
v_accvgpr_read_b32 v10, a242
v_and_b32 v8, 0xffff0000, v10
v_lshlrev_b32 v7, 16, v10
v_ldexp_f32 v8, v8, v6
v_ldexp_f32 v7, v7, v6
v_cvt_pk_bf16_f32 v10, v7, v8
v_accvgpr_write_b32 a242, v10
v_accvgpr_read_b32 v10, a243
v_and_b32 v8, 0xffff0000, v10
v_lshlrev_b32 v7, 16, v10
v_ldexp_f32 v8, v8, v6
v_ldexp_f32 v7, v7, v6
v_cvt_pk_bf16_f32 v10, v7, v8
v_accvgpr_write_b32 a243, v10
v_accvgpr_read_b32 v10, a244
v_and_b32 v8, 0xffff0000, v10
v_lshlrev_b32 v7, 16, v10
v_ldexp_f32 v8, v8, v6
v_ldexp_f32 v7, v7, v6
v_cvt_pk_bf16_f32 v10, v7, v8
v_accvgpr_write_b32 a244, v10
v_accvgpr_read_b32 v10, a245
v_and_b32 v8, 0xffff0000, v10
v_lshlrev_b32 v7, 16, v10
v_ldexp_f32 v8, v8, v6
v_ldexp_f32 v7, v7, v6
v_cvt_pk_bf16_f32 v10, v7, v8
v_accvgpr_write_b32 a245, v10
v_accvgpr_read_b32 v10, a246
v_and_b32 v8, 0xffff0000, v10
v_lshlrev_b32 v7, 16, v10
v_ldexp_f32 v8, v8, v6
v_ldexp_f32 v7, v7, v6
v_cvt_pk_bf16_f32 v10, v7, v8
v_accvgpr_write_b32 a246, v10
v_accvgpr_read_b32 v10, a247
v_and_b32 v8, 0xffff0000, v10
v_lshlrev_b32 v7, 16, v10
v_ldexp_f32 v8, v8, v6
v_ldexp_f32 v7, v7, v6
v_cvt_pk_bf16_f32 v10, v7, v8
v_accvgpr_write_b32 a247, v10
v_accvgpr_read_b32 v10, a248
v_and_b32 v8, 0xffff0000, v10
v_lshlrev_b32 v7, 16, v10
v_ldexp_f32 v8, v8, v6
v_ldexp_f32 v7, v7, v6
v_cvt_pk_bf16_f32 v10, v7, v8
v_accvgpr_write_b32 a248, v10
v_accvgpr_read_b32 v10, a249
v_and_b32 v8, 0xffff0000, v10
v_lshlrev_b32 v7, 16, v10
v_ldexp_f32 v8, v8, v6
v_ldexp_f32 v7, v7, v6
v_cvt_pk_bf16_f32 v10, v7, v8
v_accvgpr_write_b32 a249, v10
v_accvgpr_read_b32 v10, a250
v_and_b32 v8, 0xffff0000, v10
v_lshlrev_b32 v7, 16, v10
v_ldexp_f32 v8, v8, v6
v_ldexp_f32 v7, v7, v6
v_cvt_pk_bf16_f32 v10, v7, v8
v_accvgpr_write_b32 a250, v10
v_accvgpr_read_b32 v10, a251
v_and_b32 v8, 0xffff0000, v10
v_lshlrev_b32 v7, 16, v10
v_ldexp_f32 v8, v8, v6
v_ldexp_f32 v7, v7, v6
v_cvt_pk_bf16_f32 v10, v7, v8
v_accvgpr_write_b32 a251, v10
v_accvgpr_read_b32 v10, a252
v_and_b32 v8, 0xffff0000, v10
v_lshlrev_b32 v7, 16, v10
v_ldexp_f32 v8, v8, v6
v_ldexp_f32 v7, v7, v6
v_cvt_pk_bf16_f32 v10, v7, v8
v_accvgpr_write_b32 a252, v10
v_accvgpr_read_b32 v10, a253
v_and_b32 v8, 0xffff0000, v10
v_lshlrev_b32 v7, 16, v10
v_ldexp_f32 v8, v8, v6
v_ldexp_f32 v7, v7, v6
v_cvt_pk_bf16_f32 v10, v7, v8
v_accvgpr_write_b32 a253, v10
v_accvgpr_read_b32 v10, a254
v_and_b32 v8, 0xffff0000, v10
v_lshlrev_b32 v7, 16, v10
v_ldexp_f32 v8, v8, v6
v_ldexp_f32 v7, v7, v6
v_cvt_pk_bf16_f32 v10, v7, v8
v_accvgpr_write_b32 a254, v10
v_accvgpr_read_b32 v10, a255
v_and_b32 v8, 0xffff0000, v10
v_lshlrev_b32 v7, 16, v10
v_ldexp_f32 v8, v8, v6
v_ldexp_f32 v7, v7, v6
v_cvt_pk_bf16_f32 v10, v7, v8
v_accvgpr_write_b32 a255, v10
s_nop 3
s_setpc_b64 s[40:41]
L_code_end:
s_endpgm
.section .rodata,"a"
.p2align 6
.amdhsa_kernel concat_heads__mha_block_cached__mha_block_cached__near_ridge_kernel
  .amdhsa_next_free_vgpr 512
  .amdhsa_next_free_sgpr 102
  .amdhsa_accum_offset 256
  .amdhsa_group_segment_fixed_size 0
  .amdhsa_kernarg_size 104
  .amdhsa_user_sgpr_count 2
  .amdhsa_user_sgpr_kernarg_segment_ptr 1
  .amdhsa_system_sgpr_workgroup_id_x 1
  .amdhsa_float_denorm_mode_32 3
.end_amdhsa_kernel
```
